```python
import torch

def _softmax(x, axis=-1):
    return torch.softmax(x, dim=axis)

def _gelu(x):
    return torch.nn.functional.gelu(x, approximate='tanh')

def _silu(x):
    return torch.nn.functional.silu(x)

def _sigmoid(x):
    return torch.sigmoid(x)

def _layernorm(x, axis=-1, eps=1e-05):
    m = x.mean(dim=axis, keepdim=True)
    v = x.var(dim=axis, keepdim=True, unbiased=False)
    return (x - m) / torch.sqrt(v + eps)

def _scatter_add(tgt, idx, src, axis=0):
    return tgt.clone().index_add_(axis, idx, src)

def _segment_sum(src, seg, n):
    out = torch.zeros((n,) + src.shape[1:], dtype=src.dtype)
    return out.index_add_(0, seg, src)

def _pad(x, pw):
    flat = tuple((v for pair in reversed(pw) for v in pair))
    return torch.nn.functional.pad(x, flat)
kernel_name = 'parallel_sum__memory_aug_recurrent_mem_tr__dense_activation_relu__prompt'

def setup_inputs():

    _w = lambda a: (lambda t: t.to(torch.bfloat16) if t.is_floating_point() else t)(torch.as_tensor(a))

    def _A_setup():
        B, S, Dm = (1, 2048, 1024)
        H, Dh = (32, 128)
        M, seg = (8, 32)
        seg = min(seg, S)
        S = S // seg * seg
        return {'x': _w((lambda *s: torch.randn(*s, dtype=torch.bfloat16) * 0.05)(B, S, Dm)), 'mem0': _w((lambda *s: torch.randn(*s, dtype=torch.bfloat16) * 1.6)(B, M, Dm)), 'Wq': _w((lambda *s: torch.randn(*s, dtype=torch.bfloat16) * 0.8)(Dm, H, Dh) * Dm ** (-0.5)), 'Wk': _w((lambda *s: torch.randn(*s, dtype=torch.bfloat16) * 0.8)(Dm, H, Dh) * Dm ** (-0.5)), 'Wv': _w((lambda *s: torch.randn(*s, dtype=torch.bfloat16) * 1.6)(Dm, H, Dh) * Dm ** (-0.5)), 'Wo': _w((lambda *s: torch.randn(*s, dtype=torch.bfloat16) * 1.6)(H, Dh, Dm) * (H * Dh) ** (-0.5)), 'seg_len': seg}
    _A_in = _A_setup()

    def _B_setup():
        B, S, D, Dff = (1, 2048, 1024, 3584)
        return {'x': _w((lambda *s: torch.randn(*s, dtype=torch.bfloat16) * 0.05)(B, S, D)), 'w1': _w((lambda *s: torch.randn(*s, dtype=torch.bfloat16) * 0.05)(D, Dff)), 'w2': _w((lambda *s: torch.randn(*s, dtype=torch.bfloat16) * 0.05)(Dff, D))}
    _B_in = _B_setup()
    return {'A_x': _A_in['x'], 'A_mem0': _A_in['mem0'], 'A_Wq': _A_in['Wq'], 'A_Wk': _A_in['Wk'], 'A_Wv': _A_in['Wv'], 'A_Wo': _A_in['Wo'], 'A_seg_len': _A_in['seg_len'], 'B_x': _B_in['x'], 'B_w1': _B_in['w1'], 'B_w2': _B_in['w2']}

def reference(A_x, A_mem0, A_Wq, A_Wk, A_Wv, A_Wo, A_seg_len, B_x, B_w1, B_w2):

    def _A_ref(x, mem0, Wq, Wk, Wv, Wo, seg_len):
        B, S, Dm = x.shape
        H, Dh = (Wq.shape[1], Wq.shape[2])
        M = mem0.shape[1]
        scale = Dh ** (-0.5)
        n_seg = S // seg_len
        L = M + seg_len
        idx = torch.arange(L)
        mask = (idx[:, None] < M) | (idx[:, None] >= idx[None, :])
        mem = mem0
        outs = []
        for s in range(n_seg):
            xs = x[:, s * seg_len:(s + 1) * seg_len, :].clone()
            h = torch.concatenate([mem, xs], axis=1)
            q = torch.einsum('btd,dhe->bhte', h, Wq)
            k = torch.einsum('btd,dhe->bhte', h, Wk)
            v = torch.einsum('btd,dhe->bhte', h, Wv)
            scores = torch.einsum('bhqe,bhke->bhqk', q, k) * scale
            scores = torch.where(mask[None, None], scores, -1000000000.0)
            p = _softmax(scores, axis=-1)
            o = torch.einsum('bhqk,bhke->bhqe', p, v)
            o = torch.einsum('bhte,hed->btd', o, Wo)
            mem = o[:, :M, :].clone()
            outs.append(o[:, M:, :])
        return torch.concatenate(outs, axis=1)

    def _B_ref(x, w1, w2):
        h = torch.einsum('bsd,df->bsf', x, w1)
        zero = torch.zeros_like(h)
        h = torch.maximum(h, zero)
        return torch.einsum('bsf,fd->bsd', h, w2)
    x = A_x
    xn = _layernorm(x, axis=-1)
    return x + _A_ref(xn, A_mem0, A_Wq, A_Wk, A_Wv, A_Wo, A_seg_len) + _B_ref(xn, B_w1, B_w2)
```

```asm
; @launch grid=(256,1,1) block=(256,1,1) lds=131072
.amdgcn_target "amdgcn-amd-amdhsa--gfx950"
.text
.globl parallel_sum__memory_aug_recurrent_mem_tr__dense_activation_relu__prompt_kernel
.p2align 8
.type parallel_sum__memory_aug_recurrent_mem_tr__dense_activation_relu__prompt_kernel,@function
parallel_sum__memory_aug_recurrent_mem_tr__dense_activation_relu__prompt_kernel:
  s_cmp_ge_u32 s2, 256
  s_cbranch_scc1 mk_end
  s_load_dwordx2 s[8:9], s[0:1], 96
  s_load_dwordx2 s[16:17], s[0:1], 88
  s_mov_b32 s10, 268435456
  s_mov_b32 s11, 0x20000
  s_mov_b32 s96, s2
  s_mov_b32 s97, 0
  s_mov_b32 s18, 256
  s_mov_b32 s19, 0x20000
  s_getreg_b32 s2, hwreg(HW_REG_XCC_ID)
  s_and_b32 s2, s2, 7
  s_lshr_b32 s3, s96, 3
  s_mov_b32 s4, 0
  v_readfirstlane_b32 s20, v0
  s_or_b32 s21, s3, s2
  s_xor_b32 s20, s20, 192
  s_or_b32 s20, s20, s21
  s_cmp_lg_u32 s20, 0
  s_cbranch_scc1 mk_np
  s_mov_b32 s24, -1
  s_mov_b32 s25, -1
  v_mov_b32 v204, -1
  v_mov_b32 v208, 0x1f0000
  s_waitcnt lgkmcnt(0)
  buffer_store_dword v204, v208, s[8:11], 0 offen sc1
  s_waitcnt vmcnt(0)
  v_mov_b32 v208, 1048576
  s_memtime s[26:27]
  s_waitcnt lgkmcnt(0)
  buffer_store_dword v204, v208, s[8:11], 0 offen sc1
  s_waitcnt vmcnt(0)
  s_memtime s[28:29]
  s_waitcnt lgkmcnt(0)
  s_sub_u32 s28, s28, s26
  s_min_u32 s24, s24, s28
  v_mov_b32 v208, 1056768
  s_memtime s[26:27]
  s_waitcnt lgkmcnt(0)
  buffer_store_dword v204, v208, s[8:11], 0 offen sc1
  s_waitcnt vmcnt(0)
  s_memtime s[28:29]
  s_waitcnt lgkmcnt(0)
  s_sub_u32 s28, s28, s26
  s_min_u32 s25, s25, s28
  v_mov_b32 v208, 1065216
  s_memtime s[26:27]
  s_waitcnt lgkmcnt(0)
  buffer_store_dword v204, v208, s[8:11], 0 offen sc1
  s_waitcnt vmcnt(0)
  s_memtime s[28:29]
  s_waitcnt lgkmcnt(0)
  s_sub_u32 s28, s28, s26
  s_min_u32 s24, s24, s28
  v_mov_b32 v208, 1073408
  s_memtime s[26:27]
  s_waitcnt lgkmcnt(0)
  buffer_store_dword v204, v208, s[8:11], 0 offen sc1
  s_waitcnt vmcnt(0)
  s_memtime s[28:29]
  s_waitcnt lgkmcnt(0)
  s_sub_u32 s28, s28, s26
  s_min_u32 s25, s25, s28
  v_mov_b32 v208, 1081856
  s_memtime s[26:27]
  s_waitcnt lgkmcnt(0)
  buffer_store_dword v204, v208, s[8:11], 0 offen sc1
  s_waitcnt vmcnt(0)
  s_memtime s[28:29]
  s_waitcnt lgkmcnt(0)
  s_sub_u32 s28, s28, s26
  s_min_u32 s24, s24, s28
  v_mov_b32 v208, 1090048
  s_memtime s[26:27]
  s_waitcnt lgkmcnt(0)
  buffer_store_dword v204, v208, s[8:11], 0 offen sc1
  s_waitcnt vmcnt(0)
  s_memtime s[28:29]
  s_waitcnt lgkmcnt(0)
  s_sub_u32 s28, s28, s26
  s_min_u32 s25, s25, s28
  v_mov_b32 v208, 1098496
  s_memtime s[26:27]
  s_waitcnt lgkmcnt(0)
  buffer_store_dword v204, v208, s[8:11], 0 offen sc1
  s_waitcnt vmcnt(0)
  s_memtime s[28:29]
  s_waitcnt lgkmcnt(0)
  s_sub_u32 s28, s28, s26
  s_min_u32 s24, s24, s28
  v_mov_b32 v208, 1106688
  s_memtime s[26:27]
  s_waitcnt lgkmcnt(0)
  buffer_store_dword v204, v208, s[8:11], 0 offen sc1
  s_waitcnt vmcnt(0)
  s_memtime s[28:29]
  s_waitcnt lgkmcnt(0)
  s_sub_u32 s28, s28, s26
  s_min_u32 s25, s25, s28
  v_mov_b32 v208, 1115136
  s_memtime s[26:27]
  s_waitcnt lgkmcnt(0)
  buffer_store_dword v204, v208, s[8:11], 0 offen sc1
  s_waitcnt vmcnt(0)
  s_memtime s[28:29]
  s_waitcnt lgkmcnt(0)
  s_sub_u32 s28, s28, s26
  s_min_u32 s24, s24, s28
  v_mov_b32 v208, 1123328
  s_memtime s[26:27]
  s_waitcnt lgkmcnt(0)
  buffer_store_dword v204, v208, s[8:11], 0 offen sc1
  s_waitcnt vmcnt(0)
  s_memtime s[28:29]
  s_waitcnt lgkmcnt(0)
  s_sub_u32 s28, s28, s26
  s_min_u32 s25, s25, s28
  v_mov_b32 v208, 1131776
  s_memtime s[26:27]
  s_waitcnt lgkmcnt(0)
  buffer_store_dword v204, v208, s[8:11], 0 offen sc1
  s_waitcnt vmcnt(0)
  s_memtime s[28:29]
  s_waitcnt lgkmcnt(0)
  s_sub_u32 s28, s28, s26
  s_min_u32 s24, s24, s28
  v_mov_b32 v208, 1139968
  s_memtime s[26:27]
  s_waitcnt lgkmcnt(0)
  buffer_store_dword v204, v208, s[8:11], 0 offen sc1
  s_waitcnt vmcnt(0)
  s_memtime s[28:29]
  s_waitcnt lgkmcnt(0)
  s_sub_u32 s28, s28, s26
  s_min_u32 s25, s25, s28
  s_cmp_lt_u32 s25, s24
  s_cselect_b32 s4, 48, 32
mk_np:
  s_bitcmp1_b32 s96, 2
  s_cbranch_scc0 mk_nq
  s_and_b32 s6, s96, 3
  s_lshl_b32 s7, s3, 2
  s_or_b32 s6, s6, s7
  s_load_dwordx2 s[12:13], s[0:1], 0
  s_mov_b32 s14, 4194304
  s_mov_b32 s15, 0x20000
  v_and_b32 v161, 63, v0
  v_lshrrev_b32 v162, 6, v0
  s_mul_i32 s20, s6, 16
  v_add_u32 v162, s20, v162
  v_lshlrev_b32 v163, 11, v162
  v_lshl_add_u32 v163, v161, 4, v163
  v_lshrrev_b32 v164, 2, v161
  v_lshlrev_b32 v164, 17, v164
  v_and_b32 v165, 3, v161
  v_lshl_add_u32 v164, v165, 4, v164
  v_lshl_add_u32 v164, v162, 6, v164
  v_add_u32 v164, 8388608, v164
  s_waitcnt lgkmcnt(0)
  s_mov_b32 s20, 0
  buffer_load_dwordx4 v[212:215], v163, s[12:15], s20 offen
  buffer_load_dwordx4 v[216:219], v163, s[12:15], s20 offen offset:1024
  s_mov_b32 s20, 8192
  buffer_load_dwordx4 v[220:223], v163, s[12:15], s20 offen
  buffer_load_dwordx4 v[224:227], v163, s[12:15], s20 offen offset:1024
  s_mov_b32 s20, 16384
  buffer_load_dwordx4 v[228:231], v163, s[12:15], s20 offen
  buffer_load_dwordx4 v[232:235], v163, s[12:15], s20 offen offset:1024
  s_mov_b32 s20, 24576
  buffer_load_dwordx4 v[236:239], v163, s[12:15], s20 offen
  buffer_load_dwordx4 v[240:243], v163, s[12:15], s20 offen offset:1024
  v_mov_b32 v204, -1
  v_mov_b32 v205, -1
  v_mov_b32 v206, -1
  v_mov_b32 v207, -1
  s_mul_i32 s21, s96, 3072
  s_add_u32 s21, s21, 0
  v_lshlrev_b32 v203, 4, v0
  v_cmp_gt_u32 vcc, 192, v0
  v_mov_b32 v208, 2147483648
  s_nop 0
  v_cndmask_b32 v203, v208, v203, vcc
  buffer_store_dwordx4 v[204:207], v203, s[8:11], s21 offen sc1
  s_add_u32 s21, s21, 4096
  s_mul_i32 s21, s96, 10112
  s_add_u32 s21, s21, 3145728
  v_lshlrev_b32 v203, 4, v0
  buffer_store_dwordx4 v[204:207], v203, s[8:11], s21 offen sc1
  s_add_u32 s21, s21, 4096
  buffer_store_dwordx4 v[204:207], v203, s[8:11], s21 offen sc1
  s_add_u32 s21, s21, 4096
  v_cmp_gt_u32 vcc, 120, v0
  v_mov_b32 v208, 2147483648
  s_nop 0
  v_cndmask_b32 v203, v208, v203, vcc
  buffer_store_dwordx4 v[204:207], v203, s[8:11], s21 offen sc1
  s_add_u32 s21, s21, 4096
  s_mov_b32 s23, 0x3a800000
  s_mov_b32 s24, 0x3727c5ac
  s_mov_b32 s25, 0xffff0000
  s_mov_b32 s22, 2097152
  s_waitcnt vmcnt(10)
  v_lshlrev_b32 v184, 16, v212
  v_and_b32 v185, s25, v212
  v_lshlrev_b32 v186, 16, v213
  v_and_b32 v187, s25, v213
  v_lshlrev_b32 v188, 16, v214
  v_and_b32 v189, s25, v214
  v_lshlrev_b32 v190, 16, v215
  v_and_b32 v191, s25, v215
  v_lshlrev_b32 v192, 16, v216
  v_and_b32 v193, s25, v216
  v_lshlrev_b32 v194, 16, v217
  v_and_b32 v195, s25, v217
  v_lshlrev_b32 v196, 16, v218
  v_and_b32 v197, s25, v218
  v_lshlrev_b32 v198, 16, v219
  v_and_b32 v199, s25, v219
  v_add_f32 v166, v184, v185
  v_add_f32 v166, v166, v186
  v_add_f32 v166, v166, v187
  v_add_f32 v166, v166, v188
  v_add_f32 v166, v166, v189
  v_add_f32 v166, v166, v190
  v_add_f32 v166, v166, v191
  v_add_f32 v166, v166, v192
  v_add_f32 v166, v166, v193
  v_add_f32 v166, v166, v194
  v_add_f32 v166, v166, v195
  v_add_f32 v166, v166, v196
  v_add_f32 v166, v166, v197
  v_add_f32 v166, v166, v198
  v_add_f32 v166, v166, v199
  s_nop 1
  v_add_f32_dpp v166, v166, v166 row_ror:8 row_mask:0xf bank_mask:0xf
  s_nop 1
  v_add_f32_dpp v166, v166, v166 row_ror:4 row_mask:0xf bank_mask:0xf
  s_nop 1
  v_add_f32_dpp v166, v166, v166 row_ror:2 row_mask:0xf bank_mask:0xf
  s_nop 1
  v_add_f32_dpp v166, v166, v166 row_ror:1 row_mask:0xf bank_mask:0xf
  v_mov_b32 v167, v166
  s_nop 1
  v_permlane16_swap_b32 v166, v167
  v_add_f32 v166, v166, v167
  v_mov_b32 v167, v166
  s_nop 1
  v_permlane32_swap_b32 v166, v167
  v_add_f32 v166, v166, v167
  v_mul_f32 v166, s23, v166
  v_sub_f32 v200, v184, v166
  v_mul_f32 v165, v200, v200
  v_sub_f32 v200, v185, v166
  v_fmac_f32 v165, v200, v200
  v_sub_f32 v200, v186, v166
  v_fmac_f32 v165, v200, v200
  v_sub_f32 v200, v187, v166
  v_fmac_f32 v165, v200, v200
  v_sub_f32 v200, v188, v166
  v_fmac_f32 v165, v200, v200
  v_sub_f32 v200, v189, v166
  v_fmac_f32 v165, v200, v200
  v_sub_f32 v200, v190, v166
  v_fmac_f32 v165, v200, v200
  v_sub_f32 v200, v191, v166
  v_fmac_f32 v165, v200, v200
  v_sub_f32 v200, v192, v166
  v_fmac_f32 v165, v200, v200
  v_sub_f32 v200, v193, v166
  v_fmac_f32 v165, v200, v200
  v_sub_f32 v200, v194, v166
  v_fmac_f32 v165, v200, v200
  v_sub_f32 v200, v195, v166
  v_fmac_f32 v165, v200, v200
  v_sub_f32 v200, v196, v166
  v_fmac_f32 v165, v200, v200
  v_sub_f32 v200, v197, v166
  v_fmac_f32 v165, v200, v200
  v_sub_f32 v200, v198, v166
  v_fmac_f32 v165, v200, v200
  v_sub_f32 v200, v199, v166
  v_fmac_f32 v165, v200, v200
  s_nop 1
  v_add_f32_dpp v165, v165, v165 row_ror:8 row_mask:0xf bank_mask:0xf
  s_nop 1
  v_add_f32_dpp v165, v165, v165 row_ror:4 row_mask:0xf bank_mask:0xf
  s_nop 1
  v_add_f32_dpp v165, v165, v165 row_ror:2 row_mask:0xf bank_mask:0xf
  s_nop 1
  v_add_f32_dpp v165, v165, v165 row_ror:1 row_mask:0xf bank_mask:0xf
  v_mov_b32 v167, v165
  s_nop 1
  v_permlane16_swap_b32 v165, v167
  v_add_f32 v165, v165, v167
  v_mov_b32 v167, v165
  s_nop 1
  v_permlane32_swap_b32 v165, v167
  v_add_f32 v165, v165, v167
  v_mul_f32 v165, s23, v165
  v_cvt_pk_bf16_f32 v166, v166, v165
  v_and_b32 v165, s25, v166
  v_lshlrev_b32 v166, 16, v166
  v_add_f32 v165, s24, v165
  v_cvt_pk_bf16_f32 v165, v165, v165
  v_lshlrev_b32 v165, 16, v165
  v_sqrt_f32 v165, v165
  s_nop 0
  v_cvt_pk_bf16_f32 v165, v165, v165
  v_lshlrev_b32 v165, 16, v165
  v_rcp_f32 v167, v165
  v_sub_f32 v184, v184, v166
  v_sub_f32 v185, v185, v166
  v_cvt_pk_bf16_f32 v200, v184, v185
  v_lshlrev_b32 v184, 16, v200
  v_and_b32 v185, s25, v200
  v_mul_f32 v201, v184, v167
  v_fma_f32 v202, -v201, v165, v184
  v_fma_f32 v184, v202, v167, v201
  v_mul_f32 v201, v185, v167
  v_fma_f32 v202, -v201, v165, v185
  v_fma_f32 v185, v202, v167, v201
  v_cvt_pk_bf16_f32 v212, v184, v185
  v_sub_f32 v186, v186, v166
  v_sub_f32 v187, v187, v166
  v_cvt_pk_bf16_f32 v200, v186, v187
  v_lshlrev_b32 v186, 16, v200
  v_and_b32 v187, s25, v200
  v_mul_f32 v201, v186, v167
  v_fma_f32 v202, -v201, v165, v186
  v_fma_f32 v186, v202, v167, v201
  v_mul_f32 v201, v187, v167
  v_fma_f32 v202, -v201, v165, v187
  v_fma_f32 v187, v202, v167, v201
  v_cvt_pk_bf16_f32 v213, v186, v187
  v_sub_f32 v188, v188, v166
  v_sub_f32 v189, v189, v166
  v_cvt_pk_bf16_f32 v200, v188, v189
  v_lshlrev_b32 v188, 16, v200
  v_and_b32 v189, s25, v200
  v_mul_f32 v201, v188, v167
  v_fma_f32 v202, -v201, v165, v188
  v_fma_f32 v188, v202, v167, v201
  v_mul_f32 v201, v189, v167
  v_fma_f32 v202, -v201, v165, v189
  v_fma_f32 v189, v202, v167, v201
  v_cvt_pk_bf16_f32 v214, v188, v189
  v_sub_f32 v190, v190, v166
  v_sub_f32 v191, v191, v166
  v_cvt_pk_bf16_f32 v200, v190, v191
  v_lshlrev_b32 v190, 16, v200
  v_and_b32 v191, s25, v200
  v_mul_f32 v201, v190, v167
  v_fma_f32 v202, -v201, v165, v190
  v_fma_f32 v190, v202, v167, v201
  v_mul_f32 v201, v191, v167
  v_fma_f32 v202, -v201, v165, v191
  v_fma_f32 v191, v202, v167, v201
  v_cvt_pk_bf16_f32 v215, v190, v191
  v_sub_f32 v192, v192, v166
  v_sub_f32 v193, v193, v166
  v_cvt_pk_bf16_f32 v200, v192, v193
  v_lshlrev_b32 v192, 16, v200
  v_and_b32 v193, s25, v200
  v_mul_f32 v201, v192, v167
  v_fma_f32 v202, -v201, v165, v192
  v_fma_f32 v192, v202, v167, v201
  v_mul_f32 v201, v193, v167
  v_fma_f32 v202, -v201, v165, v193
  v_fma_f32 v193, v202, v167, v201
  v_cvt_pk_bf16_f32 v216, v192, v193
  v_sub_f32 v194, v194, v166
  v_sub_f32 v195, v195, v166
  v_cvt_pk_bf16_f32 v200, v194, v195
  v_lshlrev_b32 v194, 16, v200
  v_and_b32 v195, s25, v200
  v_mul_f32 v201, v194, v167
  v_fma_f32 v202, -v201, v165, v194
  v_fma_f32 v194, v202, v167, v201
  v_mul_f32 v201, v195, v167
  v_fma_f32 v202, -v201, v165, v195
  v_fma_f32 v195, v202, v167, v201
  v_cvt_pk_bf16_f32 v217, v194, v195
  v_sub_f32 v196, v196, v166
  v_sub_f32 v197, v197, v166
  v_cvt_pk_bf16_f32 v200, v196, v197
  v_lshlrev_b32 v196, 16, v200
  v_and_b32 v197, s25, v200
  v_mul_f32 v201, v196, v167
  v_fma_f32 v202, -v201, v165, v196
  v_fma_f32 v196, v202, v167, v201
  v_mul_f32 v201, v197, v167
  v_fma_f32 v202, -v201, v165, v197
  v_fma_f32 v197, v202, v167, v201
  v_cvt_pk_bf16_f32 v218, v196, v197
  v_sub_f32 v198, v198, v166
  v_sub_f32 v199, v199, v166
  v_cvt_pk_bf16_f32 v200, v198, v199
  v_lshlrev_b32 v198, 16, v200
  v_and_b32 v199, s25, v200
  v_mul_f32 v201, v198, v167
  v_fma_f32 v202, -v201, v165, v198
  v_fma_f32 v198, v202, v167, v201
  v_mul_f32 v201, v199, v167
  v_fma_f32 v202, -v201, v165, v199
  v_fma_f32 v199, v202, v167, v201
  v_cvt_pk_bf16_f32 v219, v198, v199
  buffer_store_dwordx4 v[212:215], v164, s[8:11], 0 offen offset:0 sc1
  buffer_store_dwordx4 v[216:219], v164, s[8:11], s22 offen offset:0 sc1
  s_waitcnt vmcnt(10)
  v_lshlrev_b32 v184, 16, v220
  v_and_b32 v185, s25, v220
  v_lshlrev_b32 v186, 16, v221
  v_and_b32 v187, s25, v221
  v_lshlrev_b32 v188, 16, v222
  v_and_b32 v189, s25, v222
  v_lshlrev_b32 v190, 16, v223
  v_and_b32 v191, s25, v223
  v_lshlrev_b32 v192, 16, v224
  v_and_b32 v193, s25, v224
  v_lshlrev_b32 v194, 16, v225
  v_and_b32 v195, s25, v225
  v_lshlrev_b32 v196, 16, v226
  v_and_b32 v197, s25, v226
  v_lshlrev_b32 v198, 16, v227
  v_and_b32 v199, s25, v227
  v_add_f32 v166, v184, v185
  v_add_f32 v166, v166, v186
  v_add_f32 v166, v166, v187
  v_add_f32 v166, v166, v188
  v_add_f32 v166, v166, v189
  v_add_f32 v166, v166, v190
  v_add_f32 v166, v166, v191
  v_add_f32 v166, v166, v192
  v_add_f32 v166, v166, v193
  v_add_f32 v166, v166, v194
  v_add_f32 v166, v166, v195
  v_add_f32 v166, v166, v196
  v_add_f32 v166, v166, v197
  v_add_f32 v166, v166, v198
  v_add_f32 v166, v166, v199
  s_nop 1
  v_add_f32_dpp v166, v166, v166 row_ror:8 row_mask:0xf bank_mask:0xf
  s_nop 1
  v_add_f32_dpp v166, v166, v166 row_ror:4 row_mask:0xf bank_mask:0xf
  s_nop 1
  v_add_f32_dpp v166, v166, v166 row_ror:2 row_mask:0xf bank_mask:0xf
  s_nop 1
  v_add_f32_dpp v166, v166, v166 row_ror:1 row_mask:0xf bank_mask:0xf
  v_mov_b32 v167, v166
  s_nop 1
  v_permlane16_swap_b32 v166, v167
  v_add_f32 v166, v166, v167
  v_mov_b32 v167, v166
  s_nop 1
  v_permlane32_swap_b32 v166, v167
  v_add_f32 v166, v166, v167
  v_mul_f32 v166, s23, v166
  v_sub_f32 v200, v184, v166
  v_mul_f32 v165, v200, v200
  v_sub_f32 v200, v185, v166
  v_fmac_f32 v165, v200, v200
  v_sub_f32 v200, v186, v166
  v_fmac_f32 v165, v200, v200
  v_sub_f32 v200, v187, v166
  v_fmac_f32 v165, v200, v200
  v_sub_f32 v200, v188, v166
  v_fmac_f32 v165, v200, v200
  v_sub_f32 v200, v189, v166
  v_fmac_f32 v165, v200, v200
  v_sub_f32 v200, v190, v166
  v_fmac_f32 v165, v200, v200
  v_sub_f32 v200, v191, v166
  v_fmac_f32 v165, v200, v200
  v_sub_f32 v200, v192, v166
  v_fmac_f32 v165, v200, v200
  v_sub_f32 v200, v193, v166
  v_fmac_f32 v165, v200, v200
  v_sub_f32 v200, v194, v166
  v_fmac_f32 v165, v200, v200
  v_sub_f32 v200, v195, v166
  v_fmac_f32 v165, v200, v200
  v_sub_f32 v200, v196, v166
  v_fmac_f32 v165, v200, v200
  v_sub_f32 v200, v197, v166
  v_fmac_f32 v165, v200, v200
  v_sub_f32 v200, v198, v166
  v_fmac_f32 v165, v200, v200
  v_sub_f32 v200, v199, v166
  v_fmac_f32 v165, v200, v200
  s_nop 1
  v_add_f32_dpp v165, v165, v165 row_ror:8 row_mask:0xf bank_mask:0xf
  s_nop 1
  v_add_f32_dpp v165, v165, v165 row_ror:4 row_mask:0xf bank_mask:0xf
  s_nop 1
  v_add_f32_dpp v165, v165, v165 row_ror:2 row_mask:0xf bank_mask:0xf
  s_nop 1
  v_add_f32_dpp v165, v165, v165 row_ror:1 row_mask:0xf bank_mask:0xf
  v_mov_b32 v167, v165
  s_nop 1
  v_permlane16_swap_b32 v165, v167
  v_add_f32 v165, v165, v167
  v_mov_b32 v167, v165
  s_nop 1
  v_permlane32_swap_b32 v165, v167
  v_add_f32 v165, v165, v167
  v_mul_f32 v165, s23, v165
  v_cvt_pk_bf16_f32 v166, v166, v165
  v_and_b32 v165, s25, v166
  v_lshlrev_b32 v166, 16, v166
  v_add_f32 v165, s24, v165
  v_cvt_pk_bf16_f32 v165, v165, v165
  v_lshlrev_b32 v165, 16, v165
  v_sqrt_f32 v165, v165
  s_nop 0
  v_cvt_pk_bf16_f32 v165, v165, v165
  v_lshlrev_b32 v165, 16, v165
  v_rcp_f32 v167, v165
  v_sub_f32 v184, v184, v166
  v_sub_f32 v185, v185, v166
  v_cvt_pk_bf16_f32 v200, v184, v185
  v_lshlrev_b32 v184, 16, v200
  v_and_b32 v185, s25, v200
  v_mul_f32 v201, v184, v167
  v_fma_f32 v202, -v201, v165, v184
  v_fma_f32 v184, v202, v167, v201
  v_mul_f32 v201, v185, v167
  v_fma_f32 v202, -v201, v165, v185
  v_fma_f32 v185, v202, v167, v201
  v_cvt_pk_bf16_f32 v220, v184, v185
  v_sub_f32 v186, v186, v166
  v_sub_f32 v187, v187, v166
  v_cvt_pk_bf16_f32 v200, v186, v187
  v_lshlrev_b32 v186, 16, v200
  v_and_b32 v187, s25, v200
  v_mul_f32 v201, v186, v167
  v_fma_f32 v202, -v201, v165, v186
  v_fma_f32 v186, v202, v167, v201
  v_mul_f32 v201, v187, v167
  v_fma_f32 v202, -v201, v165, v187
  v_fma_f32 v187, v202, v167, v201
  v_cvt_pk_bf16_f32 v221, v186, v187
  v_sub_f32 v188, v188, v166
  v_sub_f32 v189, v189, v166
  v_cvt_pk_bf16_f32 v200, v188, v189
  v_lshlrev_b32 v188, 16, v200
  v_and_b32 v189, s25, v200
  v_mul_f32 v201, v188, v167
  v_fma_f32 v202, -v201, v165, v188
  v_fma_f32 v188, v202, v167, v201
  v_mul_f32 v201, v189, v167
  v_fma_f32 v202, -v201, v165, v189
  v_fma_f32 v189, v202, v167, v201
  v_cvt_pk_bf16_f32 v222, v188, v189
  v_sub_f32 v190, v190, v166
  v_sub_f32 v191, v191, v166
  v_cvt_pk_bf16_f32 v200, v190, v191
  v_lshlrev_b32 v190, 16, v200
  v_and_b32 v191, s25, v200
  v_mul_f32 v201, v190, v167
  v_fma_f32 v202, -v201, v165, v190
  v_fma_f32 v190, v202, v167, v201
  v_mul_f32 v201, v191, v167
  v_fma_f32 v202, -v201, v165, v191
  v_fma_f32 v191, v202, v167, v201
  v_cvt_pk_bf16_f32 v223, v190, v191
  v_sub_f32 v192, v192, v166
  v_sub_f32 v193, v193, v166
  v_cvt_pk_bf16_f32 v200, v192, v193
  v_lshlrev_b32 v192, 16, v200
  v_and_b32 v193, s25, v200
  v_mul_f32 v201, v192, v167
  v_fma_f32 v202, -v201, v165, v192
  v_fma_f32 v192, v202, v167, v201
  v_mul_f32 v201, v193, v167
  v_fma_f32 v202, -v201, v165, v193
  v_fma_f32 v193, v202, v167, v201
  v_cvt_pk_bf16_f32 v224, v192, v193
  v_sub_f32 v194, v194, v166
  v_sub_f32 v195, v195, v166
  v_cvt_pk_bf16_f32 v200, v194, v195
  v_lshlrev_b32 v194, 16, v200
  v_and_b32 v195, s25, v200
  v_mul_f32 v201, v194, v167
  v_fma_f32 v202, -v201, v165, v194
  v_fma_f32 v194, v202, v167, v201
  v_mul_f32 v201, v195, v167
  v_fma_f32 v202, -v201, v165, v195
  v_fma_f32 v195, v202, v167, v201
  v_cvt_pk_bf16_f32 v225, v194, v195
  v_sub_f32 v196, v196, v166
  v_sub_f32 v197, v197, v166
  v_cvt_pk_bf16_f32 v200, v196, v197
  v_lshlrev_b32 v196, 16, v200
  v_and_b32 v197, s25, v200
  v_mul_f32 v201, v196, v167
  v_fma_f32 v202, -v201, v165, v196
  v_fma_f32 v196, v202, v167, v201
  v_mul_f32 v201, v197, v167
  v_fma_f32 v202, -v201, v165, v197
  v_fma_f32 v197, v202, v167, v201
  v_cvt_pk_bf16_f32 v226, v196, v197
  v_sub_f32 v198, v198, v166
  v_sub_f32 v199, v199, v166
  v_cvt_pk_bf16_f32 v200, v198, v199
  v_lshlrev_b32 v198, 16, v200
  v_and_b32 v199, s25, v200
  v_mul_f32 v201, v198, v167
  v_fma_f32 v202, -v201, v165, v198
  v_fma_f32 v198, v202, v167, v201
  v_mul_f32 v201, v199, v167
  v_fma_f32 v202, -v201, v165, v199
  v_fma_f32 v199, v202, v167, v201
  v_cvt_pk_bf16_f32 v227, v198, v199
  buffer_store_dwordx4 v[220:223], v164, s[8:11], 0 offen offset:256 sc1
  buffer_store_dwordx4 v[224:227], v164, s[8:11], s22 offen offset:256 sc1
  s_waitcnt vmcnt(10)
  v_lshlrev_b32 v184, 16, v228
  v_and_b32 v185, s25, v228
  v_lshlrev_b32 v186, 16, v229
  v_and_b32 v187, s25, v229
  v_lshlrev_b32 v188, 16, v230
  v_and_b32 v189, s25, v230
  v_lshlrev_b32 v190, 16, v231
  v_and_b32 v191, s25, v231
  v_lshlrev_b32 v192, 16, v232
  v_and_b32 v193, s25, v232
  v_lshlrev_b32 v194, 16, v233
  v_and_b32 v195, s25, v233
  v_lshlrev_b32 v196, 16, v234
  v_and_b32 v197, s25, v234
  v_lshlrev_b32 v198, 16, v235
  v_and_b32 v199, s25, v235
  v_add_f32 v166, v184, v185
  v_add_f32 v166, v166, v186
  v_add_f32 v166, v166, v187
  v_add_f32 v166, v166, v188
  v_add_f32 v166, v166, v189
  v_add_f32 v166, v166, v190
  v_add_f32 v166, v166, v191
  v_add_f32 v166, v166, v192
  v_add_f32 v166, v166, v193
  v_add_f32 v166, v166, v194
  v_add_f32 v166, v166, v195
  v_add_f32 v166, v166, v196
  v_add_f32 v166, v166, v197
  v_add_f32 v166, v166, v198
  v_add_f32 v166, v166, v199
  s_nop 1
  v_add_f32_dpp v166, v166, v166 row_ror:8 row_mask:0xf bank_mask:0xf
  s_nop 1
  v_add_f32_dpp v166, v166, v166 row_ror:4 row_mask:0xf bank_mask:0xf
  s_nop 1
  v_add_f32_dpp v166, v166, v166 row_ror:2 row_mask:0xf bank_mask:0xf
  s_nop 1
  v_add_f32_dpp v166, v166, v166 row_ror:1 row_mask:0xf bank_mask:0xf
  v_mov_b32 v167, v166
  s_nop 1
  v_permlane16_swap_b32 v166, v167
  v_add_f32 v166, v166, v167
  v_mov_b32 v167, v166
  s_nop 1
  v_permlane32_swap_b32 v166, v167
  v_add_f32 v166, v166, v167
  v_mul_f32 v166, s23, v166
  v_sub_f32 v200, v184, v166
  v_mul_f32 v165, v200, v200
  v_sub_f32 v200, v185, v166
  v_fmac_f32 v165, v200, v200
  v_sub_f32 v200, v186, v166
  v_fmac_f32 v165, v200, v200
  v_sub_f32 v200, v187, v166
  v_fmac_f32 v165, v200, v200
  v_sub_f32 v200, v188, v166
  v_fmac_f32 v165, v200, v200
  v_sub_f32 v200, v189, v166
  v_fmac_f32 v165, v200, v200
  v_sub_f32 v200, v190, v166
  v_fmac_f32 v165, v200, v200
  v_sub_f32 v200, v191, v166
  v_fmac_f32 v165, v200, v200
  v_sub_f32 v200, v192, v166
  v_fmac_f32 v165, v200, v200
  v_sub_f32 v200, v193, v166
  v_fmac_f32 v165, v200, v200
  v_sub_f32 v200, v194, v166
  v_fmac_f32 v165, v200, v200
  v_sub_f32 v200, v195, v166
  v_fmac_f32 v165, v200, v200
  v_sub_f32 v200, v196, v166
  v_fmac_f32 v165, v200, v200
  v_sub_f32 v200, v197, v166
  v_fmac_f32 v165, v200, v200
  v_sub_f32 v200, v198, v166
  v_fmac_f32 v165, v200, v200
  v_sub_f32 v200, v199, v166
  v_fmac_f32 v165, v200, v200
  s_nop 1
  v_add_f32_dpp v165, v165, v165 row_ror:8 row_mask:0xf bank_mask:0xf
  s_nop 1
  v_add_f32_dpp v165, v165, v165 row_ror:4 row_mask:0xf bank_mask:0xf
  s_nop 1
  v_add_f32_dpp v165, v165, v165 row_ror:2 row_mask:0xf bank_mask:0xf
  s_nop 1
  v_add_f32_dpp v165, v165, v165 row_ror:1 row_mask:0xf bank_mask:0xf
  v_mov_b32 v167, v165
  s_nop 1
  v_permlane16_swap_b32 v165, v167
  v_add_f32 v165, v165, v167
  v_mov_b32 v167, v165
  s_nop 1
  v_permlane32_swap_b32 v165, v167
  v_add_f32 v165, v165, v167
  v_mul_f32 v165, s23, v165
  v_cvt_pk_bf16_f32 v166, v166, v165
  v_and_b32 v165, s25, v166
  v_lshlrev_b32 v166, 16, v166
  v_add_f32 v165, s24, v165
  v_cvt_pk_bf16_f32 v165, v165, v165
  v_lshlrev_b32 v165, 16, v165
  v_sqrt_f32 v165, v165
  s_nop 0
  v_cvt_pk_bf16_f32 v165, v165, v165
  v_lshlrev_b32 v165, 16, v165
  v_rcp_f32 v167, v165
  v_sub_f32 v184, v184, v166
  v_sub_f32 v185, v185, v166
  v_cvt_pk_bf16_f32 v200, v184, v185
  v_lshlrev_b32 v184, 16, v200
  v_and_b32 v185, s25, v200
  v_mul_f32 v201, v184, v167
  v_fma_f32 v202, -v201, v165, v184
  v_fma_f32 v184, v202, v167, v201
  v_mul_f32 v201, v185, v167
  v_fma_f32 v202, -v201, v165, v185
  v_fma_f32 v185, v202, v167, v201
  v_cvt_pk_bf16_f32 v228, v184, v185
  v_sub_f32 v186, v186, v166
  v_sub_f32 v187, v187, v166
  v_cvt_pk_bf16_f32 v200, v186, v187
  v_lshlrev_b32 v186, 16, v200
  v_and_b32 v187, s25, v200
  v_mul_f32 v201, v186, v167
  v_fma_f32 v202, -v201, v165, v186
  v_fma_f32 v186, v202, v167, v201
  v_mul_f32 v201, v187, v167
  v_fma_f32 v202, -v201, v165, v187
  v_fma_f32 v187, v202, v167, v201
  v_cvt_pk_bf16_f32 v229, v186, v187
  v_sub_f32 v188, v188, v166
  v_sub_f32 v189, v189, v166
  v_cvt_pk_bf16_f32 v200, v188, v189
  v_lshlrev_b32 v188, 16, v200
  v_and_b32 v189, s25, v200
  v_mul_f32 v201, v188, v167
  v_fma_f32 v202, -v201, v165, v188
  v_fma_f32 v188, v202, v167, v201
  v_mul_f32 v201, v189, v167
  v_fma_f32 v202, -v201, v165, v189
  v_fma_f32 v189, v202, v167, v201
  v_cvt_pk_bf16_f32 v230, v188, v189
  v_sub_f32 v190, v190, v166
  v_sub_f32 v191, v191, v166
  v_cvt_pk_bf16_f32 v200, v190, v191
  v_lshlrev_b32 v190, 16, v200
  v_and_b32 v191, s25, v200
  v_mul_f32 v201, v190, v167
  v_fma_f32 v202, -v201, v165, v190
  v_fma_f32 v190, v202, v167, v201
  v_mul_f32 v201, v191, v167
  v_fma_f32 v202, -v201, v165, v191
  v_fma_f32 v191, v202, v167, v201
  v_cvt_pk_bf16_f32 v231, v190, v191
  v_sub_f32 v192, v192, v166
  v_sub_f32 v193, v193, v166
  v_cvt_pk_bf16_f32 v200, v192, v193
  v_lshlrev_b32 v192, 16, v200
  v_and_b32 v193, s25, v200
  v_mul_f32 v201, v192, v167
  v_fma_f32 v202, -v201, v165, v192
  v_fma_f32 v192, v202, v167, v201
  v_mul_f32 v201, v193, v167
  v_fma_f32 v202, -v201, v165, v193
  v_fma_f32 v193, v202, v167, v201
  v_cvt_pk_bf16_f32 v232, v192, v193
  v_sub_f32 v194, v194, v166
  v_sub_f32 v195, v195, v166
  v_cvt_pk_bf16_f32 v200, v194, v195
  v_lshlrev_b32 v194, 16, v200
  v_and_b32 v195, s25, v200
  v_mul_f32 v201, v194, v167
  v_fma_f32 v202, -v201, v165, v194
  v_fma_f32 v194, v202, v167, v201
  v_mul_f32 v201, v195, v167
  v_fma_f32 v202, -v201, v165, v195
  v_fma_f32 v195, v202, v167, v201
  v_cvt_pk_bf16_f32 v233, v194, v195
  v_sub_f32 v196, v196, v166
  v_sub_f32 v197, v197, v166
  v_cvt_pk_bf16_f32 v200, v196, v197
  v_lshlrev_b32 v196, 16, v200
  v_and_b32 v197, s25, v200
  v_mul_f32 v201, v196, v167
  v_fma_f32 v202, -v201, v165, v196
  v_fma_f32 v196, v202, v167, v201
  v_mul_f32 v201, v197, v167
  v_fma_f32 v202, -v201, v165, v197
  v_fma_f32 v197, v202, v167, v201
  v_cvt_pk_bf16_f32 v234, v196, v197
  v_sub_f32 v198, v198, v166
  v_sub_f32 v199, v199, v166
  v_cvt_pk_bf16_f32 v200, v198, v199
  v_lshlrev_b32 v198, 16, v200
  v_and_b32 v199, s25, v200
  v_mul_f32 v201, v198, v167
  v_fma_f32 v202, -v201, v165, v198
  v_fma_f32 v198, v202, v167, v201
  v_mul_f32 v201, v199, v167
  v_fma_f32 v202, -v201, v165, v199
  v_fma_f32 v199, v202, v167, v201
  v_cvt_pk_bf16_f32 v235, v198, v199
  buffer_store_dwordx4 v[228:231], v164, s[8:11], 0 offen offset:512 sc1
  buffer_store_dwordx4 v[232:235], v164, s[8:11], s22 offen offset:512 sc1
  s_waitcnt vmcnt(10)
  v_lshlrev_b32 v184, 16, v236
  v_and_b32 v185, s25, v236
  v_lshlrev_b32 v186, 16, v237
  v_and_b32 v187, s25, v237
  v_lshlrev_b32 v188, 16, v238
  v_and_b32 v189, s25, v238
  v_lshlrev_b32 v190, 16, v239
  v_and_b32 v191, s25, v239
  v_lshlrev_b32 v192, 16, v240
  v_and_b32 v193, s25, v240
  v_lshlrev_b32 v194, 16, v241
  v_and_b32 v195, s25, v241
  v_lshlrev_b32 v196, 16, v242
  v_and_b32 v197, s25, v242
  v_lshlrev_b32 v198, 16, v243
  v_and_b32 v199, s25, v243
  v_add_f32 v166, v184, v185
  v_add_f32 v166, v166, v186
  v_add_f32 v166, v166, v187
  v_add_f32 v166, v166, v188
  v_add_f32 v166, v166, v189
  v_add_f32 v166, v166, v190
  v_add_f32 v166, v166, v191
  v_add_f32 v166, v166, v192
  v_add_f32 v166, v166, v193
  v_add_f32 v166, v166, v194
  v_add_f32 v166, v166, v195
  v_add_f32 v166, v166, v196
  v_add_f32 v166, v166, v197
  v_add_f32 v166, v166, v198
  v_add_f32 v166, v166, v199
  s_nop 1
  v_add_f32_dpp v166, v166, v166 row_ror:8 row_mask:0xf bank_mask:0xf
  s_nop 1
  v_add_f32_dpp v166, v166, v166 row_ror:4 row_mask:0xf bank_mask:0xf
  s_nop 1
  v_add_f32_dpp v166, v166, v166 row_ror:2 row_mask:0xf bank_mask:0xf
  s_nop 1
  v_add_f32_dpp v166, v166, v166 row_ror:1 row_mask:0xf bank_mask:0xf
  v_mov_b32 v167, v166
  s_nop 1
  v_permlane16_swap_b32 v166, v167
  v_add_f32 v166, v166, v167
  v_mov_b32 v167, v166
  s_nop 1
  v_permlane32_swap_b32 v166, v167
  v_add_f32 v166, v166, v167
  v_mul_f32 v166, s23, v166
  v_sub_f32 v200, v184, v166
  v_mul_f32 v165, v200, v200
  v_sub_f32 v200, v185, v166
  v_fmac_f32 v165, v200, v200
  v_sub_f32 v200, v186, v166
  v_fmac_f32 v165, v200, v200
  v_sub_f32 v200, v187, v166
  v_fmac_f32 v165, v200, v200
  v_sub_f32 v200, v188, v166
  v_fmac_f32 v165, v200, v200
  v_sub_f32 v200, v189, v166
  v_fmac_f32 v165, v200, v200
  v_sub_f32 v200, v190, v166
  v_fmac_f32 v165, v200, v200
  v_sub_f32 v200, v191, v166
  v_fmac_f32 v165, v200, v200
  v_sub_f32 v200, v192, v166
  v_fmac_f32 v165, v200, v200
  v_sub_f32 v200, v193, v166
  v_fmac_f32 v165, v200, v200
  v_sub_f32 v200, v194, v166
  v_fmac_f32 v165, v200, v200
  v_sub_f32 v200, v195, v166
  v_fmac_f32 v165, v200, v200
  v_sub_f32 v200, v196, v166
  v_fmac_f32 v165, v200, v200
  v_sub_f32 v200, v197, v166
  v_fmac_f32 v165, v200, v200
  v_sub_f32 v200, v198, v166
  v_fmac_f32 v165, v200, v200
  v_sub_f32 v200, v199, v166
  v_fmac_f32 v165, v200, v200
  s_nop 1
  v_add_f32_dpp v165, v165, v165 row_ror:8 row_mask:0xf bank_mask:0xf
  s_nop 1
  v_add_f32_dpp v165, v165, v165 row_ror:4 row_mask:0xf bank_mask:0xf
  s_nop 1
  v_add_f32_dpp v165, v165, v165 row_ror:2 row_mask:0xf bank_mask:0xf
  s_nop 1
  v_add_f32_dpp v165, v165, v165 row_ror:1 row_mask:0xf bank_mask:0xf
  v_mov_b32 v167, v165
  s_nop 1
  v_permlane16_swap_b32 v165, v167
  v_add_f32 v165, v165, v167
  v_mov_b32 v167, v165
  s_nop 1
  v_permlane32_swap_b32 v165, v167
  v_add_f32 v165, v165, v167
  v_mul_f32 v165, s23, v165
  v_cvt_pk_bf16_f32 v166, v166, v165
  v_and_b32 v165, s25, v166
  v_lshlrev_b32 v166, 16, v166
  v_add_f32 v165, s24, v165
  v_cvt_pk_bf16_f32 v165, v165, v165
  v_lshlrev_b32 v165, 16, v165
  v_sqrt_f32 v165, v165
  s_nop 0
  v_cvt_pk_bf16_f32 v165, v165, v165
  v_lshlrev_b32 v165, 16, v165
  v_rcp_f32 v167, v165
  v_sub_f32 v184, v184, v166
  v_sub_f32 v185, v185, v166
  v_cvt_pk_bf16_f32 v200, v184, v185
  v_lshlrev_b32 v184, 16, v200
  v_and_b32 v185, s25, v200
  v_mul_f32 v201, v184, v167
  v_fma_f32 v202, -v201, v165, v184
  v_fma_f32 v184, v202, v167, v201
  v_mul_f32 v201, v185, v167
  v_fma_f32 v202, -v201, v165, v185
  v_fma_f32 v185, v202, v167, v201
  v_cvt_pk_bf16_f32 v236, v184, v185
  v_sub_f32 v186, v186, v166
  v_sub_f32 v187, v187, v166
  v_cvt_pk_bf16_f32 v200, v186, v187
  v_lshlrev_b32 v186, 16, v200
  v_and_b32 v187, s25, v200
  v_mul_f32 v201, v186, v167
  v_fma_f32 v202, -v201, v165, v186
  v_fma_f32 v186, v202, v167, v201
  v_mul_f32 v201, v187, v167
  v_fma_f32 v202, -v201, v165, v187
  v_fma_f32 v187, v202, v167, v201
  v_cvt_pk_bf16_f32 v237, v186, v187
  v_sub_f32 v188, v188, v166
  v_sub_f32 v189, v189, v166
  v_cvt_pk_bf16_f32 v200, v188, v189
  v_lshlrev_b32 v188, 16, v200
  v_and_b32 v189, s25, v200
  v_mul_f32 v201, v188, v167
  v_fma_f32 v202, -v201, v165, v188
  v_fma_f32 v188, v202, v167, v201
  v_mul_f32 v201, v189, v167
  v_fma_f32 v202, -v201, v165, v189
  v_fma_f32 v189, v202, v167, v201
  v_cvt_pk_bf16_f32 v238, v188, v189
  v_sub_f32 v190, v190, v166
  v_sub_f32 v191, v191, v166
  v_cvt_pk_bf16_f32 v200, v190, v191
  v_lshlrev_b32 v190, 16, v200
  v_and_b32 v191, s25, v200
  v_mul_f32 v201, v190, v167
  v_fma_f32 v202, -v201, v165, v190
  v_fma_f32 v190, v202, v167, v201
  v_mul_f32 v201, v191, v167
  v_fma_f32 v202, -v201, v165, v191
  v_fma_f32 v191, v202, v167, v201
  v_cvt_pk_bf16_f32 v239, v190, v191
  v_sub_f32 v192, v192, v166
  v_sub_f32 v193, v193, v166
  v_cvt_pk_bf16_f32 v200, v192, v193
  v_lshlrev_b32 v192, 16, v200
  v_and_b32 v193, s25, v200
  v_mul_f32 v201, v192, v167
  v_fma_f32 v202, -v201, v165, v192
  v_fma_f32 v192, v202, v167, v201
  v_mul_f32 v201, v193, v167
  v_fma_f32 v202, -v201, v165, v193
  v_fma_f32 v193, v202, v167, v201
  v_cvt_pk_bf16_f32 v240, v192, v193
  v_sub_f32 v194, v194, v166
  v_sub_f32 v195, v195, v166
  v_cvt_pk_bf16_f32 v200, v194, v195
  v_lshlrev_b32 v194, 16, v200
  v_and_b32 v195, s25, v200
  v_mul_f32 v201, v194, v167
  v_fma_f32 v202, -v201, v165, v194
  v_fma_f32 v194, v202, v167, v201
  v_mul_f32 v201, v195, v167
  v_fma_f32 v202, -v201, v165, v195
  v_fma_f32 v195, v202, v167, v201
  v_cvt_pk_bf16_f32 v241, v194, v195
  v_sub_f32 v196, v196, v166
  v_sub_f32 v197, v197, v166
  v_cvt_pk_bf16_f32 v200, v196, v197
  v_lshlrev_b32 v196, 16, v200
  v_and_b32 v197, s25, v200
  v_mul_f32 v201, v196, v167
  v_fma_f32 v202, -v201, v165, v196
  v_fma_f32 v196, v202, v167, v201
  v_mul_f32 v201, v197, v167
  v_fma_f32 v202, -v201, v165, v197
  v_fma_f32 v197, v202, v167, v201
  v_cvt_pk_bf16_f32 v242, v196, v197
  v_sub_f32 v198, v198, v166
  v_sub_f32 v199, v199, v166
  v_cvt_pk_bf16_f32 v200, v198, v199
  v_lshlrev_b32 v198, 16, v200
  v_and_b32 v199, s25, v200
  v_mul_f32 v201, v198, v167
  v_fma_f32 v202, -v201, v165, v198
  v_fma_f32 v198, v202, v167, v201
  v_mul_f32 v201, v199, v167
  v_fma_f32 v202, -v201, v165, v199
  v_fma_f32 v199, v202, v167, v201
  v_cvt_pk_bf16_f32 v243, v198, v199
  buffer_store_dwordx4 v[236:239], v164, s[8:11], 0 offen offset:768 sc1
  buffer_store_dwordx4 v[240:243], v164, s[8:11], s22 offen offset:768 sc1
  s_branch mk_sig
mk_nq:
  s_waitcnt lgkmcnt(0)
  v_mov_b32 v204, -1
  v_mov_b32 v205, -1
  v_mov_b32 v206, -1
  v_mov_b32 v207, -1
  s_mul_i32 s21, s96, 3072
  s_add_u32 s21, s21, 0
  v_lshlrev_b32 v203, 4, v0
  v_cmp_gt_u32 vcc, 192, v0
  v_mov_b32 v208, 2147483648
  s_nop 0
  v_cndmask_b32 v203, v208, v203, vcc
  buffer_store_dwordx4 v[204:207], v203, s[8:11], s21 offen sc1
  s_add_u32 s21, s21, 4096
  s_mul_i32 s21, s96, 10112
  s_add_u32 s21, s21, 3145728
  v_lshlrev_b32 v203, 4, v0
  buffer_store_dwordx4 v[204:207], v203, s[8:11], s21 offen sc1
  s_add_u32 s21, s21, 4096
  buffer_store_dwordx4 v[204:207], v203, s[8:11], s21 offen sc1
  s_add_u32 s21, s21, 4096
  v_cmp_gt_u32 vcc, 120, v0
  v_mov_b32 v208, 2147483648
  s_nop 0
  v_cndmask_b32 v203, v208, v203, vcc
  buffer_store_dwordx4 v[204:207], v203, s[8:11], s21 offen sc1
  s_add_u32 s21, s21, 4096
mk_sig:
  s_waitcnt vmcnt(0)
  s_barrier
  s_add_u32 s5, s2, 1
  s_or_b32 s5, s5, s4
  v_mov_b32 v2, 2147483648
  v_cmp_eq_u32 vcc, 192, v0
  v_mov_b32 v3, s5
  v_mov_b32 v4, s96
  v_cndmask_b32 v2, v2, v4, vcc
  buffer_store_byte v3, v2, s[16:19], 0 offen sc1
mk_start:
  s_cmp_ge_u32 s2, 4
  s_cbranch_scc1 mk_worker
  s_cmp_eq_u32 s97, 0
  s_cbranch_scc0 mk_safe
  s_lshr_b32 s5, s3, 2
  s_lshl_b32 s36, s2, 3
  s_add_u32 s5, s5, s36
  s_and_b32 s6, s3, 3
  v_lshrrev_b32 v33, 6, v0
  s_nop 0
  v_readfirstlane_b32 s7, v33
  s_load_dwordx2 s[8:9], s[0:1], 96
  s_load_dwordx8 s[60:67], s[0:1], 16
  s_mov_b32 s10, 268435456
  s_mov_b32 s11, 0x20000
  s_mov_b32 s14, 8388608
  s_mov_b32 s15, 0x20000
  v_and_b32 v1, 63, v0
  v_and_b32 v224, 7, v0
  v_bfe_u32 v225, v0, 3, 1
  v_bfe_u32 v226, v0, 4, 2
  v_lshlrev_b32 v2, 4, v1
  s_lshl_b32 s36, s7, 15
  v_lshrrev_b32 v98, 3, v1
  v_lshlrev_b32 v96, 13, v98
  v_lshl_add_u32 v96, v224, 4, v96
  v_and_b32 v34, 3, v1
  s_lshl_b32 s37, s7, 21
  s_lshl_b32 s38, s5, 8
  s_add_u32 s37, s37, s38
  s_lshr_b32 s38, s6, 1
  s_lshl_b32 s38, s38, 7
  s_add_u32 s37, s37, s38
  v_add_u32 v96, s37, v96
  v_bfe_u32 v33, v1, 2, 2
  v_lshl_add_u32 v33, v226, 3, v33
  s_and_b32 s38, s6, 1
  s_lshl_b32 s38, s38, 6
  s_add_u32 s38, s38, s36
  v_lshlrev_b32 v97, 7, v33
  v_lshl_add_u32 v99, v34, 5, v97
  v_add_u32 v99, s36, v99
  v_lshl_add_u32 v97, v34, 3, v97
  v_add_u32 v97, s38, v97
  v_lshlrev_b32 v98, 11, v98
  v_lshl_add_u32 v98, v224, 4, v98
  s_lshl_b32 s37, s5, 18
  s_lshl_b32 s38, s6, 9
  s_add_u32 s37, s37, s38
  s_lshl_b32 s38, s7, 7
  s_add_u32 s37, s37, s38
  v_add_u32 v98, s37, v98
  s_waitcnt lgkmcnt(0)
  s_mov_b32 s12, s60
  s_mov_b32 s13, s61
  s_add_u32 m0, s36, 0
  s_mov_b32 s39, 0
  buffer_load_dwordx4 v96, s[12:15], s39 offen lds
  s_add_u32 m0, s36, 1024
  s_mov_b32 s39, 65536
  buffer_load_dwordx4 v96, s[12:15], s39 offen lds
  s_add_u32 m0, s36, 2048
  s_mov_b32 s39, 131072
  buffer_load_dwordx4 v96, s[12:15], s39 offen lds
  s_add_u32 m0, s36, 3072
  s_mov_b32 s39, 196608
  buffer_load_dwordx4 v96, s[12:15], s39 offen lds
  s_add_u32 m0, s36, 4096
  s_mov_b32 s39, 262144
  buffer_load_dwordx4 v96, s[12:15], s39 offen lds
  s_add_u32 m0, s36, 5120
  s_mov_b32 s39, 327680
  buffer_load_dwordx4 v96, s[12:15], s39 offen lds
  s_add_u32 m0, s36, 6144
  s_mov_b32 s39, 393216
  buffer_load_dwordx4 v96, s[12:15], s39 offen lds
  s_add_u32 m0, s36, 7168
  s_mov_b32 s39, 458752
  buffer_load_dwordx4 v96, s[12:15], s39 offen lds
  s_mov_b32 s12, s60
  s_mov_b32 s13, s61
  s_add_u32 m0, s36, 8192
  s_mov_b32 s39, 524288
  buffer_load_dwordx4 v96, s[12:15], s39 offen lds
  s_add_u32 m0, s36, 9216
  s_mov_b32 s39, 589824
  buffer_load_dwordx4 v96, s[12:15], s39 offen lds
  s_add_u32 m0, s36, 10240
  s_mov_b32 s39, 655360
  buffer_load_dwordx4 v96, s[12:15], s39 offen lds
  s_add_u32 m0, s36, 11264
  s_mov_b32 s39, 720896
  buffer_load_dwordx4 v96, s[12:15], s39 offen lds
  s_add_u32 m0, s36, 12288
  s_mov_b32 s39, 786432
  buffer_load_dwordx4 v96, s[12:15], s39 offen lds
  s_add_u32 m0, s36, 13312
  s_mov_b32 s39, 851968
  buffer_load_dwordx4 v96, s[12:15], s39 offen lds
  s_add_u32 m0, s36, 14336
  s_mov_b32 s39, 917504
  buffer_load_dwordx4 v96, s[12:15], s39 offen lds
  s_add_u32 m0, s36, 15360
  s_mov_b32 s39, 983040
  buffer_load_dwordx4 v96, s[12:15], s39 offen lds
  s_mov_b32 s12, s60
  s_mov_b32 s13, s61
  s_add_u32 m0, s36, 16384
  s_mov_b32 s39, 1048576
  buffer_load_dwordx4 v96, s[12:15], s39 offen lds
  s_add_u32 m0, s36, 17408
  s_mov_b32 s39, 1114112
  buffer_load_dwordx4 v96, s[12:15], s39 offen lds
  s_add_u32 m0, s36, 18432
  s_mov_b32 s39, 1179648
  buffer_load_dwordx4 v96, s[12:15], s39 offen lds
  s_add_u32 m0, s36, 19456
  s_mov_b32 s39, 1245184
  buffer_load_dwordx4 v96, s[12:15], s39 offen lds
  s_add_u32 m0, s36, 20480
  s_mov_b32 s39, 1310720
  buffer_load_dwordx4 v96, s[12:15], s39 offen lds
  s_add_u32 m0, s36, 21504
  s_mov_b32 s39, 1376256
  buffer_load_dwordx4 v96, s[12:15], s39 offen lds
  s_add_u32 m0, s36, 22528
  s_mov_b32 s39, 1441792
  buffer_load_dwordx4 v96, s[12:15], s39 offen lds
  s_add_u32 m0, s36, 23552
  s_mov_b32 s39, 1507328
  buffer_load_dwordx4 v96, s[12:15], s39 offen lds
  s_mov_b32 s12, s60
  s_mov_b32 s13, s61
  s_add_u32 m0, s36, 24576
  s_mov_b32 s39, 1572864
  buffer_load_dwordx4 v96, s[12:15], s39 offen lds
  s_add_u32 m0, s36, 25600
  s_mov_b32 s39, 1638400
  buffer_load_dwordx4 v96, s[12:15], s39 offen lds
  s_add_u32 m0, s36, 26624
  s_mov_b32 s39, 1703936
  buffer_load_dwordx4 v96, s[12:15], s39 offen lds
  s_add_u32 m0, s36, 27648
  s_mov_b32 s39, 1769472
  buffer_load_dwordx4 v96, s[12:15], s39 offen lds
  s_add_u32 m0, s36, 28672
  s_mov_b32 s39, 1835008
  buffer_load_dwordx4 v96, s[12:15], s39 offen lds
  s_add_u32 m0, s36, 29696
  s_mov_b32 s39, 1900544
  buffer_load_dwordx4 v96, s[12:15], s39 offen lds
  s_add_u32 m0, s36, 30720
  s_mov_b32 s39, 1966080
  buffer_load_dwordx4 v96, s[12:15], s39 offen lds
  s_add_u32 m0, s36, 31744
  s_mov_b32 s39, 2031616
  buffer_load_dwordx4 v96, s[12:15], s39 offen lds
  v_mov_b32 v0, 2147483648
  s_mul_i32 s40, s2, 49152
  s_add_u32 s40, s40, 3145728
  s_lshl_b32 s41, s7, 12
  s_add_u32 s41, s41, s40
  v_add_u32 v3, s41, v2
  s_lshl_b32 s42, s3, 2
  s_add_u32 s42, s42, s7
  s_lshr_b32 s41, s42, 1
  s_lshl_b32 s41, s41, 8
  s_and_b32 s43, s42, 1
  s_lshl_b32 s43, s43, 3
  s_add_u32 s41, s41, s43
  s_add_u32 s41, s41, s40
  v_lshlrev_b32 v33, 5, v224
  v_lshl_add_u32 v33, v225, 4, v33
  v_lshl_add_u32 v33, v226, 2, v33
  v_add_u32 v4, s41, v33
  v_cmp_gt_u32 vcc, 2, v226
  s_nop 1
  v_cndmask_b32 v4, v0, v4, vcc
  s_mul_i32 s44, s2, 393216
  s_add_u32 s44, s44, 4128768
  s_lshl_b32 s41, s42, 10
  s_add_u32 s45, s41, s44
  v_add_u32 v5, s45, v2
  v_and_b32 v33, 1, v226
  v_lshl_add_u32 v33, v33, 3, v224
  v_lshlrev_b32 v37, 4, v33
  v_add_u32 v33, s41, v37
  v_lshl_add_u32 v7, v225, 8, v33
  s_lshl_b32 s45, s2, 8
  v_add_u32 v8, s45, v33
  v_lshl_add_u32 v33, v226, 1, v225
  s_lshl_b32 s41, s6, 5
  s_lshl_b32 s43, s7, 3
  s_add_u32 s41, s41, s43
  v_add_u32 v33, s41, v33
  v_lshlrev_b32 v33, 10, v33
  v_lshl_add_u32 v33, v224, 4, v33
  s_and_b32 s41, s5, 7
  s_lshl_b32 s41, s41, 7
  s_add_u32 s41, s41, s44
  v_add_u32 v6, s41, v33
  s_lshl_b32 s41, s5, 13
  s_add_u32 s41, s41, 3342336
  s_lshl_b32 s43, s6, 11
  s_add_u32 s43, s43, s41
  v_add_u32 v9, s41, v2
  v_add_u32 v37, 1024, v37
  v_lshl_add_u32 v10, v225, 11, v37
  v_add_u32 v10, s41, v10
  v_add_u32 v13, s43, v37
  v_and_b32 v34, 0x28, v1
  v_cmp_eq_u32 vcc, 0x20, v34
  s_nop 1
  v_cndmask_b32 v13, v0, v13, vcc
  v_and_b32 v33, 1, v226
  v_lshl_add_u32 v33, v33, 1, v225
  v_lshlrev_b32 v33, 4, v33
  v_lshl_add_u32 v33, v224, 6, v33
  v_lshrrev_b32 v34, 1, v226
  v_lshl_add_u32 v33, v34, 11, v33
  v_add_u32 v33, 1536, v33
  v_add_u32 v11, s41, v33
  v_lshlrev_b32 v33, 4, v226
  v_lshl_add_u32 v33, v224, 6, v33
  s_lshl_b32 s44, s5, 2
  s_add_u32 s44, s44, s6
  s_lshl_b32 s45, s44, 15
  v_cmp_eq_u32 vcc, 0, v225
  s_cmp_eq_u32 s7, 0
  s_cbranch_scc1 mk_f_p_1
  v_mov_b32 v13, 2147483648
  v_add_u32 v12, 1536, v33
  v_add_u32 v12, s43, v12
  v_cndmask_b32 v12, v0, v12, vcc
  s_add_u32 s46, s45, 104857600
  v_add_u32 v14, s46, v33
  v_cndmask_b32 v14, v0, v14, vcc
  s_branch mk_f_p_2
mk_f_p_1:
  v_add_u32 v12, s43, v2
  s_add_u32 s46, s45, 100663296
  v_add_u32 v14, s46, v33
  v_cndmask_b32 v14, v14, v0, vcc
mk_f_p_2:
  s_bitcmp1_b32 s7, 0
  s_cbranch_scc0 mk_f_p_3
  v_mov_b32 v14, 2147483648
mk_f_p_3:
  v_and_b32 v33, 15, v1
  v_lshlrev_b32 v33, 6, v33
  v_lshl_add_u32 v33, v226, 4, v33
  s_lshl_b32 s45, s44, 17
  s_add_u32 s45, s45, 16777216
  v_add_u32 v31, s45, v33
  s_lshl_b32 s45, s5, 19
  s_add_u32 s45, s45, 33554432
  v_add_u32 v32, s45, v33
  s_mul_i32 s45, s7, 3120
  v_lshlrev_b32 v33, 8, v226
  v_and_b32 v34, 1, v226
  v_lshl_add_u32 v33, v34, 6, v33
  v_and_b32 v34, 15, v1
  v_lshl_add_u32 v15, v34, 2, v33
  v_bfe_u32 v34, v1, 1, 1
  v_lshlrev_b32 v34, 3, v34
  v_bfe_u32 v35, v1, 2, 2
  v_lshl_add_u32 v34, v35, 1, v34
  v_and_b32 v35, 1, v1
  v_add_u32 v34, v34, v35
  v_lshl_add_u32 v19, v34, 2, v33
  v_xor_b32 v16, 64, v15
  v_xor_b32 v20, 64, v19
  v_add_u32 v15, s45, v15
  v_add_u32 v16, s45, v16
  v_add_u32 v17, 1040, v15
  v_add_u32 v18, 1040, v16
  s_add_u32 s45, s45, 2080
  v_add_u32 v19, s45, v19
  v_add_u32 v20, s45, v20
  v_lshlrev_b32 v33, 7, v224
  v_and_b32 v36, 2, v224
  v_xor_b32 v36, v36, v226
  v_lshl_add_u32 v34, v36, 5, v33
  v_mul_u32_u24 v35, 1040, v225
  v_add_u32 v21, v34, v35
  s_cmp_eq_u32 s7, 0
  s_cbranch_scc1 mk_f_p_4
  v_mul_u32_u24 v35, 3120, v225
  v_add_u32 v35, 2080, v35
  v_add_u32 v21, v34, v35
  s_cmp_eq_u32 s7, 1
  s_cbranch_scc1 mk_f_p_4
  v_lshrrev_b32 v34, 1, v36
  v_lshl_add_u32 v33, v34, 6, v33
  v_and_b32 v34, 1, v226
  v_lshl_add_u32 v33, v34, 4, v33
  v_add_u32 v21, v33, v35
mk_f_p_4:
  v_add_u32 v22, 19456, v2
  v_xor_b32 v33, 128, v22
  v_add_u32 v34, 8, v22
  v_mov_b32 v35, 20480
  v_cmp_eq_u32 vcc, 0, v225
  s_nop 1
  v_cndmask_b32 v24, v35, v22, vcc
  v_cndmask_b32 v25, v35, v33, vcc
  v_cndmask_b32 v26, v35, v34, vcc
  v_cndmask_b32 v27, v33, v35, vcc
  v_cndmask_b32 v28, v22, v35, vcc
  v_cndmask_b32 v29, v34, v35, vcc
  v_mov_b32 v33, 0xeeee
  v_mov_b32 v34, 0x4444
  v_cndmask_b32 v30, v33, v34, vcc
  s_mov_b64 s[54:55], vcc
  v_and_b32 v35, 1, v1
  v_cmp_eq_u32 vcc, 0, v35
  s_nop 1
  v_cndmask_b32 v23, v33, v34, vcc
  v_and_b32 v33, 1, v224
  v_lshlrev_b32 v33, 4, v33
  v_mov_b32 v34, 0x3f80
  v_lshlrev_b32 v34, v33, v34
  v_lshrrev_b32 v33, 1, v224
  v_cmp_eq_u32 vcc, 0, v33
  v_mov_b32 v44, 0x3f803f80
  v_mov_b32 v52, -1
  v_cndmask_b32 v40, 0, v34, vcc
  v_cmp_eq_u32 vcc, 1, v33
  v_mov_b32 v45, 0x3f803f80
  v_mov_b32 v53, -1
  v_cndmask_b32 v41, 0, v34, vcc
  v_cmp_eq_u32 vcc, 2, v33
  v_mov_b32 v46, 0x3f803f80
  v_mov_b32 v54, -1
  v_cndmask_b32 v42, 0, v34, vcc
  v_cmp_eq_u32 vcc, 3, v33
  v_mov_b32 v47, 0x3f803f80
  v_mov_b32 v55, -1
  v_cndmask_b32 v43, 0, v34, vcc
  v_cmp_gt_u32 vcc, 2, v226
  v_mov_b32 v50, 0
  v_mov_b32 v51, 0
  v_cndmask_b32 v48, 0, v44, vcc
  v_cndmask_b32 v49, 0, v44, vcc
  v_mov_b32 v206, 0
  v_mov_b32 v207, 0
  v_mov_b32 v214, 0
  v_mov_b32 v215, 0
  v_mov_b32 v170, 0
  v_mov_b32 v171, 0
  v_mov_b32 v174, 0
  v_mov_b32 v175, 0
  v_mov_b32 v178, 0
  v_mov_b32 v179, 0
  v_mov_b32 v182, 0
  v_mov_b32 v183, 0
  s_mov_b32 s35, 0x3e0293ee
  s_mov_b32 s33, 4194304
  v_lshlrev_b32 v36, 11, v224
  v_and_b32 v33, 1, v226
  v_lshl_add_u32 v36, v33, 3, v36
  v_lshl_add_u32 v36, v225, 2, v36
  s_lshl_b32 s37, s42, 4
  v_add_u32 v36, s37, v36
  v_and_b32 v37, 0x28, v1
  s_waitcnt vmcnt(24)
  ds_read_b64_tr_b16 a[0:1], v97 offset:0
  ds_read_b64_tr_b16 a[2:3], v97 offset:512
  ds_read_b64_tr_b16 a[4:5], v97 offset:4096
  ds_read_b64_tr_b16 a[6:7], v97 offset:4608
  s_waitcnt lgkmcnt(8)
  ds_read_b64_tr_b16 a[8:9], v97 offset:32
  ds_read_b64_tr_b16 a[10:11], v97 offset:544
  ds_read_b64_tr_b16 a[12:13], v97 offset:4128
  ds_read_b64_tr_b16 a[14:15], v97 offset:4640
  s_waitcnt lgkmcnt(8)
  s_waitcnt lgkmcnt(0)
  s_mov_b32 s12, s66
  s_mov_b32 s13, s67
  s_add_u32 m0, s36, 0
  s_mov_b32 s39, 0
  buffer_load_dwordx4 v98, s[12:15], s39 offen lds
  s_add_u32 m0, s36, 1024
  s_mov_b32 s39, 16384
  buffer_load_dwordx4 v98, s[12:15], s39 offen lds
  s_add_u32 m0, s36, 2048
  s_mov_b32 s39, 32768
  buffer_load_dwordx4 v98, s[12:15], s39 offen lds
  s_add_u32 m0, s36, 3072
  s_mov_b32 s39, 49152
  buffer_load_dwordx4 v98, s[12:15], s39 offen lds
  s_add_u32 m0, s36, 4096
  s_mov_b32 s39, 65536
  buffer_load_dwordx4 v98, s[12:15], s39 offen lds
  s_add_u32 m0, s36, 5120
  s_mov_b32 s39, 81920
  buffer_load_dwordx4 v98, s[12:15], s39 offen lds
  s_add_u32 m0, s36, 6144
  s_mov_b32 s39, 98304
  buffer_load_dwordx4 v98, s[12:15], s39 offen lds
  s_add_u32 m0, s36, 7168
  s_mov_b32 s39, 114688
  buffer_load_dwordx4 v98, s[12:15], s39 offen lds
  s_waitcnt vmcnt(24)
  ds_read_b64_tr_b16 a[16:17], v97 offset:8192
  ds_read_b64_tr_b16 a[18:19], v97 offset:8704
  ds_read_b64_tr_b16 a[20:21], v97 offset:12288
  ds_read_b64_tr_b16 a[22:23], v97 offset:12800
  s_waitcnt lgkmcnt(8)
  ds_read_b64_tr_b16 a[24:25], v97 offset:8224
  ds_read_b64_tr_b16 a[26:27], v97 offset:8736
  ds_read_b64_tr_b16 a[28:29], v97 offset:12320
  ds_read_b64_tr_b16 a[30:31], v97 offset:12832
  s_waitcnt lgkmcnt(8)
  s_waitcnt lgkmcnt(0)
  s_mov_b32 s12, s66
  s_mov_b32 s13, s67
  s_add_u32 m0, s36, 8192
  s_mov_b32 s39, 131072
  buffer_load_dwordx4 v98, s[12:15], s39 offen lds
  s_add_u32 m0, s36, 9216
  s_mov_b32 s39, 147456
  buffer_load_dwordx4 v98, s[12:15], s39 offen lds
  s_add_u32 m0, s36, 10240
  s_mov_b32 s39, 163840
  buffer_load_dwordx4 v98, s[12:15], s39 offen lds
  s_add_u32 m0, s36, 11264
  s_mov_b32 s39, 180224
  buffer_load_dwordx4 v98, s[12:15], s39 offen lds
  s_add_u32 m0, s36, 12288
  s_mov_b32 s39, 196608
  buffer_load_dwordx4 v98, s[12:15], s39 offen lds
  s_add_u32 m0, s36, 13312
  s_mov_b32 s39, 212992
  buffer_load_dwordx4 v98, s[12:15], s39 offen lds
  s_add_u32 m0, s36, 14336
  s_mov_b32 s39, 229376
  buffer_load_dwordx4 v98, s[12:15], s39 offen lds
  s_add_u32 m0, s36, 15360
  s_mov_b32 s39, 245760
  buffer_load_dwordx4 v98, s[12:15], s39 offen lds
  s_waitcnt vmcnt(24)
  ds_read_b64_tr_b16 a[32:33], v97 offset:16384
  ds_read_b64_tr_b16 a[34:35], v97 offset:16896
  ds_read_b64_tr_b16 a[36:37], v97 offset:20480
  ds_read_b64_tr_b16 a[38:39], v97 offset:20992
  s_waitcnt lgkmcnt(8)
  ds_read_b64_tr_b16 a[40:41], v97 offset:16416
  ds_read_b64_tr_b16 a[42:43], v97 offset:16928
  ds_read_b64_tr_b16 a[44:45], v97 offset:20512
  ds_read_b64_tr_b16 a[46:47], v97 offset:21024
  s_waitcnt lgkmcnt(8)
  s_waitcnt lgkmcnt(0)
  s_mov_b32 s12, s62
  s_mov_b32 s13, s63
  s_add_u32 m0, s36, 16384
  s_mov_b32 s39, 0
  buffer_load_dwordx4 v96, s[12:15], s39 offen lds
  s_add_u32 m0, s36, 17408
  s_mov_b32 s39, 65536
  buffer_load_dwordx4 v96, s[12:15], s39 offen lds
  s_add_u32 m0, s36, 18432
  s_mov_b32 s39, 131072
  buffer_load_dwordx4 v96, s[12:15], s39 offen lds
  s_add_u32 m0, s36, 19456
  s_mov_b32 s39, 196608
  buffer_load_dwordx4 v96, s[12:15], s39 offen lds
  s_add_u32 m0, s36, 20480
  s_mov_b32 s39, 262144
  buffer_load_dwordx4 v96, s[12:15], s39 offen lds
  s_add_u32 m0, s36, 21504
  s_mov_b32 s39, 327680
  buffer_load_dwordx4 v96, s[12:15], s39 offen lds
  s_add_u32 m0, s36, 22528
  s_mov_b32 s39, 393216
  buffer_load_dwordx4 v96, s[12:15], s39 offen lds
  s_add_u32 m0, s36, 23552
  s_mov_b32 s39, 458752
  buffer_load_dwordx4 v96, s[12:15], s39 offen lds
  s_waitcnt vmcnt(24)
  ds_read_b64_tr_b16 a[48:49], v97 offset:24576
  ds_read_b64_tr_b16 a[50:51], v97 offset:25088
  ds_read_b64_tr_b16 a[52:53], v97 offset:28672
  ds_read_b64_tr_b16 a[54:55], v97 offset:29184
  s_waitcnt lgkmcnt(8)
  ds_read_b64_tr_b16 a[56:57], v97 offset:24608
  ds_read_b64_tr_b16 a[58:59], v97 offset:25120
  ds_read_b64_tr_b16 a[60:61], v97 offset:28704
  ds_read_b64_tr_b16 a[62:63], v97 offset:29216
  s_waitcnt lgkmcnt(8)
  s_waitcnt lgkmcnt(0)
  s_mov_b32 s12, s62
  s_mov_b32 s13, s63
  s_add_u32 m0, s36, 24576
  s_mov_b32 s39, 524288
  buffer_load_dwordx4 v96, s[12:15], s39 offen lds
  s_add_u32 m0, s36, 25600
  s_mov_b32 s39, 589824
  buffer_load_dwordx4 v96, s[12:15], s39 offen lds
  s_add_u32 m0, s36, 26624
  s_mov_b32 s39, 655360
  buffer_load_dwordx4 v96, s[12:15], s39 offen lds
  s_add_u32 m0, s36, 27648
  s_mov_b32 s39, 720896
  buffer_load_dwordx4 v96, s[12:15], s39 offen lds
  s_add_u32 m0, s36, 28672
  s_mov_b32 s39, 786432
  buffer_load_dwordx4 v96, s[12:15], s39 offen lds
  s_add_u32 m0, s36, 29696
  s_mov_b32 s39, 851968
  buffer_load_dwordx4 v96, s[12:15], s39 offen lds
  s_add_u32 m0, s36, 30720
  s_mov_b32 s39, 917504
  buffer_load_dwordx4 v96, s[12:15], s39 offen lds
  s_add_u32 m0, s36, 31744
  s_mov_b32 s39, 983040
  buffer_load_dwordx4 v96, s[12:15], s39 offen lds
  s_waitcnt vmcnt(24)
  ds_read_b64_tr_b16 a[192:193], v99 offset:0
  ds_read_b64_tr_b16 a[194:195], v99 offset:512
  ds_read_b64_tr_b16 a[196:197], v99 offset:4096
  ds_read_b64_tr_b16 a[198:199], v99 offset:4608
  s_waitcnt lgkmcnt(8)
  ds_read_b64_tr_b16 a[200:201], v99 offset:8
  ds_read_b64_tr_b16 a[202:203], v99 offset:520
  ds_read_b64_tr_b16 a[204:205], v99 offset:4104
  ds_read_b64_tr_b16 a[206:207], v99 offset:4616
  s_waitcnt lgkmcnt(8)
  ds_read_b64_tr_b16 a[208:209], v99 offset:16
  ds_read_b64_tr_b16 a[210:211], v99 offset:528
  ds_read_b64_tr_b16 a[212:213], v99 offset:4112
  ds_read_b64_tr_b16 a[214:215], v99 offset:4624
  s_waitcnt lgkmcnt(8)
  ds_read_b64_tr_b16 a[216:217], v99 offset:24
  ds_read_b64_tr_b16 a[218:219], v99 offset:536
  ds_read_b64_tr_b16 a[220:221], v99 offset:4120
  ds_read_b64_tr_b16 a[222:223], v99 offset:4632
  s_waitcnt lgkmcnt(8)
  s_waitcnt lgkmcnt(0)
  s_mov_b32 s12, s62
  s_mov_b32 s13, s63
  s_add_u32 m0, s36, 0
  s_mov_b32 s39, 1048576
  buffer_load_dwordx4 v96, s[12:15], s39 offen lds
  s_add_u32 m0, s36, 1024
  s_mov_b32 s39, 1114112
  buffer_load_dwordx4 v96, s[12:15], s39 offen lds
  s_add_u32 m0, s36, 2048
  s_mov_b32 s39, 1179648
  buffer_load_dwordx4 v96, s[12:15], s39 offen lds
  s_add_u32 m0, s36, 3072
  s_mov_b32 s39, 1245184
  buffer_load_dwordx4 v96, s[12:15], s39 offen lds
  s_add_u32 m0, s36, 4096
  s_mov_b32 s39, 1310720
  buffer_load_dwordx4 v96, s[12:15], s39 offen lds
  s_add_u32 m0, s36, 5120
  s_mov_b32 s39, 1376256
  buffer_load_dwordx4 v96, s[12:15], s39 offen lds
  s_add_u32 m0, s36, 6144
  s_mov_b32 s39, 1441792
  buffer_load_dwordx4 v96, s[12:15], s39 offen lds
  s_add_u32 m0, s36, 7168
  s_mov_b32 s39, 1507328
  buffer_load_dwordx4 v96, s[12:15], s39 offen lds
  s_waitcnt vmcnt(24)
  ds_read_b64_tr_b16 a[224:225], v99 offset:8192
  ds_read_b64_tr_b16 a[226:227], v99 offset:8704
  ds_read_b64_tr_b16 a[228:229], v99 offset:12288
  ds_read_b64_tr_b16 a[230:231], v99 offset:12800
  s_waitcnt lgkmcnt(8)
  ds_read_b64_tr_b16 a[232:233], v99 offset:8200
  ds_read_b64_tr_b16 a[234:235], v99 offset:8712
  ds_read_b64_tr_b16 a[236:237], v99 offset:12296
  ds_read_b64_tr_b16 a[238:239], v99 offset:12808
  s_waitcnt lgkmcnt(8)
  ds_read_b64_tr_b16 a[240:241], v99 offset:8208
  ds_read_b64_tr_b16 a[242:243], v99 offset:8720
  ds_read_b64_tr_b16 a[244:245], v99 offset:12304
  ds_read_b64_tr_b16 a[246:247], v99 offset:12816
  s_waitcnt lgkmcnt(8)
  ds_read_b64_tr_b16 a[248:249], v99 offset:8216
  ds_read_b64_tr_b16 a[250:251], v99 offset:8728
  ds_read_b64_tr_b16 a[252:253], v99 offset:12312
  ds_read_b64_tr_b16 a[254:255], v99 offset:12824
  s_waitcnt lgkmcnt(8)
  s_waitcnt lgkmcnt(0)
  s_mov_b32 s12, s62
  s_mov_b32 s13, s63
  s_add_u32 m0, s36, 8192
  s_mov_b32 s39, 1572864
  buffer_load_dwordx4 v96, s[12:15], s39 offen lds
  s_add_u32 m0, s36, 9216
  s_mov_b32 s39, 1638400
  buffer_load_dwordx4 v96, s[12:15], s39 offen lds
  s_add_u32 m0, s36, 10240
  s_mov_b32 s39, 1703936
  buffer_load_dwordx4 v96, s[12:15], s39 offen lds
  s_add_u32 m0, s36, 11264
  s_mov_b32 s39, 1769472
  buffer_load_dwordx4 v96, s[12:15], s39 offen lds
  s_add_u32 m0, s36, 12288
  s_mov_b32 s39, 1835008
  buffer_load_dwordx4 v96, s[12:15], s39 offen lds
  s_add_u32 m0, s36, 13312
  s_mov_b32 s39, 1900544
  buffer_load_dwordx4 v96, s[12:15], s39 offen lds
  s_add_u32 m0, s36, 14336
  s_mov_b32 s39, 1966080
  buffer_load_dwordx4 v96, s[12:15], s39 offen lds
  s_add_u32 m0, s36, 15360
  s_mov_b32 s39, 2031616
  buffer_load_dwordx4 v96, s[12:15], s39 offen lds
  s_waitcnt vmcnt(24)
  ds_read_b64_tr_b16 a[64:65], v97 offset:16384
  ds_read_b64_tr_b16 a[66:67], v97 offset:16896
  ds_read_b64_tr_b16 a[68:69], v97 offset:20480
  ds_read_b64_tr_b16 a[70:71], v97 offset:20992
  s_waitcnt lgkmcnt(8)
  ds_read_b64_tr_b16 a[72:73], v97 offset:16416
  ds_read_b64_tr_b16 a[74:75], v97 offset:16928
  ds_read_b64_tr_b16 a[76:77], v97 offset:20512
  ds_read_b64_tr_b16 a[78:79], v97 offset:21024
  s_waitcnt lgkmcnt(8)
  s_waitcnt lgkmcnt(0)
  s_mov_b32 s12, s64
  s_mov_b32 s13, s65
  s_add_u32 m0, s36, 16384
  s_mov_b32 s39, 0
  buffer_load_dwordx4 v96, s[12:15], s39 offen lds
  s_add_u32 m0, s36, 17408
  s_mov_b32 s39, 65536
  buffer_load_dwordx4 v96, s[12:15], s39 offen lds
  s_add_u32 m0, s36, 18432
  s_mov_b32 s39, 131072
  buffer_load_dwordx4 v96, s[12:15], s39 offen lds
  s_add_u32 m0, s36, 19456
  s_mov_b32 s39, 196608
  buffer_load_dwordx4 v96, s[12:15], s39 offen lds
  s_add_u32 m0, s36, 20480
  s_mov_b32 s39, 262144
  buffer_load_dwordx4 v96, s[12:15], s39 offen lds
  s_add_u32 m0, s36, 21504
  s_mov_b32 s39, 327680
  buffer_load_dwordx4 v96, s[12:15], s39 offen lds
  s_add_u32 m0, s36, 22528
  s_mov_b32 s39, 393216
  buffer_load_dwordx4 v96, s[12:15], s39 offen lds
  s_add_u32 m0, s36, 23552
  s_mov_b32 s39, 458752
  buffer_load_dwordx4 v96, s[12:15], s39 offen lds
  s_waitcnt vmcnt(24)
  ds_read_b64_tr_b16 a[80:81], v97 offset:24576
  ds_read_b64_tr_b16 a[82:83], v97 offset:25088
  ds_read_b64_tr_b16 a[84:85], v97 offset:28672
  ds_read_b64_tr_b16 a[86:87], v97 offset:29184
  s_waitcnt lgkmcnt(8)
  ds_read_b64_tr_b16 a[88:89], v97 offset:24608
  ds_read_b64_tr_b16 a[90:91], v97 offset:25120
  ds_read_b64_tr_b16 a[92:93], v97 offset:28704
  ds_read_b64_tr_b16 a[94:95], v97 offset:29216
  s_waitcnt lgkmcnt(8)
  s_waitcnt lgkmcnt(0)
  s_mov_b32 s12, s64
  s_mov_b32 s13, s65
  s_add_u32 m0, s36, 24576
  s_mov_b32 s39, 524288
  buffer_load_dwordx4 v96, s[12:15], s39 offen lds
  s_add_u32 m0, s36, 25600
  s_mov_b32 s39, 589824
  buffer_load_dwordx4 v96, s[12:15], s39 offen lds
  s_add_u32 m0, s36, 26624
  s_mov_b32 s39, 655360
  buffer_load_dwordx4 v96, s[12:15], s39 offen lds
  s_add_u32 m0, s36, 27648
  s_mov_b32 s39, 720896
  buffer_load_dwordx4 v96, s[12:15], s39 offen lds
  s_add_u32 m0, s36, 28672
  s_mov_b32 s39, 786432
  buffer_load_dwordx4 v96, s[12:15], s39 offen lds
  s_add_u32 m0, s36, 29696
  s_mov_b32 s39, 851968
  buffer_load_dwordx4 v96, s[12:15], s39 offen lds
  s_add_u32 m0, s36, 30720
  s_mov_b32 s39, 917504
  buffer_load_dwordx4 v96, s[12:15], s39 offen lds
  s_add_u32 m0, s36, 31744
  s_mov_b32 s39, 983040
  buffer_load_dwordx4 v96, s[12:15], s39 offen lds
  s_waitcnt vmcnt(24)
  ds_read_b64_tr_b16 a[96:97], v97 offset:0
  ds_read_b64_tr_b16 a[98:99], v97 offset:512
  ds_read_b64_tr_b16 a[100:101], v97 offset:4096
  ds_read_b64_tr_b16 a[102:103], v97 offset:4608
  s_waitcnt lgkmcnt(8)
  ds_read_b64_tr_b16 a[104:105], v97 offset:32
  ds_read_b64_tr_b16 a[106:107], v97 offset:544
  ds_read_b64_tr_b16 a[108:109], v97 offset:4128
  ds_read_b64_tr_b16 a[110:111], v97 offset:4640
  s_waitcnt lgkmcnt(8)
  s_waitcnt lgkmcnt(0)
  s_mov_b32 s12, s64
  s_mov_b32 s13, s65
  s_add_u32 m0, s36, 0
  s_mov_b32 s39, 1048576
  buffer_load_dwordx4 v96, s[12:15], s39 offen lds
  s_add_u32 m0, s36, 1024
  s_mov_b32 s39, 1114112
  buffer_load_dwordx4 v96, s[12:15], s39 offen lds
  s_add_u32 m0, s36, 2048
  s_mov_b32 s39, 1179648
  buffer_load_dwordx4 v96, s[12:15], s39 offen lds
  s_add_u32 m0, s36, 3072
  s_mov_b32 s39, 1245184
  buffer_load_dwordx4 v96, s[12:15], s39 offen lds
  s_add_u32 m0, s36, 4096
  s_mov_b32 s39, 1310720
  buffer_load_dwordx4 v96, s[12:15], s39 offen lds
  s_add_u32 m0, s36, 5120
  s_mov_b32 s39, 1376256
  buffer_load_dwordx4 v96, s[12:15], s39 offen lds
  s_add_u32 m0, s36, 6144
  s_mov_b32 s39, 1441792
  buffer_load_dwordx4 v96, s[12:15], s39 offen lds
  s_add_u32 m0, s36, 7168
  s_mov_b32 s39, 1507328
  buffer_load_dwordx4 v96, s[12:15], s39 offen lds
  s_waitcnt vmcnt(24)
  ds_read_b64_tr_b16 a[112:113], v97 offset:8192
  ds_read_b64_tr_b16 a[114:115], v97 offset:8704
  ds_read_b64_tr_b16 a[116:117], v97 offset:12288
  ds_read_b64_tr_b16 a[118:119], v97 offset:12800
  s_waitcnt lgkmcnt(8)
  ds_read_b64_tr_b16 a[120:121], v97 offset:8224
  ds_read_b64_tr_b16 a[122:123], v97 offset:8736
  ds_read_b64_tr_b16 a[124:125], v97 offset:12320
  ds_read_b64_tr_b16 a[126:127], v97 offset:12832
  s_waitcnt lgkmcnt(8)
  s_waitcnt lgkmcnt(0)
  s_mov_b32 s12, s64
  s_mov_b32 s13, s65
  s_add_u32 m0, s36, 8192
  s_mov_b32 s39, 1572864
  buffer_load_dwordx4 v96, s[12:15], s39 offen lds
  s_add_u32 m0, s36, 9216
  s_mov_b32 s39, 1638400
  buffer_load_dwordx4 v96, s[12:15], s39 offen lds
  s_add_u32 m0, s36, 10240
  s_mov_b32 s39, 1703936
  buffer_load_dwordx4 v96, s[12:15], s39 offen lds
  s_add_u32 m0, s36, 11264
  s_mov_b32 s39, 1769472
  buffer_load_dwordx4 v96, s[12:15], s39 offen lds
  s_add_u32 m0, s36, 12288
  s_mov_b32 s39, 1835008
  buffer_load_dwordx4 v96, s[12:15], s39 offen lds
  s_add_u32 m0, s36, 13312
  s_mov_b32 s39, 1900544
  buffer_load_dwordx4 v96, s[12:15], s39 offen lds
  s_add_u32 m0, s36, 14336
  s_mov_b32 s39, 1966080
  buffer_load_dwordx4 v96, s[12:15], s39 offen lds
  s_add_u32 m0, s36, 15360
  s_mov_b32 s39, 2031616
  buffer_load_dwordx4 v96, s[12:15], s39 offen lds
  s_waitcnt vmcnt(24)
  ds_read_b64_tr_b16 a[128:129], v97 offset:16384
  ds_read_b64_tr_b16 a[130:131], v97 offset:16896
  ds_read_b64_tr_b16 a[132:133], v97 offset:20480
  ds_read_b64_tr_b16 a[134:135], v97 offset:20992
  s_waitcnt lgkmcnt(8)
  ds_read_b64_tr_b16 a[136:137], v97 offset:16416
  ds_read_b64_tr_b16 a[138:139], v97 offset:16928
  ds_read_b64_tr_b16 a[140:141], v97 offset:20512
  ds_read_b64_tr_b16 a[142:143], v97 offset:21024
  s_waitcnt lgkmcnt(8)
  s_waitcnt lgkmcnt(0)
  s_waitcnt vmcnt(16)
  ds_read_b64_tr_b16 a[144:145], v97 offset:24576
  ds_read_b64_tr_b16 a[146:147], v97 offset:25088
  ds_read_b64_tr_b16 a[148:149], v97 offset:28672
  ds_read_b64_tr_b16 a[150:151], v97 offset:29184
  s_waitcnt lgkmcnt(8)
  ds_read_b64_tr_b16 a[152:153], v97 offset:24608
  ds_read_b64_tr_b16 a[154:155], v97 offset:25120
  ds_read_b64_tr_b16 a[156:157], v97 offset:28704
  ds_read_b64_tr_b16 a[158:159], v97 offset:29216
  s_waitcnt lgkmcnt(8)
  s_waitcnt lgkmcnt(0)
  s_waitcnt vmcnt(8)
  ds_read_b64_tr_b16 a[160:161], v97 offset:0
  ds_read_b64_tr_b16 a[162:163], v97 offset:512
  ds_read_b64_tr_b16 a[164:165], v97 offset:4096
  ds_read_b64_tr_b16 a[166:167], v97 offset:4608
  s_waitcnt lgkmcnt(8)
  ds_read_b64_tr_b16 a[168:169], v97 offset:32
  ds_read_b64_tr_b16 a[170:171], v97 offset:544
  ds_read_b64_tr_b16 a[172:173], v97 offset:4128
  ds_read_b64_tr_b16 a[174:175], v97 offset:4640
  s_waitcnt lgkmcnt(8)
  s_waitcnt lgkmcnt(0)
  s_waitcnt vmcnt(0)
  ds_read_b64_tr_b16 a[176:177], v97 offset:8192
  ds_read_b64_tr_b16 a[178:179], v97 offset:8704
  ds_read_b64_tr_b16 a[180:181], v97 offset:12288
  ds_read_b64_tr_b16 a[182:183], v97 offset:12800
  s_waitcnt lgkmcnt(8)
  ds_read_b64_tr_b16 a[184:185], v97 offset:8224
  ds_read_b64_tr_b16 a[186:187], v97 offset:8736
  ds_read_b64_tr_b16 a[188:189], v97 offset:12320
  ds_read_b64_tr_b16 a[190:191], v97 offset:12832
  s_waitcnt lgkmcnt(8)
  s_waitcnt lgkmcnt(0)
  s_cmp_eq_u32 s97, 0
  s_cbranch_scc0 mk_v_8
  s_mov_b32 s98, 4194304
  s_load_dwordx2 s[56:57], s[0:1], 88
  s_mov_b32 s58, 256
  s_mov_b32 s59, 0x20000
  v_lshlrev_b32 v60, 2, v1
  s_waitcnt lgkmcnt(0)
mk_v_6:
  buffer_load_dword v56, v60, s[56:59], 0 offen sc1
  s_waitcnt vmcnt(0)
  v_subrev_u32 v57, 0x01010101, v56
  v_and_b32 v57, 0x80808080, v57
  v_cmp_ne_u32 vcc, 0, v57
  s_cbranch_vccz mk_v_7
  s_sub_u32 s98, s98, 1
  s_cbranch_scc1 mk_end
  s_sleep 4
  s_branch mk_v_6
mk_v_7:
  v_bfe_u32 v57, v56, 0, 4
  v_lshlrev_b32 v57, v57, 1
  v_mov_b32 v59, v57
  v_bfe_u32 v58, v56, 8, 4
  v_lshlrev_b32 v58, v58, 1
  v_or_b32 v59, v59, v58
  v_bfe_u32 v57, v56, 16, 4
  v_lshlrev_b32 v57, v57, 1
  v_or_b32 v59, v59, v57
  v_bfe_u32 v58, v56, 24, 4
  v_lshlrev_b32 v58, v58, 1
  v_or_b32 v59, v59, v58
  s_nop 1
  v_or_b32_dpp v59, v59, v59 quad_perm:[1,0,3,2] row_mask:0xf bank_mask:0xf
  v_cmp_ne_u32 vcc, 0x1fe, v59
  s_cbranch_vccz mk_v_9
  s_mov_b32 s97, 1
  s_mov_b32 s4, 0
  s_and_b32 s2, s96, 7
  s_lshr_b32 s3, s96, 3
  s_lshl_b32 s98, s7, 6
  v_add_u32 v0, s98, v1
  s_waitcnt vmcnt(0) lgkmcnt(0)
  s_barrier
  s_branch mk_start
mk_v_9:
  v_and_b32 v57, 0x20202020, v56
  v_cmp_ne_u32 vcc, 0, v57
  s_sub_u32 s98, s98, 1
  s_cbranch_scc1 mk_end
  s_cbranch_vccz mk_v_6
  v_and_b32 v57, 0x10101010, v56
  v_cmp_ne_u32 vcc, 0, v57
  s_cmp_lg_u64 vcc, 0
  s_cselect_b32 s4, 1, 0
mk_v_8:
  s_cmp_eq_u32 s7, 2
  s_cbranch_scc0 mk_f_p_10
  v_lshrrev_b32 v33, 4, v1
  v_lshlrev_b32 v33, 10, v33
  v_and_b32 v34, 15, v1
  v_lshl_add_u32 v12, v34, 4, v33
  s_lshl_b32 s37, s3, 12
  s_lshl_b32 s38, s2, 8
  s_add_u32 s37, s37, s38
  v_add_u32 v12, s37, v12
  v_lshrrev_b32 v34, 13, v12
  v_lshlrev_b32 v34, 14, v34
  v_and_b32 v12, 8191, v12
  v_add_u32 v12, v12, v34
  s_lshl_b32 s43, s4, 13
  s_add_u32 s43, s43, 0
  v_add_u32 v12, s43, v12
  s_lshl_b32 s37, s3, 9
  s_add_u32 s37, s37, s40
  v_add_u32 v13, s37, v2
  v_cmp_gt_u32 vcc, 32, v1
  s_nop 1
  v_cndmask_b32 v13, v0, v13, vcc
mk_f_p_10:
  v_lshrrev_b32 v34, 13, v7
  v_lshlrev_b32 v34, 14, v34
  v_and_b32 v7, 8191, v7
  v_add_u32 v7, v7, v34
  s_lshl_b32 s43, s4, 13
  s_add_u32 s43, s43, 0
  v_add_u32 v7, s43, v7
  v_lshrrev_b32 v34, 13, v8
  v_lshlrev_b32 v34, 14, v34
  v_and_b32 v8, 8191, v8
  v_add_u32 v8, v8, v34
  s_lshl_b32 s43, s4, 13
  s_add_u32 s43, s43, 0
  v_add_u32 v8, s43, v8
  v_cmp_eq_u32 vcc, 0, v37
  s_nop 1
  v_cndmask_b32 v8, v0, v8, vcc
  s_load_dwordx2 s[12:13], s[0:1], 8
  s_mov_b32 s14, 16384
  s_waitcnt lgkmcnt(0)
  buffer_load_dword v216, v36, s[12:15], 0 offen
  s_barrier
  v_mov_b32 v33, 0
  v_mov_b32 v34, 20480
  ds_write_b32 v34, v33
  ds_write_b32 v34, v33 offset:4
  s_mov_b32 s16, 0
  s_mov_b32 s17, 16384
  s_mov_b32 s18, 32768
  s_mov_b32 s19, 0
  s_mov_b32 s20, 262144
  s_mov_b32 s21, 524288
  s_mov_b32 s23, 0
  s_mov_b32 s24, 131072
  s_mov_b32 s25, 262144
  s_mov_b32 s26, 0
  s_mov_b32 s27, 262144
  s_mov_b32 s28, 524288
  s_mov_b32 s32, 0
  s_mov_b32 s34, 0
  s_waitcnt vmcnt(0)
  buffer_store_dword v216, v4, s[8:11], 0 offen
  s_lshl_b32 s52, s5, 7
  s_lshl_b32 s36, s6, 2
  s_add_u32 s52, s52, s36
  s_add_u32 s52, s52, 5705728
  s_lshl_b32 s53, s5, 3
  s_add_u32 s53, s53, 5701632
  v_mov_b32 v34, 0
mk_f_p_11:
  buffer_load_dwordx2 v[38:39], v34, s[8:11], s53 offen sc1
  s_waitcnt vmcnt(0)
  v_max_u32 v33, v38, v39
  v_cmp_eq_u32 vcc, -1, v33
  s_cbranch_vccz mk_f_p_12
  s_sub_u32 s33, s33, 1
  s_cbranch_scc1 mk_end
  s_sleep 2
  s_branch mk_f_p_11
mk_f_p_12:
  s_lshl_b32 s48, s7, 11
  s_mul_i32 s51, s7, 10240
  s_add_u32 s51, s51, 21504
  s_cmp_gt_u32 s7, 1
  s_cbranch_scc1 mk_f_p_13
  s_add_u32 m0, s51, 0
  s_add_u32 s36, s48, 0
  buffer_load_dwordx4 v32, s[8:11], s36 offen sc1 lds
  s_add_u32 m0, s51, 1024
  s_add_u32 s36, s48, 131072
  buffer_load_dwordx4 v32, s[8:11], s36 offen sc1 lds
  s_add_u32 m0, s51, 2048
  s_add_u32 s36, s48, 262144
  buffer_load_dwordx4 v32, s[8:11], s36 offen sc1 lds
  s_add_u32 m0, s51, 3072
  s_add_u32 s36, s48, 393216
  buffer_load_dwordx4 v32, s[8:11], s36 offen sc1 lds
  s_add_u32 m0, s51, 8192
  s_add_u32 s36, s48, 0
  buffer_load_dwordx4 v31, s[8:11], s36 offen sc1 lds
  s_add_u32 m0, s51, 4096
  s_add_u32 s36, s48, 1024
  buffer_load_dwordx4 v32, s[8:11], s36 offen sc1 lds
  s_add_u32 m0, s51, 5120
  s_add_u32 s36, s48, 132096
  buffer_load_dwordx4 v32, s[8:11], s36 offen sc1 lds
  s_add_u32 m0, s51, 6144
  s_add_u32 s36, s48, 263168
  buffer_load_dwordx4 v32, s[8:11], s36 offen sc1 lds
  s_add_u32 m0, s51, 7168
  s_add_u32 s36, s48, 394240
  buffer_load_dwordx4 v32, s[8:11], s36 offen sc1 lds
  s_add_u32 m0, s51, 9216
  s_add_u32 s36, s48, 1024
  buffer_load_dwordx4 v31, s[8:11], s36 offen sc1 lds
mk_f_p_13:
  s_mov_b32 s51, 21504
  s_waitcnt vmcnt(0) lgkmcnt(0)
  s_barrier
  v_add_u32 v36, s51, v2
  ds_read_b128 v[224:227], v36 offset:0
  ds_read_b128 v[228:231], v36 offset:1024
  ds_read_b128 v[232:235], v36 offset:2048
  ds_read_b128 v[236:239], v36 offset:3072
  ds_read_b128 v[240:243], v36 offset:4096
  ds_read_b128 v[244:247], v36 offset:5120
  ds_read_b128 v[248:251], v36 offset:6144
  ds_read_b128 v[252:255], v36 offset:7168
  ds_read_b128 v[132:135], v36 offset:8192
  ds_read_b128 v[136:139], v36 offset:9216
  s_waitcnt lgkmcnt(0)
  v_mfma_f32_16x16x32_bf16 v[96:99], v[224:227], a[192:195], 0
  v_mfma_f32_16x16x32_bf16 v[96:99], v[228:231], a[196:199], v[96:99]
  v_mfma_f32_16x16x32_bf16 v[96:99], v[232:235], a[224:227], v[96:99]
  v_mfma_f32_16x16x32_bf16 v[96:99], v[236:239], a[228:231], v[96:99]
  v_mfma_f32_16x16x32_bf16 v[100:103], v[240:243], a[192:195], 0
  v_mfma_f32_16x16x32_bf16 v[100:103], v[244:247], a[196:199], v[100:103]
  v_mfma_f32_16x16x32_bf16 v[100:103], v[248:251], a[224:227], v[100:103]
  v_mfma_f32_16x16x32_bf16 v[100:103], v[252:255], a[228:231], v[100:103]
  v_mfma_f32_16x16x32_bf16 v[104:107], v[224:227], a[200:203], 0
  v_mfma_f32_16x16x32_bf16 v[104:107], v[228:231], a[204:207], v[104:107]
  v_mfma_f32_16x16x32_bf16 v[104:107], v[232:235], a[232:235], v[104:107]
  v_mfma_f32_16x16x32_bf16 v[104:107], v[236:239], a[236:239], v[104:107]
  v_mfma_f32_16x16x32_bf16 v[108:111], v[240:243], a[200:203], 0
  v_mfma_f32_16x16x32_bf16 v[108:111], v[244:247], a[204:207], v[108:111]
  v_mfma_f32_16x16x32_bf16 v[108:111], v[248:251], a[232:235], v[108:111]
  v_mfma_f32_16x16x32_bf16 v[108:111], v[252:255], a[236:239], v[108:111]
  v_cvt_pk_bf16_f32 v184, v96, v97
  v_cvt_pk_bf16_f32 v185, v98, v99
  v_cvt_pk_bf16_f32 v186, v100, v101
  v_cvt_pk_bf16_f32 v187, v102, v103
  v_mfma_f32_16x16x32_bf16 v[112:115], v[224:227], a[208:211], 0
  v_mfma_f32_16x16x32_bf16 v[112:115], v[228:231], a[212:215], v[112:115]
  v_mfma_f32_16x16x32_bf16 v[112:115], v[232:235], a[240:243], v[112:115]
  v_mfma_f32_16x16x32_bf16 v[112:115], v[236:239], a[244:247], v[112:115]
  v_mfma_f32_16x16x32_bf16 v[116:119], v[240:243], a[208:211], 0
  v_mfma_f32_16x16x32_bf16 v[116:119], v[244:247], a[212:215], v[116:119]
  v_mfma_f32_16x16x32_bf16 v[116:119], v[248:251], a[240:243], v[116:119]
  v_mfma_f32_16x16x32_bf16 v[116:119], v[252:255], a[244:247], v[116:119]
  v_cvt_pk_bf16_f32 v188, v104, v105
  v_cvt_pk_bf16_f32 v189, v106, v107
  v_cvt_pk_bf16_f32 v190, v108, v109
  v_cvt_pk_bf16_f32 v191, v110, v111
  v_mfma_f32_16x16x32_bf16 v[120:123], v[224:227], a[216:219], 0
  v_mfma_f32_16x16x32_bf16 v[120:123], v[228:231], a[220:223], v[120:123]
  v_mfma_f32_16x16x32_bf16 v[120:123], v[232:235], a[248:251], v[120:123]
  v_mfma_f32_16x16x32_bf16 v[120:123], v[236:239], a[252:255], v[120:123]
  v_mfma_f32_16x16x32_bf16 v[124:127], v[240:243], a[216:219], 0
  v_mfma_f32_16x16x32_bf16 v[124:127], v[244:247], a[220:223], v[124:127]
  v_mfma_f32_16x16x32_bf16 v[124:127], v[248:251], a[248:251], v[124:127]
  v_mfma_f32_16x16x32_bf16 v[124:127], v[252:255], a[252:255], v[124:127]
  v_cvt_pk_bf16_f32 v192, v112, v113
  v_cvt_pk_bf16_f32 v193, v114, v115
  v_cvt_pk_bf16_f32 v194, v116, v117
  v_cvt_pk_bf16_f32 v195, v118, v119
  s_nop 7
  v_cvt_pk_bf16_f32 v196, v120, v121
  v_cvt_pk_bf16_f32 v197, v122, v123
  v_cvt_pk_bf16_f32 v198, v124, v125
  v_cvt_pk_bf16_f32 v199, v126, v127
  s_mov_b32 s48, 4096
  s_mov_b32 s51, 31744
  v_mov_b32 v72, 0
  v_mov_b32 v73, 0
  v_mov_b32 v74, 0
  v_mov_b32 v75, 0
  v_mov_b32 v76, 0
  v_mov_b32 v77, 0
  v_mov_b32 v78, 0
  v_mov_b32 v79, 0
  v_mov_b32 v80, 0
  v_mov_b32 v81, 0
  v_mov_b32 v82, 0
  v_mov_b32 v83, 0
  v_mov_b32 v84, 0
  v_mov_b32 v85, 0
  v_mov_b32 v86, 0
  v_mov_b32 v87, 0
  v_mov_b32 v88, 0
  v_mov_b32 v89, 0
  v_mov_b32 v90, 0
  v_mov_b32 v91, 0
  v_mov_b32 v92, 0
  v_mov_b32 v93, 0
  v_mov_b32 v94, 0
  v_mov_b32 v95, 0
  v_mov_b32 v152, 0
  v_mov_b32 v153, 0
  v_mov_b32 v154, 0
  v_mov_b32 v155, 0
  v_mov_b32 v156, 0
  v_mov_b32 v157, 0
  v_mov_b32 v158, 0
  v_mov_b32 v159, 0
  v_mov_b32 v160, 0
  v_mov_b32 v161, 0
  v_mov_b32 v162, 0
  v_mov_b32 v163, 0
  v_mov_b32 v164, 0
  v_mov_b32 v165, 0
  v_mov_b32 v166, 0
  v_mov_b32 v167, 0
.p2align 6
mk_f_loop:
  buffer_load_dwordx4 v[56:59], v3, s[8:11], s16 offen offset:0 sc1
  buffer_load_dwordx4 v[60:63], v3, s[8:11], s16 offen offset:1024 sc1
  buffer_load_dwordx4 v[64:67], v3, s[8:11], s16 offen offset:2048 sc1
  buffer_load_dwordx4 v[68:71], v3, s[8:11], s16 offen offset:3072 sc1
mk_f_dp0:
  s_waitcnt vmcnt(3)
  v_max3_u32 v33, v56, v57, v58
  v_max_u32 v33, v33, v59
  v_cmp_eq_u32 vcc, -1, v33
  s_cbranch_vccnz mk_f_dr0
mk_f_dm0:
  v_smfmac_f32_16x16x64_bf16 v[72:75], v[56:59], a[0:7], v23
  v_smfmac_f32_16x16x64_bf16 v[76:79], v[56:59], a[8:15], v23
  s_waitcnt vmcnt(2)
  v_max3_u32 v33, v60, v61, v62
  v_smfmac_f32_16x16x64_bf16 v[80:83], v[56:59], a[64:71], v23
  v_max_u32 v33, v33, v63
  v_cmp_eq_u32 vcc, -1, v33
  v_smfmac_f32_16x16x64_bf16 v[84:87], v[56:59], a[72:79], v23
  s_cbranch_vccnz mk_f_dr1
mk_f_dm1:
  v_smfmac_f32_16x16x64_bf16 v[72:75], v[60:63], a[16:23], v23
  v_smfmac_f32_16x16x64_bf16 v[76:79], v[60:63], a[24:31], v23
  s_waitcnt vmcnt(1)
  v_max3_u32 v33, v64, v65, v66
  v_smfmac_f32_16x16x64_bf16 v[80:83], v[60:63], a[80:87], v23
  v_max_u32 v33, v33, v67
  v_cmp_eq_u32 vcc, -1, v33
  v_smfmac_f32_16x16x64_bf16 v[84:87], v[60:63], a[88:95], v23
  s_cbranch_vccnz mk_f_dr2
mk_f_dm2:
  v_smfmac_f32_16x16x64_bf16 v[72:75], v[64:67], a[32:39], v23
  v_smfmac_f32_16x16x64_bf16 v[76:79], v[64:67], a[40:47], v23
  s_waitcnt vmcnt(0)
  v_max3_u32 v33, v68, v69, v70
  v_smfmac_f32_16x16x64_bf16 v[80:83], v[64:67], a[96:103], v23
  v_max_u32 v33, v33, v71
  v_cmp_eq_u32 vcc, -1, v33
  v_smfmac_f32_16x16x64_bf16 v[84:87], v[64:67], a[104:111], v23
  s_cbranch_vccnz mk_f_dr3
mk_f_dm3:
  v_smfmac_f32_16x16x64_bf16 v[72:75], v[68:71], a[48:55], v23
  v_smfmac_f32_16x16x64_bf16 v[76:79], v[68:71], a[56:63], v23
  v_smfmac_f32_16x16x64_bf16 v[80:83], v[68:71], a[112:119], v23
  v_smfmac_f32_16x16x64_bf16 v[84:87], v[68:71], a[120:127], v23
  v_smfmac_f32_16x16x64_bf16 v[88:91], v[56:59], a[128:135], v23
  v_smfmac_f32_16x16x64_bf16 v[92:95], v[56:59], a[136:143], v23
  v_smfmac_f32_16x16x64_bf16 v[88:91], v[60:63], a[144:151], v23
  v_smfmac_f32_16x16x64_bf16 v[92:95], v[60:63], a[152:159], v23
  s_nop 0
  v_add_f32 v72, v72, v73
  v_add_f32 v74, v74, v75
  v_smfmac_f32_16x16x64_bf16 v[88:91], v[64:67], a[160:167], v23
  ds_write2_b32 v15, v72, v74 offset0:0 offset1:32
  v_add_f32 v76, v76, v77
  v_add_f32 v78, v78, v79
  v_smfmac_f32_16x16x64_bf16 v[92:95], v[64:67], a[168:175], v23
  ds_write2_b32 v16, v76, v78 offset0:0 offset1:32
  v_add_f32 v80, v80, v81
  v_add_f32 v82, v82, v83
  v_smfmac_f32_16x16x64_bf16 v[88:91], v[68:71], a[176:183], v23
  ds_write2_b32 v17, v80, v82 offset0:0 offset1:32
  v_add_f32 v84, v84, v85
  v_add_f32 v86, v86, v87
  v_smfmac_f32_16x16x64_bf16 v[92:95], v[68:71], a[184:191], v23
  ds_write2_b32 v18, v84, v86 offset0:0 offset1:32
  s_nop 4
  v_add_f32 v88, v88, v89
  v_add_f32 v90, v90, v91
  ds_write2_b32 v19, v88, v90 offset0:0 offset1:32
  v_add_f32 v92, v92, v93
  v_add_f32 v94, v94, v95
  ds_write2_b32 v20, v92, v94 offset0:0 offset1:32
  s_waitcnt lgkmcnt(0)
  s_barrier
  s_cmp_eq_u32 s7, 0
  s_cbranch_scc0 mk_f_w1
  ds_read_b128 v[96:99], v21 offset:0
  ds_read_b128 v[100:103], v21 offset:16
  ds_read_b128 v[104:107], v21 offset:3120
  ds_read_b128 v[108:111], v21 offset:3136
  ds_read_b128 v[112:115], v21 offset:6240
  ds_read_b128 v[116:119], v21 offset:6256
  ds_read_b128 v[120:123], v21 offset:9360
  ds_read_b128 v[124:127], v21 offset:9376
  s_waitcnt lgkmcnt(4)
  v_pk_add_f32 v[96:97], v[96:97], v[104:105]
  v_pk_add_f32 v[98:99], v[98:99], v[106:107]
  v_pk_add_f32 v[100:101], v[100:101], v[108:109]
  v_pk_add_f32 v[102:103], v[102:103], v[110:111]
  s_waitcnt lgkmcnt(0)
  v_pk_add_f32 v[112:113], v[112:113], v[120:121]
  v_pk_add_f32 v[114:115], v[114:115], v[122:123]
  v_pk_add_f32 v[116:117], v[116:117], v[124:125]
  v_pk_add_f32 v[118:119], v[118:119], v[126:127]
  v_pk_add_f32 v[96:97], v[96:97], v[112:113]
  v_pk_add_f32 v[98:99], v[98:99], v[114:115]
  v_pk_add_f32 v[100:101], v[100:101], v[116:117]
  v_pk_add_f32 v[102:103], v[102:103], v[118:119]
  v_cvt_pk_bf16_f32 v128, v96, v97
  v_cvt_pk_bf16_f32 v129, v98, v99
  v_cvt_pk_bf16_f32 v130, v100, v101
  v_cvt_pk_bf16_f32 v131, v102, v103
  s_nop 1
  v_mfma_f32_16x16x32_bf16 v[144:147], v[136:139], v[128:131], 0
  v_mfma_f32_16x16x32_bf16 v[140:143], v[132:135], v[128:131], 0
  v_mfma_f32_16x16x32_bf16 v[148:151], v[128:131], v[128:131], 0
  s_nop 6
  v_mov_b32_dpp v140, v144 row_ror:8 row_mask:0xf bank_mask:0xc
  v_mov_b32_dpp v141, v145 row_ror:8 row_mask:0xf bank_mask:0xc
  v_mov_b32_dpp v142, v146 row_ror:8 row_mask:0xf bank_mask:0xc
  v_mov_b32_dpp v143, v147 row_ror:8 row_mask:0xf bank_mask:0xc
  buffer_store_dwordx4 v[140:143], v12, s[8:11], s19 offen
  buffer_store_dwordx4 v[148:151], v13, s[8:11], s19 offen
  s_branch mk_f_f3
mk_f_w1:
  s_cmp_eq_u32 s7, 3
  s_cbranch_scc1 mk_f_f3
  s_cmp_eq_u32 s7, 2
  s_cbranch_scc1 mk_f_w2
  ds_read_b128 v[96:99], v21 offset:0
  ds_read_b128 v[100:103], v21 offset:16
  ds_read_b128 v[104:107], v21 offset:6240
  ds_read_b128 v[108:111], v21 offset:6256
  s_waitcnt lgkmcnt(0)
  v_pk_add_f32 v[96:97], v[96:97], v[104:105]
  v_pk_add_f32 v[98:99], v[98:99], v[106:107]
  v_pk_add_f32 v[100:101], v[100:101], v[108:109]
  v_pk_add_f32 v[102:103], v[102:103], v[110:111]
  v_add_f32_dpp v104, v96, v96 row_ror:8 row_mask:0xf bank_mask:0xf
  v_add_f32_dpp v105, v97, v97 row_ror:8 row_mask:0xf bank_mask:0xf
  v_add_f32_dpp v106, v98, v98 row_ror:8 row_mask:0xf bank_mask:0xf
  v_add_f32_dpp v107, v99, v99 row_ror:8 row_mask:0xf bank_mask:0xf
  v_add_f32_dpp v108, v100, v100 row_ror:8 row_mask:0xf bank_mask:0xf
  v_add_f32_dpp v109, v101, v101 row_ror:8 row_mask:0xf bank_mask:0xf
  v_add_f32_dpp v110, v102, v102 row_ror:8 row_mask:0xf bank_mask:0xf
  v_add_f32_dpp v111, v103, v103 row_ror:8 row_mask:0xf bank_mask:0xf
  v_cvt_pk_bf16_f32 v128, v104, v105
  v_cvt_pk_bf16_f32 v129, v106, v107
  v_cvt_pk_bf16_f32 v130, v108, v109
  v_cvt_pk_bf16_f32 v131, v110, v111
  buffer_store_dwordx4 v[128:131], v12, s[8:11], s19 offen
  s_branch mk_f_f3
mk_f_w2:
  buffer_store_dwordx4 v[52:55], v13, s[8:11], s18 offen
  v_subrev_u32 v33, 16384, v6
  s_add_u32 s36, s25, 0
  buffer_store_dwordx4 v[52:55], v33, s[8:11], s36 offen
  s_add_u32 s36, s25, 8192
  buffer_store_dwordx4 v[52:55], v33, s[8:11], s36 offen
  s_add_u32 s36, s25, 16384
  buffer_store_dwordx4 v[52:55], v33, s[8:11], s36 offen
  s_add_u32 s36, s25, 24576
  buffer_store_dwordx4 v[52:55], v33, s[8:11], s36 offen
  ds_read_b64 v[96:97], v21 offset:0
  ds_read_b64 v[98:99], v21 offset:32
  ds_read_b64 v[100:101], v21 offset:8
  ds_read_b64 v[102:103], v21 offset:40
  ds_read_b64 v[104:105], v21 offset:6240
  ds_read_b64 v[106:107], v21 offset:6272
  ds_read_b64 v[108:109], v21 offset:6248
  ds_read_b64 v[110:111], v21 offset:6280
  s_waitcnt lgkmcnt(0)
  v_pk_add_f32 v[96:97], v[96:97], v[104:105]
  v_pk_add_f32 v[98:99], v[98:99], v[106:107]
  v_pk_add_f32 v[100:101], v[100:101], v[108:109]
  v_pk_add_f32 v[102:103], v[102:103], v[110:111]
  v_add_f32_dpp v104, v96, v96 row_ror:8 row_mask:0xf bank_mask:0xf
  v_add_f32_dpp v105, v97, v97 row_ror:8 row_mask:0xf bank_mask:0xf
  v_add_f32_dpp v106, v98, v98 row_ror:8 row_mask:0xf bank_mask:0xf
  v_add_f32_dpp v107, v99, v99 row_ror:8 row_mask:0xf bank_mask:0xf
  v_add_f32_dpp v108, v100, v100 row_ror:8 row_mask:0xf bank_mask:0xf
  v_add_f32_dpp v109, v101, v101 row_ror:8 row_mask:0xf bank_mask:0xf
  v_add_f32_dpp v110, v102, v102 row_ror:8 row_mask:0xf bank_mask:0xf
  v_add_f32_dpp v111, v103, v103 row_ror:8 row_mask:0xf bank_mask:0xf
  v_cvt_pk_bf16_f32 v128, v104, v105
  v_cvt_pk_bf16_f32 v129, v106, v107
  v_cvt_pk_bf16_f32 v130, v108, v109
  v_cvt_pk_bf16_f32 v131, v110, v111
mk_f_f3:
  s_cmp_eq_u32 s32, 63
  s_cbranch_scc1 mk_f_last
  s_add_u32 s22, s19, 4096
  s_cmp_eq_u32 s7, 3
  s_cbranch_scc1 mk_f_w3
  s_barrier
  ds_read_b128 v[56:59], v22 offset:22528
  ds_read_b128 v[60:63], v22 offset:23552
mk_f_kf:
  v_max_u32 v33, v38, v39
  v_cmp_eq_u32 vcc, -1, v33
  s_cbranch_vccnz mk_f_kfr
  s_sub_u32 s39, 53248, s51
  s_cmp_eq_u32 s7, 0
  s_cbranch_scc0 mk_f_n_15
  s_add_u32 m0, s39, 0
  s_add_u32 s36, s48, 0
  buffer_load_dwordx4 v32, s[8:11], s36 offen sc1 lds
  s_add_u32 m0, s39, 1024
  s_add_u32 s36, s48, 131072
  buffer_load_dwordx4 v32, s[8:11], s36 offen sc1 lds
  s_add_u32 m0, s39, 2048
  s_add_u32 s36, s48, 262144
  buffer_load_dwordx4 v32, s[8:11], s36 offen sc1 lds
  s_branch mk_f_n_14
mk_f_n_15:
  s_cmp_eq_u32 s7, 1
  s_cbranch_scc0 mk_f_n_16
  s_add_u32 m0, s39, 3072
  s_add_u32 s36, s48, 393216
  buffer_load_dwordx4 v32, s[8:11], s36 offen sc1 lds
  s_add_u32 m0, s39, 8192
  s_add_u32 s36, s48, 0
  buffer_load_dwordx4 v31, s[8:11], s36 offen sc1 lds
  s_add_u32 m0, s39, 4096
  s_add_u32 s36, s48, 1024
  buffer_load_dwordx4 v32, s[8:11], s36 offen sc1 lds
  s_branch mk_f_n_14
mk_f_n_16:
  s_add_u32 m0, s39, 5120
  s_add_u32 s36, s48, 132096
  buffer_load_dwordx4 v32, s[8:11], s36 offen sc1 lds
  s_add_u32 m0, s39, 6144
  s_add_u32 s36, s48, 263168
  buffer_load_dwordx4 v32, s[8:11], s36 offen sc1 lds
  s_add_u32 m0, s39, 7168
  s_add_u32 s36, s48, 394240
  buffer_load_dwordx4 v32, s[8:11], s36 offen sc1 lds
  s_add_u32 m0, s39, 9216
  s_add_u32 s36, s48, 1024
  buffer_load_dwordx4 v31, s[8:11], s36 offen sc1 lds
mk_f_n_14:
  s_waitcnt lgkmcnt(0)
  v_smfmac_f32_16x16x64_bf16 v[152:155], v[56:59], a[192:199], v30
  v_smfmac_f32_16x16x64_bf16 v[156:159], v[56:59], a[200:207], v30
  v_smfmac_f32_16x16x64_bf16 v[160:163], v[56:59], a[208:215], v30
  v_smfmac_f32_16x16x64_bf16 v[164:167], v[56:59], a[216:223], v30
  v_smfmac_f32_16x16x64_bf16 v[152:155], v[60:63], a[224:231], v30
  v_smfmac_f32_16x16x64_bf16 v[156:159], v[60:63], a[232:239], v30
  v_smfmac_f32_16x16x64_bf16 v[160:163], v[60:63], a[240:247], v30
  v_smfmac_f32_16x16x64_bf16 v[164:167], v[60:63], a[248:255], v30
  s_waitcnt lgkmcnt(0)
  s_barrier
  ds_read_b64 v[200:201], v24
  ds_read_b64 v[202:203], v25
  ds_read_b64 v[204:205], v26
  ds_read_b64 v[208:209], v27
  ds_read_b64 v[210:211], v28
  ds_read_b64 v[212:213], v29
  v_cvt_pk_bf16_f32 v168, v152, v153
  v_cvt_pk_bf16_f32 v169, v154, v155
  v_cvt_pk_bf16_f32 v172, v156, v157
  v_cvt_pk_bf16_f32 v173, v158, v159
  v_cvt_pk_bf16_f32 v176, v160, v161
  v_cvt_pk_bf16_f32 v177, v162, v163
  v_cvt_pk_bf16_f32 v180, v164, v165
  v_cvt_pk_bf16_f32 v181, v166, v167
  s_waitcnt lgkmcnt(3)
  v_mfma_f32_16x16x32_bf16 v[148:151], v[44:47], v[200:203], 0
  v_mfma_f32_16x16x32_bf16 v[148:151], v[48:51], v[204:207], v[148:151]
  v_mfma_f32_16x16x32_bf16 v[140:143], v[184:187], v[200:203], 0
  v_mfma_f32_16x16x32_bf16 v[144:147], v[188:191], v[200:203], 0
  v_mfma_f32_16x16x32_bf16 v[140:143], v[168:171], v[204:207], v[140:143]
  v_mfma_f32_16x16x32_bf16 v[144:147], v[172:175], v[204:207], v[144:147]
  s_waitcnt lgkmcnt(0)
  v_mfma_f32_16x16x32_bf16 v[140:143], v[192:195], v[208:211], v[140:143]
  v_mfma_f32_16x16x32_bf16 v[144:147], v[196:199], v[208:211], v[144:147]
  s_branch mk_f_fin
mk_f_w3:
  s_nop 15
  s_nop 15
  s_nop 15
  s_nop 15
  s_nop 15
  buffer_load_dwordx4 v[96:99], v9, s[8:11], s19 offen sc1
  buffer_load_dwordx4 v[100:103], v9, s[8:11], s19 offen offset:2048 sc1
  buffer_load_dwordx4 v[104:107], v9, s[8:11], s22 offen sc1
  buffer_load_dwordx4 v[108:111], v9, s[8:11], s22 offen offset:2048 sc1
  buffer_load_dwordx4 v[112:115], v10, s[8:11], s19 offen sc1
  buffer_load_dwordx4 v[116:119], v10, s[8:11], s22 offen sc1
  buffer_load_dwordx4 v[120:123], v11, s[8:11], s19 offen sc1
  buffer_load_dwordx4 v[124:127], v11, s[8:11], s22 offen sc1
  s_nop 15
  s_nop 15
  buffer_load_dwordx4 v[224:227], v9, s[8:11], s19 offen sc1
  buffer_load_dwordx4 v[228:231], v9, s[8:11], s19 offen offset:2048 sc1
  buffer_load_dwordx4 v[232:235], v9, s[8:11], s22 offen sc1
  buffer_load_dwordx4 v[236:239], v9, s[8:11], s22 offen offset:2048 sc1
  buffer_load_dwordx4 v[240:243], v10, s[8:11], s19 offen sc1
  buffer_load_dwordx4 v[244:247], v10, s[8:11], s22 offen sc1
  buffer_load_dwordx4 v[248:251], v11, s[8:11], s19 offen sc1
  buffer_load_dwordx4 v[252:255], v11, s[8:11], s22 offen sc1
mk_f_sp:
  s_waitcnt vmcnt(8)
  v_max3_u32 v33, v96, v97, v98
  v_max3_u32 v34, v102, v103, v104
  v_max3_u32 v35, v108, v109, v110
  v_max3_u32 v36, v114, v115, v116
  v_max3_u32 v33, v33, v99, v100
  v_max3_u32 v34, v34, v105, v106
  v_max3_u32 v35, v35, v111, v112
  v_max3_u32 v36, v36, v117, v118
  v_max3_u32 v33, v33, v101, v107
  v_max3_u32 v34, v34, v113, v119
  v_max3_u32 v35, v35, v120, v121
  v_max3_u32 v36, v36, v122, v123
  v_max3_u32 v33, v33, v124, v125
  v_max3_u32 v34, v34, v126, v127
  v_max3_u32 v33, v33, v35, v36
  v_max_u32 v33, v33, v34
  v_cmp_eq_u32 vcc, -1, v33
  s_cbranch_vccz mk_f_sg0
  buffer_load_dwordx4 v[96:99], v9, s[8:11], s19 offen sc1
  buffer_load_dwordx4 v[100:103], v9, s[8:11], s19 offen offset:2048 sc1
  buffer_load_dwordx4 v[104:107], v9, s[8:11], s22 offen sc1
  buffer_load_dwordx4 v[108:111], v9, s[8:11], s22 offen offset:2048 sc1
  buffer_load_dwordx4 v[112:115], v10, s[8:11], s19 offen sc1
  buffer_load_dwordx4 v[116:119], v10, s[8:11], s22 offen sc1
  buffer_load_dwordx4 v[120:123], v11, s[8:11], s19 offen sc1
  buffer_load_dwordx4 v[124:127], v11, s[8:11], s22 offen sc1
  s_sub_u32 s33, s33, 1
  s_cbranch_scc1 mk_end
  s_waitcnt vmcnt(8)
  v_max3_u32 v33, v224, v225, v226
  v_max3_u32 v34, v230, v231, v232
  v_max3_u32 v35, v236, v237, v238
  v_max3_u32 v36, v242, v243, v244
  v_max3_u32 v33, v33, v227, v228
  v_max3_u32 v34, v34, v233, v234
  v_max3_u32 v35, v35, v239, v240
  v_max3_u32 v36, v36, v245, v246
  v_max3_u32 v33, v33, v229, v235
  v_max3_u32 v34, v34, v241, v247
  v_max3_u32 v35, v35, v248, v249
  v_max3_u32 v36, v36, v250, v251
  v_max3_u32 v33, v33, v252, v253
  v_max3_u32 v34, v34, v254, v255
  v_max3_u32 v33, v33, v35, v36
  v_max_u32 v33, v33, v34
  v_cmp_eq_u32 vcc, -1, v33
  s_cbranch_vccz mk_f_sg1
  buffer_load_dwordx4 v[224:227], v9, s[8:11], s19 offen sc1
  buffer_load_dwordx4 v[228:231], v9, s[8:11], s19 offen offset:2048 sc1
  buffer_load_dwordx4 v[232:235], v9, s[8:11], s22 offen sc1
  buffer_load_dwordx4 v[236:239], v9, s[8:11], s22 offen offset:2048 sc1
  buffer_load_dwordx4 v[240:243], v10, s[8:11], s19 offen sc1
  buffer_load_dwordx4 v[244:247], v10, s[8:11], s22 offen sc1
  buffer_load_dwordx4 v[248:251], v11, s[8:11], s19 offen sc1
  buffer_load_dwordx4 v[252:255], v11, s[8:11], s22 offen sc1
  s_sub_u32 s33, s33, 1
  s_cbranch_scc1 mk_end
  s_branch mk_f_sp
mk_f_sg0:
  ds_write_b128 v22, v[120:123] offset:22528
  ds_write_b128 v22, v[124:127] offset:23552
  v_pk_add_f32 v[112:113], v[112:113], v[116:117]
  v_pk_add_f32 v[114:115], v[114:115], v[118:119]
  v_pk_add_f32 v[96:97], v[96:97], v[100:101]
  v_pk_add_f32 v[104:105], v[104:105], v[108:109]
  v_pk_add_f32 v[98:99], v[98:99], v[102:103]
  v_pk_add_f32 v[106:107], v[106:107], v[110:111]
  v_add_f32_dpp v100, v112, v112 row_ror:8 row_mask:0xf bank_mask:0xf
  v_add_f32_dpp v101, v113, v113 row_ror:8 row_mask:0xf bank_mask:0xf
  v_add_f32_dpp v102, v114, v114 row_ror:8 row_mask:0xf bank_mask:0xf
  v_add_f32_dpp v103, v115, v115 row_ror:8 row_mask:0xf bank_mask:0xf
  v_pk_add_f32 v[96:97], v[96:97], v[104:105]
  v_pk_add_f32 v[98:99], v[98:99], v[106:107]
  s_waitcnt lgkmcnt(0)
  s_barrier
  v_max3_f32 v33, v100, v101, v102
  v_max3_f32 v33, v33, v103, v96
  v_max3_f32 v33, v33, v97, v98
  v_max_f32 v33, v33, v99
  s_nop 1
  v_max_f32_dpp v33, v33, v33 row_ror:8 row_mask:0xf bank_mask:0xf
  v_mov_b32 v34, v33
  s_nop 1
  v_permlane16_swap_b32 v33, v34
  v_max_f32 v33, v33, v34
  v_mov_b32 v34, v33
  s_nop 1
  v_permlane32_swap_b32 v33, v34
  v_max_f32 v33, v33, v34
  v_mul_f32 v33, s35, v33
  v_fma_f32 v96, v96, s35, -v33
  v_fma_f32 v97, v97, s35, -v33
  v_fma_f32 v98, v98, s35, -v33
  v_fma_f32 v99, v99, s35, -v33
  v_fma_f32 v100, v100, s35, -v33
  v_fma_f32 v101, v101, s35, -v33
  v_fma_f32 v102, v102, s35, -v33
  v_fma_f32 v103, v103, s35, -v33
  v_exp_f32 v96, v96
  v_exp_f32 v97, v97
  v_exp_f32 v98, v98
  v_exp_f32 v99, v99
  v_exp_f32 v100, v100
  v_exp_f32 v101, v101
  v_exp_f32 v102, v102
  v_exp_f32 v103, v103
  s_nop 0
  v_cvt_pk_bf16_f32 v128, v96, v97
  v_cvt_pk_bf16_f32 v129, v98, v99
  v_cvt_pk_bf16_f32 v130, v100, v101
  v_cvt_pk_bf16_f32 v131, v102, v103
  ds_write_b128 v22, v[128:131]
  v_smfmac_f32_16x16x64_bf16 v[152:155], v[120:123], a[192:199], v30
  v_smfmac_f32_16x16x64_bf16 v[156:159], v[120:123], a[200:207], v30
  v_smfmac_f32_16x16x64_bf16 v[160:163], v[120:123], a[208:215], v30
  s_waitcnt lgkmcnt(0)
  s_barrier
  ds_read_b64 v[200:201], v24
  ds_read_b64 v[202:203], v25
  ds_read_b64 v[204:205], v26
  ds_read_b64 v[208:209], v27
  ds_read_b64 v[210:211], v28
  ds_read_b64 v[212:213], v29
  v_smfmac_f32_16x16x64_bf16 v[164:167], v[120:123], a[216:223], v30
  v_smfmac_f32_16x16x64_bf16 v[152:155], v[124:127], a[224:231], v30
  v_smfmac_f32_16x16x64_bf16 v[156:159], v[124:127], a[232:239], v30
  v_smfmac_f32_16x16x64_bf16 v[160:163], v[124:127], a[240:247], v30
  v_smfmac_f32_16x16x64_bf16 v[164:167], v[124:127], a[248:255], v30
  s_branch mk_f_sj
mk_f_sg1:
  ds_write_b128 v22, v[248:251] offset:22528
  ds_write_b128 v22, v[252:255] offset:23552
  v_pk_add_f32 v[240:241], v[240:241], v[244:245]
  v_pk_add_f32 v[242:243], v[242:243], v[246:247]
  v_pk_add_f32 v[224:225], v[224:225], v[228:229]
  v_pk_add_f32 v[232:233], v[232:233], v[236:237]
  v_pk_add_f32 v[226:227], v[226:227], v[230:231]
  v_pk_add_f32 v[234:235], v[234:235], v[238:239]
  v_add_f32_dpp v228, v240, v240 row_ror:8 row_mask:0xf bank_mask:0xf
  v_add_f32_dpp v229, v241, v241 row_ror:8 row_mask:0xf bank_mask:0xf
  v_add_f32_dpp v230, v242, v242 row_ror:8 row_mask:0xf bank_mask:0xf
  v_add_f32_dpp v231, v243, v243 row_ror:8 row_mask:0xf bank_mask:0xf
  v_pk_add_f32 v[224:225], v[224:225], v[232:233]
  v_pk_add_f32 v[226:227], v[226:227], v[234:235]
  s_waitcnt lgkmcnt(0)
  s_barrier
  v_max3_f32 v33, v228, v229, v230
  v_max3_f32 v33, v33, v231, v224
  v_max3_f32 v33, v33, v225, v226
  v_max_f32 v33, v33, v227
  s_nop 1
  v_max_f32_dpp v33, v33, v33 row_ror:8 row_mask:0xf bank_mask:0xf
  v_mov_b32 v34, v33
  s_nop 1
  v_permlane16_swap_b32 v33, v34
  v_max_f32 v33, v33, v34
  v_mov_b32 v34, v33
  s_nop 1
  v_permlane32_swap_b32 v33, v34
  v_max_f32 v33, v33, v34
  v_mul_f32 v33, s35, v33
  v_fma_f32 v224, v224, s35, -v33
  v_fma_f32 v225, v225, s35, -v33
  v_fma_f32 v226, v226, s35, -v33
  v_fma_f32 v227, v227, s35, -v33
  v_fma_f32 v228, v228, s35, -v33
  v_fma_f32 v229, v229, s35, -v33
  v_fma_f32 v230, v230, s35, -v33
  v_fma_f32 v231, v231, s35, -v33
  v_exp_f32 v224, v224
  v_exp_f32 v225, v225
  v_exp_f32 v226, v226
  v_exp_f32 v227, v227
  v_exp_f32 v228, v228
  v_exp_f32 v229, v229
  v_exp_f32 v230, v230
  v_exp_f32 v231, v231
  s_nop 0
  v_cvt_pk_bf16_f32 v128, v224, v225
  v_cvt_pk_bf16_f32 v129, v226, v227
  v_cvt_pk_bf16_f32 v130, v228, v229
  v_cvt_pk_bf16_f32 v131, v230, v231
  ds_write_b128 v22, v[128:131]
  v_smfmac_f32_16x16x64_bf16 v[152:155], v[248:251], a[192:199], v30
  v_smfmac_f32_16x16x64_bf16 v[156:159], v[248:251], a[200:207], v30
  v_smfmac_f32_16x16x64_bf16 v[160:163], v[248:251], a[208:215], v30
  s_waitcnt lgkmcnt(0)
  s_barrier
  ds_read_b64 v[200:201], v24
  ds_read_b64 v[202:203], v25
  ds_read_b64 v[204:205], v26
  ds_read_b64 v[208:209], v27
  ds_read_b64 v[210:211], v28
  ds_read_b64 v[212:213], v29
  v_smfmac_f32_16x16x64_bf16 v[164:167], v[248:251], a[216:223], v30
  v_smfmac_f32_16x16x64_bf16 v[152:155], v[252:255], a[224:231], v30
  v_smfmac_f32_16x16x64_bf16 v[156:159], v[252:255], a[232:239], v30
  v_smfmac_f32_16x16x64_bf16 v[160:163], v[252:255], a[240:247], v30
  v_smfmac_f32_16x16x64_bf16 v[164:167], v[252:255], a[248:255], v30
mk_f_sj:
  s_waitcnt lgkmcnt(3)
  v_mfma_f32_16x16x32_bf16 v[148:151], v[44:47], v[200:203], 0
  v_mfma_f32_16x16x32_bf16 v[148:151], v[48:51], v[204:207], v[148:151]
  v_mfma_f32_16x16x32_bf16 v[140:143], v[184:187], v[200:203], 0
  v_mfma_f32_16x16x32_bf16 v[144:147], v[188:191], v[200:203], 0
  s_waitcnt vmcnt(0) lgkmcnt(0)
  v_mfma_f32_16x16x32_bf16 v[140:143], v[192:195], v[208:211], v[140:143]
  v_cvt_pk_bf16_f32 v168, v152, v153
  v_cvt_pk_bf16_f32 v169, v154, v155
  v_mfma_f32_16x16x32_bf16 v[144:147], v[196:199], v[208:211], v[144:147]
  v_cvt_pk_bf16_f32 v172, v156, v157
  v_cvt_pk_bf16_f32 v173, v158, v159
  v_cvt_pk_bf16_f32 v176, v160, v161
  v_cvt_pk_bf16_f32 v177, v162, v163
  v_mfma_f32_16x16x32_bf16 v[140:143], v[168:171], v[204:207], v[140:143]
  v_cvt_pk_bf16_f32 v180, v164, v165
  v_cvt_pk_bf16_f32 v181, v166, v167
  v_mfma_f32_16x16x32_bf16 v[144:147], v[172:175], v[204:207], v[144:147]
mk_f_fin:
  s_nop 0
  v_rcp_f32 v33, v148
  v_mfma_f32_16x16x32_bf16 v[140:143], v[176:179], v[212:215], v[140:143]
  v_mfma_f32_16x16x32_bf16 v[144:147], v[180:183], v[212:215], v[144:147]
  s_nop 0
  v_mov_b32_dpp v33, v33 row_ror:8 row_mask:0xf bank_mask:0xc
  s_nop 4
  v_mul_f32 v140, v140, v33
  v_mul_f32 v141, v141, v33
  v_cvt_pk_bf16_f32 v216, v140, v141
  v_mul_f32 v142, v142, v33
  v_mul_f32 v143, v143, v33
  v_cvt_pk_bf16_f32 v217, v142, v143
  v_mul_f32 v144, v144, v33
  v_mul_f32 v145, v145, v33
  v_cvt_pk_bf16_f32 v218, v144, v145
  v_mul_f32 v146, v146, v33
  v_mul_f32 v147, v147, v33
  v_cvt_pk_bf16_f32 v219, v146, v147
  buffer_store_dwordx4 v[216:219], v6, s[8:11], s23 offen
  v_add_u32 v36, s51, v2
  ds_read_b128 v[224:227], v36 offset:0
  ds_read_b128 v[228:231], v36 offset:1024
  ds_read_b128 v[232:235], v36 offset:2048
  ds_read_b128 v[236:239], v36 offset:3072
  ds_read_b128 v[240:243], v36 offset:4096
  ds_read_b128 v[244:247], v36 offset:5120
  ds_read_b128 v[248:251], v36 offset:6144
  ds_read_b128 v[252:255], v36 offset:7168
  ds_read_b128 v[132:135], v36 offset:8192
  ds_read_b128 v[136:139], v36 offset:9216
  buffer_load_dwordx4 v[56:59], v5, s[8:11], s23 offen sc1
  s_nop 15
  buffer_load_dwordx4 v[60:63], v5, s[8:11], s23 offen sc1
  s_nop 15
  buffer_load_dwordx4 v[64:67], v5, s[8:11], s23 offen sc1
mk_f_hb:
  s_waitcnt vmcnt(2)
  v_mfma_f32_16x16x32_bf16 v[220:223], v[40:43], v[56:59], 0
  v_max3_u32 v33, v56, v57, v58
  v_max_u32 v33, v33, v59
  v_cmp_eq_u32 vcc, -1, v33
  s_cbranch_vccz mk_f_hbd
  buffer_load_dwordx4 v[56:59], v5, s[8:11], s23 offen sc1
  s_sub_u32 s33, s33, 1
  s_cbranch_scc1 mk_end
  s_waitcnt vmcnt(2)
  v_mfma_f32_16x16x32_bf16 v[220:223], v[40:43], v[60:63], 0
  v_max3_u32 v33, v60, v61, v62
  v_max_u32 v33, v33, v63
  v_cmp_eq_u32 vcc, -1, v33
  s_cbranch_vccz mk_f_hbd
  buffer_load_dwordx4 v[60:63], v5, s[8:11], s23 offen sc1
  s_sub_u32 s33, s33, 1
  s_cbranch_scc1 mk_end
  s_waitcnt vmcnt(2)
  v_mfma_f32_16x16x32_bf16 v[220:223], v[40:43], v[64:67], 0
  v_max3_u32 v33, v64, v65, v66
  v_max_u32 v33, v33, v67
  v_cmp_eq_u32 vcc, -1, v33
  s_cbranch_vccz mk_f_hbd
  buffer_load_dwordx4 v[64:67], v5, s[8:11], s23 offen sc1
  s_sub_u32 s33, s33, 1
  s_cbranch_scc1 mk_end
  s_branch mk_f_hb
mk_f_hbd:
  s_nop 3
  v_add_f32_dpp v216, v220, v220 row_ror:8 row_mask:0xf bank_mask:0xf
  v_add_f32_dpp v217, v221, v221 row_ror:8 row_mask:0xf bank_mask:0xf
  v_add_f32_dpp v218, v222, v222 row_ror:8 row_mask:0xf bank_mask:0xf
  v_add_f32_dpp v219, v223, v223 row_ror:8 row_mask:0xf bank_mask:0xf
  buffer_store_dwordx4 v[216:219], v8, s[8:11], s26 offen sc1
  s_waitcnt lgkmcnt(0)
  s_sub_u32 s51, 53248, s51
  s_cmp_gt_u32 s7, 1
  s_cbranch_scc1 mk_f_n_18
  buffer_store_dwordx4 v[52:55], v12, s[8:11], s21 offen
  buffer_store_dwordx4 v[52:55], v13, s[8:11], s21 offen
mk_f_n_18:
  s_cmp_eq_u32 s7, 2
  s_cbranch_scc0 mk_f_n_19
  buffer_store_dwordx4 v[52:55], v12, s[8:11], s27 offen sc1
mk_f_n_19:
  buffer_store_dwordx4 v[128:131], v14, s[8:11], s34 offen sc1
  s_cmp_eq_u32 s7, 1
  s_cbranch_scc0 mk_f_n_20
  v_mov_b32 v33, s32
  v_mov_b32 v34, 0
  buffer_store_dword v33, v34, s[8:11], s52 offen sc1
mk_f_n_20:
  v_mfma_f32_16x16x32_bf16 v[96:99], v[224:227], a[192:195], 0
  v_mfma_f32_16x16x32_bf16 v[96:99], v[228:231], a[196:199], v[96:99]
  v_mfma_f32_16x16x32_bf16 v[96:99], v[232:235], a[224:227], v[96:99]
  v_mfma_f32_16x16x32_bf16 v[96:99], v[236:239], a[228:231], v[96:99]
  v_mfma_f32_16x16x32_bf16 v[100:103], v[240:243], a[192:195], 0
  v_mfma_f32_16x16x32_bf16 v[100:103], v[244:247], a[196:199], v[100:103]
  v_mfma_f32_16x16x32_bf16 v[100:103], v[248:251], a[224:227], v[100:103]
  v_mfma_f32_16x16x32_bf16 v[100:103], v[252:255], a[228:231], v[100:103]
  v_mfma_f32_16x16x32_bf16 v[104:107], v[224:227], a[200:203], 0
  v_mfma_f32_16x16x32_bf16 v[104:107], v[228:231], a[204:207], v[104:107]
  v_mfma_f32_16x16x32_bf16 v[104:107], v[232:235], a[232:235], v[104:107]
  v_mfma_f32_16x16x32_bf16 v[104:107], v[236:239], a[236:239], v[104:107]
  v_mfma_f32_16x16x32_bf16 v[108:111], v[240:243], a[200:203], 0
  v_mfma_f32_16x16x32_bf16 v[108:111], v[244:247], a[204:207], v[108:111]
  v_mfma_f32_16x16x32_bf16 v[108:111], v[248:251], a[232:235], v[108:111]
  v_mfma_f32_16x16x32_bf16 v[108:111], v[252:255], a[236:239], v[108:111]
  v_cvt_pk_bf16_f32 v184, v96, v97
  v_cvt_pk_bf16_f32 v185, v98, v99
  v_cvt_pk_bf16_f32 v186, v100, v101
  v_cvt_pk_bf16_f32 v187, v102, v103
  v_mfma_f32_16x16x32_bf16 v[112:115], v[224:227], a[208:211], 0
  v_mfma_f32_16x16x32_bf16 v[112:115], v[228:231], a[212:215], v[112:115]
  v_mfma_f32_16x16x32_bf16 v[112:115], v[232:235], a[240:243], v[112:115]
  v_mfma_f32_16x16x32_bf16 v[112:115], v[236:239], a[244:247], v[112:115]
  v_mfma_f32_16x16x32_bf16 v[116:119], v[240:243], a[208:211], 0
  v_mfma_f32_16x16x32_bf16 v[116:119], v[244:247], a[212:215], v[116:119]
  v_mfma_f32_16x16x32_bf16 v[116:119], v[248:251], a[240:243], v[116:119]
  v_mfma_f32_16x16x32_bf16 v[116:119], v[252:255], a[244:247], v[116:119]
  v_cvt_pk_bf16_f32 v188, v104, v105
  v_cvt_pk_bf16_f32 v189, v106, v107
  v_cvt_pk_bf16_f32 v190, v108, v109
  v_cvt_pk_bf16_f32 v191, v110, v111
  buffer_load_dwordx4 v[56:59], v7, s[8:11], s26 offen sc1
  buffer_load_dwordx4 v[60:63], v7, s[8:11], s26 offen offset:512 sc1
  v_mfma_f32_16x16x32_bf16 v[120:123], v[224:227], a[216:219], 0
  v_mfma_f32_16x16x32_bf16 v[120:123], v[228:231], a[220:223], v[120:123]
  v_mfma_f32_16x16x32_bf16 v[120:123], v[232:235], a[248:251], v[120:123]
  v_mfma_f32_16x16x32_bf16 v[120:123], v[236:239], a[252:255], v[120:123]
  v_mfma_f32_16x16x32_bf16 v[124:127], v[240:243], a[216:219], 0
  v_mfma_f32_16x16x32_bf16 v[124:127], v[244:247], a[220:223], v[124:127]
  v_mfma_f32_16x16x32_bf16 v[124:127], v[248:251], a[248:251], v[124:127]
  v_mfma_f32_16x16x32_bf16 v[124:127], v[252:255], a[252:255], v[124:127]
  v_cvt_pk_bf16_f32 v192, v112, v113
  v_cvt_pk_bf16_f32 v193, v114, v115
  v_cvt_pk_bf16_f32 v194, v116, v117
  v_cvt_pk_bf16_f32 v195, v118, v119
  s_add_u32 s36, s32, 3
  s_and_b32 s37, s36, 0x34
  s_lshr_b32 s36, s36, 3
  s_cmp_eq_u32 s37, 4
  s_cselect_b32 s37, 8, 0
  s_add_u32 s36, s36, s37
  s_lshl_b32 s36, s36, 8
  s_add_u32 s36, s36, s53
  v_mov_b32 v34, 0
  buffer_load_dwordx2 v[38:39], v34, s[8:11], s36 offen sc1
  s_add_u32 s48, s48, 2048
  s_mov_b32 s36, s19
  s_mov_b32 s19, s20
  s_mov_b32 s20, s21
  s_mov_b32 s21, s36
  s_mov_b32 s36, s23
  s_mov_b32 s23, s24
  s_mov_b32 s24, s25
  s_mov_b32 s25, s36
  s_mov_b32 s36, s16
  s_mov_b32 s16, s17
  s_mov_b32 s17, s18
  s_mov_b32 s18, s36
  s_add_u32 s32, s32, 1
  s_add_u32 s34, s34, 512
  v_cvt_pk_bf16_f32 v196, v120, v121
  v_cvt_pk_bf16_f32 v197, v122, v123
  v_cvt_pk_bf16_f32 v198, v124, v125
  v_cvt_pk_bf16_f32 v199, v126, v127
  s_waitcnt vmcnt(1)
mk_f_hc:
  v_max3_u32 v33, v56, v57, v58
  v_max3_u32 v34, v59, v60, v61
  v_max3_u32 v33, v33, v62, v63
  v_max_u32 v33, v33, v34
  v_cmp_eq_u32 vcc, -1, v33
  v_pk_add_f32 v[220:221], v[56:57], v[60:61]
  v_pk_add_f32 v[222:223], v[58:59], v[62:63]
  s_cbranch_vccnz mk_f_hcr
mk_f_hd:
  v_add_f32_dpp v140, v220, v220 row_ror:8 row_mask:0xf bank_mask:0xf
  v_add_f32_dpp v141, v221, v221 row_ror:8 row_mask:0xf bank_mask:0xf
  v_add_f32_dpp v142, v222, v222 row_ror:8 row_mask:0xf bank_mask:0xf
  v_add_f32_dpp v143, v223, v223 row_ror:8 row_mask:0xf bank_mask:0xf
  v_cvt_pk_bf16_f32 v216, v140, v141
  v_cvt_pk_bf16_f32 v217, v142, v143
  v_cndmask_b32 v216, v217, v216, s[54:55]
  buffer_store_dword v216, v4, s[8:11], s16 offen
  v_mov_b32 v72, 0
  v_mov_b32 v73, 0
  v_mov_b32 v74, 0
  v_mov_b32 v75, 0
  v_mov_b32 v76, 0
  v_mov_b32 v77, 0
  v_mov_b32 v78, 0
  v_mov_b32 v79, 0
  v_mov_b32 v80, 0
  v_mov_b32 v81, 0
  v_mov_b32 v82, 0
  v_mov_b32 v83, 0
  v_mov_b32 v84, 0
  v_mov_b32 v85, 0
  v_mov_b32 v86, 0
  v_mov_b32 v87, 0
  v_mov_b32 v88, 0
  v_mov_b32 v89, 0
  v_mov_b32 v90, 0
  v_mov_b32 v91, 0
  v_mov_b32 v92, 0
  v_mov_b32 v93, 0
  v_mov_b32 v94, 0
  v_mov_b32 v95, 0
  v_mov_b32 v152, 0
  v_mov_b32 v153, 0
  v_mov_b32 v154, 0
  v_mov_b32 v155, 0
  v_mov_b32 v156, 0
  v_mov_b32 v157, 0
  v_mov_b32 v158, 0
  v_mov_b32 v159, 0
  v_mov_b32 v160, 0
  v_mov_b32 v161, 0
  v_mov_b32 v162, 0
  v_mov_b32 v163, 0
  v_mov_b32 v164, 0
  v_mov_b32 v165, 0
  v_mov_b32 v166, 0
  v_mov_b32 v167, 0
  s_mov_b32 s36, s26
  s_mov_b32 s26, s27
  s_mov_b32 s27, s28
  s_mov_b32 s28, s36
  s_branch mk_f_loop
mk_f_dr0:
  s_sub_u32 s33, s33, 1
  s_cbranch_scc1 mk_end
  buffer_load_dwordx4 v[56:59], v3, s[8:11], s16 offen offset:0 sc1
  buffer_load_dwordx4 v[60:63], v3, s[8:11], s16 offen offset:1024 sc1
  buffer_load_dwordx4 v[64:67], v3, s[8:11], s16 offen offset:2048 sc1
  buffer_load_dwordx4 v[68:71], v3, s[8:11], s16 offen offset:3072 sc1
  s_branch mk_f_dp0
mk_f_dr1:
  s_sub_u32 s33, s33, 1
  s_cbranch_scc1 mk_end
  buffer_load_dwordx4 v[60:63], v3, s[8:11], s16 offen offset:1024 sc1
  buffer_load_dwordx4 v[64:67], v3, s[8:11], s16 offen offset:2048 sc1
  buffer_load_dwordx4 v[68:71], v3, s[8:11], s16 offen offset:3072 sc1
  s_waitcnt vmcnt(2)
  v_max3_u32 v33, v60, v61, v62
  v_max_u32 v33, v33, v63
  v_cmp_eq_u32 vcc, -1, v33
  s_cbranch_vccnz mk_f_dr1
  s_branch mk_f_dm1
mk_f_dr2:
  s_sub_u32 s33, s33, 1
  s_cbranch_scc1 mk_end
  buffer_load_dwordx4 v[64:67], v3, s[8:11], s16 offen offset:2048 sc1
  buffer_load_dwordx4 v[68:71], v3, s[8:11], s16 offen offset:3072 sc1
  s_waitcnt vmcnt(1)
  v_max3_u32 v33, v64, v65, v66
  v_max_u32 v33, v33, v67
  v_cmp_eq_u32 vcc, -1, v33
  s_cbranch_vccnz mk_f_dr2
  s_branch mk_f_dm2
mk_f_dr3:
  s_sub_u32 s33, s33, 1
  s_cbranch_scc1 mk_end
  buffer_load_dwordx4 v[68:71], v3, s[8:11], s16 offen offset:3072 sc1
  s_waitcnt vmcnt(0)
  v_max3_u32 v33, v68, v69, v70
  v_max_u32 v33, v33, v71
  v_cmp_eq_u32 vcc, -1, v33
  s_cbranch_vccnz mk_f_dr3
  s_branch mk_f_dm3
mk_f_hcr:
  s_sub_u32 s33, s33, 1
  s_cbranch_scc1 mk_end
  buffer_load_dwordx4 v[56:59], v7, s[8:11], s26 offen sc1
  buffer_load_dwordx4 v[60:63], v7, s[8:11], s26 offen offset:512 sc1
  s_waitcnt vmcnt(0)
  s_branch mk_f_hc
mk_f_kfr:
  s_sub_u32 s33, s33, 1
  s_cbranch_scc1 mk_end
  s_add_u32 s36, s32, 2
  s_and_b32 s37, s36, 0x34
  s_lshr_b32 s36, s36, 3
  s_cmp_eq_u32 s37, 4
  s_cselect_b32 s37, 8, 0
  s_add_u32 s36, s36, s37
  s_lshl_b32 s36, s36, 8
  s_add_u32 s36, s36, s53
  v_mov_b32 v34, 0
  buffer_load_dwordx2 v[38:39], v34, s[8:11], s36 offen sc1
  s_waitcnt vmcnt(0)
  s_branch mk_f_kf
mk_f_last:
  buffer_store_dwordx4 v[128:131], v14, s[8:11], s34 offen sc1
  s_waitcnt vmcnt(0)
  s_barrier
  v_mov_b32 v33, 64
  v_mov_b32 v34, 0
  buffer_store_dword v33, v34, s[8:11], s52 offen sc1
  s_branch mk_end
mk_safe:
  s_lshr_b32 s5, s3, 2
  s_lshl_b32 s36, s2, 3
  s_add_u32 s5, s5, s36
  s_and_b32 s6, s3, 3
  v_lshrrev_b32 v33, 6, v0
  s_nop 0
  v_readfirstlane_b32 s7, v33
  s_load_dwordx2 s[8:9], s[0:1], 96
  s_load_dwordx8 s[60:67], s[0:1], 16
  s_mov_b32 s10, 268435456
  s_mov_b32 s11, 0x20000
  s_mov_b32 s14, 8388608
  s_mov_b32 s15, 0x20000
  v_and_b32 v1, 63, v0
  v_and_b32 v224, 7, v0
  v_bfe_u32 v225, v0, 3, 1
  v_bfe_u32 v226, v0, 4, 2
  v_lshlrev_b32 v2, 4, v1
  s_lshl_b32 s36, s7, 15
  v_lshrrev_b32 v98, 3, v1
  v_lshlrev_b32 v96, 13, v98
  v_lshl_add_u32 v96, v224, 4, v96
  v_and_b32 v34, 3, v1
  s_lshl_b32 s37, s7, 21
  s_lshl_b32 s38, s5, 8
  s_add_u32 s37, s37, s38
  s_lshr_b32 s38, s6, 1
  s_lshl_b32 s38, s38, 7
  s_add_u32 s37, s37, s38
  v_add_u32 v96, s37, v96
  v_bfe_u32 v33, v1, 2, 2
  v_lshl_add_u32 v33, v226, 3, v33
  s_and_b32 s38, s6, 1
  s_lshl_b32 s38, s38, 6
  s_add_u32 s38, s38, s36
  v_lshlrev_b32 v97, 7, v33
  v_lshl_add_u32 v99, v34, 5, v97
  v_add_u32 v99, s36, v99
  v_lshl_add_u32 v97, v34, 3, v97
  v_add_u32 v97, s38, v97
  v_lshlrev_b32 v98, 11, v98
  v_lshl_add_u32 v98, v224, 4, v98
  s_lshl_b32 s37, s5, 18
  s_lshl_b32 s38, s6, 9
  s_add_u32 s37, s37, s38
  s_lshl_b32 s38, s7, 7
  s_add_u32 s37, s37, s38
  v_add_u32 v98, s37, v98
  s_waitcnt lgkmcnt(0)
  s_mov_b32 s12, s60
  s_mov_b32 s13, s61
  s_add_u32 m0, s36, 0
  s_mov_b32 s39, 0
  buffer_load_dwordx4 v96, s[12:15], s39 offen lds
  s_add_u32 m0, s36, 1024
  s_mov_b32 s39, 65536
  buffer_load_dwordx4 v96, s[12:15], s39 offen lds
  s_add_u32 m0, s36, 2048
  s_mov_b32 s39, 131072
  buffer_load_dwordx4 v96, s[12:15], s39 offen lds
  s_add_u32 m0, s36, 3072
  s_mov_b32 s39, 196608
  buffer_load_dwordx4 v96, s[12:15], s39 offen lds
  s_add_u32 m0, s36, 4096
  s_mov_b32 s39, 262144
  buffer_load_dwordx4 v96, s[12:15], s39 offen lds
  s_add_u32 m0, s36, 5120
  s_mov_b32 s39, 327680
  buffer_load_dwordx4 v96, s[12:15], s39 offen lds
  s_add_u32 m0, s36, 6144
  s_mov_b32 s39, 393216
  buffer_load_dwordx4 v96, s[12:15], s39 offen lds
  s_add_u32 m0, s36, 7168
  s_mov_b32 s39, 458752
  buffer_load_dwordx4 v96, s[12:15], s39 offen lds
  s_mov_b32 s12, s60
  s_mov_b32 s13, s61
  s_add_u32 m0, s36, 8192
  s_mov_b32 s39, 524288
  buffer_load_dwordx4 v96, s[12:15], s39 offen lds
  s_add_u32 m0, s36, 9216
  s_mov_b32 s39, 589824
  buffer_load_dwordx4 v96, s[12:15], s39 offen lds
  s_add_u32 m0, s36, 10240
  s_mov_b32 s39, 655360
  buffer_load_dwordx4 v96, s[12:15], s39 offen lds
  s_add_u32 m0, s36, 11264
  s_mov_b32 s39, 720896
  buffer_load_dwordx4 v96, s[12:15], s39 offen lds
  s_add_u32 m0, s36, 12288
  s_mov_b32 s39, 786432
  buffer_load_dwordx4 v96, s[12:15], s39 offen lds
  s_add_u32 m0, s36, 13312
  s_mov_b32 s39, 851968
  buffer_load_dwordx4 v96, s[12:15], s39 offen lds
  s_add_u32 m0, s36, 14336
  s_mov_b32 s39, 917504
  buffer_load_dwordx4 v96, s[12:15], s39 offen lds
  s_add_u32 m0, s36, 15360
  s_mov_b32 s39, 983040
  buffer_load_dwordx4 v96, s[12:15], s39 offen lds
  s_mov_b32 s12, s60
  s_mov_b32 s13, s61
  s_add_u32 m0, s36, 16384
  s_mov_b32 s39, 1048576
  buffer_load_dwordx4 v96, s[12:15], s39 offen lds
  s_add_u32 m0, s36, 17408
  s_mov_b32 s39, 1114112
  buffer_load_dwordx4 v96, s[12:15], s39 offen lds
  s_add_u32 m0, s36, 18432
  s_mov_b32 s39, 1179648
  buffer_load_dwordx4 v96, s[12:15], s39 offen lds
  s_add_u32 m0, s36, 19456
  s_mov_b32 s39, 1245184
  buffer_load_dwordx4 v96, s[12:15], s39 offen lds
  s_add_u32 m0, s36, 20480
  s_mov_b32 s39, 1310720
  buffer_load_dwordx4 v96, s[12:15], s39 offen lds
  s_add_u32 m0, s36, 21504
  s_mov_b32 s39, 1376256
  buffer_load_dwordx4 v96, s[12:15], s39 offen lds
  s_add_u32 m0, s36, 22528
  s_mov_b32 s39, 1441792
  buffer_load_dwordx4 v96, s[12:15], s39 offen lds
  s_add_u32 m0, s36, 23552
  s_mov_b32 s39, 1507328
  buffer_load_dwordx4 v96, s[12:15], s39 offen lds
  s_mov_b32 s12, s60
  s_mov_b32 s13, s61
  s_add_u32 m0, s36, 24576
  s_mov_b32 s39, 1572864
  buffer_load_dwordx4 v96, s[12:15], s39 offen lds
  s_add_u32 m0, s36, 25600
  s_mov_b32 s39, 1638400
  buffer_load_dwordx4 v96, s[12:15], s39 offen lds
  s_add_u32 m0, s36, 26624
  s_mov_b32 s39, 1703936
  buffer_load_dwordx4 v96, s[12:15], s39 offen lds
  s_add_u32 m0, s36, 27648
  s_mov_b32 s39, 1769472
  buffer_load_dwordx4 v96, s[12:15], s39 offen lds
  s_add_u32 m0, s36, 28672
  s_mov_b32 s39, 1835008
  buffer_load_dwordx4 v96, s[12:15], s39 offen lds
  s_add_u32 m0, s36, 29696
  s_mov_b32 s39, 1900544
  buffer_load_dwordx4 v96, s[12:15], s39 offen lds
  s_add_u32 m0, s36, 30720
  s_mov_b32 s39, 1966080
  buffer_load_dwordx4 v96, s[12:15], s39 offen lds
  s_add_u32 m0, s36, 31744
  s_mov_b32 s39, 2031616
  buffer_load_dwordx4 v96, s[12:15], s39 offen lds
  v_mov_b32 v0, 2147483648
  s_mul_i32 s40, s2, 49152
  s_add_u32 s40, s40, 3145728
  s_lshl_b32 s41, s7, 12
  s_add_u32 s41, s41, s40
  v_add_u32 v3, s41, v2
  s_lshl_b32 s42, s3, 2
  s_add_u32 s42, s42, s7
  s_lshr_b32 s41, s42, 1
  s_lshl_b32 s41, s41, 8
  s_and_b32 s43, s42, 1
  s_lshl_b32 s43, s43, 3
  s_add_u32 s41, s41, s43
  s_add_u32 s41, s41, s40
  v_lshlrev_b32 v33, 5, v224
  v_lshl_add_u32 v33, v225, 4, v33
  v_lshl_add_u32 v33, v226, 2, v33
  v_add_u32 v4, s41, v33
  v_cmp_gt_u32 vcc, 2, v226
  s_nop 1
  v_cndmask_b32 v4, v0, v4, vcc
  s_mul_i32 s44, s2, 393216
  s_add_u32 s44, s44, 4128768
  s_lshl_b32 s41, s42, 10
  s_add_u32 s45, s41, s44
  v_add_u32 v5, s45, v2
  v_and_b32 v33, 1, v226
  v_lshl_add_u32 v33, v33, 3, v224
  v_lshlrev_b32 v37, 4, v33
  v_add_u32 v33, s41, v37
  v_lshl_add_u32 v7, v225, 8, v33
  s_lshl_b32 s45, s2, 8
  v_add_u32 v8, s45, v33
  v_lshl_add_u32 v33, v226, 1, v225
  s_lshl_b32 s41, s6, 5
  s_lshl_b32 s43, s7, 3
  s_add_u32 s41, s41, s43
  v_add_u32 v33, s41, v33
  v_lshlrev_b32 v33, 10, v33
  v_lshl_add_u32 v33, v224, 4, v33
  s_and_b32 s41, s5, 7
  s_lshl_b32 s41, s41, 7
  s_add_u32 s41, s41, s44
  v_add_u32 v6, s41, v33
  s_lshl_b32 s41, s5, 13
  s_add_u32 s41, s41, 3342336
  s_lshl_b32 s43, s6, 11
  s_add_u32 s43, s43, s41
  v_add_u32 v9, s41, v2
  v_add_u32 v37, 1024, v37
  v_lshl_add_u32 v10, v225, 11, v37
  v_add_u32 v10, s41, v10
  v_add_u32 v13, s43, v37
  v_and_b32 v34, 0x28, v1
  v_cmp_eq_u32 vcc, 0x20, v34
  s_nop 1
  v_cndmask_b32 v13, v0, v13, vcc
  v_and_b32 v33, 1, v226
  v_lshl_add_u32 v33, v33, 1, v225
  v_lshlrev_b32 v33, 4, v33
  v_lshl_add_u32 v33, v224, 6, v33
  v_lshrrev_b32 v34, 1, v226
  v_lshl_add_u32 v33, v34, 11, v33
  v_add_u32 v33, 1536, v33
  v_add_u32 v11, s41, v33
  v_lshlrev_b32 v33, 4, v226
  v_lshl_add_u32 v33, v224, 6, v33
  s_lshl_b32 s44, s5, 2
  s_add_u32 s44, s44, s6
  s_lshl_b32 s45, s44, 15
  v_cmp_eq_u32 vcc, 0, v225
  s_cmp_eq_u32 s7, 0
  s_cbranch_scc1 mk_s_p_21
  v_mov_b32 v13, 2147483648
  v_add_u32 v12, 1536, v33
  v_add_u32 v12, s43, v12
  v_cndmask_b32 v12, v0, v12, vcc
  s_add_u32 s46, s45, 104857600
  v_add_u32 v14, s46, v33
  v_cndmask_b32 v14, v0, v14, vcc
  s_branch mk_s_p_22
mk_s_p_21:
  v_add_u32 v12, s43, v2
  s_add_u32 s46, s45, 100663296
  v_add_u32 v14, s46, v33
  v_cndmask_b32 v14, v14, v0, vcc
mk_s_p_22:
  s_bitcmp1_b32 s7, 0
  s_cbranch_scc0 mk_s_p_23
  v_mov_b32 v14, 2147483648
mk_s_p_23:
  v_and_b32 v33, 15, v1
  v_lshlrev_b32 v33, 6, v33
  v_lshl_add_u32 v33, v226, 4, v33
  s_lshl_b32 s45, s44, 17
  s_add_u32 s45, s45, 16777216
  v_add_u32 v31, s45, v33
  s_lshl_b32 s45, s5, 19
  s_add_u32 s45, s45, 33554432
  v_add_u32 v32, s45, v33
  s_mul_i32 s45, s7, 3120
  v_lshlrev_b32 v33, 8, v226
  v_and_b32 v34, 1, v226
  v_lshl_add_u32 v33, v34, 6, v33
  v_and_b32 v34, 15, v1
  v_lshl_add_u32 v15, v34, 2, v33
  v_bfe_u32 v34, v1, 1, 1
  v_lshlrev_b32 v34, 3, v34
  v_bfe_u32 v35, v1, 2, 2
  v_lshl_add_u32 v34, v35, 1, v34
  v_and_b32 v35, 1, v1
  v_add_u32 v34, v34, v35
  v_lshl_add_u32 v19, v34, 2, v33
  v_xor_b32 v16, 64, v15
  v_xor_b32 v20, 64, v19
  v_add_u32 v15, s45, v15
  v_add_u32 v16, s45, v16
  v_add_u32 v17, 1040, v15
  v_add_u32 v18, 1040, v16
  s_add_u32 s45, s45, 2080
  v_add_u32 v19, s45, v19
  v_add_u32 v20, s45, v20
  v_lshlrev_b32 v33, 7, v224
  v_and_b32 v36, 2, v224
  v_xor_b32 v36, v36, v226
  v_lshl_add_u32 v34, v36, 5, v33
  v_mul_u32_u24 v35, 1040, v225
  v_add_u32 v21, v34, v35
  s_cmp_eq_u32 s7, 0
  s_cbranch_scc1 mk_s_p_24
  v_mul_u32_u24 v35, 3120, v225
  v_add_u32 v35, 2080, v35
  v_add_u32 v21, v34, v35
  s_cmp_eq_u32 s7, 1
  s_cbranch_scc1 mk_s_p_24
  v_lshrrev_b32 v34, 1, v36
  v_lshl_add_u32 v33, v34, 6, v33
  v_and_b32 v34, 1, v226
  v_lshl_add_u32 v33, v34, 4, v33
  v_add_u32 v21, v33, v35
mk_s_p_24:
  v_add_u32 v22, 19456, v2
  v_xor_b32 v33, 128, v22
  v_add_u32 v34, 8, v22
  v_mov_b32 v35, 20480
  v_cmp_eq_u32 vcc, 0, v225
  s_nop 1
  v_cndmask_b32 v24, v35, v22, vcc
  v_cndmask_b32 v25, v35, v33, vcc
  v_cndmask_b32 v26, v35, v34, vcc
  v_cndmask_b32 v27, v33, v35, vcc
  v_cndmask_b32 v28, v22, v35, vcc
  v_cndmask_b32 v29, v34, v35, vcc
  v_mov_b32 v33, 0xeeee
  v_mov_b32 v34, 0x4444
  v_cndmask_b32 v30, v33, v34, vcc
  s_mov_b64 s[54:55], vcc
  v_and_b32 v35, 1, v1
  v_cmp_eq_u32 vcc, 0, v35
  s_nop 1
  v_cndmask_b32 v23, v33, v34, vcc
  v_and_b32 v33, 1, v224
  v_lshlrev_b32 v33, 4, v33
  v_mov_b32 v34, 0x3f80
  v_lshlrev_b32 v34, v33, v34
  v_lshrrev_b32 v33, 1, v224
  v_cmp_eq_u32 vcc, 0, v33
  v_mov_b32 v44, 0x3f803f80
  v_mov_b32 v52, -1
  v_cndmask_b32 v40, 0, v34, vcc
  v_cmp_eq_u32 vcc, 1, v33
  v_mov_b32 v45, 0x3f803f80
  v_mov_b32 v53, -1
  v_cndmask_b32 v41, 0, v34, vcc
  v_cmp_eq_u32 vcc, 2, v33
  v_mov_b32 v46, 0x3f803f80
  v_mov_b32 v54, -1
  v_cndmask_b32 v42, 0, v34, vcc
  v_cmp_eq_u32 vcc, 3, v33
  v_mov_b32 v47, 0x3f803f80
  v_mov_b32 v55, -1
  v_cndmask_b32 v43, 0, v34, vcc
  v_cmp_gt_u32 vcc, 2, v226
  v_mov_b32 v50, 0
  v_mov_b32 v51, 0
  v_cndmask_b32 v48, 0, v44, vcc
  v_cndmask_b32 v49, 0, v44, vcc
  v_mov_b32 v206, 0
  v_mov_b32 v207, 0
  v_mov_b32 v214, 0
  v_mov_b32 v215, 0
  v_mov_b32 v170, 0
  v_mov_b32 v171, 0
  v_mov_b32 v174, 0
  v_mov_b32 v175, 0
  v_mov_b32 v178, 0
  v_mov_b32 v179, 0
  v_mov_b32 v182, 0
  v_mov_b32 v183, 0
  s_mov_b32 s35, 0x3e0293ee
  s_mov_b32 s33, 4194304
  v_lshlrev_b32 v36, 11, v224
  v_and_b32 v33, 1, v226
  v_lshl_add_u32 v36, v33, 3, v36
  v_lshl_add_u32 v36, v225, 2, v36
  s_lshl_b32 s37, s42, 4
  v_add_u32 v36, s37, v36
  v_and_b32 v37, 0x28, v1
  s_waitcnt vmcnt(24)
  ds_read_b64_tr_b16 a[0:1], v97 offset:0
  ds_read_b64_tr_b16 a[2:3], v97 offset:512
  ds_read_b64_tr_b16 a[4:5], v97 offset:4096
  ds_read_b64_tr_b16 a[6:7], v97 offset:4608
  s_waitcnt lgkmcnt(8)
  ds_read_b64_tr_b16 a[8:9], v97 offset:32
  ds_read_b64_tr_b16 a[10:11], v97 offset:544
  ds_read_b64_tr_b16 a[12:13], v97 offset:4128
  ds_read_b64_tr_b16 a[14:15], v97 offset:4640
  s_waitcnt lgkmcnt(8)
  s_waitcnt lgkmcnt(0)
  s_mov_b32 s12, s66
  s_mov_b32 s13, s67
  s_add_u32 m0, s36, 0
  s_mov_b32 s39, 0
  buffer_load_dwordx4 v98, s[12:15], s39 offen lds
  s_add_u32 m0, s36, 1024
  s_mov_b32 s39, 16384
  buffer_load_dwordx4 v98, s[12:15], s39 offen lds
  s_add_u32 m0, s36, 2048
  s_mov_b32 s39, 32768
  buffer_load_dwordx4 v98, s[12:15], s39 offen lds
  s_add_u32 m0, s36, 3072
  s_mov_b32 s39, 49152
  buffer_load_dwordx4 v98, s[12:15], s39 offen lds
  s_add_u32 m0, s36, 4096
  s_mov_b32 s39, 65536
  buffer_load_dwordx4 v98, s[12:15], s39 offen lds
  s_add_u32 m0, s36, 5120
  s_mov_b32 s39, 81920
  buffer_load_dwordx4 v98, s[12:15], s39 offen lds
  s_add_u32 m0, s36, 6144
  s_mov_b32 s39, 98304
  buffer_load_dwordx4 v98, s[12:15], s39 offen lds
  s_add_u32 m0, s36, 7168
  s_mov_b32 s39, 114688
  buffer_load_dwordx4 v98, s[12:15], s39 offen lds
  s_waitcnt vmcnt(24)
  ds_read_b64_tr_b16 a[16:17], v97 offset:8192
  ds_read_b64_tr_b16 a[18:19], v97 offset:8704
  ds_read_b64_tr_b16 a[20:21], v97 offset:12288
  ds_read_b64_tr_b16 a[22:23], v97 offset:12800
  s_waitcnt lgkmcnt(8)
  ds_read_b64_tr_b16 a[24:25], v97 offset:8224
  ds_read_b64_tr_b16 a[26:27], v97 offset:8736
  ds_read_b64_tr_b16 a[28:29], v97 offset:12320
  ds_read_b64_tr_b16 a[30:31], v97 offset:12832
  s_waitcnt lgkmcnt(8)
  s_waitcnt lgkmcnt(0)
  s_mov_b32 s12, s66
  s_mov_b32 s13, s67
  s_add_u32 m0, s36, 8192
  s_mov_b32 s39, 131072
  buffer_load_dwordx4 v98, s[12:15], s39 offen lds
  s_add_u32 m0, s36, 9216
  s_mov_b32 s39, 147456
  buffer_load_dwordx4 v98, s[12:15], s39 offen lds
  s_add_u32 m0, s36, 10240
  s_mov_b32 s39, 163840
  buffer_load_dwordx4 v98, s[12:15], s39 offen lds
  s_add_u32 m0, s36, 11264
  s_mov_b32 s39, 180224
  buffer_load_dwordx4 v98, s[12:15], s39 offen lds
  s_add_u32 m0, s36, 12288
  s_mov_b32 s39, 196608
  buffer_load_dwordx4 v98, s[12:15], s39 offen lds
  s_add_u32 m0, s36, 13312
  s_mov_b32 s39, 212992
  buffer_load_dwordx4 v98, s[12:15], s39 offen lds
  s_add_u32 m0, s36, 14336
  s_mov_b32 s39, 229376
  buffer_load_dwordx4 v98, s[12:15], s39 offen lds
  s_add_u32 m0, s36, 15360
  s_mov_b32 s39, 245760
  buffer_load_dwordx4 v98, s[12:15], s39 offen lds
  s_waitcnt vmcnt(24)
  ds_read_b64_tr_b16 a[32:33], v97 offset:16384
  ds_read_b64_tr_b16 a[34:35], v97 offset:16896
  ds_read_b64_tr_b16 a[36:37], v97 offset:20480
  ds_read_b64_tr_b16 a[38:39], v97 offset:20992
  s_waitcnt lgkmcnt(8)
  ds_read_b64_tr_b16 a[40:41], v97 offset:16416
  ds_read_b64_tr_b16 a[42:43], v97 offset:16928
  ds_read_b64_tr_b16 a[44:45], v97 offset:20512
  ds_read_b64_tr_b16 a[46:47], v97 offset:21024
  s_waitcnt lgkmcnt(8)
  s_waitcnt lgkmcnt(0)
  s_mov_b32 s12, s62
  s_mov_b32 s13, s63
  s_add_u32 m0, s36, 16384
  s_mov_b32 s39, 0
  buffer_load_dwordx4 v96, s[12:15], s39 offen lds
  s_add_u32 m0, s36, 17408
  s_mov_b32 s39, 65536
  buffer_load_dwordx4 v96, s[12:15], s39 offen lds
  s_add_u32 m0, s36, 18432
  s_mov_b32 s39, 131072
  buffer_load_dwordx4 v96, s[12:15], s39 offen lds
  s_add_u32 m0, s36, 19456
  s_mov_b32 s39, 196608
  buffer_load_dwordx4 v96, s[12:15], s39 offen lds
  s_add_u32 m0, s36, 20480
  s_mov_b32 s39, 262144
  buffer_load_dwordx4 v96, s[12:15], s39 offen lds
  s_add_u32 m0, s36, 21504
  s_mov_b32 s39, 327680
  buffer_load_dwordx4 v96, s[12:15], s39 offen lds
  s_add_u32 m0, s36, 22528
  s_mov_b32 s39, 393216
  buffer_load_dwordx4 v96, s[12:15], s39 offen lds
  s_add_u32 m0, s36, 23552
  s_mov_b32 s39, 458752
  buffer_load_dwordx4 v96, s[12:15], s39 offen lds
  s_waitcnt vmcnt(24)
  ds_read_b64_tr_b16 a[48:49], v97 offset:24576
  ds_read_b64_tr_b16 a[50:51], v97 offset:25088
  ds_read_b64_tr_b16 a[52:53], v97 offset:28672
  ds_read_b64_tr_b16 a[54:55], v97 offset:29184
  s_waitcnt lgkmcnt(8)
  ds_read_b64_tr_b16 a[56:57], v97 offset:24608
  ds_read_b64_tr_b16 a[58:59], v97 offset:25120
  ds_read_b64_tr_b16 a[60:61], v97 offset:28704
  ds_read_b64_tr_b16 a[62:63], v97 offset:29216
  s_waitcnt lgkmcnt(8)
  s_waitcnt lgkmcnt(0)
  s_mov_b32 s12, s62
  s_mov_b32 s13, s63
  s_add_u32 m0, s36, 24576
  s_mov_b32 s39, 524288
  buffer_load_dwordx4 v96, s[12:15], s39 offen lds
  s_add_u32 m0, s36, 25600
  s_mov_b32 s39, 589824
  buffer_load_dwordx4 v96, s[12:15], s39 offen lds
  s_add_u32 m0, s36, 26624
  s_mov_b32 s39, 655360
  buffer_load_dwordx4 v96, s[12:15], s39 offen lds
  s_add_u32 m0, s36, 27648
  s_mov_b32 s39, 720896
  buffer_load_dwordx4 v96, s[12:15], s39 offen lds
  s_add_u32 m0, s36, 28672
  s_mov_b32 s39, 786432
  buffer_load_dwordx4 v96, s[12:15], s39 offen lds
  s_add_u32 m0, s36, 29696
  s_mov_b32 s39, 851968
  buffer_load_dwordx4 v96, s[12:15], s39 offen lds
  s_add_u32 m0, s36, 30720
  s_mov_b32 s39, 917504
  buffer_load_dwordx4 v96, s[12:15], s39 offen lds
  s_add_u32 m0, s36, 31744
  s_mov_b32 s39, 983040
  buffer_load_dwordx4 v96, s[12:15], s39 offen lds
  s_waitcnt vmcnt(24)
  ds_read_b64_tr_b16 a[192:193], v99 offset:0
  ds_read_b64_tr_b16 a[194:195], v99 offset:512
  ds_read_b64_tr_b16 a[196:197], v99 offset:4096
  ds_read_b64_tr_b16 a[198:199], v99 offset:4608
  s_waitcnt lgkmcnt(8)
  ds_read_b64_tr_b16 a[200:201], v99 offset:8
  ds_read_b64_tr_b16 a[202:203], v99 offset:520
  ds_read_b64_tr_b16 a[204:205], v99 offset:4104
  ds_read_b64_tr_b16 a[206:207], v99 offset:4616
  s_waitcnt lgkmcnt(8)
  ds_read_b64_tr_b16 a[208:209], v99 offset:16
  ds_read_b64_tr_b16 a[210:211], v99 offset:528
  ds_read_b64_tr_b16 a[212:213], v99 offset:4112
  ds_read_b64_tr_b16 a[214:215], v99 offset:4624
  s_waitcnt lgkmcnt(8)
  ds_read_b64_tr_b16 a[216:217], v99 offset:24
  ds_read_b64_tr_b16 a[218:219], v99 offset:536
  ds_read_b64_tr_b16 a[220:221], v99 offset:4120
  ds_read_b64_tr_b16 a[222:223], v99 offset:4632
  s_waitcnt lgkmcnt(8)
  s_waitcnt lgkmcnt(0)
  s_mov_b32 s12, s62
  s_mov_b32 s13, s63
  s_add_u32 m0, s36, 0
  s_mov_b32 s39, 1048576
  buffer_load_dwordx4 v96, s[12:15], s39 offen lds
  s_add_u32 m0, s36, 1024
  s_mov_b32 s39, 1114112
  buffer_load_dwordx4 v96, s[12:15], s39 offen lds
  s_add_u32 m0, s36, 2048
  s_mov_b32 s39, 1179648
  buffer_load_dwordx4 v96, s[12:15], s39 offen lds
  s_add_u32 m0, s36, 3072
  s_mov_b32 s39, 1245184
  buffer_load_dwordx4 v96, s[12:15], s39 offen lds
  s_add_u32 m0, s36, 4096
  s_mov_b32 s39, 1310720
  buffer_load_dwordx4 v96, s[12:15], s39 offen lds
  s_add_u32 m0, s36, 5120
  s_mov_b32 s39, 1376256
  buffer_load_dwordx4 v96, s[12:15], s39 offen lds
  s_add_u32 m0, s36, 6144
  s_mov_b32 s39, 1441792
  buffer_load_dwordx4 v96, s[12:15], s39 offen lds
  s_add_u32 m0, s36, 7168
  s_mov_b32 s39, 1507328
  buffer_load_dwordx4 v96, s[12:15], s39 offen lds
  s_waitcnt vmcnt(24)
  ds_read_b64_tr_b16 a[224:225], v99 offset:8192
  ds_read_b64_tr_b16 a[226:227], v99 offset:8704
  ds_read_b64_tr_b16 a[228:229], v99 offset:12288
  ds_read_b64_tr_b16 a[230:231], v99 offset:12800
  s_waitcnt lgkmcnt(8)
  ds_read_b64_tr_b16 a[232:233], v99 offset:8200
  ds_read_b64_tr_b16 a[234:235], v99 offset:8712
  ds_read_b64_tr_b16 a[236:237], v99 offset:12296
  ds_read_b64_tr_b16 a[238:239], v99 offset:12808
  s_waitcnt lgkmcnt(8)
  ds_read_b64_tr_b16 a[240:241], v99 offset:8208
  ds_read_b64_tr_b16 a[242:243], v99 offset:8720
  ds_read_b64_tr_b16 a[244:245], v99 offset:12304
  ds_read_b64_tr_b16 a[246:247], v99 offset:12816
  s_waitcnt lgkmcnt(8)
  ds_read_b64_tr_b16 a[248:249], v99 offset:8216
  ds_read_b64_tr_b16 a[250:251], v99 offset:8728
  ds_read_b64_tr_b16 a[252:253], v99 offset:12312
  ds_read_b64_tr_b16 a[254:255], v99 offset:12824
  s_waitcnt lgkmcnt(8)
  s_waitcnt lgkmcnt(0)
  s_mov_b32 s12, s62
  s_mov_b32 s13, s63
  s_add_u32 m0, s36, 8192
  s_mov_b32 s39, 1572864
  buffer_load_dwordx4 v96, s[12:15], s39 offen lds
  s_add_u32 m0, s36, 9216
  s_mov_b32 s39, 1638400
  buffer_load_dwordx4 v96, s[12:15], s39 offen lds
  s_add_u32 m0, s36, 10240
  s_mov_b32 s39, 1703936
  buffer_load_dwordx4 v96, s[12:15], s39 offen lds
  s_add_u32 m0, s36, 11264
  s_mov_b32 s39, 1769472
  buffer_load_dwordx4 v96, s[12:15], s39 offen lds
  s_add_u32 m0, s36, 12288
  s_mov_b32 s39, 1835008
  buffer_load_dwordx4 v96, s[12:15], s39 offen lds
  s_add_u32 m0, s36, 13312
  s_mov_b32 s39, 1900544
  buffer_load_dwordx4 v96, s[12:15], s39 offen lds
  s_add_u32 m0, s36, 14336
  s_mov_b32 s39, 1966080
  buffer_load_dwordx4 v96, s[12:15], s39 offen lds
  s_add_u32 m0, s36, 15360
  s_mov_b32 s39, 2031616
  buffer_load_dwordx4 v96, s[12:15], s39 offen lds
  s_waitcnt vmcnt(24)
  ds_read_b64_tr_b16 a[64:65], v97 offset:16384
  ds_read_b64_tr_b16 a[66:67], v97 offset:16896
  ds_read_b64_tr_b16 a[68:69], v97 offset:20480
  ds_read_b64_tr_b16 a[70:71], v97 offset:20992
  s_waitcnt lgkmcnt(8)
  ds_read_b64_tr_b16 a[72:73], v97 offset:16416
  ds_read_b64_tr_b16 a[74:75], v97 offset:16928
  ds_read_b64_tr_b16 a[76:77], v97 offset:20512
  ds_read_b64_tr_b16 a[78:79], v97 offset:21024
  s_waitcnt lgkmcnt(8)
  s_waitcnt lgkmcnt(0)
  s_mov_b32 s12, s64
  s_mov_b32 s13, s65
  s_add_u32 m0, s36, 16384
  s_mov_b32 s39, 0
  buffer_load_dwordx4 v96, s[12:15], s39 offen lds
  s_add_u32 m0, s36, 17408
  s_mov_b32 s39, 65536
  buffer_load_dwordx4 v96, s[12:15], s39 offen lds
  s_add_u32 m0, s36, 18432
  s_mov_b32 s39, 131072
  buffer_load_dwordx4 v96, s[12:15], s39 offen lds
  s_add_u32 m0, s36, 19456
  s_mov_b32 s39, 196608
  buffer_load_dwordx4 v96, s[12:15], s39 offen lds
  s_add_u32 m0, s36, 20480
  s_mov_b32 s39, 262144
  buffer_load_dwordx4 v96, s[12:15], s39 offen lds
  s_add_u32 m0, s36, 21504
  s_mov_b32 s39, 327680
  buffer_load_dwordx4 v96, s[12:15], s39 offen lds
  s_add_u32 m0, s36, 22528
  s_mov_b32 s39, 393216
  buffer_load_dwordx4 v96, s[12:15], s39 offen lds
  s_add_u32 m0, s36, 23552
  s_mov_b32 s39, 458752
  buffer_load_dwordx4 v96, s[12:15], s39 offen lds
  s_waitcnt vmcnt(24)
  ds_read_b64_tr_b16 a[80:81], v97 offset:24576
  ds_read_b64_tr_b16 a[82:83], v97 offset:25088
  ds_read_b64_tr_b16 a[84:85], v97 offset:28672
  ds_read_b64_tr_b16 a[86:87], v97 offset:29184
  s_waitcnt lgkmcnt(8)
  ds_read_b64_tr_b16 a[88:89], v97 offset:24608
  ds_read_b64_tr_b16 a[90:91], v97 offset:25120
  ds_read_b64_tr_b16 a[92:93], v97 offset:28704
  ds_read_b64_tr_b16 a[94:95], v97 offset:29216
  s_waitcnt lgkmcnt(8)
  s_waitcnt lgkmcnt(0)
  s_mov_b32 s12, s64
  s_mov_b32 s13, s65
  s_add_u32 m0, s36, 24576
  s_mov_b32 s39, 524288
  buffer_load_dwordx4 v96, s[12:15], s39 offen lds
  s_add_u32 m0, s36, 25600
  s_mov_b32 s39, 589824
  buffer_load_dwordx4 v96, s[12:15], s39 offen lds
  s_add_u32 m0, s36, 26624
  s_mov_b32 s39, 655360
  buffer_load_dwordx4 v96, s[12:15], s39 offen lds
  s_add_u32 m0, s36, 27648
  s_mov_b32 s39, 720896
  buffer_load_dwordx4 v96, s[12:15], s39 offen lds
  s_add_u32 m0, s36, 28672
  s_mov_b32 s39, 786432
  buffer_load_dwordx4 v96, s[12:15], s39 offen lds
  s_add_u32 m0, s36, 29696
  s_mov_b32 s39, 851968
  buffer_load_dwordx4 v96, s[12:15], s39 offen lds
  s_add_u32 m0, s36, 30720
  s_mov_b32 s39, 917504
  buffer_load_dwordx4 v96, s[12:15], s39 offen lds
  s_add_u32 m0, s36, 31744
  s_mov_b32 s39, 983040
  buffer_load_dwordx4 v96, s[12:15], s39 offen lds
  s_waitcnt vmcnt(24)
  ds_read_b64_tr_b16 a[96:97], v97 offset:0
  ds_read_b64_tr_b16 a[98:99], v97 offset:512
  ds_read_b64_tr_b16 a[100:101], v97 offset:4096
  ds_read_b64_tr_b16 a[102:103], v97 offset:4608
  s_waitcnt lgkmcnt(8)
  ds_read_b64_tr_b16 a[104:105], v97 offset:32
  ds_read_b64_tr_b16 a[106:107], v97 offset:544
  ds_read_b64_tr_b16 a[108:109], v97 offset:4128
  ds_read_b64_tr_b16 a[110:111], v97 offset:4640
  s_waitcnt lgkmcnt(8)
  s_waitcnt lgkmcnt(0)
  s_mov_b32 s12, s64
  s_mov_b32 s13, s65
  s_add_u32 m0, s36, 0
  s_mov_b32 s39, 1048576
  buffer_load_dwordx4 v96, s[12:15], s39 offen lds
  s_add_u32 m0, s36, 1024
  s_mov_b32 s39, 1114112
  buffer_load_dwordx4 v96, s[12:15], s39 offen lds
  s_add_u32 m0, s36, 2048
  s_mov_b32 s39, 1179648
  buffer_load_dwordx4 v96, s[12:15], s39 offen lds
  s_add_u32 m0, s36, 3072
  s_mov_b32 s39, 1245184
  buffer_load_dwordx4 v96, s[12:15], s39 offen lds
  s_add_u32 m0, s36, 4096
  s_mov_b32 s39, 1310720
  buffer_load_dwordx4 v96, s[12:15], s39 offen lds
  s_add_u32 m0, s36, 5120
  s_mov_b32 s39, 1376256
  buffer_load_dwordx4 v96, s[12:15], s39 offen lds
  s_add_u32 m0, s36, 6144
  s_mov_b32 s39, 1441792
  buffer_load_dwordx4 v96, s[12:15], s39 offen lds
  s_add_u32 m0, s36, 7168
  s_mov_b32 s39, 1507328
  buffer_load_dwordx4 v96, s[12:15], s39 offen lds
  s_waitcnt vmcnt(24)
  ds_read_b64_tr_b16 a[112:113], v97 offset:8192
  ds_read_b64_tr_b16 a[114:115], v97 offset:8704
  ds_read_b64_tr_b16 a[116:117], v97 offset:12288
  ds_read_b64_tr_b16 a[118:119], v97 offset:12800
  s_waitcnt lgkmcnt(8)
  ds_read_b64_tr_b16 a[120:121], v97 offset:8224
  ds_read_b64_tr_b16 a[122:123], v97 offset:8736
  ds_read_b64_tr_b16 a[124:125], v97 offset:12320
  ds_read_b64_tr_b16 a[126:127], v97 offset:12832
  s_waitcnt lgkmcnt(8)
  s_waitcnt lgkmcnt(0)
  s_mov_b32 s12, s64
  s_mov_b32 s13, s65
  s_add_u32 m0, s36, 8192
  s_mov_b32 s39, 1572864
  buffer_load_dwordx4 v96, s[12:15], s39 offen lds
  s_add_u32 m0, s36, 9216
  s_mov_b32 s39, 1638400
  buffer_load_dwordx4 v96, s[12:15], s39 offen lds
  s_add_u32 m0, s36, 10240
  s_mov_b32 s39, 1703936
  buffer_load_dwordx4 v96, s[12:15], s39 offen lds
  s_add_u32 m0, s36, 11264
  s_mov_b32 s39, 1769472
  buffer_load_dwordx4 v96, s[12:15], s39 offen lds
  s_add_u32 m0, s36, 12288
  s_mov_b32 s39, 1835008
  buffer_load_dwordx4 v96, s[12:15], s39 offen lds
  s_add_u32 m0, s36, 13312
  s_mov_b32 s39, 1900544
  buffer_load_dwordx4 v96, s[12:15], s39 offen lds
  s_add_u32 m0, s36, 14336
  s_mov_b32 s39, 1966080
  buffer_load_dwordx4 v96, s[12:15], s39 offen lds
  s_add_u32 m0, s36, 15360
  s_mov_b32 s39, 2031616
  buffer_load_dwordx4 v96, s[12:15], s39 offen lds
  s_waitcnt vmcnt(24)
  ds_read_b64_tr_b16 a[128:129], v97 offset:16384
  ds_read_b64_tr_b16 a[130:131], v97 offset:16896
  ds_read_b64_tr_b16 a[132:133], v97 offset:20480
  ds_read_b64_tr_b16 a[134:135], v97 offset:20992
  s_waitcnt lgkmcnt(8)
  ds_read_b64_tr_b16 a[136:137], v97 offset:16416
  ds_read_b64_tr_b16 a[138:139], v97 offset:16928
  ds_read_b64_tr_b16 a[140:141], v97 offset:20512
  ds_read_b64_tr_b16 a[142:143], v97 offset:21024
  s_waitcnt lgkmcnt(8)
  s_waitcnt lgkmcnt(0)
  s_waitcnt vmcnt(16)
  ds_read_b64_tr_b16 a[144:145], v97 offset:24576
  ds_read_b64_tr_b16 a[146:147], v97 offset:25088
  ds_read_b64_tr_b16 a[148:149], v97 offset:28672
  ds_read_b64_tr_b16 a[150:151], v97 offset:29184
  s_waitcnt lgkmcnt(8)
  ds_read_b64_tr_b16 a[152:153], v97 offset:24608
  ds_read_b64_tr_b16 a[154:155], v97 offset:25120
  ds_read_b64_tr_b16 a[156:157], v97 offset:28704
  ds_read_b64_tr_b16 a[158:159], v97 offset:29216
  s_waitcnt lgkmcnt(8)
  s_waitcnt lgkmcnt(0)
  s_waitcnt vmcnt(8)
  ds_read_b64_tr_b16 a[160:161], v97 offset:0
  ds_read_b64_tr_b16 a[162:163], v97 offset:512
  ds_read_b64_tr_b16 a[164:165], v97 offset:4096
  ds_read_b64_tr_b16 a[166:167], v97 offset:4608
  s_waitcnt lgkmcnt(8)
  ds_read_b64_tr_b16 a[168:169], v97 offset:32
  ds_read_b64_tr_b16 a[170:171], v97 offset:544
  ds_read_b64_tr_b16 a[172:173], v97 offset:4128
  ds_read_b64_tr_b16 a[174:175], v97 offset:4640
  s_waitcnt lgkmcnt(8)
  s_waitcnt lgkmcnt(0)
  s_waitcnt vmcnt(0)
  ds_read_b64_tr_b16 a[176:177], v97 offset:8192
  ds_read_b64_tr_b16 a[178:179], v97 offset:8704
  ds_read_b64_tr_b16 a[180:181], v97 offset:12288
  ds_read_b64_tr_b16 a[182:183], v97 offset:12800
  s_waitcnt lgkmcnt(8)
  ds_read_b64_tr_b16 a[184:185], v97 offset:8224
  ds_read_b64_tr_b16 a[186:187], v97 offset:8736
  ds_read_b64_tr_b16 a[188:189], v97 offset:12320
  ds_read_b64_tr_b16 a[190:191], v97 offset:12832
  s_waitcnt lgkmcnt(8)
  s_waitcnt lgkmcnt(0)
  s_cmp_eq_u32 s7, 2
  s_cbranch_scc0 mk_s_p_26
  v_lshrrev_b32 v33, 4, v1
  v_lshlrev_b32 v33, 10, v33
  v_and_b32 v34, 15, v1
  v_lshl_add_u32 v12, v34, 4, v33
  s_lshl_b32 s37, s3, 12
  s_lshl_b32 s38, s2, 8
  s_add_u32 s37, s37, s38
  v_add_u32 v12, s37, v12
  v_lshrrev_b32 v34, 13, v12
  v_lshlrev_b32 v34, 14, v34
  v_and_b32 v12, 8191, v12
  v_add_u32 v12, v12, v34
  s_lshl_b32 s43, s4, 13
  s_add_u32 s43, s43, 0
  v_add_u32 v12, s43, v12
  s_lshl_b32 s37, s3, 9
  s_add_u32 s37, s37, s40
  v_add_u32 v13, s37, v2
  v_cmp_gt_u32 vcc, 32, v1
  s_nop 1
  v_cndmask_b32 v13, v0, v13, vcc
mk_s_p_26:
  v_lshrrev_b32 v34, 13, v7
  v_lshlrev_b32 v34, 14, v34
  v_and_b32 v7, 8191, v7
  v_add_u32 v7, v7, v34
  s_lshl_b32 s43, s4, 13
  s_add_u32 s43, s43, 0
  v_add_u32 v7, s43, v7
  v_lshrrev_b32 v34, 13, v8
  v_lshlrev_b32 v34, 14, v34
  v_and_b32 v8, 8191, v8
  v_add_u32 v8, v8, v34
  s_lshl_b32 s43, s4, 13
  s_add_u32 s43, s43, 0
  v_add_u32 v8, s43, v8
  v_cmp_eq_u32 vcc, 0, v37
  s_nop 1
  v_cndmask_b32 v8, v0, v8, vcc
  s_load_dwordx2 s[12:13], s[0:1], 8
  s_mov_b32 s14, 16384
  s_waitcnt lgkmcnt(0)
  buffer_load_dword v216, v36, s[12:15], 0 offen
  s_barrier
  v_mov_b32 v33, 0
  v_mov_b32 v34, 20480
  ds_write_b32 v34, v33
  ds_write_b32 v34, v33 offset:4
  s_mov_b32 s16, 0
  s_mov_b32 s17, 16384
  s_mov_b32 s18, 32768
  s_mov_b32 s19, 0
  s_mov_b32 s20, 262144
  s_mov_b32 s21, 524288
  s_mov_b32 s23, 0
  s_mov_b32 s24, 131072
  s_mov_b32 s25, 262144
  s_mov_b32 s26, 0
  s_mov_b32 s27, 262144
  s_mov_b32 s28, 524288
  s_mov_b32 s32, 0
  s_mov_b32 s34, 0
  s_waitcnt vmcnt(0)
  buffer_store_dword v216, v4, s[8:11], 0 offen sc1
  s_lshl_b32 s52, s5, 7
  s_lshl_b32 s36, s6, 2
  s_add_u32 s52, s52, s36
  s_add_u32 s52, s52, 5705728
  s_lshl_b32 s53, s5, 3
  s_add_u32 s53, s53, 5701632
  v_mov_b32 v34, 0
mk_s_p_27:
  buffer_load_dwordx2 v[38:39], v34, s[8:11], s53 offen sc1
  s_waitcnt vmcnt(0)
  v_max_u32 v33, v38, v39
  v_cmp_eq_u32 vcc, -1, v33
  s_cbranch_vccz mk_s_p_28
  s_sub_u32 s33, s33, 1
  s_cbranch_scc1 mk_end
  s_sleep 2
  s_branch mk_s_p_27
mk_s_p_28:
  s_lshl_b32 s48, s7, 11
  s_mul_i32 s51, s7, 10240
  s_add_u32 s51, s51, 21504
  s_cmp_gt_u32 s7, 1
  s_cbranch_scc1 mk_s_p_29
  s_add_u32 m0, s51, 0
  s_add_u32 s36, s48, 0
  buffer_load_dwordx4 v32, s[8:11], s36 offen sc1 lds
  s_add_u32 m0, s51, 1024
  s_add_u32 s36, s48, 131072
  buffer_load_dwordx4 v32, s[8:11], s36 offen sc1 lds
  s_add_u32 m0, s51, 2048
  s_add_u32 s36, s48, 262144
  buffer_load_dwordx4 v32, s[8:11], s36 offen sc1 lds
  s_add_u32 m0, s51, 3072
  s_add_u32 s36, s48, 393216
  buffer_load_dwordx4 v32, s[8:11], s36 offen sc1 lds
  s_add_u32 m0, s51, 8192
  s_add_u32 s36, s48, 0
  buffer_load_dwordx4 v31, s[8:11], s36 offen sc1 lds
  s_add_u32 m0, s51, 4096
  s_add_u32 s36, s48, 1024
  buffer_load_dwordx4 v32, s[8:11], s36 offen sc1 lds
  s_add_u32 m0, s51, 5120
  s_add_u32 s36, s48, 132096
  buffer_load_dwordx4 v32, s[8:11], s36 offen sc1 lds
  s_add_u32 m0, s51, 6144
  s_add_u32 s36, s48, 263168
  buffer_load_dwordx4 v32, s[8:11], s36 offen sc1 lds
  s_add_u32 m0, s51, 7168
  s_add_u32 s36, s48, 394240
  buffer_load_dwordx4 v32, s[8:11], s36 offen sc1 lds
  s_add_u32 m0, s51, 9216
  s_add_u32 s36, s48, 1024
  buffer_load_dwordx4 v31, s[8:11], s36 offen sc1 lds
mk_s_p_29:
  s_mov_b32 s51, 21504
  s_waitcnt vmcnt(0) lgkmcnt(0)
  s_barrier
  v_add_u32 v36, s51, v2
  ds_read_b128 v[224:227], v36 offset:0
  ds_read_b128 v[228:231], v36 offset:1024
  ds_read_b128 v[232:235], v36 offset:2048
  ds_read_b128 v[236:239], v36 offset:3072
  ds_read_b128 v[240:243], v36 offset:4096
  ds_read_b128 v[244:247], v36 offset:5120
  ds_read_b128 v[248:251], v36 offset:6144
  ds_read_b128 v[252:255], v36 offset:7168
  ds_read_b128 v[132:135], v36 offset:8192
  ds_read_b128 v[136:139], v36 offset:9216
  s_waitcnt lgkmcnt(0)
  v_mfma_f32_16x16x32_bf16 v[96:99], v[224:227], a[192:195], 0
  v_mfma_f32_16x16x32_bf16 v[96:99], v[228:231], a[196:199], v[96:99]
  v_mfma_f32_16x16x32_bf16 v[96:99], v[232:235], a[224:227], v[96:99]
  v_mfma_f32_16x16x32_bf16 v[96:99], v[236:239], a[228:231], v[96:99]
  v_mfma_f32_16x16x32_bf16 v[100:103], v[240:243], a[192:195], 0
  v_mfma_f32_16x16x32_bf16 v[100:103], v[244:247], a[196:199], v[100:103]
  v_mfma_f32_16x16x32_bf16 v[100:103], v[248:251], a[224:227], v[100:103]
  v_mfma_f32_16x16x32_bf16 v[100:103], v[252:255], a[228:231], v[100:103]
  v_mfma_f32_16x16x32_bf16 v[104:107], v[224:227], a[200:203], 0
  v_mfma_f32_16x16x32_bf16 v[104:107], v[228:231], a[204:207], v[104:107]
  v_mfma_f32_16x16x32_bf16 v[104:107], v[232:235], a[232:235], v[104:107]
  v_mfma_f32_16x16x32_bf16 v[104:107], v[236:239], a[236:239], v[104:107]
  v_mfma_f32_16x16x32_bf16 v[108:111], v[240:243], a[200:203], 0
  v_mfma_f32_16x16x32_bf16 v[108:111], v[244:247], a[204:207], v[108:111]
  v_mfma_f32_16x16x32_bf16 v[108:111], v[248:251], a[232:235], v[108:111]
  v_mfma_f32_16x16x32_bf16 v[108:111], v[252:255], a[236:239], v[108:111]
  v_cvt_pk_bf16_f32 v184, v96, v97
  v_cvt_pk_bf16_f32 v185, v98, v99
  v_cvt_pk_bf16_f32 v186, v100, v101
  v_cvt_pk_bf16_f32 v187, v102, v103
  v_mfma_f32_16x16x32_bf16 v[112:115], v[224:227], a[208:211], 0
  v_mfma_f32_16x16x32_bf16 v[112:115], v[228:231], a[212:215], v[112:115]
  v_mfma_f32_16x16x32_bf16 v[112:115], v[232:235], a[240:243], v[112:115]
  v_mfma_f32_16x16x32_bf16 v[112:115], v[236:239], a[244:247], v[112:115]
  v_mfma_f32_16x16x32_bf16 v[116:119], v[240:243], a[208:211], 0
  v_mfma_f32_16x16x32_bf16 v[116:119], v[244:247], a[212:215], v[116:119]
  v_mfma_f32_16x16x32_bf16 v[116:119], v[248:251], a[240:243], v[116:119]
  v_mfma_f32_16x16x32_bf16 v[116:119], v[252:255], a[244:247], v[116:119]
  v_cvt_pk_bf16_f32 v188, v104, v105
  v_cvt_pk_bf16_f32 v189, v106, v107
  v_cvt_pk_bf16_f32 v190, v108, v109
  v_cvt_pk_bf16_f32 v191, v110, v111
  v_mfma_f32_16x16x32_bf16 v[120:123], v[224:227], a[216:219], 0
  v_mfma_f32_16x16x32_bf16 v[120:123], v[228:231], a[220:223], v[120:123]
  v_mfma_f32_16x16x32_bf16 v[120:123], v[232:235], a[248:251], v[120:123]
  v_mfma_f32_16x16x32_bf16 v[120:123], v[236:239], a[252:255], v[120:123]
  v_mfma_f32_16x16x32_bf16 v[124:127], v[240:243], a[216:219], 0
  v_mfma_f32_16x16x32_bf16 v[124:127], v[244:247], a[220:223], v[124:127]
  v_mfma_f32_16x16x32_bf16 v[124:127], v[248:251], a[248:251], v[124:127]
  v_mfma_f32_16x16x32_bf16 v[124:127], v[252:255], a[252:255], v[124:127]
  v_cvt_pk_bf16_f32 v192, v112, v113
  v_cvt_pk_bf16_f32 v193, v114, v115
  v_cvt_pk_bf16_f32 v194, v116, v117
  v_cvt_pk_bf16_f32 v195, v118, v119
  s_nop 7
  v_cvt_pk_bf16_f32 v196, v120, v121
  v_cvt_pk_bf16_f32 v197, v122, v123
  v_cvt_pk_bf16_f32 v198, v124, v125
  v_cvt_pk_bf16_f32 v199, v126, v127
  s_mov_b32 s48, 4096
  s_mov_b32 s51, 31744
  v_mov_b32 v72, 0
  v_mov_b32 v73, 0
  v_mov_b32 v74, 0
  v_mov_b32 v75, 0
  v_mov_b32 v76, 0
  v_mov_b32 v77, 0
  v_mov_b32 v78, 0
  v_mov_b32 v79, 0
  v_mov_b32 v80, 0
  v_mov_b32 v81, 0
  v_mov_b32 v82, 0
  v_mov_b32 v83, 0
  v_mov_b32 v84, 0
  v_mov_b32 v85, 0
  v_mov_b32 v86, 0
  v_mov_b32 v87, 0
  v_mov_b32 v88, 0
  v_mov_b32 v89, 0
  v_mov_b32 v90, 0
  v_mov_b32 v91, 0
  v_mov_b32 v92, 0
  v_mov_b32 v93, 0
  v_mov_b32 v94, 0
  v_mov_b32 v95, 0
  v_mov_b32 v152, 0
  v_mov_b32 v153, 0
  v_mov_b32 v154, 0
  v_mov_b32 v155, 0
  v_mov_b32 v156, 0
  v_mov_b32 v157, 0
  v_mov_b32 v158, 0
  v_mov_b32 v159, 0
  v_mov_b32 v160, 0
  v_mov_b32 v161, 0
  v_mov_b32 v162, 0
  v_mov_b32 v163, 0
  v_mov_b32 v164, 0
  v_mov_b32 v165, 0
  v_mov_b32 v166, 0
  v_mov_b32 v167, 0
.p2align 6
mk_s_loop:
  buffer_load_dwordx4 v[56:59], v3, s[8:11], s16 offen offset:0 sc1
  buffer_load_dwordx4 v[60:63], v3, s[8:11], s16 offen offset:1024 sc1
  buffer_load_dwordx4 v[64:67], v3, s[8:11], s16 offen offset:2048 sc1
  buffer_load_dwordx4 v[68:71], v3, s[8:11], s16 offen offset:3072 sc1
mk_s_dp0:
  s_waitcnt vmcnt(3)
  v_max3_u32 v33, v56, v57, v58
  v_max_u32 v33, v33, v59
  v_cmp_eq_u32 vcc, -1, v33
  s_cbranch_vccnz mk_s_dr0
mk_s_dm0:
  v_smfmac_f32_16x16x64_bf16 v[72:75], v[56:59], a[0:7], v23
  v_smfmac_f32_16x16x64_bf16 v[76:79], v[56:59], a[8:15], v23
  s_waitcnt vmcnt(2)
  v_max3_u32 v33, v60, v61, v62
  v_smfmac_f32_16x16x64_bf16 v[80:83], v[56:59], a[64:71], v23
  v_max_u32 v33, v33, v63
  v_cmp_eq_u32 vcc, -1, v33
  v_smfmac_f32_16x16x64_bf16 v[84:87], v[56:59], a[72:79], v23
  s_cbranch_vccnz mk_s_dr1
mk_s_dm1:
  v_smfmac_f32_16x16x64_bf16 v[72:75], v[60:63], a[16:23], v23
  v_smfmac_f32_16x16x64_bf16 v[76:79], v[60:63], a[24:31], v23
  s_waitcnt vmcnt(1)
  v_max3_u32 v33, v64, v65, v66
  v_smfmac_f32_16x16x64_bf16 v[80:83], v[60:63], a[80:87], v23
  v_max_u32 v33, v33, v67
  v_cmp_eq_u32 vcc, -1, v33
  v_smfmac_f32_16x16x64_bf16 v[84:87], v[60:63], a[88:95], v23
  s_cbranch_vccnz mk_s_dr2
mk_s_dm2:
  v_smfmac_f32_16x16x64_bf16 v[72:75], v[64:67], a[32:39], v23
  v_smfmac_f32_16x16x64_bf16 v[76:79], v[64:67], a[40:47], v23
  s_waitcnt vmcnt(0)
  v_max3_u32 v33, v68, v69, v70
  v_smfmac_f32_16x16x64_bf16 v[80:83], v[64:67], a[96:103], v23
  v_max_u32 v33, v33, v71
  v_cmp_eq_u32 vcc, -1, v33
  v_smfmac_f32_16x16x64_bf16 v[84:87], v[64:67], a[104:111], v23
  s_cbranch_vccnz mk_s_dr3
mk_s_dm3:
  v_smfmac_f32_16x16x64_bf16 v[72:75], v[68:71], a[48:55], v23
  v_smfmac_f32_16x16x64_bf16 v[76:79], v[68:71], a[56:63], v23
  v_smfmac_f32_16x16x64_bf16 v[80:83], v[68:71], a[112:119], v23
  v_smfmac_f32_16x16x64_bf16 v[84:87], v[68:71], a[120:127], v23
  v_smfmac_f32_16x16x64_bf16 v[88:91], v[56:59], a[128:135], v23
  v_smfmac_f32_16x16x64_bf16 v[92:95], v[56:59], a[136:143], v23
  v_smfmac_f32_16x16x64_bf16 v[88:91], v[60:63], a[144:151], v23
  v_smfmac_f32_16x16x64_bf16 v[92:95], v[60:63], a[152:159], v23
  s_nop 0
  v_add_f32 v72, v72, v73
  v_add_f32 v74, v74, v75
  v_smfmac_f32_16x16x64_bf16 v[88:91], v[64:67], a[160:167], v23
  ds_write2_b32 v15, v72, v74 offset0:0 offset1:32
  v_add_f32 v76, v76, v77
  v_add_f32 v78, v78, v79
  v_smfmac_f32_16x16x64_bf16 v[92:95], v[64:67], a[168:175], v23
  ds_write2_b32 v16, v76, v78 offset0:0 offset1:32
  v_add_f32 v80, v80, v81
  v_add_f32 v82, v82, v83
  v_smfmac_f32_16x16x64_bf16 v[88:91], v[68:71], a[176:183], v23
  ds_write2_b32 v17, v80, v82 offset0:0 offset1:32
  v_add_f32 v84, v84, v85
  v_add_f32 v86, v86, v87
  v_smfmac_f32_16x16x64_bf16 v[92:95], v[68:71], a[184:191], v23
  ds_write2_b32 v18, v84, v86 offset0:0 offset1:32
  s_nop 4
  v_add_f32 v88, v88, v89
  v_add_f32 v90, v90, v91
  ds_write2_b32 v19, v88, v90 offset0:0 offset1:32
  v_add_f32 v92, v92, v93
  v_add_f32 v94, v94, v95
  ds_write2_b32 v20, v92, v94 offset0:0 offset1:32
  s_waitcnt lgkmcnt(0)
  s_barrier
  s_cmp_eq_u32 s7, 0
  s_cbranch_scc0 mk_s_w1
  ds_read_b128 v[96:99], v21 offset:0
  ds_read_b128 v[100:103], v21 offset:16
  ds_read_b128 v[104:107], v21 offset:3120
  ds_read_b128 v[108:111], v21 offset:3136
  ds_read_b128 v[112:115], v21 offset:6240
  ds_read_b128 v[116:119], v21 offset:6256
  ds_read_b128 v[120:123], v21 offset:9360
  ds_read_b128 v[124:127], v21 offset:9376
  s_waitcnt lgkmcnt(4)
  v_pk_add_f32 v[96:97], v[96:97], v[104:105]
  v_pk_add_f32 v[98:99], v[98:99], v[106:107]
  v_pk_add_f32 v[100:101], v[100:101], v[108:109]
  v_pk_add_f32 v[102:103], v[102:103], v[110:111]
  s_waitcnt lgkmcnt(0)
  v_pk_add_f32 v[112:113], v[112:113], v[120:121]
  v_pk_add_f32 v[114:115], v[114:115], v[122:123]
  v_pk_add_f32 v[116:117], v[116:117], v[124:125]
  v_pk_add_f32 v[118:119], v[118:119], v[126:127]
  v_pk_add_f32 v[96:97], v[96:97], v[112:113]
  v_pk_add_f32 v[98:99], v[98:99], v[114:115]
  v_pk_add_f32 v[100:101], v[100:101], v[116:117]
  v_pk_add_f32 v[102:103], v[102:103], v[118:119]
  v_cvt_pk_bf16_f32 v128, v96, v97
  v_cvt_pk_bf16_f32 v129, v98, v99
  v_cvt_pk_bf16_f32 v130, v100, v101
  v_cvt_pk_bf16_f32 v131, v102, v103
  s_nop 1
  v_mfma_f32_16x16x32_bf16 v[144:147], v[136:139], v[128:131], 0
  v_mfma_f32_16x16x32_bf16 v[140:143], v[132:135], v[128:131], 0
  v_mfma_f32_16x16x32_bf16 v[148:151], v[128:131], v[128:131], 0
  s_nop 6
  v_mov_b32_dpp v140, v144 row_ror:8 row_mask:0xf bank_mask:0xc
  v_mov_b32_dpp v141, v145 row_ror:8 row_mask:0xf bank_mask:0xc
  v_mov_b32_dpp v142, v146 row_ror:8 row_mask:0xf bank_mask:0xc
  v_mov_b32_dpp v143, v147 row_ror:8 row_mask:0xf bank_mask:0xc
  buffer_store_dwordx4 v[140:143], v12, s[8:11], s19 offen sc1
  buffer_store_dwordx4 v[148:151], v13, s[8:11], s19 offen sc1
  s_branch mk_s_f3
mk_s_w1:
  s_cmp_eq_u32 s7, 3
  s_cbranch_scc1 mk_s_f3
  s_cmp_eq_u32 s7, 2
  s_cbranch_scc1 mk_s_w2
  ds_read_b128 v[96:99], v21 offset:0
  ds_read_b128 v[100:103], v21 offset:16
  ds_read_b128 v[104:107], v21 offset:6240
  ds_read_b128 v[108:111], v21 offset:6256
  s_waitcnt lgkmcnt(0)
  v_pk_add_f32 v[96:97], v[96:97], v[104:105]
  v_pk_add_f32 v[98:99], v[98:99], v[106:107]
  v_pk_add_f32 v[100:101], v[100:101], v[108:109]
  v_pk_add_f32 v[102:103], v[102:103], v[110:111]
  v_add_f32_dpp v104, v96, v96 row_ror:8 row_mask:0xf bank_mask:0xf
  v_add_f32_dpp v105, v97, v97 row_ror:8 row_mask:0xf bank_mask:0xf
  v_add_f32_dpp v106, v98, v98 row_ror:8 row_mask:0xf bank_mask:0xf
  v_add_f32_dpp v107, v99, v99 row_ror:8 row_mask:0xf bank_mask:0xf
  v_add_f32_dpp v108, v100, v100 row_ror:8 row_mask:0xf bank_mask:0xf
  v_add_f32_dpp v109, v101, v101 row_ror:8 row_mask:0xf bank_mask:0xf
  v_add_f32_dpp v110, v102, v102 row_ror:8 row_mask:0xf bank_mask:0xf
  v_add_f32_dpp v111, v103, v103 row_ror:8 row_mask:0xf bank_mask:0xf
  v_cvt_pk_bf16_f32 v128, v104, v105
  v_cvt_pk_bf16_f32 v129, v106, v107
  v_cvt_pk_bf16_f32 v130, v108, v109
  v_cvt_pk_bf16_f32 v131, v110, v111
  buffer_store_dwordx4 v[128:131], v12, s[8:11], s19 offen sc1
  s_branch mk_s_f3
mk_s_w2:
  buffer_store_dwordx4 v[52:55], v13, s[8:11], s18 offen sc1
  v_subrev_u32 v33, 16384, v6
  s_add_u32 s36, s25, 0
  buffer_store_dwordx4 v[52:55], v33, s[8:11], s36 offen sc1
  s_add_u32 s36, s25, 8192
  buffer_store_dwordx4 v[52:55], v33, s[8:11], s36 offen sc1
  s_add_u32 s36, s25, 16384
  buffer_store_dwordx4 v[52:55], v33, s[8:11], s36 offen sc1
  s_add_u32 s36, s25, 24576
  buffer_store_dwordx4 v[52:55], v33, s[8:11], s36 offen sc1
  ds_read_b64 v[96:97], v21 offset:0
  ds_read_b64 v[98:99], v21 offset:32
  ds_read_b64 v[100:101], v21 offset:8
  ds_read_b64 v[102:103], v21 offset:40
  ds_read_b64 v[104:105], v21 offset:6240
  ds_read_b64 v[106:107], v21 offset:6272
  ds_read_b64 v[108:109], v21 offset:6248
  ds_read_b64 v[110:111], v21 offset:6280
  s_waitcnt lgkmcnt(0)
  v_pk_add_f32 v[96:97], v[96:97], v[104:105]
  v_pk_add_f32 v[98:99], v[98:99], v[106:107]
  v_pk_add_f32 v[100:101], v[100:101], v[108:109]
  v_pk_add_f32 v[102:103], v[102:103], v[110:111]
  v_add_f32_dpp v104, v96, v96 row_ror:8 row_mask:0xf bank_mask:0xf
  v_add_f32_dpp v105, v97, v97 row_ror:8 row_mask:0xf bank_mask:0xf
  v_add_f32_dpp v106, v98, v98 row_ror:8 row_mask:0xf bank_mask:0xf
  v_add_f32_dpp v107, v99, v99 row_ror:8 row_mask:0xf bank_mask:0xf
  v_add_f32_dpp v108, v100, v100 row_ror:8 row_mask:0xf bank_mask:0xf
  v_add_f32_dpp v109, v101, v101 row_ror:8 row_mask:0xf bank_mask:0xf
  v_add_f32_dpp v110, v102, v102 row_ror:8 row_mask:0xf bank_mask:0xf
  v_add_f32_dpp v111, v103, v103 row_ror:8 row_mask:0xf bank_mask:0xf
  v_cvt_pk_bf16_f32 v128, v104, v105
  v_cvt_pk_bf16_f32 v129, v106, v107
  v_cvt_pk_bf16_f32 v130, v108, v109
  v_cvt_pk_bf16_f32 v131, v110, v111
mk_s_f3:
  s_cmp_eq_u32 s32, 63
  s_cbranch_scc1 mk_s_last
  s_add_u32 s22, s19, 4096
  s_cmp_eq_u32 s7, 3
  s_cbranch_scc1 mk_s_w3
  s_barrier
  ds_read_b128 v[56:59], v22 offset:22528
  ds_read_b128 v[60:63], v22 offset:23552
mk_s_kf:
  v_max_u32 v33, v38, v39
  v_cmp_eq_u32 vcc, -1, v33
  s_cbranch_vccnz mk_s_kfr
  s_sub_u32 s39, 53248, s51
  s_cmp_eq_u32 s7, 0
  s_cbranch_scc0 mk_s_n_31
  s_add_u32 m0, s39, 0
  s_add_u32 s36, s48, 0
  buffer_load_dwordx4 v32, s[8:11], s36 offen sc1 lds
  s_add_u32 m0, s39, 1024
  s_add_u32 s36, s48, 131072
  buffer_load_dwordx4 v32, s[8:11], s36 offen sc1 lds
  s_add_u32 m0, s39, 2048
  s_add_u32 s36, s48, 262144
  buffer_load_dwordx4 v32, s[8:11], s36 offen sc1 lds
  s_branch mk_s_n_30
mk_s_n_31:
  s_cmp_eq_u32 s7, 1
  s_cbranch_scc0 mk_s_n_32
  s_add_u32 m0, s39, 3072
  s_add_u32 s36, s48, 393216
  buffer_load_dwordx4 v32, s[8:11], s36 offen sc1 lds
  s_add_u32 m0, s39, 8192
  s_add_u32 s36, s48, 0
  buffer_load_dwordx4 v31, s[8:11], s36 offen sc1 lds
  s_add_u32 m0, s39, 4096
  s_add_u32 s36, s48, 1024
  buffer_load_dwordx4 v32, s[8:11], s36 offen sc1 lds
  s_branch mk_s_n_30
mk_s_n_32:
  s_add_u32 m0, s39, 5120
  s_add_u32 s36, s48, 132096
  buffer_load_dwordx4 v32, s[8:11], s36 offen sc1 lds
  s_add_u32 m0, s39, 6144
  s_add_u32 s36, s48, 263168
  buffer_load_dwordx4 v32, s[8:11], s36 offen sc1 lds
  s_add_u32 m0, s39, 7168
  s_add_u32 s36, s48, 394240
  buffer_load_dwordx4 v32, s[8:11], s36 offen sc1 lds
  s_add_u32 m0, s39, 9216
  s_add_u32 s36, s48, 1024
  buffer_load_dwordx4 v31, s[8:11], s36 offen sc1 lds
mk_s_n_30:
  s_waitcnt lgkmcnt(0)
  v_smfmac_f32_16x16x64_bf16 v[152:155], v[56:59], a[192:199], v30
  v_smfmac_f32_16x16x64_bf16 v[156:159], v[56:59], a[200:207], v30
  v_smfmac_f32_16x16x64_bf16 v[160:163], v[56:59], a[208:215], v30
  v_smfmac_f32_16x16x64_bf16 v[164:167], v[56:59], a[216:223], v30
  v_smfmac_f32_16x16x64_bf16 v[152:155], v[60:63], a[224:231], v30
  v_smfmac_f32_16x16x64_bf16 v[156:159], v[60:63], a[232:239], v30
  v_smfmac_f32_16x16x64_bf16 v[160:163], v[60:63], a[240:247], v30
  v_smfmac_f32_16x16x64_bf16 v[164:167], v[60:63], a[248:255], v30
  s_waitcnt lgkmcnt(0)
  s_barrier
  ds_read_b64 v[200:201], v24
  ds_read_b64 v[202:203], v25
  ds_read_b64 v[204:205], v26
  ds_read_b64 v[208:209], v27
  ds_read_b64 v[210:211], v28
  ds_read_b64 v[212:213], v29
  v_cvt_pk_bf16_f32 v168, v152, v153
  v_cvt_pk_bf16_f32 v169, v154, v155
  v_cvt_pk_bf16_f32 v172, v156, v157
  v_cvt_pk_bf16_f32 v173, v158, v159
  v_cvt_pk_bf16_f32 v176, v160, v161
  v_cvt_pk_bf16_f32 v177, v162, v163
  v_cvt_pk_bf16_f32 v180, v164, v165
  v_cvt_pk_bf16_f32 v181, v166, v167
  s_waitcnt lgkmcnt(3)
  v_mfma_f32_16x16x32_bf16 v[148:151], v[44:47], v[200:203], 0
  v_mfma_f32_16x16x32_bf16 v[148:151], v[48:51], v[204:207], v[148:151]
  v_mfma_f32_16x16x32_bf16 v[140:143], v[184:187], v[200:203], 0
  v_mfma_f32_16x16x32_bf16 v[144:147], v[188:191], v[200:203], 0
  v_mfma_f32_16x16x32_bf16 v[140:143], v[168:171], v[204:207], v[140:143]
  v_mfma_f32_16x16x32_bf16 v[144:147], v[172:175], v[204:207], v[144:147]
  s_waitcnt lgkmcnt(0)
  v_mfma_f32_16x16x32_bf16 v[140:143], v[192:195], v[208:211], v[140:143]
  v_mfma_f32_16x16x32_bf16 v[144:147], v[196:199], v[208:211], v[144:147]
  s_branch mk_s_fin
mk_s_w3:
  s_nop 15
  s_nop 15
  s_nop 15
  s_nop 15
  s_nop 15
  buffer_load_dwordx4 v[96:99], v9, s[8:11], s19 offen sc1
  buffer_load_dwordx4 v[100:103], v9, s[8:11], s19 offen offset:2048 sc1
  buffer_load_dwordx4 v[104:107], v9, s[8:11], s22 offen sc1
  buffer_load_dwordx4 v[108:111], v9, s[8:11], s22 offen offset:2048 sc1
  buffer_load_dwordx4 v[112:115], v10, s[8:11], s19 offen sc1
  buffer_load_dwordx4 v[116:119], v10, s[8:11], s22 offen sc1
  buffer_load_dwordx4 v[120:123], v11, s[8:11], s19 offen sc1
  buffer_load_dwordx4 v[124:127], v11, s[8:11], s22 offen sc1
  s_nop 15
  s_nop 15
  buffer_load_dwordx4 v[224:227], v9, s[8:11], s19 offen sc1
  buffer_load_dwordx4 v[228:231], v9, s[8:11], s19 offen offset:2048 sc1
  buffer_load_dwordx4 v[232:235], v9, s[8:11], s22 offen sc1
  buffer_load_dwordx4 v[236:239], v9, s[8:11], s22 offen offset:2048 sc1
  buffer_load_dwordx4 v[240:243], v10, s[8:11], s19 offen sc1
  buffer_load_dwordx4 v[244:247], v10, s[8:11], s22 offen sc1
  buffer_load_dwordx4 v[248:251], v11, s[8:11], s19 offen sc1
  buffer_load_dwordx4 v[252:255], v11, s[8:11], s22 offen sc1
mk_s_sp:
  s_waitcnt vmcnt(8)
  v_max3_u32 v33, v96, v97, v98
  v_max3_u32 v34, v102, v103, v104
  v_max3_u32 v35, v108, v109, v110
  v_max3_u32 v36, v114, v115, v116
  v_max3_u32 v33, v33, v99, v100
  v_max3_u32 v34, v34, v105, v106
  v_max3_u32 v35, v35, v111, v112
  v_max3_u32 v36, v36, v117, v118
  v_max3_u32 v33, v33, v101, v107
  v_max3_u32 v34, v34, v113, v119
  v_max3_u32 v35, v35, v120, v121
  v_max3_u32 v36, v36, v122, v123
  v_max3_u32 v33, v33, v124, v125
  v_max3_u32 v34, v34, v126, v127
  v_max3_u32 v33, v33, v35, v36
  v_max_u32 v33, v33, v34
  v_cmp_eq_u32 vcc, -1, v33
  s_cbranch_vccz mk_s_sg0
  buffer_load_dwordx4 v[96:99], v9, s[8:11], s19 offen sc1
  buffer_load_dwordx4 v[100:103], v9, s[8:11], s19 offen offset:2048 sc1
  buffer_load_dwordx4 v[104:107], v9, s[8:11], s22 offen sc1
  buffer_load_dwordx4 v[108:111], v9, s[8:11], s22 offen offset:2048 sc1
  buffer_load_dwordx4 v[112:115], v10, s[8:11], s19 offen sc1
  buffer_load_dwordx4 v[116:119], v10, s[8:11], s22 offen sc1
  buffer_load_dwordx4 v[120:123], v11, s[8:11], s19 offen sc1
  buffer_load_dwordx4 v[124:127], v11, s[8:11], s22 offen sc1
  s_sub_u32 s33, s33, 1
  s_cbranch_scc1 mk_end
  s_waitcnt vmcnt(8)
  v_max3_u32 v33, v224, v225, v226
  v_max3_u32 v34, v230, v231, v232
  v_max3_u32 v35, v236, v237, v238
  v_max3_u32 v36, v242, v243, v244
  v_max3_u32 v33, v33, v227, v228
  v_max3_u32 v34, v34, v233, v234
  v_max3_u32 v35, v35, v239, v240
  v_max3_u32 v36, v36, v245, v246
  v_max3_u32 v33, v33, v229, v235
  v_max3_u32 v34, v34, v241, v247
  v_max3_u32 v35, v35, v248, v249
  v_max3_u32 v36, v36, v250, v251
  v_max3_u32 v33, v33, v252, v253
  v_max3_u32 v34, v34, v254, v255
  v_max3_u32 v33, v33, v35, v36
  v_max_u32 v33, v33, v34
  v_cmp_eq_u32 vcc, -1, v33
  s_cbranch_vccz mk_s_sg1
  buffer_load_dwordx4 v[224:227], v9, s[8:11], s19 offen sc1
  buffer_load_dwordx4 v[228:231], v9, s[8:11], s19 offen offset:2048 sc1
  buffer_load_dwordx4 v[232:235], v9, s[8:11], s22 offen sc1
  buffer_load_dwordx4 v[236:239], v9, s[8:11], s22 offen offset:2048 sc1
  buffer_load_dwordx4 v[240:243], v10, s[8:11], s19 offen sc1
  buffer_load_dwordx4 v[244:247], v10, s[8:11], s22 offen sc1
  buffer_load_dwordx4 v[248:251], v11, s[8:11], s19 offen sc1
  buffer_load_dwordx4 v[252:255], v11, s[8:11], s22 offen sc1
  s_sub_u32 s33, s33, 1
  s_cbranch_scc1 mk_end
  s_branch mk_s_sp
mk_s_sg0:
  ds_write_b128 v22, v[120:123] offset:22528
  ds_write_b128 v22, v[124:127] offset:23552
  v_pk_add_f32 v[112:113], v[112:113], v[116:117]
  v_pk_add_f32 v[114:115], v[114:115], v[118:119]
  v_pk_add_f32 v[96:97], v[96:97], v[100:101]
  v_pk_add_f32 v[104:105], v[104:105], v[108:109]
  v_pk_add_f32 v[98:99], v[98:99], v[102:103]
  v_pk_add_f32 v[106:107], v[106:107], v[110:111]
  v_add_f32_dpp v100, v112, v112 row_ror:8 row_mask:0xf bank_mask:0xf
  v_add_f32_dpp v101, v113, v113 row_ror:8 row_mask:0xf bank_mask:0xf
  v_add_f32_dpp v102, v114, v114 row_ror:8 row_mask:0xf bank_mask:0xf
  v_add_f32_dpp v103, v115, v115 row_ror:8 row_mask:0xf bank_mask:0xf
  v_pk_add_f32 v[96:97], v[96:97], v[104:105]
  v_pk_add_f32 v[98:99], v[98:99], v[106:107]
  s_waitcnt lgkmcnt(0)
  s_barrier
  v_max3_f32 v33, v100, v101, v102
  v_max3_f32 v33, v33, v103, v96
  v_max3_f32 v33, v33, v97, v98
  v_max_f32 v33, v33, v99
  s_nop 1
  v_max_f32_dpp v33, v33, v33 row_ror:8 row_mask:0xf bank_mask:0xf
  v_mov_b32 v34, v33
  s_nop 1
  v_permlane16_swap_b32 v33, v34
  v_max_f32 v33, v33, v34
  v_mov_b32 v34, v33
  s_nop 1
  v_permlane32_swap_b32 v33, v34
  v_max_f32 v33, v33, v34
  v_mul_f32 v33, s35, v33
  v_fma_f32 v96, v96, s35, -v33
  v_fma_f32 v97, v97, s35, -v33
  v_fma_f32 v98, v98, s35, -v33
  v_fma_f32 v99, v99, s35, -v33
  v_fma_f32 v100, v100, s35, -v33
  v_fma_f32 v101, v101, s35, -v33
  v_fma_f32 v102, v102, s35, -v33
  v_fma_f32 v103, v103, s35, -v33
  v_exp_f32 v96, v96
  v_exp_f32 v97, v97
  v_exp_f32 v98, v98
  v_exp_f32 v99, v99
  v_exp_f32 v100, v100
  v_exp_f32 v101, v101
  v_exp_f32 v102, v102
  v_exp_f32 v103, v103
  s_nop 0
  v_cvt_pk_bf16_f32 v128, v96, v97
  v_cvt_pk_bf16_f32 v129, v98, v99
  v_cvt_pk_bf16_f32 v130, v100, v101
  v_cvt_pk_bf16_f32 v131, v102, v103
  ds_write_b128 v22, v[128:131]
  v_smfmac_f32_16x16x64_bf16 v[152:155], v[120:123], a[192:199], v30
  v_smfmac_f32_16x16x64_bf16 v[156:159], v[120:123], a[200:207], v30
  v_smfmac_f32_16x16x64_bf16 v[160:163], v[120:123], a[208:215], v30
  s_waitcnt lgkmcnt(0)
  s_barrier
  ds_read_b64 v[200:201], v24
  ds_read_b64 v[202:203], v25
  ds_read_b64 v[204:205], v26
  ds_read_b64 v[208:209], v27
  ds_read_b64 v[210:211], v28
  ds_read_b64 v[212:213], v29
  v_smfmac_f32_16x16x64_bf16 v[164:167], v[120:123], a[216:223], v30
  v_smfmac_f32_16x16x64_bf16 v[152:155], v[124:127], a[224:231], v30
  v_smfmac_f32_16x16x64_bf16 v[156:159], v[124:127], a[232:239], v30
  v_smfmac_f32_16x16x64_bf16 v[160:163], v[124:127], a[240:247], v30
  v_smfmac_f32_16x16x64_bf16 v[164:167], v[124:127], a[248:255], v30
  s_branch mk_s_sj
mk_s_sg1:
  ds_write_b128 v22, v[248:251] offset:22528
  ds_write_b128 v22, v[252:255] offset:23552
  v_pk_add_f32 v[240:241], v[240:241], v[244:245]
  v_pk_add_f32 v[242:243], v[242:243], v[246:247]
  v_pk_add_f32 v[224:225], v[224:225], v[228:229]
  v_pk_add_f32 v[232:233], v[232:233], v[236:237]
  v_pk_add_f32 v[226:227], v[226:227], v[230:231]
  v_pk_add_f32 v[234:235], v[234:235], v[238:239]
  v_add_f32_dpp v228, v240, v240 row_ror:8 row_mask:0xf bank_mask:0xf
  v_add_f32_dpp v229, v241, v241 row_ror:8 row_mask:0xf bank_mask:0xf
  v_add_f32_dpp v230, v242, v242 row_ror:8 row_mask:0xf bank_mask:0xf
  v_add_f32_dpp v231, v243, v243 row_ror:8 row_mask:0xf bank_mask:0xf
  v_pk_add_f32 v[224:225], v[224:225], v[232:233]
  v_pk_add_f32 v[226:227], v[226:227], v[234:235]
  s_waitcnt lgkmcnt(0)
  s_barrier
  v_max3_f32 v33, v228, v229, v230
  v_max3_f32 v33, v33, v231, v224
  v_max3_f32 v33, v33, v225, v226
  v_max_f32 v33, v33, v227
  s_nop 1
  v_max_f32_dpp v33, v33, v33 row_ror:8 row_mask:0xf bank_mask:0xf
  v_mov_b32 v34, v33
  s_nop 1
  v_permlane16_swap_b32 v33, v34
  v_max_f32 v33, v33, v34
  v_mov_b32 v34, v33
  s_nop 1
  v_permlane32_swap_b32 v33, v34
  v_max_f32 v33, v33, v34
  v_mul_f32 v33, s35, v33
  v_fma_f32 v224, v224, s35, -v33
  v_fma_f32 v225, v225, s35, -v33
  v_fma_f32 v226, v226, s35, -v33
  v_fma_f32 v227, v227, s35, -v33
  v_fma_f32 v228, v228, s35, -v33
  v_fma_f32 v229, v229, s35, -v33
  v_fma_f32 v230, v230, s35, -v33
  v_fma_f32 v231, v231, s35, -v33
  v_exp_f32 v224, v224
  v_exp_f32 v225, v225
  v_exp_f32 v226, v226
  v_exp_f32 v227, v227
  v_exp_f32 v228, v228
  v_exp_f32 v229, v229
  v_exp_f32 v230, v230
  v_exp_f32 v231, v231
  s_nop 0
  v_cvt_pk_bf16_f32 v128, v224, v225
  v_cvt_pk_bf16_f32 v129, v226, v227
  v_cvt_pk_bf16_f32 v130, v228, v229
  v_cvt_pk_bf16_f32 v131, v230, v231
  ds_write_b128 v22, v[128:131]
  v_smfmac_f32_16x16x64_bf16 v[152:155], v[248:251], a[192:199], v30
  v_smfmac_f32_16x16x64_bf16 v[156:159], v[248:251], a[200:207], v30
  v_smfmac_f32_16x16x64_bf16 v[160:163], v[248:251], a[208:215], v30
  s_waitcnt lgkmcnt(0)
  s_barrier
  ds_read_b64 v[200:201], v24
  ds_read_b64 v[202:203], v25
  ds_read_b64 v[204:205], v26
  ds_read_b64 v[208:209], v27
  ds_read_b64 v[210:211], v28
  ds_read_b64 v[212:213], v29
  v_smfmac_f32_16x16x64_bf16 v[164:167], v[248:251], a[216:223], v30
  v_smfmac_f32_16x16x64_bf16 v[152:155], v[252:255], a[224:231], v30
  v_smfmac_f32_16x16x64_bf16 v[156:159], v[252:255], a[232:239], v30
  v_smfmac_f32_16x16x64_bf16 v[160:163], v[252:255], a[240:247], v30
  v_smfmac_f32_16x16x64_bf16 v[164:167], v[252:255], a[248:255], v30
mk_s_sj:
  s_waitcnt lgkmcnt(3)
  v_mfma_f32_16x16x32_bf16 v[148:151], v[44:47], v[200:203], 0
  v_mfma_f32_16x16x32_bf16 v[148:151], v[48:51], v[204:207], v[148:151]
  v_mfma_f32_16x16x32_bf16 v[140:143], v[184:187], v[200:203], 0
  v_mfma_f32_16x16x32_bf16 v[144:147], v[188:191], v[200:203], 0
  s_waitcnt vmcnt(0) lgkmcnt(0)
  v_mfma_f32_16x16x32_bf16 v[140:143], v[192:195], v[208:211], v[140:143]
  v_cvt_pk_bf16_f32 v168, v152, v153
  v_cvt_pk_bf16_f32 v169, v154, v155
  v_mfma_f32_16x16x32_bf16 v[144:147], v[196:199], v[208:211], v[144:147]
  v_cvt_pk_bf16_f32 v172, v156, v157
  v_cvt_pk_bf16_f32 v173, v158, v159
  v_cvt_pk_bf16_f32 v176, v160, v161
  v_cvt_pk_bf16_f32 v177, v162, v163
  v_mfma_f32_16x16x32_bf16 v[140:143], v[168:171], v[204:207], v[140:143]
  v_cvt_pk_bf16_f32 v180, v164, v165
  v_cvt_pk_bf16_f32 v181, v166, v167
  v_mfma_f32_16x16x32_bf16 v[144:147], v[172:175], v[204:207], v[144:147]
mk_s_fin:
  s_nop 0
  v_rcp_f32 v33, v148
  v_mfma_f32_16x16x32_bf16 v[140:143], v[176:179], v[212:215], v[140:143]
  v_mfma_f32_16x16x32_bf16 v[144:147], v[180:183], v[212:215], v[144:147]
  s_nop 0
  v_mov_b32_dpp v33, v33 row_ror:8 row_mask:0xf bank_mask:0xc
  s_nop 4
  v_mul_f32 v140, v140, v33
  v_mul_f32 v141, v141, v33
  v_cvt_pk_bf16_f32 v216, v140, v141
  v_mul_f32 v142, v142, v33
  v_mul_f32 v143, v143, v33
  v_cvt_pk_bf16_f32 v217, v142, v143
  v_mul_f32 v144, v144, v33
  v_mul_f32 v145, v145, v33
  v_cvt_pk_bf16_f32 v218, v144, v145
  v_mul_f32 v146, v146, v33
  v_mul_f32 v147, v147, v33
  v_cvt_pk_bf16_f32 v219, v146, v147
  buffer_store_dwordx4 v[216:219], v6, s[8:11], s23 offen sc1
  v_add_u32 v36, s51, v2
  ds_read_b128 v[224:227], v36 offset:0
  ds_read_b128 v[228:231], v36 offset:1024
  ds_read_b128 v[232:235], v36 offset:2048
  ds_read_b128 v[236:239], v36 offset:3072
  ds_read_b128 v[240:243], v36 offset:4096
  ds_read_b128 v[244:247], v36 offset:5120
  ds_read_b128 v[248:251], v36 offset:6144
  ds_read_b128 v[252:255], v36 offset:7168
  ds_read_b128 v[132:135], v36 offset:8192
  ds_read_b128 v[136:139], v36 offset:9216
  buffer_load_dwordx4 v[56:59], v5, s[8:11], s23 offen sc1
  s_nop 15
  buffer_load_dwordx4 v[60:63], v5, s[8:11], s23 offen sc1
  s_nop 15
  buffer_load_dwordx4 v[64:67], v5, s[8:11], s23 offen sc1
mk_s_hb:
  s_waitcnt vmcnt(2)
  v_mfma_f32_16x16x32_bf16 v[220:223], v[40:43], v[56:59], 0
  v_max3_u32 v33, v56, v57, v58
  v_max_u32 v33, v33, v59
  v_cmp_eq_u32 vcc, -1, v33
  s_cbranch_vccz mk_s_hbd
  buffer_load_dwordx4 v[56:59], v5, s[8:11], s23 offen sc1
  s_sub_u32 s33, s33, 1
  s_cbranch_scc1 mk_end
  s_waitcnt vmcnt(2)
  v_mfma_f32_16x16x32_bf16 v[220:223], v[40:43], v[60:63], 0
  v_max3_u32 v33, v60, v61, v62
  v_max_u32 v33, v33, v63
  v_cmp_eq_u32 vcc, -1, v33
  s_cbranch_vccz mk_s_hbd
  buffer_load_dwordx4 v[60:63], v5, s[8:11], s23 offen sc1
  s_sub_u32 s33, s33, 1
  s_cbranch_scc1 mk_end
  s_waitcnt vmcnt(2)
  v_mfma_f32_16x16x32_bf16 v[220:223], v[40:43], v[64:67], 0
  v_max3_u32 v33, v64, v65, v66
  v_max_u32 v33, v33, v67
  v_cmp_eq_u32 vcc, -1, v33
  s_cbranch_vccz mk_s_hbd
  buffer_load_dwordx4 v[64:67], v5, s[8:11], s23 offen sc1
  s_sub_u32 s33, s33, 1
  s_cbranch_scc1 mk_end
  s_branch mk_s_hb
mk_s_hbd:
  s_nop 3
  v_add_f32_dpp v216, v220, v220 row_ror:8 row_mask:0xf bank_mask:0xf
  v_add_f32_dpp v217, v221, v221 row_ror:8 row_mask:0xf bank_mask:0xf
  v_add_f32_dpp v218, v222, v222 row_ror:8 row_mask:0xf bank_mask:0xf
  v_add_f32_dpp v219, v223, v223 row_ror:8 row_mask:0xf bank_mask:0xf
  buffer_store_dwordx4 v[216:219], v8, s[8:11], s26 offen sc1
  s_waitcnt lgkmcnt(0)
  s_sub_u32 s51, 53248, s51
  s_cmp_gt_u32 s7, 1
  s_cbranch_scc1 mk_s_n_34
  buffer_store_dwordx4 v[52:55], v12, s[8:11], s21 offen sc1
  buffer_store_dwordx4 v[52:55], v13, s[8:11], s21 offen sc1
mk_s_n_34:
  s_cmp_eq_u32 s7, 2
  s_cbranch_scc0 mk_s_n_35
  buffer_store_dwordx4 v[52:55], v12, s[8:11], s27 offen sc1
mk_s_n_35:
  buffer_store_dwordx4 v[128:131], v14, s[8:11], s34 offen sc1
  s_cmp_eq_u32 s7, 1
  s_cbranch_scc0 mk_s_n_36
  v_mov_b32 v33, s32
  v_mov_b32 v34, 0
  buffer_store_dword v33, v34, s[8:11], s52 offen sc1
mk_s_n_36:
  v_mfma_f32_16x16x32_bf16 v[96:99], v[224:227], a[192:195], 0
  v_mfma_f32_16x16x32_bf16 v[96:99], v[228:231], a[196:199], v[96:99]
  v_mfma_f32_16x16x32_bf16 v[96:99], v[232:235], a[224:227], v[96:99]
  v_mfma_f32_16x16x32_bf16 v[96:99], v[236:239], a[228:231], v[96:99]
  v_mfma_f32_16x16x32_bf16 v[100:103], v[240:243], a[192:195], 0
  v_mfma_f32_16x16x32_bf16 v[100:103], v[244:247], a[196:199], v[100:103]
  v_mfma_f32_16x16x32_bf16 v[100:103], v[248:251], a[224:227], v[100:103]
  v_mfma_f32_16x16x32_bf16 v[100:103], v[252:255], a[228:231], v[100:103]
  v_mfma_f32_16x16x32_bf16 v[104:107], v[224:227], a[200:203], 0
  v_mfma_f32_16x16x32_bf16 v[104:107], v[228:231], a[204:207], v[104:107]
  v_mfma_f32_16x16x32_bf16 v[104:107], v[232:235], a[232:235], v[104:107]
  v_mfma_f32_16x16x32_bf16 v[104:107], v[236:239], a[236:239], v[104:107]
  v_mfma_f32_16x16x32_bf16 v[108:111], v[240:243], a[200:203], 0
  v_mfma_f32_16x16x32_bf16 v[108:111], v[244:247], a[204:207], v[108:111]
  v_mfma_f32_16x16x32_bf16 v[108:111], v[248:251], a[232:235], v[108:111]
  v_mfma_f32_16x16x32_bf16 v[108:111], v[252:255], a[236:239], v[108:111]
  v_cvt_pk_bf16_f32 v184, v96, v97
  v_cvt_pk_bf16_f32 v185, v98, v99
  v_cvt_pk_bf16_f32 v186, v100, v101
  v_cvt_pk_bf16_f32 v187, v102, v103
  v_mfma_f32_16x16x32_bf16 v[112:115], v[224:227], a[208:211], 0
  v_mfma_f32_16x16x32_bf16 v[112:115], v[228:231], a[212:215], v[112:115]
  v_mfma_f32_16x16x32_bf16 v[112:115], v[232:235], a[240:243], v[112:115]
  v_mfma_f32_16x16x32_bf16 v[112:115], v[236:239], a[244:247], v[112:115]
  v_mfma_f32_16x16x32_bf16 v[116:119], v[240:243], a[208:211], 0
  v_mfma_f32_16x16x32_bf16 v[116:119], v[244:247], a[212:215], v[116:119]
  v_mfma_f32_16x16x32_bf16 v[116:119], v[248:251], a[240:243], v[116:119]
  v_mfma_f32_16x16x32_bf16 v[116:119], v[252:255], a[244:247], v[116:119]
  v_cvt_pk_bf16_f32 v188, v104, v105
  v_cvt_pk_bf16_f32 v189, v106, v107
  v_cvt_pk_bf16_f32 v190, v108, v109
  v_cvt_pk_bf16_f32 v191, v110, v111
  buffer_load_dwordx4 v[56:59], v7, s[8:11], s26 offen sc1
  buffer_load_dwordx4 v[60:63], v7, s[8:11], s26 offen offset:512 sc1
  v_mfma_f32_16x16x32_bf16 v[120:123], v[224:227], a[216:219], 0
  v_mfma_f32_16x16x32_bf16 v[120:123], v[228:231], a[220:223], v[120:123]
  v_mfma_f32_16x16x32_bf16 v[120:123], v[232:235], a[248:251], v[120:123]
  v_mfma_f32_16x16x32_bf16 v[120:123], v[236:239], a[252:255], v[120:123]
  v_mfma_f32_16x16x32_bf16 v[124:127], v[240:243], a[216:219], 0
  v_mfma_f32_16x16x32_bf16 v[124:127], v[244:247], a[220:223], v[124:127]
  v_mfma_f32_16x16x32_bf16 v[124:127], v[248:251], a[248:251], v[124:127]
  v_mfma_f32_16x16x32_bf16 v[124:127], v[252:255], a[252:255], v[124:127]
  v_cvt_pk_bf16_f32 v192, v112, v113
  v_cvt_pk_bf16_f32 v193, v114, v115
  v_cvt_pk_bf16_f32 v194, v116, v117
  v_cvt_pk_bf16_f32 v195, v118, v119
  s_add_u32 s36, s32, 3
  s_and_b32 s37, s36, 0x34
  s_lshr_b32 s36, s36, 3
  s_cmp_eq_u32 s37, 4
  s_cselect_b32 s37, 8, 0
  s_add_u32 s36, s36, s37
  s_lshl_b32 s36, s36, 8
  s_add_u32 s36, s36, s53
  v_mov_b32 v34, 0
  buffer_load_dwordx2 v[38:39], v34, s[8:11], s36 offen sc1
  s_add_u32 s48, s48, 2048
  s_mov_b32 s36, s19
  s_mov_b32 s19, s20
  s_mov_b32 s20, s21
  s_mov_b32 s21, s36
  s_mov_b32 s36, s23
  s_mov_b32 s23, s24
  s_mov_b32 s24, s25
  s_mov_b32 s25, s36
  s_mov_b32 s36, s16
  s_mov_b32 s16, s17
  s_mov_b32 s17, s18
  s_mov_b32 s18, s36
  s_add_u32 s32, s32, 1
  s_add_u32 s34, s34, 512
  v_cvt_pk_bf16_f32 v196, v120, v121
  v_cvt_pk_bf16_f32 v197, v122, v123
  v_cvt_pk_bf16_f32 v198, v124, v125
  v_cvt_pk_bf16_f32 v199, v126, v127
  s_waitcnt vmcnt(1)
mk_s_hc:
  v_max3_u32 v33, v56, v57, v58
  v_max3_u32 v34, v59, v60, v61
  v_max3_u32 v33, v33, v62, v63
  v_max_u32 v33, v33, v34
  v_cmp_eq_u32 vcc, -1, v33
  v_pk_add_f32 v[220:221], v[56:57], v[60:61]
  v_pk_add_f32 v[222:223], v[58:59], v[62:63]
  s_cbranch_vccnz mk_s_hcr
mk_s_hd:
  v_add_f32_dpp v140, v220, v220 row_ror:8 row_mask:0xf bank_mask:0xf
  v_add_f32_dpp v141, v221, v221 row_ror:8 row_mask:0xf bank_mask:0xf
  v_add_f32_dpp v142, v222, v222 row_ror:8 row_mask:0xf bank_mask:0xf
  v_add_f32_dpp v143, v223, v223 row_ror:8 row_mask:0xf bank_mask:0xf
  v_cvt_pk_bf16_f32 v216, v140, v141
  v_cvt_pk_bf16_f32 v217, v142, v143
  v_cndmask_b32 v216, v217, v216, s[54:55]
  buffer_store_dword v216, v4, s[8:11], s16 offen sc1
  v_mov_b32 v72, 0
  v_mov_b32 v73, 0
  v_mov_b32 v74, 0
  v_mov_b32 v75, 0
  v_mov_b32 v76, 0
  v_mov_b32 v77, 0
  v_mov_b32 v78, 0
  v_mov_b32 v79, 0
  v_mov_b32 v80, 0
  v_mov_b32 v81, 0
  v_mov_b32 v82, 0
  v_mov_b32 v83, 0
  v_mov_b32 v84, 0
  v_mov_b32 v85, 0
  v_mov_b32 v86, 0
  v_mov_b32 v87, 0
  v_mov_b32 v88, 0
  v_mov_b32 v89, 0
  v_mov_b32 v90, 0
  v_mov_b32 v91, 0
  v_mov_b32 v92, 0
  v_mov_b32 v93, 0
  v_mov_b32 v94, 0
  v_mov_b32 v95, 0
  v_mov_b32 v152, 0
  v_mov_b32 v153, 0
  v_mov_b32 v154, 0
  v_mov_b32 v155, 0
  v_mov_b32 v156, 0
  v_mov_b32 v157, 0
  v_mov_b32 v158, 0
  v_mov_b32 v159, 0
  v_mov_b32 v160, 0
  v_mov_b32 v161, 0
  v_mov_b32 v162, 0
  v_mov_b32 v163, 0
  v_mov_b32 v164, 0
  v_mov_b32 v165, 0
  v_mov_b32 v166, 0
  v_mov_b32 v167, 0
  s_mov_b32 s36, s26
  s_mov_b32 s26, s27
  s_mov_b32 s27, s28
  s_mov_b32 s28, s36
  s_branch mk_s_loop
mk_s_dr0:
  s_sub_u32 s33, s33, 1
  s_cbranch_scc1 mk_end
  buffer_load_dwordx4 v[56:59], v3, s[8:11], s16 offen offset:0 sc1
  buffer_load_dwordx4 v[60:63], v3, s[8:11], s16 offen offset:1024 sc1
  buffer_load_dwordx4 v[64:67], v3, s[8:11], s16 offen offset:2048 sc1
  buffer_load_dwordx4 v[68:71], v3, s[8:11], s16 offen offset:3072 sc1
  s_branch mk_s_dp0
mk_s_dr1:
  s_sub_u32 s33, s33, 1
  s_cbranch_scc1 mk_end
  buffer_load_dwordx4 v[60:63], v3, s[8:11], s16 offen offset:1024 sc1
  buffer_load_dwordx4 v[64:67], v3, s[8:11], s16 offen offset:2048 sc1
  buffer_load_dwordx4 v[68:71], v3, s[8:11], s16 offen offset:3072 sc1
  s_waitcnt vmcnt(2)
  v_max3_u32 v33, v60, v61, v62
  v_max_u32 v33, v33, v63
  v_cmp_eq_u32 vcc, -1, v33
  s_cbranch_vccnz mk_s_dr1
  s_branch mk_s_dm1
mk_s_dr2:
  s_sub_u32 s33, s33, 1
  s_cbranch_scc1 mk_end
  buffer_load_dwordx4 v[64:67], v3, s[8:11], s16 offen offset:2048 sc1
  buffer_load_dwordx4 v[68:71], v3, s[8:11], s16 offen offset:3072 sc1
  s_waitcnt vmcnt(1)
  v_max3_u32 v33, v64, v65, v66
  v_max_u32 v33, v33, v67
  v_cmp_eq_u32 vcc, -1, v33
  s_cbranch_vccnz mk_s_dr2
  s_branch mk_s_dm2
mk_s_dr3:
  s_sub_u32 s33, s33, 1
  s_cbranch_scc1 mk_end
  buffer_load_dwordx4 v[68:71], v3, s[8:11], s16 offen offset:3072 sc1
  s_waitcnt vmcnt(0)
  v_max3_u32 v33, v68, v69, v70
  v_max_u32 v33, v33, v71
  v_cmp_eq_u32 vcc, -1, v33
  s_cbranch_vccnz mk_s_dr3
  s_branch mk_s_dm3
mk_s_hcr:
  s_sub_u32 s33, s33, 1
  s_cbranch_scc1 mk_end
  buffer_load_dwordx4 v[56:59], v7, s[8:11], s26 offen sc1
  buffer_load_dwordx4 v[60:63], v7, s[8:11], s26 offen offset:512 sc1
  s_waitcnt vmcnt(0)
  s_branch mk_s_hc
mk_s_kfr:
  s_sub_u32 s33, s33, 1
  s_cbranch_scc1 mk_end
  s_add_u32 s36, s32, 2
  s_and_b32 s37, s36, 0x34
  s_lshr_b32 s36, s36, 3
  s_cmp_eq_u32 s37, 4
  s_cselect_b32 s37, 8, 0
  s_add_u32 s36, s36, s37
  s_lshl_b32 s36, s36, 8
  s_add_u32 s36, s36, s53
  v_mov_b32 v34, 0
  buffer_load_dwordx2 v[38:39], v34, s[8:11], s36 offen sc1
  s_waitcnt vmcnt(0)
  s_branch mk_s_kf
mk_s_last:
  buffer_store_dwordx4 v[128:131], v14, s[8:11], s34 offen sc1
  s_waitcnt vmcnt(0)
  s_barrier
  v_mov_b32 v33, 64
  v_mov_b32 v34, 0
  buffer_store_dword v33, v34, s[8:11], s52 offen sc1
  s_branch mk_end
mk_worker:
  s_load_dwordx4 s[60:63], s[0:1], 16
  s_load_dwordx2 s[64:65], s[0:1], 32
  s_load_dwordx2 s[66:67], s[0:1], 64
  s_load_dwordx2 s[68:69], s[0:1], 72
  s_load_dwordx2 s[72:73], s[0:1], 0
  s_mov_b32 s74, 4194304
  s_mov_b32 s75, 0x20000
  s_mov_b32 s15, 0x20000
  s_mov_b32 s92, s8
  s_mov_b32 s93, s9
  s_mov_b32 s95, 0x20000
  s_sub_u32 s5, s2, 4
  s_lshl_b32 s5, s5, 5
  s_add_u32 s5, s5, s3
  s_mov_b32 s49, s5
  s_mul_i32 s5, s5, 640
  s_getpc_b64 s[70:71]
mk_pc:
  s_add_u32 s5, s5, mk_jobs-mk_pc
  s_add_u32 s70, s70, s5
  s_addc_u32 s71, s71, 0
  s_load_dwordx8 s[76:83], s[70:71], 0
  s_load_dwordx8 s[84:91], s[70:71], 32
  v_mov_b32 v250, 2147483648
  v_cmp_eq_u32 vcc, 0, v0
  v_mov_b32 v251, 0
  s_nop 0
  v_cndmask_b32 v250, v250, v0, vcc
  v_lshrrev_b32 v36, 6, v0
  s_nop 0
  v_readfirstlane_b32 s28, v36
  v_and_b32 v1, 63, v0
  s_and_b32 s32, s28, 1
  s_lshr_b32 s33, s28, 1
  v_bfe_u32 v40, v1, 2, 1
  v_bfe_u32 v41, v1, 3, 1
  v_xor_b32 v40, v40, v41
  v_lshl_add_u32 v38, v40, 1, v41
  v_and_b32 v36, 15, v1
  v_lshrrev_b32 v37, 4, v1
  v_xor_b32 v37, v37, v38
  v_lshlrev_b32 v37, 4, v37
  v_lshl_add_u32 v37, v36, 6, v37
  s_mul_i32 s40, s33, 4096
  v_add_u32 v2, s40, v37
  v_add_u32 v3, 65536, v2
  v_bfe_u32 v36, v1, 2, 2
  v_lshrrev_b32 v37, 4, v1
  v_lshl_add_u32 v37, v37, 3, v36
  v_mul_u32_u24 v37, 256, v37
  v_and_b32 v38, 3, v1
  v_lshlrev_b32 v38, 3, v38
  v_bfe_u32 v39, v1, 4, 1
  v_lshl_add_u32 v38, v39, 5, v38
  v_add_u32 v37, v37, v38
  v_add_u32 v37, 8192, v37
  s_mul_i32 s40, s32, 2
  s_add_u32 s41, s40, 0
  v_xor_b32 v38, s41, v36
  v_lshl_add_u32 v4, v38, 6, v37
  v_xor_b32 v8, 32, v4
  v_add_u32 v12, 65536, v4
  v_add_u32 v16, 65536, v8
  s_add_u32 s41, s40, 1
  v_xor_b32 v38, s41, v36
  v_lshl_add_u32 v5, v38, 6, v37
  v_xor_b32 v9, 32, v5
  v_add_u32 v13, 65536, v5
  v_add_u32 v17, 65536, v9
  v_bfe_u32 v40, v1, 4, 1
  v_bfe_u32 v41, v1, 5, 1
  v_xor_b32 v40, v40, v41
  v_lshl_add_u32 v37, v40, 1, v41
  v_and_b32 v36, 3, v1
  v_xor_b32 v36, v36, v37
  v_lshlrev_b32 v36, 4, v36
  v_lshrrev_b32 v37, 2, v1
  v_lshl_add_u32 v36, v37, 6, v36
  s_mul_i32 s26, s28, 2048
  v_add_u32 v33, s26, v36
  s_mul_i32 s40, s28, 8
  s_add_u32 s40, s40, 0
  v_lshrrev_b32 v25, 4, v1
  v_add_u32 v25, s40, v25
  v_and_b32 v37, 3, v25
  v_lshlrev_b32 v37, 2, v37
  v_and_b32 v38, 15, v1
  v_xor_b32 v37, v37, v38
  v_bfe_u32 v38, v25, 3, 1
  v_lshlrev_b32 v38, 1, v38
  v_xor_b32 v37, v37, v38
  v_lshlrev_b32 v29, 4, v37
  v_subrev_u32 v29, 0, v29
  s_mul_i32 s40, s28, 8
  s_add_u32 s40, s40, 4
  v_lshrrev_b32 v26, 4, v1
  v_add_u32 v26, s40, v26
  v_and_b32 v37, 3, v26
  v_lshlrev_b32 v37, 2, v37
  v_and_b32 v38, 15, v1
  v_xor_b32 v37, v37, v38
  v_bfe_u32 v38, v26, 3, 1
  v_lshlrev_b32 v38, 1, v38
  v_xor_b32 v37, v37, v38
  v_lshlrev_b32 v30, 4, v37
  v_subrev_u32 v30, 1024, v30
  s_mul_i32 s27, s28, 2048
  s_add_u32 s27, s27, 8192
  v_bfe_u32 v37, v1, 4, 1
  v_lshlrev_b32 v37, 5, v37
  v_bfe_u32 v38, v1, 5, 1
  v_lshl_add_u32 v34, v38, 4, v37
  s_waitcnt lgkmcnt(0)
  s_and_b32 s5, s76, 3
  s_mov_b32 s38, 8192
  s_mov_b32 s14, 8388608
  s_mov_b32 s12, s62
  s_mov_b32 s13, s63
  s_cmp_eq_u32 s5, 0
  s_cbranch_scc1 mk_t_37
  s_mov_b32 s12, s64
  s_mov_b32 s13, s65
  s_cmp_eq_u32 s5, 1
  s_cbranch_scc1 mk_t_37
  s_mov_b32 s12, s60
  s_mov_b32 s13, s61
  s_cmp_eq_u32 s5, 2
  s_cbranch_scc1 mk_t_37
  s_mov_b32 s12, s66
  s_mov_b32 s13, s67
  s_mov_b32 s38, 7168
  s_mov_b32 s14, 7340032
mk_t_37:
  s_mov_b32 s36, s77
  s_mov_b32 s37, s78
  s_mov_b32 s94, 268435456
  v_add_u32 v20, s36, v33
  v_mul_lo_u32 v21, v25, s38
  v_add_u32 v21, v21, v29
  v_add_u32 v21, s37, v21
  v_mul_lo_u32 v22, v26, s38
  v_add_u32 v22, v22, v30
  v_add_u32 v22, s37, v22
  s_mov_b32 s20, 0
  s_mov_b32 s21, 0
  s_lshl_b32 s23, s38, 5
  s_mov_b32 s46, 0x80008000
  s_add_u32 m0, s27, 0
  s_nop 0
  buffer_load_dwordx4 v21, s[12:15], s21 offen offset:0 lds
  buffer_load_dwordx4 v22, s[12:15], s21 offen offset:1024 lds
  s_add_u32 s21, s21, s23
  s_add_u32 m0, s27, 16384
  s_nop 0
  buffer_load_dwordx4 v21, s[12:15], s21 offen offset:0 lds
  buffer_load_dwordx4 v22, s[12:15], s21 offen offset:1024 lds
  s_add_u32 s21, s21, s23
  s_add_u32 m0, s27, 32768
  s_nop 0
  buffer_load_dwordx4 v21, s[12:15], s21 offen offset:0 lds
  buffer_load_dwordx4 v22, s[12:15], s21 offen offset:1024 lds
  s_add_u32 s21, s21, s23
  s_add_u32 m0, s27, 49152
  s_nop 0
  buffer_load_dwordx4 v21, s[12:15], s21 offen offset:0 lds
  buffer_load_dwordx4 v22, s[12:15], s21 offen offset:1024 lds
  s_add_u32 s21, s21, s23
  s_add_u32 m0, s27, 65536
  s_nop 0
  buffer_load_dwordx4 v21, s[12:15], s21 offen offset:0 lds
  buffer_load_dwordx4 v22, s[12:15], s21 offen offset:1024 lds
  s_add_u32 s21, s21, s23
  s_add_u32 m0, s27, 81920
  s_nop 0
  buffer_load_dwordx4 v21, s[12:15], s21 offen offset:0 lds
  buffer_load_dwordx4 v22, s[12:15], s21 offen offset:1024 lds
  s_add_u32 s21, s21, s23
  s_add_u32 m0, s27, 98304
  s_nop 0
  buffer_load_dwordx4 v21, s[12:15], s21 offen offset:0 lds
  buffer_load_dwordx4 v22, s[12:15], s21 offen offset:1024 lds
  s_add_u32 s21, s21, s23
  s_add_u32 m0, s27, 114688
  s_nop 0
  buffer_load_dwordx4 v21, s[12:15], s21 offen offset:0 lds
  buffer_load_dwordx4 v22, s[12:15], s21 offen offset:1024 lds
  s_add_u32 s21, s21, s23
  s_cmp_eq_u32 s97, 0
  s_cbranch_scc0 mk_v_41
  s_mov_b32 s98, 4194304
  s_load_dwordx2 s[56:57], s[0:1], 88
  s_mov_b32 s58, 256
  s_mov_b32 s59, 0x20000
  v_lshlrev_b32 v40, 2, v1
  s_waitcnt lgkmcnt(0)
mk_v_39:
  buffer_load_dword v36, v40, s[56:59], 0 offen sc1
  s_waitcnt vmcnt(0)
  v_subrev_u32 v37, 0x01010101, v36
  v_and_b32 v37, 0x80808080, v37
  v_cmp_ne_u32 vcc, 0, v37
  s_cbranch_vccz mk_v_40
  s_sub_u32 s98, s98, 1
  s_cbranch_scc1 mk_end
  s_sleep 4
  s_branch mk_v_39
mk_v_40:
  v_bfe_u32 v37, v36, 0, 4
  v_lshlrev_b32 v37, v37, 1
  v_mov_b32 v39, v37
  v_bfe_u32 v38, v36, 8, 4
  v_lshlrev_b32 v38, v38, 1
  v_or_b32 v39, v39, v38
  v_bfe_u32 v37, v36, 16, 4
  v_lshlrev_b32 v37, v37, 1
  v_or_b32 v39, v39, v37
  v_bfe_u32 v38, v36, 24, 4
  v_lshlrev_b32 v38, v38, 1
  v_or_b32 v39, v39, v38
  s_nop 1
  v_or_b32_dpp v39, v39, v39 quad_perm:[1,0,3,2] row_mask:0xf bank_mask:0xf
  v_cmp_ne_u32 vcc, 0x1fe, v39
  s_cbranch_vccz mk_v_41
  s_mov_b32 s97, 1
  s_mov_b32 s4, 0
  s_and_b32 s2, s96, 7
  s_lshr_b32 s3, s96, 3
  s_lshl_b32 s98, s28, 6
  v_add_u32 v0, s98, v1
  s_waitcnt vmcnt(0) lgkmcnt(0)
  s_barrier
  s_branch mk_start
mk_v_41:
  s_add_u32 m0, s26, 0
  s_nop 0
  buffer_load_dwordx4 v20, s[92:95], s20 offen offset:0 lds
  buffer_load_dwordx4 v20, s[92:95], s20 offen offset:1024 lds
  s_add_u32 s20, s20, 131072
  s_add_u32 m0, s26, 16384
  s_nop 0
  buffer_load_dwordx4 v20, s[92:95], s20 offen offset:0 lds
  buffer_load_dwordx4 v20, s[92:95], s20 offen offset:1024 lds
  s_add_u32 s20, s20, 131072
  s_add_u32 m0, s26, 32768
  s_nop 0
  buffer_load_dwordx4 v20, s[92:95], s20 offen offset:0 lds
  buffer_load_dwordx4 v20, s[92:95], s20 offen offset:1024 lds
  s_add_u32 s20, s20, 131072
  s_add_u32 m0, s26, 49152
  s_nop 0
  buffer_load_dwordx4 v20, s[92:95], s20 offen offset:0 lds
  buffer_load_dwordx4 v20, s[92:95], s20 offen offset:1024 lds
  s_add_u32 s20, s20, 131072
  s_add_u32 m0, s26, 65536
  s_nop 0
  buffer_load_dwordx4 v20, s[92:95], s20 offen offset:0 lds
  buffer_load_dwordx4 v20, s[92:95], s20 offen offset:1024 lds
  s_add_u32 s20, s20, 131072
  s_add_u32 m0, s26, 81920
  s_nop 0
  buffer_load_dwordx4 v20, s[92:95], s20 offen offset:0 lds
  buffer_load_dwordx4 v20, s[92:95], s20 offen offset:1024 lds
  s_add_u32 s20, s20, 131072
  s_add_u32 m0, s26, 98304
  s_nop 0
  buffer_load_dwordx4 v20, s[92:95], s20 offen offset:0 lds
  buffer_load_dwordx4 v20, s[92:95], s20 offen offset:1024 lds
  s_add_u32 s20, s20, 131072
  s_add_u32 m0, s26, 114688
  s_nop 0
  buffer_load_dwordx4 v20, s[92:95], s20 offen offset:0 lds
  buffer_load_dwordx4 v20, s[92:95], s20 offen offset:1024 lds
  s_add_u32 s20, s20, 131072
  s_waitcnt vmcnt(0)
  s_barrier
  ds_read_b64_tr_b16 v[56:57], v4 offset:0
  ds_read_b64_tr_b16 v[58:59], v4 offset:1024
  ds_read_b128 v[48:51], v2 offset:0
  ds_read_b64_tr_b16 v[72:73], v8 offset:0
  ds_read_b64_tr_b16 v[74:75], v8 offset:1024
  ds_read_b128 v[64:67], v2 offset:1024
  ds_read_b64_tr_b16 v[60:61], v5 offset:0
  ds_read_b64_tr_b16 v[62:63], v5 offset:1024
  ds_read_b128 v[52:55], v2 offset:2048
  ds_read_b64_tr_b16 v[76:77], v9 offset:0
  ds_read_b64_tr_b16 v[78:79], v9 offset:1024
  ds_read_b128 v[68:71], v2 offset:3072
.p2align 6
mk_small:
  s_waitcnt vmcnt(34) lgkmcnt(0)
  s_barrier
  v_mfma_f32_16x16x32_bf16 a[0:3], v[56:59], v[48:51], 0
  ds_read_b64_tr_b16 v[88:89], v4 offset:16384
  ds_read_b64_tr_b16 v[90:91], v4 offset:17408
  v_mfma_f32_16x16x32_bf16 a[8:11], v[56:59], v[64:67], 0
  ds_read_b128 v[80:83], v2 offset:16384
  v_mfma_f32_16x16x32_bf16 a[16:19], v[56:59], v[52:55], 0
  s_add_u32 m0, s26, 0
  s_nop 0
  buffer_load_dwordx4 v20, s[92:95], s20 offen offset:0 lds
  ds_read_b64_tr_b16 v[104:105], v8 offset:16384
  v_mfma_f32_16x16x32_bf16 a[24:27], v[56:59], v[68:71], 0
  ds_read_b64_tr_b16 v[106:107], v8 offset:17408
  v_mfma_f32_16x16x32_bf16 a[4:7], v[72:75], v[48:51], 0
  ds_read_b128 v[96:99], v2 offset:17408
  buffer_load_dwordx4 v20, s[92:95], s20 offen offset:1024 lds
  s_add_u32 s20, s20, 131072
  v_mfma_f32_16x16x32_bf16 a[12:15], v[72:75], v[64:67], 0
  ds_read_b64_tr_b16 v[92:93], v5 offset:16384
  v_mfma_f32_16x16x32_bf16 a[20:23], v[72:75], v[52:55], 0
  ds_read_b64_tr_b16 v[94:95], v5 offset:17408
  ds_read_b128 v[84:87], v2 offset:18432
  v_mfma_f32_16x16x32_bf16 a[28:31], v[72:75], v[68:71], 0
  s_add_u32 m0, s27, 0
  s_nop 0
  buffer_load_dwordx4 v21, s[12:15], s21 offen offset:0 lds
  v_mfma_f32_16x16x32_bf16 a[32:35], v[60:63], v[48:51], 0
  ds_read_b64_tr_b16 v[108:109], v9 offset:16384
  ds_read_b64_tr_b16 v[110:111], v9 offset:17408
  v_mfma_f32_16x16x32_bf16 a[40:43], v[60:63], v[64:67], 0
  ds_read_b128 v[100:103], v2 offset:19456
  v_mfma_f32_16x16x32_bf16 a[48:51], v[60:63], v[52:55], 0
  buffer_load_dwordx4 v22, s[12:15], s21 offen offset:1024 lds
  s_add_u32 s21, s21, s23
  v_mfma_f32_16x16x32_bf16 a[56:59], v[60:63], v[68:71], 0
  v_mfma_f32_16x16x32_bf16 a[36:39], v[76:79], v[48:51], 0
  v_mfma_f32_16x16x32_bf16 a[44:47], v[76:79], v[64:67], 0
  v_mfma_f32_16x16x32_bf16 a[52:55], v[76:79], v[52:55], 0
  v_mfma_f32_16x16x32_bf16 a[60:63], v[76:79], v[68:71], 0
  s_waitcnt vmcnt(34) lgkmcnt(0)
  s_barrier
  v_mfma_f32_16x16x32_bf16 a[0:3], v[88:91], v[80:83], a[0:3]
  ds_read_b64_tr_b16 v[56:57], v4 offset:32768
  ds_read_b64_tr_b16 v[58:59], v4 offset:33792
  v_mfma_f32_16x16x32_bf16 a[8:11], v[88:91], v[96:99], a[8:11]
  ds_read_b128 v[48:51], v2 offset:32768
  v_mfma_f32_16x16x32_bf16 a[16:19], v[88:91], v[84:87], a[16:19]
  s_add_u32 m0, s26, 16384
  s_nop 0
  buffer_load_dwordx4 v20, s[92:95], s20 offen offset:0 lds
  ds_read_b64_tr_b16 v[72:73], v8 offset:32768
  v_mfma_f32_16x16x32_bf16 a[24:27], v[88:91], v[100:103], a[24:27]
  ds_read_b64_tr_b16 v[74:75], v8 offset:33792
  v_mfma_f32_16x16x32_bf16 a[4:7], v[104:107], v[80:83], a[4:7]
  ds_read_b128 v[64:67], v2 offset:33792
  buffer_load_dwordx4 v20, s[92:95], s20 offen offset:1024 lds
  s_add_u32 s20, s20, 131072
  v_mfma_f32_16x16x32_bf16 a[12:15], v[104:107], v[96:99], a[12:15]
  ds_read_b64_tr_b16 v[60:61], v5 offset:32768
  v_mfma_f32_16x16x32_bf16 a[20:23], v[104:107], v[84:87], a[20:23]
  ds_read_b64_tr_b16 v[62:63], v5 offset:33792
  ds_read_b128 v[52:55], v2 offset:34816
  v_mfma_f32_16x16x32_bf16 a[28:31], v[104:107], v[100:103], a[28:31]
  s_add_u32 m0, s27, 16384
  s_nop 0
  buffer_load_dwordx4 v21, s[12:15], s21 offen offset:0 lds
  v_mfma_f32_16x16x32_bf16 a[32:35], v[92:95], v[80:83], a[32:35]
  ds_read_b64_tr_b16 v[76:77], v9 offset:32768
  ds_read_b64_tr_b16 v[78:79], v9 offset:33792
  v_mfma_f32_16x16x32_bf16 a[40:43], v[92:95], v[96:99], a[40:43]
  ds_read_b128 v[68:71], v2 offset:35840
  v_mfma_f32_16x16x32_bf16 a[48:51], v[92:95], v[84:87], a[48:51]
  buffer_load_dwordx4 v22, s[12:15], s21 offen offset:1024 lds
  s_add_u32 s21, s21, s23
  v_mfma_f32_16x16x32_bf16 a[56:59], v[92:95], v[100:103], a[56:59]
  v_mfma_f32_16x16x32_bf16 a[36:39], v[108:111], v[80:83], a[36:39]
  v_mfma_f32_16x16x32_bf16 a[44:47], v[108:111], v[96:99], a[44:47]
  v_mfma_f32_16x16x32_bf16 a[52:55], v[108:111], v[84:87], a[52:55]
  v_mfma_f32_16x16x32_bf16 a[60:63], v[108:111], v[100:103], a[60:63]
  s_waitcnt vmcnt(34) lgkmcnt(0)
  s_barrier
  v_mfma_f32_16x16x32_bf16 a[0:3], v[56:59], v[48:51], a[0:3]
  ds_read_b64_tr_b16 v[88:89], v4 offset:49152
  ds_read_b64_tr_b16 v[90:91], v4 offset:50176
  v_mfma_f32_16x16x32_bf16 a[8:11], v[56:59], v[64:67], a[8:11]
  ds_read_b128 v[80:83], v2 offset:49152
  v_mfma_f32_16x16x32_bf16 a[16:19], v[56:59], v[52:55], a[16:19]
  s_add_u32 m0, s26, 32768
  s_nop 0
  buffer_load_dwordx4 v20, s[92:95], s20 offen offset:0 lds
  ds_read_b64_tr_b16 v[104:105], v8 offset:49152
  v_mfma_f32_16x16x32_bf16 a[24:27], v[56:59], v[68:71], a[24:27]
  ds_read_b64_tr_b16 v[106:107], v8 offset:50176
  v_mfma_f32_16x16x32_bf16 a[4:7], v[72:75], v[48:51], a[4:7]
  ds_read_b128 v[96:99], v2 offset:50176
  buffer_load_dwordx4 v20, s[92:95], s20 offen offset:1024 lds
  s_add_u32 s20, s20, 131072
  v_mfma_f32_16x16x32_bf16 a[12:15], v[72:75], v[64:67], a[12:15]
  ds_read_b64_tr_b16 v[92:93], v5 offset:49152
  v_mfma_f32_16x16x32_bf16 a[20:23], v[72:75], v[52:55], a[20:23]
  ds_read_b64_tr_b16 v[94:95], v5 offset:50176
  ds_read_b128 v[84:87], v2 offset:51200
  v_mfma_f32_16x16x32_bf16 a[28:31], v[72:75], v[68:71], a[28:31]
  s_add_u32 m0, s27, 32768
  s_nop 0
  buffer_load_dwordx4 v21, s[12:15], s21 offen offset:0 lds
  v_mfma_f32_16x16x32_bf16 a[32:35], v[60:63], v[48:51], a[32:35]
  ds_read_b64_tr_b16 v[108:109], v9 offset:49152
  ds_read_b64_tr_b16 v[110:111], v9 offset:50176
  v_mfma_f32_16x16x32_bf16 a[40:43], v[60:63], v[64:67], a[40:43]
  ds_read_b128 v[100:103], v2 offset:52224
  v_mfma_f32_16x16x32_bf16 a[48:51], v[60:63], v[52:55], a[48:51]
  buffer_load_dwordx4 v22, s[12:15], s21 offen offset:1024 lds
  s_add_u32 s21, s21, s23
  v_mfma_f32_16x16x32_bf16 a[56:59], v[60:63], v[68:71], a[56:59]
  v_mfma_f32_16x16x32_bf16 a[36:39], v[76:79], v[48:51], a[36:39]
  v_mfma_f32_16x16x32_bf16 a[44:47], v[76:79], v[64:67], a[44:47]
  v_mfma_f32_16x16x32_bf16 a[52:55], v[76:79], v[52:55], a[52:55]
  v_mfma_f32_16x16x32_bf16 a[60:63], v[76:79], v[68:71], a[60:63]
  s_waitcnt vmcnt(34) lgkmcnt(0)
  s_barrier
  v_mfma_f32_16x16x32_bf16 a[0:3], v[88:91], v[80:83], a[0:3]
  ds_read_b64_tr_b16 v[56:57], v12 offset:0
  ds_read_b64_tr_b16 v[58:59], v12 offset:1024
  v_mfma_f32_16x16x32_bf16 a[8:11], v[88:91], v[96:99], a[8:11]
  ds_read_b128 v[48:51], v3 offset:0
  v_mfma_f32_16x16x32_bf16 a[16:19], v[88:91], v[84:87], a[16:19]
  s_add_u32 m0, s26, 49152
  s_nop 0
  buffer_load_dwordx4 v20, s[92:95], s20 offen offset:0 lds
  ds_read_b64_tr_b16 v[72:73], v16 offset:0
  v_mfma_f32_16x16x32_bf16 a[24:27], v[88:91], v[100:103], a[24:27]
  ds_read_b64_tr_b16 v[74:75], v16 offset:1024
  v_mfma_f32_16x16x32_bf16 a[4:7], v[104:107], v[80:83], a[4:7]
  ds_read_b128 v[64:67], v3 offset:1024
  buffer_load_dwordx4 v20, s[92:95], s20 offen offset:1024 lds
  s_add_u32 s20, s20, 131072
  v_mfma_f32_16x16x32_bf16 a[12:15], v[104:107], v[96:99], a[12:15]
  ds_read_b64_tr_b16 v[60:61], v13 offset:0
  v_mfma_f32_16x16x32_bf16 a[20:23], v[104:107], v[84:87], a[20:23]
  ds_read_b64_tr_b16 v[62:63], v13 offset:1024
  ds_read_b128 v[52:55], v3 offset:2048
  v_mfma_f32_16x16x32_bf16 a[28:31], v[104:107], v[100:103], a[28:31]
  s_add_u32 m0, s27, 49152
  s_nop 0
  buffer_load_dwordx4 v21, s[12:15], s21 offen offset:0 lds
  v_mfma_f32_16x16x32_bf16 a[32:35], v[92:95], v[80:83], a[32:35]
  ds_read_b64_tr_b16 v[76:77], v17 offset:0
  ds_read_b64_tr_b16 v[78:79], v17 offset:1024
  v_mfma_f32_16x16x32_bf16 a[40:43], v[92:95], v[96:99], a[40:43]
  ds_read_b128 v[68:71], v3 offset:3072
  v_mfma_f32_16x16x32_bf16 a[48:51], v[92:95], v[84:87], a[48:51]
  buffer_load_dwordx4 v22, s[12:15], s21 offen offset:1024 lds
  s_add_u32 s21, s21, s23
  v_mfma_f32_16x16x32_bf16 a[56:59], v[92:95], v[100:103], a[56:59]
  v_mfma_f32_16x16x32_bf16 a[36:39], v[108:111], v[80:83], a[36:39]
  v_mfma_f32_16x16x32_bf16 a[44:47], v[108:111], v[96:99], a[44:47]
  v_mfma_f32_16x16x32_bf16 a[52:55], v[108:111], v[84:87], a[52:55]
  v_mfma_f32_16x16x32_bf16 a[60:63], v[108:111], v[100:103], a[60:63]
  s_waitcnt vmcnt(34) lgkmcnt(0)
  s_barrier
  v_mfma_f32_16x16x32_bf16 a[0:3], v[56:59], v[48:51], a[0:3]
  ds_read_b64_tr_b16 v[88:89], v12 offset:16384
  ds_read_b64_tr_b16 v[90:91], v12 offset:17408
  v_mfma_f32_16x16x32_bf16 a[8:11], v[56:59], v[64:67], a[8:11]
  ds_read_b128 v[80:83], v3 offset:16384
  v_mfma_f32_16x16x32_bf16 a[16:19], v[56:59], v[52:55], a[16:19]
  s_add_u32 m0, s26, 65536
  s_nop 0
  buffer_load_dwordx4 v20, s[92:95], s20 offen offset:0 lds
  ds_read_b64_tr_b16 v[104:105], v16 offset:16384
  v_mfma_f32_16x16x32_bf16 a[24:27], v[56:59], v[68:71], a[24:27]
  ds_read_b64_tr_b16 v[106:107], v16 offset:17408
  v_mfma_f32_16x16x32_bf16 a[4:7], v[72:75], v[48:51], a[4:7]
  ds_read_b128 v[96:99], v3 offset:17408
  buffer_load_dwordx4 v20, s[92:95], s20 offen offset:1024 lds
  s_add_u32 s20, s20, 131072
  v_mfma_f32_16x16x32_bf16 a[12:15], v[72:75], v[64:67], a[12:15]
  ds_read_b64_tr_b16 v[92:93], v13 offset:16384
  v_mfma_f32_16x16x32_bf16 a[20:23], v[72:75], v[52:55], a[20:23]
  ds_read_b64_tr_b16 v[94:95], v13 offset:17408
  ds_read_b128 v[84:87], v3 offset:18432
  v_mfma_f32_16x16x32_bf16 a[28:31], v[72:75], v[68:71], a[28:31]
  s_add_u32 m0, s27, 65536
  s_nop 0
  buffer_load_dwordx4 v21, s[12:15], s21 offen offset:0 lds
  v_mfma_f32_16x16x32_bf16 a[32:35], v[60:63], v[48:51], a[32:35]
  ds_read_b64_tr_b16 v[108:109], v17 offset:16384
  ds_read_b64_tr_b16 v[110:111], v17 offset:17408
  v_mfma_f32_16x16x32_bf16 a[40:43], v[60:63], v[64:67], a[40:43]
  ds_read_b128 v[100:103], v3 offset:19456
  v_mfma_f32_16x16x32_bf16 a[48:51], v[60:63], v[52:55], a[48:51]
  buffer_load_dwordx4 v22, s[12:15], s21 offen offset:1024 lds
  s_add_u32 s21, s21, s23
  v_mfma_f32_16x16x32_bf16 a[56:59], v[60:63], v[68:71], a[56:59]
  v_mfma_f32_16x16x32_bf16 a[36:39], v[76:79], v[48:51], a[36:39]
  v_mfma_f32_16x16x32_bf16 a[44:47], v[76:79], v[64:67], a[44:47]
  v_mfma_f32_16x16x32_bf16 a[52:55], v[76:79], v[52:55], a[52:55]
  v_mfma_f32_16x16x32_bf16 a[60:63], v[76:79], v[68:71], a[60:63]
  s_waitcnt vmcnt(34) lgkmcnt(0)
  s_barrier
  v_mfma_f32_16x16x32_bf16 a[0:3], v[88:91], v[80:83], a[0:3]
  ds_read_b64_tr_b16 v[56:57], v12 offset:32768
  ds_read_b64_tr_b16 v[58:59], v12 offset:33792
  v_mfma_f32_16x16x32_bf16 a[8:11], v[88:91], v[96:99], a[8:11]
  ds_read_b128 v[48:51], v3 offset:32768
  v_mfma_f32_16x16x32_bf16 a[16:19], v[88:91], v[84:87], a[16:19]
  s_add_u32 m0, s26, 81920
  s_nop 0
  buffer_load_dwordx4 v20, s[92:95], s20 offen offset:0 lds
  ds_read_b64_tr_b16 v[72:73], v16 offset:32768
  v_mfma_f32_16x16x32_bf16 a[24:27], v[88:91], v[100:103], a[24:27]
  ds_read_b64_tr_b16 v[74:75], v16 offset:33792
  v_mfma_f32_16x16x32_bf16 a[4:7], v[104:107], v[80:83], a[4:7]
  ds_read_b128 v[64:67], v3 offset:33792
  buffer_load_dwordx4 v20, s[92:95], s20 offen offset:1024 lds
  s_add_u32 s20, s20, 131072
  v_mfma_f32_16x16x32_bf16 a[12:15], v[104:107], v[96:99], a[12:15]
  ds_read_b64_tr_b16 v[60:61], v13 offset:32768
  v_mfma_f32_16x16x32_bf16 a[20:23], v[104:107], v[84:87], a[20:23]
  ds_read_b64_tr_b16 v[62:63], v13 offset:33792
  ds_read_b128 v[52:55], v3 offset:34816
  v_mfma_f32_16x16x32_bf16 a[28:31], v[104:107], v[100:103], a[28:31]
  s_add_u32 m0, s27, 81920
  s_nop 0
  buffer_load_dwordx4 v21, s[12:15], s21 offen offset:0 lds
  v_mfma_f32_16x16x32_bf16 a[32:35], v[92:95], v[80:83], a[32:35]
  ds_read_b64_tr_b16 v[76:77], v17 offset:32768
  ds_read_b64_tr_b16 v[78:79], v17 offset:33792
  v_mfma_f32_16x16x32_bf16 a[40:43], v[92:95], v[96:99], a[40:43]
  ds_read_b128 v[68:71], v3 offset:35840
  v_mfma_f32_16x16x32_bf16 a[48:51], v[92:95], v[84:87], a[48:51]
  buffer_load_dwordx4 v22, s[12:15], s21 offen offset:1024 lds
  s_add_u32 s21, s21, s23
  v_mfma_f32_16x16x32_bf16 a[56:59], v[92:95], v[100:103], a[56:59]
  v_mfma_f32_16x16x32_bf16 a[36:39], v[108:111], v[80:83], a[36:39]
  v_mfma_f32_16x16x32_bf16 a[44:47], v[108:111], v[96:99], a[44:47]
  v_mfma_f32_16x16x32_bf16 a[52:55], v[108:111], v[84:87], a[52:55]
  v_mfma_f32_16x16x32_bf16 a[60:63], v[108:111], v[100:103], a[60:63]
  s_waitcnt vmcnt(34) lgkmcnt(0)
  s_barrier
  v_mfma_f32_16x16x32_bf16 a[0:3], v[56:59], v[48:51], a[0:3]
  ds_read_b64_tr_b16 v[88:89], v12 offset:49152
  ds_read_b64_tr_b16 v[90:91], v12 offset:50176
  v_mfma_f32_16x16x32_bf16 a[8:11], v[56:59], v[64:67], a[8:11]
  ds_read_b128 v[80:83], v3 offset:49152
  v_mfma_f32_16x16x32_bf16 a[16:19], v[56:59], v[52:55], a[16:19]
  s_add_u32 m0, s26, 98304
  s_nop 0
  buffer_load_dwordx4 v20, s[92:95], s20 offen offset:0 lds
  ds_read_b64_tr_b16 v[104:105], v16 offset:49152
  v_mfma_f32_16x16x32_bf16 a[24:27], v[56:59], v[68:71], a[24:27]
  ds_read_b64_tr_b16 v[106:107], v16 offset:50176
  v_mfma_f32_16x16x32_bf16 a[4:7], v[72:75], v[48:51], a[4:7]
  ds_read_b128 v[96:99], v3 offset:50176
  buffer_load_dwordx4 v20, s[92:95], s20 offen offset:1024 lds
  s_add_u32 s20, s20, 131072
  v_mfma_f32_16x16x32_bf16 a[12:15], v[72:75], v[64:67], a[12:15]
  ds_read_b64_tr_b16 v[92:93], v13 offset:49152
  v_mfma_f32_16x16x32_bf16 a[20:23], v[72:75], v[52:55], a[20:23]
  ds_read_b64_tr_b16 v[94:95], v13 offset:50176
  ds_read_b128 v[84:87], v3 offset:51200
  v_mfma_f32_16x16x32_bf16 a[28:31], v[72:75], v[68:71], a[28:31]
  s_add_u32 m0, s27, 98304
  s_nop 0
  buffer_load_dwordx4 v21, s[12:15], s21 offen offset:0 lds
  v_mfma_f32_16x16x32_bf16 a[32:35], v[60:63], v[48:51], a[32:35]
  ds_read_b64_tr_b16 v[108:109], v17 offset:49152
  ds_read_b64_tr_b16 v[110:111], v17 offset:50176
  v_mfma_f32_16x16x32_bf16 a[40:43], v[60:63], v[64:67], a[40:43]
  ds_read_b128 v[100:103], v3 offset:52224
  v_mfma_f32_16x16x32_bf16 a[48:51], v[60:63], v[52:55], a[48:51]
  buffer_load_dwordx4 v22, s[12:15], s21 offen offset:1024 lds
  s_add_u32 s21, s21, s23
  v_mfma_f32_16x16x32_bf16 a[56:59], v[60:63], v[68:71], a[56:59]
  v_mfma_f32_16x16x32_bf16 a[36:39], v[76:79], v[48:51], a[36:39]
  v_mfma_f32_16x16x32_bf16 a[44:47], v[76:79], v[64:67], a[44:47]
  v_mfma_f32_16x16x32_bf16 a[52:55], v[76:79], v[52:55], a[52:55]
  v_mfma_f32_16x16x32_bf16 a[60:63], v[76:79], v[68:71], a[60:63]
  s_waitcnt vmcnt(24) lgkmcnt(0)
  s_barrier
  v_mfma_f32_16x16x32_bf16 a[0:3], v[88:91], v[80:83], a[0:3]
  ds_read_b64_tr_b16 v[56:57], v4 offset:0
  ds_read_b64_tr_b16 v[58:59], v4 offset:1024
  v_mfma_f32_16x16x32_bf16 a[8:11], v[88:91], v[96:99], a[8:11]
  ds_read_b128 v[48:51], v2 offset:0
  v_mfma_f32_16x16x32_bf16 a[16:19], v[88:91], v[84:87], a[16:19]
  s_add_u32 m0, s26, 114688
  s_nop 0
  buffer_load_dwordx4 v20, s[92:95], s20 offen offset:0 lds
  ds_read_b64_tr_b16 v[72:73], v8 offset:0
  v_mfma_f32_16x16x32_bf16 a[24:27], v[88:91], v[100:103], a[24:27]
  ds_read_b64_tr_b16 v[74:75], v8 offset:1024
  v_mfma_f32_16x16x32_bf16 a[4:7], v[104:107], v[80:83], a[4:7]
  ds_read_b128 v[64:67], v2 offset:1024
  buffer_load_dwordx4 v20, s[92:95], s20 offen offset:1024 lds
  s_add_u32 s20, s20, 131072
  v_mfma_f32_16x16x32_bf16 a[12:15], v[104:107], v[96:99], a[12:15]
  ds_read_b64_tr_b16 v[60:61], v5 offset:0
  v_mfma_f32_16x16x32_bf16 a[20:23], v[104:107], v[84:87], a[20:23]
  ds_read_b64_tr_b16 v[62:63], v5 offset:1024
  ds_read_b128 v[52:55], v2 offset:2048
  v_mfma_f32_16x16x32_bf16 a[28:31], v[104:107], v[100:103], a[28:31]
  s_add_u32 m0, s27, 114688
  s_nop 0
  buffer_load_dwordx4 v21, s[12:15], s21 offen offset:0 lds
  v_mfma_f32_16x16x32_bf16 a[32:35], v[92:95], v[80:83], a[32:35]
  ds_read_b64_tr_b16 v[76:77], v9 offset:0
  ds_read_b64_tr_b16 v[78:79], v9 offset:1024
  v_mfma_f32_16x16x32_bf16 a[40:43], v[92:95], v[96:99], a[40:43]
  ds_read_b128 v[68:71], v2 offset:3072
  v_mfma_f32_16x16x32_bf16 a[48:51], v[92:95], v[84:87], a[48:51]
  buffer_load_dwordx4 v22, s[12:15], s21 offen offset:1024 lds
  s_add_u32 s21, s21, s23
  v_mfma_f32_16x16x32_bf16 a[56:59], v[92:95], v[100:103], a[56:59]
  v_mfma_f32_16x16x32_bf16 a[36:39], v[108:111], v[80:83], a[36:39]
  v_mfma_f32_16x16x32_bf16 a[44:47], v[108:111], v[96:99], a[44:47]
  v_mfma_f32_16x16x32_bf16 a[52:55], v[108:111], v[84:87], a[52:55]
  v_mfma_f32_16x16x32_bf16 a[60:63], v[108:111], v[100:103], a[60:63]
  s_mov_b32 s22, 3
.p2align 6
mk_gs_loop0:
  s_cmp_eq_u32 s22, 1
  s_cbranch_scc0 mk_h_43
  s_mov_b32 s94, 0
  s_mov_b32 s14, 0
  s_cmp_lt_u32 s84, 16
  s_cbranch_scc0 mk_h_43
  s_and_b32 s5, s84, 3
  s_mov_b32 s38, 8192
  s_mov_b32 s14, 8388608
  s_mov_b32 s12, s62
  s_mov_b32 s13, s63
  s_cmp_eq_u32 s5, 0
  s_cbranch_scc1 mk_t_44
  s_mov_b32 s12, s64
  s_mov_b32 s13, s65
  s_cmp_eq_u32 s5, 1
  s_cbranch_scc1 mk_t_44
  s_mov_b32 s12, s60
  s_mov_b32 s13, s61
  s_cmp_eq_u32 s5, 2
  s_cbranch_scc1 mk_t_44
  s_mov_b32 s12, s66
  s_mov_b32 s13, s67
  s_mov_b32 s38, 7168
  s_mov_b32 s14, 7340032
mk_t_44:
  s_mov_b32 s36, s85
  s_mov_b32 s37, s86
  s_mov_b32 s94, 268435456
  v_add_u32 v20, s36, v33
  v_mul_lo_u32 v21, v25, s38
  v_add_u32 v21, v21, v29
  v_add_u32 v21, s37, v21
  v_mul_lo_u32 v22, v26, s38
  v_add_u32 v22, v22, v30
  v_add_u32 v22, s37, v22
  s_mov_b32 s20, 0
  s_mov_b32 s21, 0
  s_lshl_b32 s23, s38, 5
mk_h_43:
  s_waitcnt vmcnt(24) lgkmcnt(0)
  s_barrier
  v_mfma_f32_16x16x32_bf16 a[0:3], v[56:59], v[48:51], a[0:3]
  ds_read_b64_tr_b16 v[88:89], v4 offset:16384
  ds_read_b64_tr_b16 v[90:91], v4 offset:17408
  v_mfma_f32_16x16x32_bf16 a[8:11], v[56:59], v[64:67], a[8:11]
  ds_read_b128 v[80:83], v2 offset:16384
  v_mfma_f32_16x16x32_bf16 a[16:19], v[56:59], v[52:55], a[16:19]
  s_add_u32 m0, s26, 0
  s_nop 0
  buffer_load_dwordx4 v20, s[92:95], s20 offen offset:0 lds
  ds_read_b64_tr_b16 v[104:105], v8 offset:16384
  v_mfma_f32_16x16x32_bf16 a[24:27], v[56:59], v[68:71], a[24:27]
  ds_read_b64_tr_b16 v[106:107], v8 offset:17408
  v_mfma_f32_16x16x32_bf16 a[4:7], v[72:75], v[48:51], a[4:7]
  ds_read_b128 v[96:99], v2 offset:17408
  buffer_load_dwordx4 v20, s[92:95], s20 offen offset:1024 lds
  s_add_u32 s20, s20, 131072
  v_mfma_f32_16x16x32_bf16 a[12:15], v[72:75], v[64:67], a[12:15]
  ds_read_b64_tr_b16 v[92:93], v5 offset:16384
  v_mfma_f32_16x16x32_bf16 a[20:23], v[72:75], v[52:55], a[20:23]
  ds_read_b64_tr_b16 v[94:95], v5 offset:17408
  ds_read_b128 v[84:87], v2 offset:18432
  v_mfma_f32_16x16x32_bf16 a[28:31], v[72:75], v[68:71], a[28:31]
  s_add_u32 m0, s27, 0
  s_nop 0
  buffer_load_dwordx4 v21, s[12:15], s21 offen offset:0 lds
  v_mfma_f32_16x16x32_bf16 a[32:35], v[60:63], v[48:51], a[32:35]
  ds_read_b64_tr_b16 v[108:109], v9 offset:16384
  ds_read_b64_tr_b16 v[110:111], v9 offset:17408
  v_mfma_f32_16x16x32_bf16 a[40:43], v[60:63], v[64:67], a[40:43]
  ds_read_b128 v[100:103], v2 offset:19456
  v_mfma_f32_16x16x32_bf16 a[48:51], v[60:63], v[52:55], a[48:51]
  buffer_load_dwordx4 v22, s[12:15], s21 offen offset:1024 lds
  s_add_u32 s21, s21, s23
  v_mfma_f32_16x16x32_bf16 a[56:59], v[60:63], v[68:71], a[56:59]
  v_mfma_f32_16x16x32_bf16 a[36:39], v[76:79], v[48:51], a[36:39]
  v_mfma_f32_16x16x32_bf16 a[44:47], v[76:79], v[64:67], a[44:47]
  v_mfma_f32_16x16x32_bf16 a[52:55], v[76:79], v[52:55], a[52:55]
  v_mfma_f32_16x16x32_bf16 a[60:63], v[76:79], v[68:71], a[60:63]
  s_waitcnt vmcnt(24) lgkmcnt(0)
  s_barrier
  v_mfma_f32_16x16x32_bf16 a[0:3], v[88:91], v[80:83], a[0:3]
  ds_read_b64_tr_b16 v[56:57], v4 offset:32768
  ds_read_b64_tr_b16 v[58:59], v4 offset:33792
  v_mfma_f32_16x16x32_bf16 a[8:11], v[88:91], v[96:99], a[8:11]
  ds_read_b128 v[48:51], v2 offset:32768
  v_mfma_f32_16x16x32_bf16 a[16:19], v[88:91], v[84:87], a[16:19]
  s_add_u32 m0, s26, 16384
  s_nop 0
  buffer_load_dwordx4 v20, s[92:95], s20 offen offset:0 lds
  ds_read_b64_tr_b16 v[72:73], v8 offset:32768
  v_mfma_f32_16x16x32_bf16 a[24:27], v[88:91], v[100:103], a[24:27]
  ds_read_b64_tr_b16 v[74:75], v8 offset:33792
  v_mfma_f32_16x16x32_bf16 a[4:7], v[104:107], v[80:83], a[4:7]
  ds_read_b128 v[64:67], v2 offset:33792
  buffer_load_dwordx4 v20, s[92:95], s20 offen offset:1024 lds
  s_add_u32 s20, s20, 131072
  v_mfma_f32_16x16x32_bf16 a[12:15], v[104:107], v[96:99], a[12:15]
  ds_read_b64_tr_b16 v[60:61], v5 offset:32768
  v_mfma_f32_16x16x32_bf16 a[20:23], v[104:107], v[84:87], a[20:23]
  ds_read_b64_tr_b16 v[62:63], v5 offset:33792
  ds_read_b128 v[52:55], v2 offset:34816
  v_mfma_f32_16x16x32_bf16 a[28:31], v[104:107], v[100:103], a[28:31]
  s_add_u32 m0, s27, 16384
  s_nop 0
  buffer_load_dwordx4 v21, s[12:15], s21 offen offset:0 lds
  v_mfma_f32_16x16x32_bf16 a[32:35], v[92:95], v[80:83], a[32:35]
  ds_read_b64_tr_b16 v[76:77], v9 offset:32768
  ds_read_b64_tr_b16 v[78:79], v9 offset:33792
  v_mfma_f32_16x16x32_bf16 a[40:43], v[92:95], v[96:99], a[40:43]
  ds_read_b128 v[68:71], v2 offset:35840
  v_mfma_f32_16x16x32_bf16 a[48:51], v[92:95], v[84:87], a[48:51]
  buffer_load_dwordx4 v22, s[12:15], s21 offen offset:1024 lds
  s_add_u32 s21, s21, s23
  v_mfma_f32_16x16x32_bf16 a[56:59], v[92:95], v[100:103], a[56:59]
  v_mfma_f32_16x16x32_bf16 a[36:39], v[108:111], v[80:83], a[36:39]
  v_mfma_f32_16x16x32_bf16 a[44:47], v[108:111], v[96:99], a[44:47]
  v_mfma_f32_16x16x32_bf16 a[52:55], v[108:111], v[84:87], a[52:55]
  v_mfma_f32_16x16x32_bf16 a[60:63], v[108:111], v[100:103], a[60:63]
  s_waitcnt vmcnt(24) lgkmcnt(0)
  s_barrier
  v_mfma_f32_16x16x32_bf16 a[0:3], v[56:59], v[48:51], a[0:3]
  ds_read_b64_tr_b16 v[88:89], v4 offset:49152
  ds_read_b64_tr_b16 v[90:91], v4 offset:50176
  v_mfma_f32_16x16x32_bf16 a[8:11], v[56:59], v[64:67], a[8:11]
  ds_read_b128 v[80:83], v2 offset:49152
  v_mfma_f32_16x16x32_bf16 a[16:19], v[56:59], v[52:55], a[16:19]
  s_add_u32 m0, s26, 32768
  s_nop 0
  buffer_load_dwordx4 v20, s[92:95], s20 offen offset:0 lds
  ds_read_b64_tr_b16 v[104:105], v8 offset:49152
  v_mfma_f32_16x16x32_bf16 a[24:27], v[56:59], v[68:71], a[24:27]
  ds_read_b64_tr_b16 v[106:107], v8 offset:50176
  v_mfma_f32_16x16x32_bf16 a[4:7], v[72:75], v[48:51], a[4:7]
  ds_read_b128 v[96:99], v2 offset:50176
  buffer_load_dwordx4 v20, s[92:95], s20 offen offset:1024 lds
  s_add_u32 s20, s20, 131072
  v_mfma_f32_16x16x32_bf16 a[12:15], v[72:75], v[64:67], a[12:15]
  ds_read_b64_tr_b16 v[92:93], v5 offset:49152
  v_mfma_f32_16x16x32_bf16 a[20:23], v[72:75], v[52:55], a[20:23]
  ds_read_b64_tr_b16 v[94:95], v5 offset:50176
  ds_read_b128 v[84:87], v2 offset:51200
  v_mfma_f32_16x16x32_bf16 a[28:31], v[72:75], v[68:71], a[28:31]
  s_add_u32 m0, s27, 32768
  s_nop 0
  buffer_load_dwordx4 v21, s[12:15], s21 offen offset:0 lds
  v_mfma_f32_16x16x32_bf16 a[32:35], v[60:63], v[48:51], a[32:35]
  ds_read_b64_tr_b16 v[108:109], v9 offset:49152
  ds_read_b64_tr_b16 v[110:111], v9 offset:50176
  v_mfma_f32_16x16x32_bf16 a[40:43], v[60:63], v[64:67], a[40:43]
  ds_read_b128 v[100:103], v2 offset:52224
  v_mfma_f32_16x16x32_bf16 a[48:51], v[60:63], v[52:55], a[48:51]
  buffer_load_dwordx4 v22, s[12:15], s21 offen offset:1024 lds
  s_add_u32 s21, s21, s23
  v_mfma_f32_16x16x32_bf16 a[56:59], v[60:63], v[68:71], a[56:59]
  v_mfma_f32_16x16x32_bf16 a[36:39], v[76:79], v[48:51], a[36:39]
  v_mfma_f32_16x16x32_bf16 a[44:47], v[76:79], v[64:67], a[44:47]
  v_mfma_f32_16x16x32_bf16 a[52:55], v[76:79], v[52:55], a[52:55]
  v_mfma_f32_16x16x32_bf16 a[60:63], v[76:79], v[68:71], a[60:63]
  s_waitcnt vmcnt(24) lgkmcnt(0)
  s_barrier
  v_mfma_f32_16x16x32_bf16 a[0:3], v[88:91], v[80:83], a[0:3]
  ds_read_b64_tr_b16 v[56:57], v12 offset:0
  ds_read_b64_tr_b16 v[58:59], v12 offset:1024
  v_mfma_f32_16x16x32_bf16 a[8:11], v[88:91], v[96:99], a[8:11]
  ds_read_b128 v[48:51], v3 offset:0
  v_mfma_f32_16x16x32_bf16 a[16:19], v[88:91], v[84:87], a[16:19]
  s_add_u32 m0, s26, 49152
  s_nop 0
  buffer_load_dwordx4 v20, s[92:95], s20 offen offset:0 lds
  ds_read_b64_tr_b16 v[72:73], v16 offset:0
  v_mfma_f32_16x16x32_bf16 a[24:27], v[88:91], v[100:103], a[24:27]
  ds_read_b64_tr_b16 v[74:75], v16 offset:1024
  v_mfma_f32_16x16x32_bf16 a[4:7], v[104:107], v[80:83], a[4:7]
  ds_read_b128 v[64:67], v3 offset:1024
  buffer_load_dwordx4 v20, s[92:95], s20 offen offset:1024 lds
  s_add_u32 s20, s20, 131072
  v_mfma_f32_16x16x32_bf16 a[12:15], v[104:107], v[96:99], a[12:15]
  ds_read_b64_tr_b16 v[60:61], v13 offset:0
  v_mfma_f32_16x16x32_bf16 a[20:23], v[104:107], v[84:87], a[20:23]
  ds_read_b64_tr_b16 v[62:63], v13 offset:1024
  ds_read_b128 v[52:55], v3 offset:2048
  v_mfma_f32_16x16x32_bf16 a[28:31], v[104:107], v[100:103], a[28:31]
  s_add_u32 m0, s27, 49152
  s_nop 0
  buffer_load_dwordx4 v21, s[12:15], s21 offen offset:0 lds
  v_mfma_f32_16x16x32_bf16 a[32:35], v[92:95], v[80:83], a[32:35]
  ds_read_b64_tr_b16 v[76:77], v17 offset:0
  ds_read_b64_tr_b16 v[78:79], v17 offset:1024
  v_mfma_f32_16x16x32_bf16 a[40:43], v[92:95], v[96:99], a[40:43]
  ds_read_b128 v[68:71], v3 offset:3072
  v_mfma_f32_16x16x32_bf16 a[48:51], v[92:95], v[84:87], a[48:51]
  buffer_load_dwordx4 v22, s[12:15], s21 offen offset:1024 lds
  s_add_u32 s21, s21, s23
  v_mfma_f32_16x16x32_bf16 a[56:59], v[92:95], v[100:103], a[56:59]
  v_mfma_f32_16x16x32_bf16 a[36:39], v[108:111], v[80:83], a[36:39]
  v_mfma_f32_16x16x32_bf16 a[44:47], v[108:111], v[96:99], a[44:47]
  v_mfma_f32_16x16x32_bf16 a[52:55], v[108:111], v[84:87], a[52:55]
  v_mfma_f32_16x16x32_bf16 a[60:63], v[108:111], v[100:103], a[60:63]
  s_waitcnt vmcnt(24) lgkmcnt(0)
  s_barrier
  v_mfma_f32_16x16x32_bf16 a[0:3], v[56:59], v[48:51], a[0:3]
  ds_read_b64_tr_b16 v[88:89], v12 offset:16384
  ds_read_b64_tr_b16 v[90:91], v12 offset:17408
  v_mfma_f32_16x16x32_bf16 a[8:11], v[56:59], v[64:67], a[8:11]
  ds_read_b128 v[80:83], v3 offset:16384
  v_mfma_f32_16x16x32_bf16 a[16:19], v[56:59], v[52:55], a[16:19]
  s_add_u32 m0, s26, 65536
  s_nop 0
  buffer_load_dwordx4 v20, s[92:95], s20 offen offset:0 lds
  ds_read_b64_tr_b16 v[104:105], v16 offset:16384
  v_mfma_f32_16x16x32_bf16 a[24:27], v[56:59], v[68:71], a[24:27]
  ds_read_b64_tr_b16 v[106:107], v16 offset:17408
  v_mfma_f32_16x16x32_bf16 a[4:7], v[72:75], v[48:51], a[4:7]
  ds_read_b128 v[96:99], v3 offset:17408
  buffer_load_dwordx4 v20, s[92:95], s20 offen offset:1024 lds
  s_add_u32 s20, s20, 131072
  v_mfma_f32_16x16x32_bf16 a[12:15], v[72:75], v[64:67], a[12:15]
  ds_read_b64_tr_b16 v[92:93], v13 offset:16384
  v_mfma_f32_16x16x32_bf16 a[20:23], v[72:75], v[52:55], a[20:23]
  ds_read_b64_tr_b16 v[94:95], v13 offset:17408
  ds_read_b128 v[84:87], v3 offset:18432
  v_mfma_f32_16x16x32_bf16 a[28:31], v[72:75], v[68:71], a[28:31]
  s_add_u32 m0, s27, 65536
  s_nop 0
  buffer_load_dwordx4 v21, s[12:15], s21 offen offset:0 lds
  v_mfma_f32_16x16x32_bf16 a[32:35], v[60:63], v[48:51], a[32:35]
  ds_read_b64_tr_b16 v[108:109], v17 offset:16384
  ds_read_b64_tr_b16 v[110:111], v17 offset:17408
  v_mfma_f32_16x16x32_bf16 a[40:43], v[60:63], v[64:67], a[40:43]
  ds_read_b128 v[100:103], v3 offset:19456
  v_mfma_f32_16x16x32_bf16 a[48:51], v[60:63], v[52:55], a[48:51]
  buffer_load_dwordx4 v22, s[12:15], s21 offen offset:1024 lds
  s_add_u32 s21, s21, s23
  v_mfma_f32_16x16x32_bf16 a[56:59], v[60:63], v[68:71], a[56:59]
  v_mfma_f32_16x16x32_bf16 a[36:39], v[76:79], v[48:51], a[36:39]
  v_mfma_f32_16x16x32_bf16 a[44:47], v[76:79], v[64:67], a[44:47]
  v_mfma_f32_16x16x32_bf16 a[52:55], v[76:79], v[52:55], a[52:55]
  v_mfma_f32_16x16x32_bf16 a[60:63], v[76:79], v[68:71], a[60:63]
  s_waitcnt vmcnt(24) lgkmcnt(0)
  s_barrier
  v_mfma_f32_16x16x32_bf16 a[0:3], v[88:91], v[80:83], a[0:3]
  ds_read_b64_tr_b16 v[56:57], v12 offset:32768
  ds_read_b64_tr_b16 v[58:59], v12 offset:33792
  v_mfma_f32_16x16x32_bf16 a[8:11], v[88:91], v[96:99], a[8:11]
  ds_read_b128 v[48:51], v3 offset:32768
  v_mfma_f32_16x16x32_bf16 a[16:19], v[88:91], v[84:87], a[16:19]
  s_add_u32 m0, s26, 81920
  s_nop 0
  buffer_load_dwordx4 v20, s[92:95], s20 offen offset:0 lds
  ds_read_b64_tr_b16 v[72:73], v16 offset:32768
  v_mfma_f32_16x16x32_bf16 a[24:27], v[88:91], v[100:103], a[24:27]
  ds_read_b64_tr_b16 v[74:75], v16 offset:33792
  v_mfma_f32_16x16x32_bf16 a[4:7], v[104:107], v[80:83], a[4:7]
  ds_read_b128 v[64:67], v3 offset:33792
  buffer_load_dwordx4 v20, s[92:95], s20 offen offset:1024 lds
  s_add_u32 s20, s20, 131072
  v_mfma_f32_16x16x32_bf16 a[12:15], v[104:107], v[96:99], a[12:15]
  ds_read_b64_tr_b16 v[60:61], v13 offset:32768
  v_mfma_f32_16x16x32_bf16 a[20:23], v[104:107], v[84:87], a[20:23]
  ds_read_b64_tr_b16 v[62:63], v13 offset:33792
  ds_read_b128 v[52:55], v3 offset:34816
  v_mfma_f32_16x16x32_bf16 a[28:31], v[104:107], v[100:103], a[28:31]
  s_add_u32 m0, s27, 81920
  s_nop 0
  buffer_load_dwordx4 v21, s[12:15], s21 offen offset:0 lds
  v_mfma_f32_16x16x32_bf16 a[32:35], v[92:95], v[80:83], a[32:35]
  ds_read_b64_tr_b16 v[76:77], v17 offset:32768
  ds_read_b64_tr_b16 v[78:79], v17 offset:33792
  v_mfma_f32_16x16x32_bf16 a[40:43], v[92:95], v[96:99], a[40:43]
  ds_read_b128 v[68:71], v3 offset:35840
  v_mfma_f32_16x16x32_bf16 a[48:51], v[92:95], v[84:87], a[48:51]
  buffer_load_dwordx4 v22, s[12:15], s21 offen offset:1024 lds
  s_add_u32 s21, s21, s23
  v_mfma_f32_16x16x32_bf16 a[56:59], v[92:95], v[100:103], a[56:59]
  v_mfma_f32_16x16x32_bf16 a[36:39], v[108:111], v[80:83], a[36:39]
  v_mfma_f32_16x16x32_bf16 a[44:47], v[108:111], v[96:99], a[44:47]
  v_mfma_f32_16x16x32_bf16 a[52:55], v[108:111], v[84:87], a[52:55]
  v_mfma_f32_16x16x32_bf16 a[60:63], v[108:111], v[100:103], a[60:63]
  s_waitcnt vmcnt(24) lgkmcnt(0)
  s_barrier
  v_mfma_f32_16x16x32_bf16 a[0:3], v[56:59], v[48:51], a[0:3]
  ds_read_b64_tr_b16 v[88:89], v12 offset:49152
  ds_read_b64_tr_b16 v[90:91], v12 offset:50176
  v_mfma_f32_16x16x32_bf16 a[8:11], v[56:59], v[64:67], a[8:11]
  ds_read_b128 v[80:83], v3 offset:49152
  v_mfma_f32_16x16x32_bf16 a[16:19], v[56:59], v[52:55], a[16:19]
  s_add_u32 m0, s26, 98304
  s_nop 0
  buffer_load_dwordx4 v20, s[92:95], s20 offen offset:0 lds
  ds_read_b64_tr_b16 v[104:105], v16 offset:49152
  v_mfma_f32_16x16x32_bf16 a[24:27], v[56:59], v[68:71], a[24:27]
  ds_read_b64_tr_b16 v[106:107], v16 offset:50176
  v_mfma_f32_16x16x32_bf16 a[4:7], v[72:75], v[48:51], a[4:7]
  ds_read_b128 v[96:99], v3 offset:50176
  buffer_load_dwordx4 v20, s[92:95], s20 offen offset:1024 lds
  s_add_u32 s20, s20, 131072
  v_mfma_f32_16x16x32_bf16 a[12:15], v[72:75], v[64:67], a[12:15]
  ds_read_b64_tr_b16 v[92:93], v13 offset:49152
  v_mfma_f32_16x16x32_bf16 a[20:23], v[72:75], v[52:55], a[20:23]
  ds_read_b64_tr_b16 v[94:95], v13 offset:50176
  ds_read_b128 v[84:87], v3 offset:51200
  v_mfma_f32_16x16x32_bf16 a[28:31], v[72:75], v[68:71], a[28:31]
  s_add_u32 m0, s27, 98304
  s_nop 0
  buffer_load_dwordx4 v21, s[12:15], s21 offen offset:0 lds
  v_mfma_f32_16x16x32_bf16 a[32:35], v[60:63], v[48:51], a[32:35]
  ds_read_b64_tr_b16 v[108:109], v17 offset:49152
  ds_read_b64_tr_b16 v[110:111], v17 offset:50176
  v_mfma_f32_16x16x32_bf16 a[40:43], v[60:63], v[64:67], a[40:43]
  ds_read_b128 v[100:103], v3 offset:52224
  v_mfma_f32_16x16x32_bf16 a[48:51], v[60:63], v[52:55], a[48:51]
  buffer_load_dwordx4 v22, s[12:15], s21 offen offset:1024 lds
  s_add_u32 s21, s21, s23
  v_mfma_f32_16x16x32_bf16 a[56:59], v[60:63], v[68:71], a[56:59]
  v_mfma_f32_16x16x32_bf16 a[36:39], v[76:79], v[48:51], a[36:39]
  v_mfma_f32_16x16x32_bf16 a[44:47], v[76:79], v[64:67], a[44:47]
  v_mfma_f32_16x16x32_bf16 a[52:55], v[76:79], v[52:55], a[52:55]
  v_mfma_f32_16x16x32_bf16 a[60:63], v[76:79], v[68:71], a[60:63]
  s_waitcnt vmcnt(24) lgkmcnt(0)
  s_barrier
  v_mfma_f32_16x16x32_bf16 a[0:3], v[88:91], v[80:83], a[0:3]
  ds_read_b64_tr_b16 v[56:57], v4 offset:0
  ds_read_b64_tr_b16 v[58:59], v4 offset:1024
  v_mfma_f32_16x16x32_bf16 a[8:11], v[88:91], v[96:99], a[8:11]
  ds_read_b128 v[48:51], v2 offset:0
  v_mfma_f32_16x16x32_bf16 a[16:19], v[88:91], v[84:87], a[16:19]
  s_add_u32 m0, s26, 114688
  s_nop 0
  buffer_load_dwordx4 v20, s[92:95], s20 offen offset:0 lds
  ds_read_b64_tr_b16 v[72:73], v8 offset:0
  v_mfma_f32_16x16x32_bf16 a[24:27], v[88:91], v[100:103], a[24:27]
  ds_read_b64_tr_b16 v[74:75], v8 offset:1024
  v_mfma_f32_16x16x32_bf16 a[4:7], v[104:107], v[80:83], a[4:7]
  ds_read_b128 v[64:67], v2 offset:1024
  buffer_load_dwordx4 v20, s[92:95], s20 offen offset:1024 lds
  s_add_u32 s20, s20, 131072
  v_mfma_f32_16x16x32_bf16 a[12:15], v[104:107], v[96:99], a[12:15]
  ds_read_b64_tr_b16 v[60:61], v5 offset:0
  v_mfma_f32_16x16x32_bf16 a[20:23], v[104:107], v[84:87], a[20:23]
  ds_read_b64_tr_b16 v[62:63], v5 offset:1024
  ds_read_b128 v[52:55], v2 offset:2048
  v_mfma_f32_16x16x32_bf16 a[28:31], v[104:107], v[100:103], a[28:31]
  s_add_u32 m0, s27, 114688
  s_nop 0
  buffer_load_dwordx4 v21, s[12:15], s21 offen offset:0 lds
  v_mfma_f32_16x16x32_bf16 a[32:35], v[92:95], v[80:83], a[32:35]
  ds_read_b64_tr_b16 v[76:77], v9 offset:0
  ds_read_b64_tr_b16 v[78:79], v9 offset:1024
  v_mfma_f32_16x16x32_bf16 a[40:43], v[92:95], v[96:99], a[40:43]
  ds_read_b128 v[68:71], v2 offset:3072
  v_mfma_f32_16x16x32_bf16 a[48:51], v[92:95], v[84:87], a[48:51]
  buffer_load_dwordx4 v22, s[12:15], s21 offen offset:1024 lds
  s_add_u32 s21, s21, s23
  v_mfma_f32_16x16x32_bf16 a[56:59], v[92:95], v[100:103], a[56:59]
  v_mfma_f32_16x16x32_bf16 a[36:39], v[108:111], v[80:83], a[36:39]
  v_mfma_f32_16x16x32_bf16 a[44:47], v[108:111], v[96:99], a[44:47]
  v_mfma_f32_16x16x32_bf16 a[52:55], v[108:111], v[84:87], a[52:55]
  v_mfma_f32_16x16x32_bf16 a[60:63], v[108:111], v[100:103], a[60:63]
  s_sub_u32 s22, s22, 1
  s_cmp_lg_u32 s22, 0
  s_cbranch_scc1 mk_gs_loop0
  s_waitcnt lgkmcnt(0)
  v_and_b32 v36, 15, v1
  v_lshl_add_u32 v36, v36, 6, v34
  s_mul_i32 s40, s32, 262144
  s_mul_i32 s41, s33, 4096
  s_add_u32 s40, s40, s41
  s_add_u32 s40, s40, s79
  v_add_u32 v35, s40, v36
  s_nop 7
  s_mov_b32 s42, 0
  v_accvgpr_read_b32 v88, a0
  v_accvgpr_read_b32 v89, a1
  v_accvgpr_read_b32 v90, a2
  v_accvgpr_read_b32 v91, a3
  v_accvgpr_read_b32 v92, a4
  v_accvgpr_read_b32 v93, a5
  v_accvgpr_read_b32 v94, a6
  v_accvgpr_read_b32 v95, a7
  v_accvgpr_read_b32 v96, a8
  v_accvgpr_read_b32 v97, a9
  v_accvgpr_read_b32 v98, a10
  v_accvgpr_read_b32 v99, a11
  v_accvgpr_read_b32 v100, a12
  v_accvgpr_read_b32 v101, a13
  v_accvgpr_read_b32 v102, a14
  v_accvgpr_read_b32 v103, a15
  v_cvt_pk_bf16_f32 v80, v88, v89
  v_cvt_pk_bf16_f32 v81, v90, v91
  v_cvt_pk_bf16_f32 v82, v92, v93
  v_cvt_pk_bf16_f32 v83, v94, v95
  v_cvt_pk_bf16_f32 v84, v96, v97
  v_cvt_pk_bf16_f32 v85, v98, v99
  v_cvt_pk_bf16_f32 v86, v100, v101
  v_cvt_pk_bf16_f32 v87, v102, v103
  v_pk_max_i16 v80, v80, s46
  v_pk_max_i16 v81, v81, s46
  v_pk_max_i16 v82, v82, s46
  v_pk_max_i16 v83, v83, s46
  v_pk_max_i16 v84, v84, s46
  v_pk_max_i16 v85, v85, s46
  v_pk_max_i16 v86, v86, s46
  v_pk_max_i16 v87, v87, s46
  s_nop 1
  v_permlane16_swap_b32 v80, v82
  v_permlane16_swap_b32 v81, v83
  v_permlane16_swap_b32 v84, v86
  v_permlane16_swap_b32 v85, v87
  buffer_store_dwordx4 v[80:83], v35, s[8:11], s42 offen offset:0 sc1
  buffer_store_dwordx4 v[84:87], v35, s[8:11], s42 offen offset:1024 sc1
  v_accvgpr_read_b32 v112, a16
  v_accvgpr_read_b32 v113, a17
  v_accvgpr_read_b32 v114, a18
  v_accvgpr_read_b32 v115, a19
  v_accvgpr_read_b32 v116, a20
  v_accvgpr_read_b32 v117, a21
  v_accvgpr_read_b32 v118, a22
  v_accvgpr_read_b32 v119, a23
  v_accvgpr_read_b32 v120, a24
  v_accvgpr_read_b32 v121, a25
  v_accvgpr_read_b32 v122, a26
  v_accvgpr_read_b32 v123, a27
  v_accvgpr_read_b32 v124, a28
  v_accvgpr_read_b32 v125, a29
  v_accvgpr_read_b32 v126, a30
  v_accvgpr_read_b32 v127, a31
  v_cvt_pk_bf16_f32 v104, v112, v113
  v_cvt_pk_bf16_f32 v105, v114, v115
  v_cvt_pk_bf16_f32 v106, v116, v117
  v_cvt_pk_bf16_f32 v107, v118, v119
  v_cvt_pk_bf16_f32 v108, v120, v121
  v_cvt_pk_bf16_f32 v109, v122, v123
  v_cvt_pk_bf16_f32 v110, v124, v125
  v_cvt_pk_bf16_f32 v111, v126, v127
  v_pk_max_i16 v104, v104, s46
  v_pk_max_i16 v105, v105, s46
  v_pk_max_i16 v106, v106, s46
  v_pk_max_i16 v107, v107, s46
  v_pk_max_i16 v108, v108, s46
  v_pk_max_i16 v109, v109, s46
  v_pk_max_i16 v110, v110, s46
  v_pk_max_i16 v111, v111, s46
  s_nop 1
  v_permlane16_swap_b32 v104, v106
  v_permlane16_swap_b32 v105, v107
  v_permlane16_swap_b32 v108, v110
  v_permlane16_swap_b32 v109, v111
  buffer_store_dwordx4 v[104:107], v35, s[8:11], s42 offen offset:2048 sc1
  buffer_store_dwordx4 v[108:111], v35, s[8:11], s42 offen offset:3072 sc1
  s_mov_b32 s42, 131072
  v_accvgpr_read_b32 v88, a32
  v_accvgpr_read_b32 v89, a33
  v_accvgpr_read_b32 v90, a34
  v_accvgpr_read_b32 v91, a35
  v_accvgpr_read_b32 v92, a36
  v_accvgpr_read_b32 v93, a37
  v_accvgpr_read_b32 v94, a38
  v_accvgpr_read_b32 v95, a39
  v_accvgpr_read_b32 v96, a40
  v_accvgpr_read_b32 v97, a41
  v_accvgpr_read_b32 v98, a42
  v_accvgpr_read_b32 v99, a43
  v_accvgpr_read_b32 v100, a44
  v_accvgpr_read_b32 v101, a45
  v_accvgpr_read_b32 v102, a46
  v_accvgpr_read_b32 v103, a47
  v_cvt_pk_bf16_f32 v80, v88, v89
  v_cvt_pk_bf16_f32 v81, v90, v91
  v_cvt_pk_bf16_f32 v82, v92, v93
  v_cvt_pk_bf16_f32 v83, v94, v95
  v_cvt_pk_bf16_f32 v84, v96, v97
  v_cvt_pk_bf16_f32 v85, v98, v99
  v_cvt_pk_bf16_f32 v86, v100, v101
  v_cvt_pk_bf16_f32 v87, v102, v103
  v_pk_max_i16 v80, v80, s46
  v_pk_max_i16 v81, v81, s46
  v_pk_max_i16 v82, v82, s46
  v_pk_max_i16 v83, v83, s46
  v_pk_max_i16 v84, v84, s46
  v_pk_max_i16 v85, v85, s46
  v_pk_max_i16 v86, v86, s46
  v_pk_max_i16 v87, v87, s46
  s_nop 1
  v_permlane16_swap_b32 v80, v82
  v_permlane16_swap_b32 v81, v83
  v_permlane16_swap_b32 v84, v86
  v_permlane16_swap_b32 v85, v87
  buffer_store_dwordx4 v[80:83], v35, s[8:11], s42 offen offset:0 sc1
  buffer_store_dwordx4 v[84:87], v35, s[8:11], s42 offen offset:1024 sc1
  v_accvgpr_read_b32 v112, a48
  v_accvgpr_read_b32 v113, a49
  v_accvgpr_read_b32 v114, a50
  v_accvgpr_read_b32 v115, a51
  v_accvgpr_read_b32 v116, a52
  v_accvgpr_read_b32 v117, a53
  v_accvgpr_read_b32 v118, a54
  v_accvgpr_read_b32 v119, a55
  v_accvgpr_read_b32 v120, a56
  v_accvgpr_read_b32 v121, a57
  v_accvgpr_read_b32 v122, a58
  v_accvgpr_read_b32 v123, a59
  v_accvgpr_read_b32 v124, a60
  v_accvgpr_read_b32 v125, a61
  v_accvgpr_read_b32 v126, a62
  v_accvgpr_read_b32 v127, a63
  v_cvt_pk_bf16_f32 v104, v112, v113
  v_cvt_pk_bf16_f32 v105, v114, v115
  v_cvt_pk_bf16_f32 v106, v116, v117
  v_cvt_pk_bf16_f32 v107, v118, v119
  v_cvt_pk_bf16_f32 v108, v120, v121
  v_cvt_pk_bf16_f32 v109, v122, v123
  v_cvt_pk_bf16_f32 v110, v124, v125
  v_cvt_pk_bf16_f32 v111, v126, v127
  v_pk_max_i16 v104, v104, s46
  v_pk_max_i16 v105, v105, s46
  v_pk_max_i16 v106, v106, s46
  v_pk_max_i16 v107, v107, s46
  v_pk_max_i16 v108, v108, s46
  v_pk_max_i16 v109, v109, s46
  v_pk_max_i16 v110, v110, s46
  v_pk_max_i16 v111, v111, s46
  s_nop 1
  v_permlane16_swap_b32 v104, v106
  v_permlane16_swap_b32 v105, v107
  v_permlane16_swap_b32 v108, v110
  v_permlane16_swap_b32 v109, v111
  buffer_store_dwordx4 v[104:107], v35, s[8:11], s42 offen offset:2048 sc1
  buffer_store_dwordx4 v[108:111], v35, s[8:11], s42 offen offset:3072 sc1
  s_mov_b32 s47, s80
  s_mov_b32 s48, s81
  s_waitcnt vmcnt(0)
  s_barrier
  buffer_store_dword v251, v250, s[8:11], s47 offen sc1
  buffer_store_dword v251, v250, s[8:11], s48 offen sc1
  s_mov_b32 s76, s84
  s_mov_b32 s77, s85
  s_mov_b32 s78, s86
  s_mov_b32 s79, s87
  s_mov_b32 s80, s88
  s_mov_b32 s81, s89
  s_mov_b32 s82, s90
  s_mov_b32 s83, s91
  s_add_u32 s70, s70, 32
  s_addc_u32 s71, s71, 0
  s_load_dwordx8 s[84:91], s[70:71], 32
  s_cmp_lt_u32 s76, 16
  s_waitcnt lgkmcnt(0)
  s_cbranch_scc1 mk_small
  v_lshrrev_b32 v36, 6, v0
  s_nop 0
  v_readfirstlane_b32 s28, v36
  v_and_b32 v1, 63, v0
  s_and_b32 s32, s28, 1
  s_lshr_b32 s33, s28, 1
  v_bfe_u32 v40, v1, 2, 1
  v_bfe_u32 v41, v1, 3, 1
  v_xor_b32 v40, v40, v41
  v_lshl_add_u32 v38, v40, 1, v41
  v_and_b32 v36, 15, v1
  v_lshrrev_b32 v37, 4, v1
  v_xor_b32 v37, v37, v38
  v_lshlrev_b32 v37, 4, v37
  v_lshl_add_u32 v37, v36, 6, v37
  s_mul_i32 s40, s33, 8192
  v_add_u32 v2, s40, v37
  v_add_u32 v3, 65536, v2
  v_bfe_u32 v36, v1, 2, 2
  v_lshrrev_b32 v37, 4, v1
  v_lshl_add_u32 v37, v37, 3, v36
  v_mul_u32_u24 v37, 512, v37
  v_and_b32 v38, 3, v1
  v_lshlrev_b32 v38, 3, v38
  v_bfe_u32 v39, v1, 4, 1
  v_lshl_add_u32 v38, v39, 5, v38
  v_add_u32 v37, v37, v38
  v_add_u32 v37, 16384, v37
  s_mul_i32 s40, s32, 4
  s_add_u32 s41, s40, 0
  v_xor_b32 v38, s41, v36
  v_lshl_add_u32 v4, v38, 6, v37
  v_xor_b32 v8, 32, v4
  v_add_u32 v12, 65536, v4
  v_add_u32 v16, 65536, v8
  s_add_u32 s41, s40, 1
  v_xor_b32 v38, s41, v36
  v_lshl_add_u32 v5, v38, 6, v37
  v_xor_b32 v9, 32, v5
  v_add_u32 v13, 65536, v5
  v_add_u32 v17, 65536, v9
  s_add_u32 s41, s40, 2
  v_xor_b32 v38, s41, v36
  v_lshl_add_u32 v6, v38, 6, v37
  v_xor_b32 v10, 32, v6
  v_add_u32 v14, 65536, v6
  v_add_u32 v18, 65536, v10
  s_add_u32 s41, s40, 3
  v_xor_b32 v38, s41, v36
  v_lshl_add_u32 v7, v38, 6, v37
  v_xor_b32 v11, 32, v7
  v_add_u32 v15, 65536, v7
  v_add_u32 v19, 65536, v11
  v_bfe_u32 v40, v1, 4, 1
  v_bfe_u32 v41, v1, 5, 1
  v_xor_b32 v40, v40, v41
  v_lshl_add_u32 v37, v40, 1, v41
  v_and_b32 v36, 3, v1
  v_xor_b32 v36, v36, v37
  v_lshlrev_b32 v36, 4, v36
  v_lshrrev_b32 v37, 2, v1
  v_lshl_add_u32 v36, v37, 6, v36
  s_mul_i32 s26, s28, 4096
  v_add_u32 v33, s26, v36
  s_mul_i32 s40, s28, 8
  s_add_u32 s40, s40, 0
  v_lshrrev_b32 v25, 5, v1
  v_add_u32 v25, s40, v25
  v_and_b32 v37, 3, v25
  v_lshlrev_b32 v37, 2, v37
  v_and_b32 v38, 31, v1
  v_xor_b32 v37, v37, v38
  v_bfe_u32 v38, v25, 3, 1
  v_lshlrev_b32 v38, 1, v38
  v_xor_b32 v37, v37, v38
  v_lshlrev_b32 v29, 4, v37
  v_subrev_u32 v29, 0, v29
  s_mul_i32 s40, s28, 8
  s_add_u32 s40, s40, 2
  v_lshrrev_b32 v26, 5, v1
  v_add_u32 v26, s40, v26
  v_and_b32 v37, 3, v26
  v_lshlrev_b32 v37, 2, v37
  v_and_b32 v38, 31, v1
  v_xor_b32 v37, v37, v38
  v_bfe_u32 v38, v26, 3, 1
  v_lshlrev_b32 v38, 1, v38
  v_xor_b32 v37, v37, v38
  v_lshlrev_b32 v30, 4, v37
  v_subrev_u32 v30, 1024, v30
  s_mul_i32 s40, s28, 8
  s_add_u32 s40, s40, 4
  v_lshrrev_b32 v27, 5, v1
  v_add_u32 v27, s40, v27
  v_and_b32 v37, 3, v27
  v_lshlrev_b32 v37, 2, v37
  v_and_b32 v38, 31, v1
  v_xor_b32 v37, v37, v38
  v_bfe_u32 v38, v27, 3, 1
  v_lshlrev_b32 v38, 1, v38
  v_xor_b32 v37, v37, v38
  v_lshlrev_b32 v31, 4, v37
  v_subrev_u32 v31, 2048, v31
  s_mul_i32 s40, s28, 8
  s_add_u32 s40, s40, 6
  v_lshrrev_b32 v28, 5, v1
  v_add_u32 v28, s40, v28
  v_and_b32 v37, 3, v28
  v_lshlrev_b32 v37, 2, v37
  v_and_b32 v38, 31, v1
  v_xor_b32 v37, v37, v38
  v_bfe_u32 v38, v28, 3, 1
  v_lshlrev_b32 v38, 1, v38
  v_xor_b32 v37, v37, v38
  v_lshlrev_b32 v32, 4, v37
  v_subrev_u32 v32, 3072, v32
  s_mul_i32 s27, s28, 4096
  s_add_u32 s27, s27, 16384
  v_bfe_u32 v37, v1, 4, 1
  v_lshlrev_b32 v37, 5, v37
  v_bfe_u32 v38, v1, 5, 1
  v_lshl_add_u32 v34, v38, 4, v37
  s_waitcnt lgkmcnt(0)
  s_and_b32 s5, s76, 3
  s_mov_b32 s38, 8192
  s_mov_b32 s14, 8388608
  s_mov_b32 s12, s62
  s_mov_b32 s13, s63
  s_cmp_eq_u32 s5, 0
  s_cbranch_scc1 mk_t_46
  s_mov_b32 s12, s64
  s_mov_b32 s13, s65
  s_cmp_eq_u32 s5, 1
  s_cbranch_scc1 mk_t_46
  s_mov_b32 s12, s60
  s_mov_b32 s13, s61
  s_cmp_eq_u32 s5, 2
  s_cbranch_scc1 mk_t_46
  s_mov_b32 s12, s66
  s_mov_b32 s13, s67
  s_mov_b32 s38, 7168
  s_mov_b32 s14, 7340032
mk_t_46:
  s_mov_b32 s36, s77
  s_mov_b32 s37, s78
  s_mov_b32 s94, 268435456
  v_add_u32 v20, s36, v33
  v_mul_lo_u32 v21, v25, s38
  v_add_u32 v21, v21, v29
  v_add_u32 v21, s37, v21
  v_mul_lo_u32 v22, v26, s38
  v_add_u32 v22, v22, v30
  v_add_u32 v22, s37, v22
  v_mul_lo_u32 v23, v27, s38
  v_add_u32 v23, v23, v31
  v_add_u32 v23, s37, v23
  v_mul_lo_u32 v24, v28, s38
  v_add_u32 v24, v24, v32
  v_add_u32 v24, s37, v24
  s_mov_b32 s20, 0
  s_mov_b32 s21, 0
  s_lshl_b32 s23, s38, 5
  s_mov_b32 s39, 7
  s_mov_b32 s47, 2147483648
  s_mov_b32 s48, 2147483648
  s_barrier
  s_add_u32 m0, s26, 0
  s_nop 0
  buffer_load_dwordx4 v20, s[92:95], s20 offen offset:0 lds
  buffer_load_dwordx4 v20, s[92:95], s20 offen offset:1024 lds
  buffer_load_dwordx4 v20, s[92:95], s20 offen offset:2048 lds
  buffer_load_dwordx4 v20, s[92:95], s20 offen offset:3072 lds
  s_add_u32 s20, s20, 131072
  s_add_u32 m0, s27, 0
  s_nop 0
  buffer_load_dwordx4 v21, s[12:15], s21 offen offset:0 lds
  buffer_load_dwordx4 v22, s[12:15], s21 offen offset:1024 lds
  buffer_load_dwordx4 v23, s[12:15], s21 offen offset:2048 lds
  buffer_load_dwordx4 v24, s[12:15], s21 offen offset:3072 lds
  s_add_u32 s21, s21, s23
  s_add_u32 m0, s26, 32768
  s_nop 0
  buffer_load_dwordx4 v20, s[92:95], s20 offen offset:0 lds
  buffer_load_dwordx4 v20, s[92:95], s20 offen offset:1024 lds
  buffer_load_dwordx4 v20, s[92:95], s20 offen offset:2048 lds
  buffer_load_dwordx4 v20, s[92:95], s20 offen offset:3072 lds
  s_add_u32 s20, s20, 131072
  s_add_u32 m0, s27, 32768
  s_nop 0
  buffer_load_dwordx4 v21, s[12:15], s21 offen offset:0 lds
  buffer_load_dwordx4 v22, s[12:15], s21 offen offset:1024 lds
  buffer_load_dwordx4 v23, s[12:15], s21 offen offset:2048 lds
  buffer_load_dwordx4 v24, s[12:15], s21 offen offset:3072 lds
  s_add_u32 s21, s21, s23
  s_add_u32 m0, s26, 65536
  s_nop 0
  buffer_load_dwordx4 v20, s[92:95], s20 offen offset:0 lds
  buffer_load_dwordx4 v20, s[92:95], s20 offen offset:1024 lds
  buffer_load_dwordx4 v20, s[92:95], s20 offen offset:2048 lds
  buffer_load_dwordx4 v20, s[92:95], s20 offen offset:3072 lds
  s_add_u32 s20, s20, 131072
  s_add_u32 m0, s27, 65536
  s_nop 0
  buffer_load_dwordx4 v21, s[12:15], s21 offen offset:0 lds
  buffer_load_dwordx4 v22, s[12:15], s21 offen offset:1024 lds
  buffer_load_dwordx4 v23, s[12:15], s21 offen offset:2048 lds
  buffer_load_dwordx4 v24, s[12:15], s21 offen offset:3072 lds
  s_add_u32 s21, s21, s23
  s_add_u32 m0, s26, 98304
  s_nop 0
  buffer_load_dwordx4 v20, s[92:95], s20 offen offset:0 lds
  buffer_load_dwordx4 v20, s[92:95], s20 offen offset:1024 lds
  buffer_load_dwordx4 v20, s[92:95], s20 offen offset:2048 lds
  buffer_load_dwordx4 v20, s[92:95], s20 offen offset:3072 lds
  s_add_u32 s20, s20, 131072
  s_add_u32 m0, s27, 98304
  s_nop 0
  buffer_load_dwordx4 v21, s[12:15], s21 offen offset:0 lds
  buffer_load_dwordx4 v22, s[12:15], s21 offen offset:1024 lds
  buffer_load_dwordx4 v23, s[12:15], s21 offen offset:2048 lds
  buffer_load_dwordx4 v24, s[12:15], s21 offen offset:3072 lds
  s_add_u32 s21, s21, s23
  s_waitcnt vmcnt(24)
  s_barrier
  ds_read_b64_tr_b16 v[64:65], v4 offset:0
  ds_read_b64_tr_b16 v[66:67], v4 offset:2048
  ds_read_b128 v[48:51], v2 offset:0
  ds_read_b64_tr_b16 v[96:97], v8 offset:0
  ds_read_b64_tr_b16 v[98:99], v8 offset:2048
  ds_read_b128 v[80:83], v2 offset:1024
  ds_read_b64_tr_b16 v[68:69], v5 offset:0
  ds_read_b64_tr_b16 v[70:71], v5 offset:2048
  ds_read_b128 v[52:55], v2 offset:2048
  ds_read_b64_tr_b16 v[100:101], v9 offset:0
  ds_read_b64_tr_b16 v[102:103], v9 offset:2048
  ds_read_b128 v[84:87], v2 offset:3072
  ds_read_b64_tr_b16 v[72:73], v6 offset:0
  ds_read_b64_tr_b16 v[74:75], v6 offset:2048
  ds_read_b128 v[56:59], v2 offset:4096
  ds_read_b64_tr_b16 v[104:105], v10 offset:0
  ds_read_b64_tr_b16 v[106:107], v10 offset:2048
  ds_read_b128 v[88:91], v2 offset:5120
  ds_read_b64_tr_b16 v[76:77], v7 offset:0
  ds_read_b64_tr_b16 v[78:79], v7 offset:2048
  ds_read_b128 v[60:63], v2 offset:6144
  ds_read_b64_tr_b16 v[108:109], v11 offset:0
  ds_read_b64_tr_b16 v[110:111], v11 offset:2048
  ds_read_b128 v[92:95], v2 offset:7168
  s_mov_b32 s22, s39
  s_mul_i32 s5, s49, 57344
  v_lshlrev_b32 v36, 4, v0
  s_mov_b32 s58, 7340032
  s_mov_b32 s59, 0x20000
  s_mov_b32 s56, s66
  s_mov_b32 s57, s67
  s_mov_b32 s6, s5
  buffer_load_dwordx4 v[240:243], v36, s[56:59], s6 offen
  s_add_u32 s6, s6, 4096
  buffer_load_dwordx4 v[240:243], v36, s[56:59], s6 offen
  s_add_u32 s6, s6, 4096
  buffer_load_dwordx4 v[240:243], v36, s[56:59], s6 offen
  s_add_u32 s6, s6, 4096
  buffer_load_dwordx4 v[240:243], v36, s[56:59], s6 offen
  s_add_u32 s6, s6, 4096
  buffer_load_dwordx4 v[240:243], v36, s[56:59], s6 offen
  s_add_u32 s6, s6, 4096
  buffer_load_dwordx4 v[240:243], v36, s[56:59], s6 offen
  s_add_u32 s6, s6, 4096
  buffer_load_dwordx4 v[240:243], v36, s[56:59], s6 offen
  s_add_u32 s6, s6, 4096
  buffer_load_dwordx4 v[240:243], v36, s[56:59], s6 offen
  s_add_u32 s6, s6, 4096
  buffer_load_dwordx4 v[240:243], v36, s[56:59], s6 offen
  s_add_u32 s6, s6, 4096
  buffer_load_dwordx4 v[240:243], v36, s[56:59], s6 offen
  s_add_u32 s6, s6, 4096
  buffer_load_dwordx4 v[240:243], v36, s[56:59], s6 offen
  s_add_u32 s6, s6, 4096
  buffer_load_dwordx4 v[240:243], v36, s[56:59], s6 offen
  s_add_u32 s6, s6, 4096
  buffer_load_dwordx4 v[240:243], v36, s[56:59], s6 offen
  s_add_u32 s6, s6, 4096
  buffer_load_dwordx4 v[240:243], v36, s[56:59], s6 offen
  buffer_load_dwordx4 v[240:243], v36, s[56:59], s6 offen
  buffer_load_dwordx4 v[240:243], v36, s[56:59], s6 offen
  s_mov_b32 s56, s68
  s_mov_b32 s57, s69
  s_mov_b32 s6, s5
  buffer_load_dwordx4 v[240:243], v36, s[56:59], s6 offen
  s_add_u32 s6, s6, 4096
  buffer_load_dwordx4 v[240:243], v36, s[56:59], s6 offen
  s_add_u32 s6, s6, 4096
  buffer_load_dwordx4 v[240:243], v36, s[56:59], s6 offen
  s_add_u32 s6, s6, 4096
  buffer_load_dwordx4 v[240:243], v36, s[56:59], s6 offen
  s_add_u32 s6, s6, 4096
  buffer_load_dwordx4 v[240:243], v36, s[56:59], s6 offen
  s_add_u32 s6, s6, 4096
  buffer_load_dwordx4 v[240:243], v36, s[56:59], s6 offen
  s_add_u32 s6, s6, 4096
  buffer_load_dwordx4 v[240:243], v36, s[56:59], s6 offen
  s_add_u32 s6, s6, 4096
  buffer_load_dwordx4 v[240:243], v36, s[56:59], s6 offen
  s_add_u32 s6, s6, 4096
  buffer_load_dwordx4 v[240:243], v36, s[56:59], s6 offen
  s_add_u32 s6, s6, 4096
  buffer_load_dwordx4 v[240:243], v36, s[56:59], s6 offen
  s_add_u32 s6, s6, 4096
  buffer_load_dwordx4 v[240:243], v36, s[56:59], s6 offen
  s_add_u32 s6, s6, 4096
  buffer_load_dwordx4 v[240:243], v36, s[56:59], s6 offen
  s_add_u32 s6, s6, 4096
  buffer_load_dwordx4 v[240:243], v36, s[56:59], s6 offen
  s_add_u32 s6, s6, 4096
  buffer_load_dwordx4 v[240:243], v36, s[56:59], s6 offen
  buffer_load_dwordx4 v[240:243], v36, s[56:59], s6 offen
  buffer_load_dwordx4 v[240:243], v36, s[56:59], s6 offen
.p2align 6
mk_big:
  s_waitcnt vmcnt(48) lgkmcnt(0)
  s_barrier
  v_mfma_f32_16x16x32_bf16 a[0:3], v[64:67], v[48:51], 0
  ds_read_b64_tr_b16 v[128:129], v4 offset:32768
  v_mfma_f32_16x16x32_bf16 a[8:11], v[64:67], v[80:83], 0
  ds_read_b64_tr_b16 v[130:131], v4 offset:34816
  v_mfma_f32_16x16x32_bf16 a[16:19], v[64:67], v[52:55], 0
  v_mfma_f32_16x16x32_bf16 a[24:27], v[64:67], v[84:87], 0
  ds_read_b128 v[112:115], v2 offset:32768
  v_mfma_f32_16x16x32_bf16 a[32:35], v[64:67], v[56:59], 0
  v_mfma_f32_16x16x32_bf16 a[40:43], v[64:67], v[88:91], 0
  s_add_u32 m0, s26, 0
  s_nop 0
  buffer_load_dwordx4 v20, s[92:95], s20 offen offset:0 lds
  v_mfma_f32_16x16x32_bf16 a[48:51], v[64:67], v[60:63], 0
  v_mfma_f32_16x16x32_bf16 a[56:59], v[64:67], v[92:95], 0
  ds_read_b64_tr_b16 v[160:161], v8 offset:32768
  v_mfma_f32_16x16x32_bf16 a[4:7], v[96:99], v[48:51], 0
  v_mfma_f32_16x16x32_bf16 a[12:15], v[96:99], v[80:83], 0
  ds_read_b64_tr_b16 v[162:163], v8 offset:34816
  v_mfma_f32_16x16x32_bf16 a[20:23], v[96:99], v[52:55], 0
  v_mfma_f32_16x16x32_bf16 a[28:31], v[96:99], v[84:87], 0
  ds_read_b128 v[144:147], v2 offset:33792
  v_mfma_f32_16x16x32_bf16 a[36:39], v[96:99], v[56:59], 0
  buffer_load_dwordx4 v20, s[92:95], s20 offen offset:1024 lds
  v_mfma_f32_16x16x32_bf16 a[44:47], v[96:99], v[88:91], 0
  v_mfma_f32_16x16x32_bf16 a[52:55], v[96:99], v[60:63], 0
  ds_read_b64_tr_b16 v[132:133], v5 offset:32768
  v_mfma_f32_16x16x32_bf16 a[60:63], v[96:99], v[92:95], 0
  v_mfma_f32_16x16x32_bf16 a[64:67], v[68:71], v[48:51], 0
  ds_read_b64_tr_b16 v[134:135], v5 offset:34816
  v_mfma_f32_16x16x32_bf16 a[72:75], v[68:71], v[80:83], 0
  v_mfma_f32_16x16x32_bf16 a[80:83], v[68:71], v[52:55], 0
  ds_read_b128 v[116:119], v2 offset:34816
  v_mfma_f32_16x16x32_bf16 a[88:91], v[68:71], v[84:87], 0
  v_mfma_f32_16x16x32_bf16 a[96:99], v[68:71], v[56:59], 0
  buffer_load_dwordx4 v20, s[92:95], s20 offen offset:2048 lds
  v_mfma_f32_16x16x32_bf16 a[104:107], v[68:71], v[88:91], 0
  v_mfma_f32_16x16x32_bf16 a[112:115], v[68:71], v[60:63], 0
  ds_read_b64_tr_b16 v[164:165], v9 offset:32768
  v_mfma_f32_16x16x32_bf16 a[120:123], v[68:71], v[92:95], 0
  ds_read_b64_tr_b16 v[166:167], v9 offset:34816
  v_mfma_f32_16x16x32_bf16 a[68:71], v[100:103], v[48:51], 0
  v_mfma_f32_16x16x32_bf16 a[76:79], v[100:103], v[80:83], 0
  ds_read_b128 v[148:151], v2 offset:35840
  v_mfma_f32_16x16x32_bf16 a[84:87], v[100:103], v[52:55], 0
  v_mfma_f32_16x16x32_bf16 a[92:95], v[100:103], v[84:87], 0
  buffer_load_dwordx4 v20, s[92:95], s20 offen offset:3072 lds
  s_add_u32 s20, s20, 131072
  v_mfma_f32_16x16x32_bf16 a[100:103], v[100:103], v[56:59], 0
  v_mfma_f32_16x16x32_bf16 a[108:111], v[100:103], v[88:91], 0
  ds_read_b64_tr_b16 v[136:137], v6 offset:32768
  v_mfma_f32_16x16x32_bf16 a[116:119], v[100:103], v[60:63], 0
  v_mfma_f32_16x16x32_bf16 a[124:127], v[100:103], v[92:95], 0
  ds_read_b64_tr_b16 v[138:139], v6 offset:34816
  v_mfma_f32_16x16x32_bf16 a[128:131], v[72:75], v[48:51], 0
  v_mfma_f32_16x16x32_bf16 a[136:139], v[72:75], v[80:83], 0
  ds_read_b128 v[120:123], v2 offset:36864
  v_mfma_f32_16x16x32_bf16 a[144:147], v[72:75], v[52:55], 0
  v_mfma_f32_16x16x32_bf16 a[152:155], v[72:75], v[84:87], 0
  s_add_u32 m0, s27, 0
  s_nop 0
  buffer_load_dwordx4 v21, s[12:15], s21 offen offset:0 lds
  v_mfma_f32_16x16x32_bf16 a[160:163], v[72:75], v[56:59], 0
  ds_read_b64_tr_b16 v[168:169], v10 offset:32768
  v_mfma_f32_16x16x32_bf16 a[168:171], v[72:75], v[88:91], 0
  v_mfma_f32_16x16x32_bf16 a[176:179], v[72:75], v[60:63], 0
  ds_read_b64_tr_b16 v[170:171], v10 offset:34816
  v_mfma_f32_16x16x32_bf16 a[184:187], v[72:75], v[92:95], 0
  v_mfma_f32_16x16x32_bf16 a[132:135], v[104:107], v[48:51], 0
  ds_read_b128 v[152:155], v2 offset:37888
  v_mfma_f32_16x16x32_bf16 a[140:143], v[104:107], v[80:83], 0
  v_mfma_f32_16x16x32_bf16 a[148:151], v[104:107], v[52:55], 0
  buffer_load_dwordx4 v22, s[12:15], s21 offen offset:1024 lds
  v_mfma_f32_16x16x32_bf16 a[156:159], v[104:107], v[84:87], 0
  v_mfma_f32_16x16x32_bf16 a[164:167], v[104:107], v[56:59], 0
  ds_read_b64_tr_b16 v[140:141], v7 offset:32768
  v_mfma_f32_16x16x32_bf16 a[172:175], v[104:107], v[88:91], 0
  v_mfma_f32_16x16x32_bf16 a[180:183], v[104:107], v[60:63], 0
  ds_read_b64_tr_b16 v[142:143], v7 offset:34816
  v_mfma_f32_16x16x32_bf16 a[188:191], v[104:107], v[92:95], 0
  ds_read_b128 v[124:127], v2 offset:38912
  v_mfma_f32_16x16x32_bf16 a[192:195], v[76:79], v[48:51], 0
  v_mfma_f32_16x16x32_bf16 a[200:203], v[76:79], v[80:83], 0
  buffer_load_dwordx4 v23, s[12:15], s21 offen offset:2048 lds
  v_mfma_f32_16x16x32_bf16 a[208:211], v[76:79], v[52:55], 0
  v_mfma_f32_16x16x32_bf16 a[216:219], v[76:79], v[84:87], 0
  ds_read_b64_tr_b16 v[172:173], v11 offset:32768
  v_mfma_f32_16x16x32_bf16 a[224:227], v[76:79], v[56:59], 0
  v_mfma_f32_16x16x32_bf16 a[232:235], v[76:79], v[88:91], 0
  ds_read_b64_tr_b16 v[174:175], v11 offset:34816
  v_mfma_f32_16x16x32_bf16 a[240:243], v[76:79], v[60:63], 0
  v_mfma_f32_16x16x32_bf16 a[248:251], v[76:79], v[92:95], 0
  ds_read_b128 v[156:159], v2 offset:39936
  v_mfma_f32_16x16x32_bf16 a[196:199], v[108:111], v[48:51], 0
  v_mfma_f32_16x16x32_bf16 a[204:207], v[108:111], v[80:83], 0
  buffer_load_dwordx4 v24, s[12:15], s21 offen offset:3072 lds
  s_add_u32 s21, s21, s23
  v_mfma_f32_16x16x32_bf16 a[212:215], v[108:111], v[52:55], 0
  v_mfma_f32_16x16x32_bf16 a[220:223], v[108:111], v[84:87], 0
  v_mfma_f32_16x16x32_bf16 a[228:231], v[108:111], v[56:59], 0
  v_mfma_f32_16x16x32_bf16 a[236:239], v[108:111], v[88:91], 0
  v_mfma_f32_16x16x32_bf16 a[244:247], v[108:111], v[60:63], 0
  v_mfma_f32_16x16x32_bf16 a[252:255], v[108:111], v[92:95], 0
  s_waitcnt vmcnt(48) lgkmcnt(0)
  s_barrier
  v_mfma_f32_16x16x32_bf16 a[0:3], v[128:131], v[112:115], a[0:3]
  ds_read_b64_tr_b16 v[64:65], v12 offset:0
  v_mfma_f32_16x16x32_bf16 a[8:11], v[128:131], v[144:147], a[8:11]
  ds_read_b64_tr_b16 v[66:67], v12 offset:2048
  v_mfma_f32_16x16x32_bf16 a[16:19], v[128:131], v[116:119], a[16:19]
  v_mfma_f32_16x16x32_bf16 a[24:27], v[128:131], v[148:151], a[24:27]
  ds_read_b128 v[48:51], v3 offset:0
  v_mfma_f32_16x16x32_bf16 a[32:35], v[128:131], v[120:123], a[32:35]
  v_mfma_f32_16x16x32_bf16 a[40:43], v[128:131], v[152:155], a[40:43]
  s_add_u32 m0, s26, 32768
  s_nop 0
  buffer_load_dwordx4 v20, s[92:95], s20 offen offset:0 lds
  v_mfma_f32_16x16x32_bf16 a[48:51], v[128:131], v[124:127], a[48:51]
  v_mfma_f32_16x16x32_bf16 a[56:59], v[128:131], v[156:159], a[56:59]
  ds_read_b64_tr_b16 v[96:97], v16 offset:0
  v_mfma_f32_16x16x32_bf16 a[4:7], v[160:163], v[112:115], a[4:7]
  v_mfma_f32_16x16x32_bf16 a[12:15], v[160:163], v[144:147], a[12:15]
  ds_read_b64_tr_b16 v[98:99], v16 offset:2048
  v_mfma_f32_16x16x32_bf16 a[20:23], v[160:163], v[116:119], a[20:23]
  v_mfma_f32_16x16x32_bf16 a[28:31], v[160:163], v[148:151], a[28:31]
  ds_read_b128 v[80:83], v3 offset:1024
  v_mfma_f32_16x16x32_bf16 a[36:39], v[160:163], v[120:123], a[36:39]
  buffer_load_dwordx4 v20, s[92:95], s20 offen offset:1024 lds
  v_mfma_f32_16x16x32_bf16 a[44:47], v[160:163], v[152:155], a[44:47]
  v_mfma_f32_16x16x32_bf16 a[52:55], v[160:163], v[124:127], a[52:55]
  ds_read_b64_tr_b16 v[68:69], v13 offset:0
  v_mfma_f32_16x16x32_bf16 a[60:63], v[160:163], v[156:159], a[60:63]
  v_mfma_f32_16x16x32_bf16 a[64:67], v[132:135], v[112:115], a[64:67]
  ds_read_b64_tr_b16 v[70:71], v13 offset:2048
  v_mfma_f32_16x16x32_bf16 a[72:75], v[132:135], v[144:147], a[72:75]
  v_mfma_f32_16x16x32_bf16 a[80:83], v[132:135], v[116:119], a[80:83]
  ds_read_b128 v[52:55], v3 offset:2048
  v_mfma_f32_16x16x32_bf16 a[88:91], v[132:135], v[148:151], a[88:91]
  v_mfma_f32_16x16x32_bf16 a[96:99], v[132:135], v[120:123], a[96:99]
  buffer_load_dwordx4 v20, s[92:95], s20 offen offset:2048 lds
  v_mfma_f32_16x16x32_bf16 a[104:107], v[132:135], v[152:155], a[104:107]
  v_mfma_f32_16x16x32_bf16 a[112:115], v[132:135], v[124:127], a[112:115]
  ds_read_b64_tr_b16 v[100:101], v17 offset:0
  v_mfma_f32_16x16x32_bf16 a[120:123], v[132:135], v[156:159], a[120:123]
  ds_read_b64_tr_b16 v[102:103], v17 offset:2048
  v_mfma_f32_16x16x32_bf16 a[68:71], v[164:167], v[112:115], a[68:71]
  v_mfma_f32_16x16x32_bf16 a[76:79], v[164:167], v[144:147], a[76:79]
  ds_read_b128 v[84:87], v3 offset:3072
  v_mfma_f32_16x16x32_bf16 a[84:87], v[164:167], v[116:119], a[84:87]
  v_mfma_f32_16x16x32_bf16 a[92:95], v[164:167], v[148:151], a[92:95]
  buffer_load_dwordx4 v20, s[92:95], s20 offen offset:3072 lds
  s_add_u32 s20, s20, 131072
  v_mfma_f32_16x16x32_bf16 a[100:103], v[164:167], v[120:123], a[100:103]
  v_mfma_f32_16x16x32_bf16 a[108:111], v[164:167], v[152:155], a[108:111]
  ds_read_b64_tr_b16 v[72:73], v14 offset:0
  v_mfma_f32_16x16x32_bf16 a[116:119], v[164:167], v[124:127], a[116:119]
  v_mfma_f32_16x16x32_bf16 a[124:127], v[164:167], v[156:159], a[124:127]
  ds_read_b64_tr_b16 v[74:75], v14 offset:2048
  v_mfma_f32_16x16x32_bf16 a[128:131], v[136:139], v[112:115], a[128:131]
  v_mfma_f32_16x16x32_bf16 a[136:139], v[136:139], v[144:147], a[136:139]
  ds_read_b128 v[56:59], v3 offset:4096
  v_mfma_f32_16x16x32_bf16 a[144:147], v[136:139], v[116:119], a[144:147]
  v_mfma_f32_16x16x32_bf16 a[152:155], v[136:139], v[148:151], a[152:155]
  s_add_u32 m0, s27, 32768
  s_nop 0
  buffer_load_dwordx4 v21, s[12:15], s21 offen offset:0 lds
  v_mfma_f32_16x16x32_bf16 a[160:163], v[136:139], v[120:123], a[160:163]
  ds_read_b64_tr_b16 v[104:105], v18 offset:0
  v_mfma_f32_16x16x32_bf16 a[168:171], v[136:139], v[152:155], a[168:171]
  v_mfma_f32_16x16x32_bf16 a[176:179], v[136:139], v[124:127], a[176:179]
  ds_read_b64_tr_b16 v[106:107], v18 offset:2048
  v_mfma_f32_16x16x32_bf16 a[184:187], v[136:139], v[156:159], a[184:187]
  v_mfma_f32_16x16x32_bf16 a[132:135], v[168:171], v[112:115], a[132:135]
  ds_read_b128 v[88:91], v3 offset:5120
  v_mfma_f32_16x16x32_bf16 a[140:143], v[168:171], v[144:147], a[140:143]
  v_mfma_f32_16x16x32_bf16 a[148:151], v[168:171], v[116:119], a[148:151]
  buffer_load_dwordx4 v22, s[12:15], s21 offen offset:1024 lds
  v_mfma_f32_16x16x32_bf16 a[156:159], v[168:171], v[148:151], a[156:159]
  v_mfma_f32_16x16x32_bf16 a[164:167], v[168:171], v[120:123], a[164:167]
  ds_read_b64_tr_b16 v[76:77], v15 offset:0
  v_mfma_f32_16x16x32_bf16 a[172:175], v[168:171], v[152:155], a[172:175]
  v_mfma_f32_16x16x32_bf16 a[180:183], v[168:171], v[124:127], a[180:183]
  ds_read_b64_tr_b16 v[78:79], v15 offset:2048
  v_mfma_f32_16x16x32_bf16 a[188:191], v[168:171], v[156:159], a[188:191]
  ds_read_b128 v[60:63], v3 offset:6144
  v_mfma_f32_16x16x32_bf16 a[192:195], v[140:143], v[112:115], a[192:195]
  v_mfma_f32_16x16x32_bf16 a[200:203], v[140:143], v[144:147], a[200:203]
  buffer_load_dwordx4 v23, s[12:15], s21 offen offset:2048 lds
  v_mfma_f32_16x16x32_bf16 a[208:211], v[140:143], v[116:119], a[208:211]
  v_mfma_f32_16x16x32_bf16 a[216:219], v[140:143], v[148:151], a[216:219]
  ds_read_b64_tr_b16 v[108:109], v19 offset:0
  v_mfma_f32_16x16x32_bf16 a[224:227], v[140:143], v[120:123], a[224:227]
  v_mfma_f32_16x16x32_bf16 a[232:235], v[140:143], v[152:155], a[232:235]
  ds_read_b64_tr_b16 v[110:111], v19 offset:2048
  v_mfma_f32_16x16x32_bf16 a[240:243], v[140:143], v[124:127], a[240:243]
  v_mfma_f32_16x16x32_bf16 a[248:251], v[140:143], v[156:159], a[248:251]
  ds_read_b128 v[92:95], v3 offset:7168
  v_mfma_f32_16x16x32_bf16 a[196:199], v[172:175], v[112:115], a[196:199]
  v_mfma_f32_16x16x32_bf16 a[204:207], v[172:175], v[144:147], a[204:207]
  buffer_load_dwordx4 v24, s[12:15], s21 offen offset:3072 lds
  s_add_u32 s21, s21, s23
  v_mfma_f32_16x16x32_bf16 a[212:215], v[172:175], v[116:119], a[212:215]
  v_mfma_f32_16x16x32_bf16 a[220:223], v[172:175], v[148:151], a[220:223]
  v_mfma_f32_16x16x32_bf16 a[228:231], v[172:175], v[120:123], a[228:231]
  v_mfma_f32_16x16x32_bf16 a[236:239], v[172:175], v[152:155], a[236:239]
  v_mfma_f32_16x16x32_bf16 a[244:247], v[172:175], v[124:127], a[244:247]
  v_mfma_f32_16x16x32_bf16 a[252:255], v[172:175], v[156:159], a[252:255]
  s_waitcnt vmcnt(48) lgkmcnt(0)
  s_barrier
  v_mfma_f32_16x16x32_bf16 a[0:3], v[64:67], v[48:51], a[0:3]
  ds_read_b64_tr_b16 v[128:129], v12 offset:32768
  v_mfma_f32_16x16x32_bf16 a[8:11], v[64:67], v[80:83], a[8:11]
  ds_read_b64_tr_b16 v[130:131], v12 offset:34816
  v_mfma_f32_16x16x32_bf16 a[16:19], v[64:67], v[52:55], a[16:19]
  v_mfma_f32_16x16x32_bf16 a[24:27], v[64:67], v[84:87], a[24:27]
  ds_read_b128 v[112:115], v3 offset:32768
  v_mfma_f32_16x16x32_bf16 a[32:35], v[64:67], v[56:59], a[32:35]
  v_mfma_f32_16x16x32_bf16 a[40:43], v[64:67], v[88:91], a[40:43]
  s_add_u32 m0, s26, 65536
  s_nop 0
  buffer_load_dwordx4 v20, s[92:95], s20 offen offset:0 lds
  v_mfma_f32_16x16x32_bf16 a[48:51], v[64:67], v[60:63], a[48:51]
  v_mfma_f32_16x16x32_bf16 a[56:59], v[64:67], v[92:95], a[56:59]
  ds_read_b64_tr_b16 v[160:161], v16 offset:32768
  v_mfma_f32_16x16x32_bf16 a[4:7], v[96:99], v[48:51], a[4:7]
  v_mfma_f32_16x16x32_bf16 a[12:15], v[96:99], v[80:83], a[12:15]
  ds_read_b64_tr_b16 v[162:163], v16 offset:34816
  v_mfma_f32_16x16x32_bf16 a[20:23], v[96:99], v[52:55], a[20:23]
  v_mfma_f32_16x16x32_bf16 a[28:31], v[96:99], v[84:87], a[28:31]
  ds_read_b128 v[144:147], v3 offset:33792
  v_mfma_f32_16x16x32_bf16 a[36:39], v[96:99], v[56:59], a[36:39]
  buffer_load_dwordx4 v20, s[92:95], s20 offen offset:1024 lds
  v_mfma_f32_16x16x32_bf16 a[44:47], v[96:99], v[88:91], a[44:47]
  v_mfma_f32_16x16x32_bf16 a[52:55], v[96:99], v[60:63], a[52:55]
  ds_read_b64_tr_b16 v[132:133], v13 offset:32768
  v_mfma_f32_16x16x32_bf16 a[60:63], v[96:99], v[92:95], a[60:63]
  v_mfma_f32_16x16x32_bf16 a[64:67], v[68:71], v[48:51], a[64:67]
  ds_read_b64_tr_b16 v[134:135], v13 offset:34816
  v_mfma_f32_16x16x32_bf16 a[72:75], v[68:71], v[80:83], a[72:75]
  v_mfma_f32_16x16x32_bf16 a[80:83], v[68:71], v[52:55], a[80:83]
  ds_read_b128 v[116:119], v3 offset:34816
  v_mfma_f32_16x16x32_bf16 a[88:91], v[68:71], v[84:87], a[88:91]
  v_mfma_f32_16x16x32_bf16 a[96:99], v[68:71], v[56:59], a[96:99]
  buffer_load_dwordx4 v20, s[92:95], s20 offen offset:2048 lds
  v_mfma_f32_16x16x32_bf16 a[104:107], v[68:71], v[88:91], a[104:107]
  v_mfma_f32_16x16x32_bf16 a[112:115], v[68:71], v[60:63], a[112:115]
  ds_read_b64_tr_b16 v[164:165], v17 offset:32768
  v_mfma_f32_16x16x32_bf16 a[120:123], v[68:71], v[92:95], a[120:123]
  ds_read_b64_tr_b16 v[166:167], v17 offset:34816
  v_mfma_f32_16x16x32_bf16 a[68:71], v[100:103], v[48:51], a[68:71]
  v_mfma_f32_16x16x32_bf16 a[76:79], v[100:103], v[80:83], a[76:79]
  ds_read_b128 v[148:151], v3 offset:35840
  v_mfma_f32_16x16x32_bf16 a[84:87], v[100:103], v[52:55], a[84:87]
  v_mfma_f32_16x16x32_bf16 a[92:95], v[100:103], v[84:87], a[92:95]
  buffer_load_dwordx4 v20, s[92:95], s20 offen offset:3072 lds
  s_add_u32 s20, s20, 131072
  v_mfma_f32_16x16x32_bf16 a[100:103], v[100:103], v[56:59], a[100:103]
  v_mfma_f32_16x16x32_bf16 a[108:111], v[100:103], v[88:91], a[108:111]
  ds_read_b64_tr_b16 v[136:137], v14 offset:32768
  v_mfma_f32_16x16x32_bf16 a[116:119], v[100:103], v[60:63], a[116:119]
  v_mfma_f32_16x16x32_bf16 a[124:127], v[100:103], v[92:95], a[124:127]
  ds_read_b64_tr_b16 v[138:139], v14 offset:34816
  v_mfma_f32_16x16x32_bf16 a[128:131], v[72:75], v[48:51], a[128:131]
  v_mfma_f32_16x16x32_bf16 a[136:139], v[72:75], v[80:83], a[136:139]
  ds_read_b128 v[120:123], v3 offset:36864
  v_mfma_f32_16x16x32_bf16 a[144:147], v[72:75], v[52:55], a[144:147]
  v_mfma_f32_16x16x32_bf16 a[152:155], v[72:75], v[84:87], a[152:155]
  s_add_u32 m0, s27, 65536
  s_nop 0
  buffer_load_dwordx4 v21, s[12:15], s21 offen offset:0 lds
  v_mfma_f32_16x16x32_bf16 a[160:163], v[72:75], v[56:59], a[160:163]
  ds_read_b64_tr_b16 v[168:169], v18 offset:32768
  v_mfma_f32_16x16x32_bf16 a[168:171], v[72:75], v[88:91], a[168:171]
  v_mfma_f32_16x16x32_bf16 a[176:179], v[72:75], v[60:63], a[176:179]
  ds_read_b64_tr_b16 v[170:171], v18 offset:34816
  v_mfma_f32_16x16x32_bf16 a[184:187], v[72:75], v[92:95], a[184:187]
  v_mfma_f32_16x16x32_bf16 a[132:135], v[104:107], v[48:51], a[132:135]
  ds_read_b128 v[152:155], v3 offset:37888
  v_mfma_f32_16x16x32_bf16 a[140:143], v[104:107], v[80:83], a[140:143]
  v_mfma_f32_16x16x32_bf16 a[148:151], v[104:107], v[52:55], a[148:151]
  buffer_load_dwordx4 v22, s[12:15], s21 offen offset:1024 lds
  v_mfma_f32_16x16x32_bf16 a[156:159], v[104:107], v[84:87], a[156:159]
  v_mfma_f32_16x16x32_bf16 a[164:167], v[104:107], v[56:59], a[164:167]
  ds_read_b64_tr_b16 v[140:141], v15 offset:32768
  v_mfma_f32_16x16x32_bf16 a[172:175], v[104:107], v[88:91], a[172:175]
  v_mfma_f32_16x16x32_bf16 a[180:183], v[104:107], v[60:63], a[180:183]
  ds_read_b64_tr_b16 v[142:143], v15 offset:34816
  v_mfma_f32_16x16x32_bf16 a[188:191], v[104:107], v[92:95], a[188:191]
  ds_read_b128 v[124:127], v3 offset:38912
  v_mfma_f32_16x16x32_bf16 a[192:195], v[76:79], v[48:51], a[192:195]
  v_mfma_f32_16x16x32_bf16 a[200:203], v[76:79], v[80:83], a[200:203]
  buffer_load_dwordx4 v23, s[12:15], s21 offen offset:2048 lds
  v_mfma_f32_16x16x32_bf16 a[208:211], v[76:79], v[52:55], a[208:211]
  v_mfma_f32_16x16x32_bf16 a[216:219], v[76:79], v[84:87], a[216:219]
  ds_read_b64_tr_b16 v[172:173], v19 offset:32768
  v_mfma_f32_16x16x32_bf16 a[224:227], v[76:79], v[56:59], a[224:227]
  v_mfma_f32_16x16x32_bf16 a[232:235], v[76:79], v[88:91], a[232:235]
  ds_read_b64_tr_b16 v[174:175], v19 offset:34816
  v_mfma_f32_16x16x32_bf16 a[240:243], v[76:79], v[60:63], a[240:243]
  v_mfma_f32_16x16x32_bf16 a[248:251], v[76:79], v[92:95], a[248:251]
  ds_read_b128 v[156:159], v3 offset:39936
  v_mfma_f32_16x16x32_bf16 a[196:199], v[108:111], v[48:51], a[196:199]
  v_mfma_f32_16x16x32_bf16 a[204:207], v[108:111], v[80:83], a[204:207]
  buffer_load_dwordx4 v24, s[12:15], s21 offen offset:3072 lds
  s_add_u32 s21, s21, s23
  v_mfma_f32_16x16x32_bf16 a[212:215], v[108:111], v[52:55], a[212:215]
  v_mfma_f32_16x16x32_bf16 a[220:223], v[108:111], v[84:87], a[220:223]
  v_mfma_f32_16x16x32_bf16 a[228:231], v[108:111], v[56:59], a[228:231]
  v_mfma_f32_16x16x32_bf16 a[236:239], v[108:111], v[88:91], a[236:239]
  v_mfma_f32_16x16x32_bf16 a[244:247], v[108:111], v[60:63], a[244:247]
  v_mfma_f32_16x16x32_bf16 a[252:255], v[108:111], v[92:95], a[252:255]
  s_waitcnt vmcnt(16) lgkmcnt(0)
  s_barrier
  buffer_store_dword v251, v250, s[8:11], s47 offen sc1
  buffer_store_dword v251, v250, s[8:11], s48 offen sc1
  v_mfma_f32_16x16x32_bf16 a[0:3], v[128:131], v[112:115], a[0:3]
  ds_read_b64_tr_b16 v[64:65], v4 offset:0
  v_mfma_f32_16x16x32_bf16 a[8:11], v[128:131], v[144:147], a[8:11]
  ds_read_b64_tr_b16 v[66:67], v4 offset:2048
  v_mfma_f32_16x16x32_bf16 a[16:19], v[128:131], v[116:119], a[16:19]
  v_mfma_f32_16x16x32_bf16 a[24:27], v[128:131], v[148:151], a[24:27]
  ds_read_b128 v[48:51], v2 offset:0
  v_mfma_f32_16x16x32_bf16 a[32:35], v[128:131], v[120:123], a[32:35]
  v_mfma_f32_16x16x32_bf16 a[40:43], v[128:131], v[152:155], a[40:43]
  s_add_u32 m0, s26, 98304
  s_nop 0
  buffer_load_dwordx4 v20, s[92:95], s20 offen offset:0 lds
  v_mfma_f32_16x16x32_bf16 a[48:51], v[128:131], v[124:127], a[48:51]
  v_mfma_f32_16x16x32_bf16 a[56:59], v[128:131], v[156:159], a[56:59]
  ds_read_b64_tr_b16 v[96:97], v8 offset:0
  v_mfma_f32_16x16x32_bf16 a[4:7], v[160:163], v[112:115], a[4:7]
  v_mfma_f32_16x16x32_bf16 a[12:15], v[160:163], v[144:147], a[12:15]
  ds_read_b64_tr_b16 v[98:99], v8 offset:2048
  v_mfma_f32_16x16x32_bf16 a[20:23], v[160:163], v[116:119], a[20:23]
  v_mfma_f32_16x16x32_bf16 a[28:31], v[160:163], v[148:151], a[28:31]
  ds_read_b128 v[80:83], v2 offset:1024
  v_mfma_f32_16x16x32_bf16 a[36:39], v[160:163], v[120:123], a[36:39]
  buffer_load_dwordx4 v20, s[92:95], s20 offen offset:1024 lds
  v_mfma_f32_16x16x32_bf16 a[44:47], v[160:163], v[152:155], a[44:47]
  v_mfma_f32_16x16x32_bf16 a[52:55], v[160:163], v[124:127], a[52:55]
  ds_read_b64_tr_b16 v[68:69], v5 offset:0
  v_mfma_f32_16x16x32_bf16 a[60:63], v[160:163], v[156:159], a[60:63]
  v_mfma_f32_16x16x32_bf16 a[64:67], v[132:135], v[112:115], a[64:67]
  ds_read_b64_tr_b16 v[70:71], v5 offset:2048
  v_mfma_f32_16x16x32_bf16 a[72:75], v[132:135], v[144:147], a[72:75]
  v_mfma_f32_16x16x32_bf16 a[80:83], v[132:135], v[116:119], a[80:83]
  ds_read_b128 v[52:55], v2 offset:2048
  v_mfma_f32_16x16x32_bf16 a[88:91], v[132:135], v[148:151], a[88:91]
  v_mfma_f32_16x16x32_bf16 a[96:99], v[132:135], v[120:123], a[96:99]
  buffer_load_dwordx4 v20, s[92:95], s20 offen offset:2048 lds
  v_mfma_f32_16x16x32_bf16 a[104:107], v[132:135], v[152:155], a[104:107]
  v_mfma_f32_16x16x32_bf16 a[112:115], v[132:135], v[124:127], a[112:115]
  ds_read_b64_tr_b16 v[100:101], v9 offset:0
  v_mfma_f32_16x16x32_bf16 a[120:123], v[132:135], v[156:159], a[120:123]
  ds_read_b64_tr_b16 v[102:103], v9 offset:2048
  v_mfma_f32_16x16x32_bf16 a[68:71], v[164:167], v[112:115], a[68:71]
  v_mfma_f32_16x16x32_bf16 a[76:79], v[164:167], v[144:147], a[76:79]
  ds_read_b128 v[84:87], v2 offset:3072
  v_mfma_f32_16x16x32_bf16 a[84:87], v[164:167], v[116:119], a[84:87]
  v_mfma_f32_16x16x32_bf16 a[92:95], v[164:167], v[148:151], a[92:95]
  buffer_load_dwordx4 v20, s[92:95], s20 offen offset:3072 lds
  s_add_u32 s20, s20, 131072
  v_mfma_f32_16x16x32_bf16 a[100:103], v[164:167], v[120:123], a[100:103]
  v_mfma_f32_16x16x32_bf16 a[108:111], v[164:167], v[152:155], a[108:111]
  ds_read_b64_tr_b16 v[72:73], v6 offset:0
  v_mfma_f32_16x16x32_bf16 a[116:119], v[164:167], v[124:127], a[116:119]
  v_mfma_f32_16x16x32_bf16 a[124:127], v[164:167], v[156:159], a[124:127]
  ds_read_b64_tr_b16 v[74:75], v6 offset:2048
  v_mfma_f32_16x16x32_bf16 a[128:131], v[136:139], v[112:115], a[128:131]
  v_mfma_f32_16x16x32_bf16 a[136:139], v[136:139], v[144:147], a[136:139]
  ds_read_b128 v[56:59], v2 offset:4096
  v_mfma_f32_16x16x32_bf16 a[144:147], v[136:139], v[116:119], a[144:147]
  v_mfma_f32_16x16x32_bf16 a[152:155], v[136:139], v[148:151], a[152:155]
  s_add_u32 m0, s27, 98304
  s_nop 0
  buffer_load_dwordx4 v21, s[12:15], s21 offen offset:0 lds
  v_mfma_f32_16x16x32_bf16 a[160:163], v[136:139], v[120:123], a[160:163]
  ds_read_b64_tr_b16 v[104:105], v10 offset:0
  v_mfma_f32_16x16x32_bf16 a[168:171], v[136:139], v[152:155], a[168:171]
  v_mfma_f32_16x16x32_bf16 a[176:179], v[136:139], v[124:127], a[176:179]
  ds_read_b64_tr_b16 v[106:107], v10 offset:2048
  v_mfma_f32_16x16x32_bf16 a[184:187], v[136:139], v[156:159], a[184:187]
  v_mfma_f32_16x16x32_bf16 a[132:135], v[168:171], v[112:115], a[132:135]
  ds_read_b128 v[88:91], v2 offset:5120
  v_mfma_f32_16x16x32_bf16 a[140:143], v[168:171], v[144:147], a[140:143]
  v_mfma_f32_16x16x32_bf16 a[148:151], v[168:171], v[116:119], a[148:151]
  buffer_load_dwordx4 v22, s[12:15], s21 offen offset:1024 lds
  v_mfma_f32_16x16x32_bf16 a[156:159], v[168:171], v[148:151], a[156:159]
  v_mfma_f32_16x16x32_bf16 a[164:167], v[168:171], v[120:123], a[164:167]
  ds_read_b64_tr_b16 v[76:77], v7 offset:0
  v_mfma_f32_16x16x32_bf16 a[172:175], v[168:171], v[152:155], a[172:175]
  v_mfma_f32_16x16x32_bf16 a[180:183], v[168:171], v[124:127], a[180:183]
  ds_read_b64_tr_b16 v[78:79], v7 offset:2048
  v_mfma_f32_16x16x32_bf16 a[188:191], v[168:171], v[156:159], a[188:191]
  ds_read_b128 v[60:63], v2 offset:6144
  v_mfma_f32_16x16x32_bf16 a[192:195], v[140:143], v[112:115], a[192:195]
  v_mfma_f32_16x16x32_bf16 a[200:203], v[140:143], v[144:147], a[200:203]
  buffer_load_dwordx4 v23, s[12:15], s21 offen offset:2048 lds
  v_mfma_f32_16x16x32_bf16 a[208:211], v[140:143], v[116:119], a[208:211]
  v_mfma_f32_16x16x32_bf16 a[216:219], v[140:143], v[148:151], a[216:219]
  ds_read_b64_tr_b16 v[108:109], v11 offset:0
  v_mfma_f32_16x16x32_bf16 a[224:227], v[140:143], v[120:123], a[224:227]
  v_mfma_f32_16x16x32_bf16 a[232:235], v[140:143], v[152:155], a[232:235]
  ds_read_b64_tr_b16 v[110:111], v11 offset:2048
  v_mfma_f32_16x16x32_bf16 a[240:243], v[140:143], v[124:127], a[240:243]
  v_mfma_f32_16x16x32_bf16 a[248:251], v[140:143], v[156:159], a[248:251]
  ds_read_b128 v[92:95], v2 offset:7168
  v_mfma_f32_16x16x32_bf16 a[196:199], v[172:175], v[112:115], a[196:199]
  v_mfma_f32_16x16x32_bf16 a[204:207], v[172:175], v[144:147], a[204:207]
  buffer_load_dwordx4 v24, s[12:15], s21 offen offset:3072 lds
  s_add_u32 s21, s21, s23
  v_mfma_f32_16x16x32_bf16 a[212:215], v[172:175], v[116:119], a[212:215]
  v_mfma_f32_16x16x32_bf16 a[220:223], v[172:175], v[148:151], a[220:223]
  v_mfma_f32_16x16x32_bf16 a[228:231], v[172:175], v[120:123], a[228:231]
  v_mfma_f32_16x16x32_bf16 a[236:239], v[172:175], v[152:155], a[236:239]
  v_mfma_f32_16x16x32_bf16 a[244:247], v[172:175], v[124:127], a[244:247]
  v_mfma_f32_16x16x32_bf16 a[252:255], v[172:175], v[156:159], a[252:255]
  s_mov_b32 s22, 7
.p2align 6
mk_gb_loop:
  s_cmp_eq_u32 s22, 1
  s_cbranch_scc0 mk_h_48
  s_mov_b32 s94, 0
  s_mov_b32 s14, 0
  s_and_b32 s5, s84, 0xf0
  s_cmp_eq_u32 s5, 16
  s_cbranch_scc0 mk_h_48
  s_and_b32 s5, s84, 3
  s_mov_b32 s38, 8192
  s_mov_b32 s14, 8388608
  s_mov_b32 s12, s62
  s_mov_b32 s13, s63
  s_cmp_eq_u32 s5, 0
  s_cbranch_scc1 mk_t_50
  s_mov_b32 s12, s64
  s_mov_b32 s13, s65
  s_cmp_eq_u32 s5, 1
  s_cbranch_scc1 mk_t_50
  s_mov_b32 s12, s60
  s_mov_b32 s13, s61
  s_cmp_eq_u32 s5, 2
  s_cbranch_scc1 mk_t_50
  s_mov_b32 s12, s66
  s_mov_b32 s13, s67
  s_mov_b32 s38, 7168
  s_mov_b32 s14, 7340032
mk_t_50:
  s_mov_b32 s36, s85
  s_mov_b32 s37, s86
  s_mov_b32 s94, 268435456
  v_add_u32 v20, s36, v33
  v_mul_lo_u32 v21, v25, s38
  v_add_u32 v21, v21, v29
  v_add_u32 v21, s37, v21
  v_mul_lo_u32 v22, v26, s38
  v_add_u32 v22, v22, v30
  v_add_u32 v22, s37, v22
  v_mul_lo_u32 v23, v27, s38
  v_add_u32 v23, v23, v31
  v_add_u32 v23, s37, v23
  v_mul_lo_u32 v24, v28, s38
  v_add_u32 v24, v24, v32
  v_add_u32 v24, s37, v24
  s_mov_b32 s20, 0
  s_mov_b32 s21, 0
  s_lshl_b32 s23, s38, 5
mk_h_48:
  s_waitcnt vmcnt(16) lgkmcnt(0)
  s_barrier
  v_mfma_f32_16x16x32_bf16 a[0:3], v[64:67], v[48:51], a[0:3]
  ds_read_b64_tr_b16 v[128:129], v4 offset:32768
  v_mfma_f32_16x16x32_bf16 a[8:11], v[64:67], v[80:83], a[8:11]
  ds_read_b64_tr_b16 v[130:131], v4 offset:34816
  v_mfma_f32_16x16x32_bf16 a[16:19], v[64:67], v[52:55], a[16:19]
  v_mfma_f32_16x16x32_bf16 a[24:27], v[64:67], v[84:87], a[24:27]
  ds_read_b128 v[112:115], v2 offset:32768
  v_mfma_f32_16x16x32_bf16 a[32:35], v[64:67], v[56:59], a[32:35]
  v_mfma_f32_16x16x32_bf16 a[40:43], v[64:67], v[88:91], a[40:43]
  s_add_u32 m0, s26, 0
  s_nop 0
  buffer_load_dwordx4 v20, s[92:95], s20 offen offset:0 lds
  v_mfma_f32_16x16x32_bf16 a[48:51], v[64:67], v[60:63], a[48:51]
  v_mfma_f32_16x16x32_bf16 a[56:59], v[64:67], v[92:95], a[56:59]
  ds_read_b64_tr_b16 v[160:161], v8 offset:32768
  v_mfma_f32_16x16x32_bf16 a[4:7], v[96:99], v[48:51], a[4:7]
  v_mfma_f32_16x16x32_bf16 a[12:15], v[96:99], v[80:83], a[12:15]
  ds_read_b64_tr_b16 v[162:163], v8 offset:34816
  v_mfma_f32_16x16x32_bf16 a[20:23], v[96:99], v[52:55], a[20:23]
  v_mfma_f32_16x16x32_bf16 a[28:31], v[96:99], v[84:87], a[28:31]
  ds_read_b128 v[144:147], v2 offset:33792
  v_mfma_f32_16x16x32_bf16 a[36:39], v[96:99], v[56:59], a[36:39]
  buffer_load_dwordx4 v20, s[92:95], s20 offen offset:1024 lds
  v_mfma_f32_16x16x32_bf16 a[44:47], v[96:99], v[88:91], a[44:47]
  v_mfma_f32_16x16x32_bf16 a[52:55], v[96:99], v[60:63], a[52:55]
  ds_read_b64_tr_b16 v[132:133], v5 offset:32768
  v_mfma_f32_16x16x32_bf16 a[60:63], v[96:99], v[92:95], a[60:63]
  v_mfma_f32_16x16x32_bf16 a[64:67], v[68:71], v[48:51], a[64:67]
  ds_read_b64_tr_b16 v[134:135], v5 offset:34816
  v_mfma_f32_16x16x32_bf16 a[72:75], v[68:71], v[80:83], a[72:75]
  v_mfma_f32_16x16x32_bf16 a[80:83], v[68:71], v[52:55], a[80:83]
  ds_read_b128 v[116:119], v2 offset:34816
  v_mfma_f32_16x16x32_bf16 a[88:91], v[68:71], v[84:87], a[88:91]
  v_mfma_f32_16x16x32_bf16 a[96:99], v[68:71], v[56:59], a[96:99]
  buffer_load_dwordx4 v20, s[92:95], s20 offen offset:2048 lds
  v_mfma_f32_16x16x32_bf16 a[104:107], v[68:71], v[88:91], a[104:107]
  v_mfma_f32_16x16x32_bf16 a[112:115], v[68:71], v[60:63], a[112:115]
  ds_read_b64_tr_b16 v[164:165], v9 offset:32768
  v_mfma_f32_16x16x32_bf16 a[120:123], v[68:71], v[92:95], a[120:123]
  ds_read_b64_tr_b16 v[166:167], v9 offset:34816
  v_mfma_f32_16x16x32_bf16 a[68:71], v[100:103], v[48:51], a[68:71]
  v_mfma_f32_16x16x32_bf16 a[76:79], v[100:103], v[80:83], a[76:79]
  ds_read_b128 v[148:151], v2 offset:35840
  v_mfma_f32_16x16x32_bf16 a[84:87], v[100:103], v[52:55], a[84:87]
  v_mfma_f32_16x16x32_bf16 a[92:95], v[100:103], v[84:87], a[92:95]
  buffer_load_dwordx4 v20, s[92:95], s20 offen offset:3072 lds
  s_add_u32 s20, s20, 131072
  v_mfma_f32_16x16x32_bf16 a[100:103], v[100:103], v[56:59], a[100:103]
  v_mfma_f32_16x16x32_bf16 a[108:111], v[100:103], v[88:91], a[108:111]
  ds_read_b64_tr_b16 v[136:137], v6 offset:32768
  v_mfma_f32_16x16x32_bf16 a[116:119], v[100:103], v[60:63], a[116:119]
  v_mfma_f32_16x16x32_bf16 a[124:127], v[100:103], v[92:95], a[124:127]
  ds_read_b64_tr_b16 v[138:139], v6 offset:34816
  v_mfma_f32_16x16x32_bf16 a[128:131], v[72:75], v[48:51], a[128:131]
  v_mfma_f32_16x16x32_bf16 a[136:139], v[72:75], v[80:83], a[136:139]
  ds_read_b128 v[120:123], v2 offset:36864
  v_mfma_f32_16x16x32_bf16 a[144:147], v[72:75], v[52:55], a[144:147]
  v_mfma_f32_16x16x32_bf16 a[152:155], v[72:75], v[84:87], a[152:155]
  s_add_u32 m0, s27, 0
  s_nop 0
  buffer_load_dwordx4 v21, s[12:15], s21 offen offset:0 lds
  v_mfma_f32_16x16x32_bf16 a[160:163], v[72:75], v[56:59], a[160:163]
  ds_read_b64_tr_b16 v[168:169], v10 offset:32768
  v_mfma_f32_16x16x32_bf16 a[168:171], v[72:75], v[88:91], a[168:171]
  v_mfma_f32_16x16x32_bf16 a[176:179], v[72:75], v[60:63], a[176:179]
  ds_read_b64_tr_b16 v[170:171], v10 offset:34816
  v_mfma_f32_16x16x32_bf16 a[184:187], v[72:75], v[92:95], a[184:187]
  v_mfma_f32_16x16x32_bf16 a[132:135], v[104:107], v[48:51], a[132:135]
  ds_read_b128 v[152:155], v2 offset:37888
  v_mfma_f32_16x16x32_bf16 a[140:143], v[104:107], v[80:83], a[140:143]
  v_mfma_f32_16x16x32_bf16 a[148:151], v[104:107], v[52:55], a[148:151]
  buffer_load_dwordx4 v22, s[12:15], s21 offen offset:1024 lds
  v_mfma_f32_16x16x32_bf16 a[156:159], v[104:107], v[84:87], a[156:159]
  v_mfma_f32_16x16x32_bf16 a[164:167], v[104:107], v[56:59], a[164:167]
  ds_read_b64_tr_b16 v[140:141], v7 offset:32768
  v_mfma_f32_16x16x32_bf16 a[172:175], v[104:107], v[88:91], a[172:175]
  v_mfma_f32_16x16x32_bf16 a[180:183], v[104:107], v[60:63], a[180:183]
  ds_read_b64_tr_b16 v[142:143], v7 offset:34816
  v_mfma_f32_16x16x32_bf16 a[188:191], v[104:107], v[92:95], a[188:191]
  ds_read_b128 v[124:127], v2 offset:38912
  v_mfma_f32_16x16x32_bf16 a[192:195], v[76:79], v[48:51], a[192:195]
  v_mfma_f32_16x16x32_bf16 a[200:203], v[76:79], v[80:83], a[200:203]
  buffer_load_dwordx4 v23, s[12:15], s21 offen offset:2048 lds
  v_mfma_f32_16x16x32_bf16 a[208:211], v[76:79], v[52:55], a[208:211]
  v_mfma_f32_16x16x32_bf16 a[216:219], v[76:79], v[84:87], a[216:219]
  ds_read_b64_tr_b16 v[172:173], v11 offset:32768
  v_mfma_f32_16x16x32_bf16 a[224:227], v[76:79], v[56:59], a[224:227]
  v_mfma_f32_16x16x32_bf16 a[232:235], v[76:79], v[88:91], a[232:235]
  ds_read_b64_tr_b16 v[174:175], v11 offset:34816
  v_mfma_f32_16x16x32_bf16 a[240:243], v[76:79], v[60:63], a[240:243]
  v_mfma_f32_16x16x32_bf16 a[248:251], v[76:79], v[92:95], a[248:251]
  ds_read_b128 v[156:159], v2 offset:39936
  v_mfma_f32_16x16x32_bf16 a[196:199], v[108:111], v[48:51], a[196:199]
  v_mfma_f32_16x16x32_bf16 a[204:207], v[108:111], v[80:83], a[204:207]
  buffer_load_dwordx4 v24, s[12:15], s21 offen offset:3072 lds
  s_add_u32 s21, s21, s23
  v_mfma_f32_16x16x32_bf16 a[212:215], v[108:111], v[52:55], a[212:215]
  v_mfma_f32_16x16x32_bf16 a[220:223], v[108:111], v[84:87], a[220:223]
  v_mfma_f32_16x16x32_bf16 a[228:231], v[108:111], v[56:59], a[228:231]
  v_mfma_f32_16x16x32_bf16 a[236:239], v[108:111], v[88:91], a[236:239]
  v_mfma_f32_16x16x32_bf16 a[244:247], v[108:111], v[60:63], a[244:247]
  v_mfma_f32_16x16x32_bf16 a[252:255], v[108:111], v[92:95], a[252:255]
  s_waitcnt vmcnt(16) lgkmcnt(0)
  s_barrier
  v_mfma_f32_16x16x32_bf16 a[0:3], v[128:131], v[112:115], a[0:3]
  ds_read_b64_tr_b16 v[64:65], v12 offset:0
  v_mfma_f32_16x16x32_bf16 a[8:11], v[128:131], v[144:147], a[8:11]
  ds_read_b64_tr_b16 v[66:67], v12 offset:2048
  v_mfma_f32_16x16x32_bf16 a[16:19], v[128:131], v[116:119], a[16:19]
  v_mfma_f32_16x16x32_bf16 a[24:27], v[128:131], v[148:151], a[24:27]
  ds_read_b128 v[48:51], v3 offset:0
  v_mfma_f32_16x16x32_bf16 a[32:35], v[128:131], v[120:123], a[32:35]
  v_mfma_f32_16x16x32_bf16 a[40:43], v[128:131], v[152:155], a[40:43]
  s_add_u32 m0, s26, 32768
  s_nop 0
  buffer_load_dwordx4 v20, s[92:95], s20 offen offset:0 lds
  v_mfma_f32_16x16x32_bf16 a[48:51], v[128:131], v[124:127], a[48:51]
  v_mfma_f32_16x16x32_bf16 a[56:59], v[128:131], v[156:159], a[56:59]
  ds_read_b64_tr_b16 v[96:97], v16 offset:0
  v_mfma_f32_16x16x32_bf16 a[4:7], v[160:163], v[112:115], a[4:7]
  v_mfma_f32_16x16x32_bf16 a[12:15], v[160:163], v[144:147], a[12:15]
  ds_read_b64_tr_b16 v[98:99], v16 offset:2048
  v_mfma_f32_16x16x32_bf16 a[20:23], v[160:163], v[116:119], a[20:23]
  v_mfma_f32_16x16x32_bf16 a[28:31], v[160:163], v[148:151], a[28:31]
  ds_read_b128 v[80:83], v3 offset:1024
  v_mfma_f32_16x16x32_bf16 a[36:39], v[160:163], v[120:123], a[36:39]
  buffer_load_dwordx4 v20, s[92:95], s20 offen offset:1024 lds
  v_mfma_f32_16x16x32_bf16 a[44:47], v[160:163], v[152:155], a[44:47]
  v_mfma_f32_16x16x32_bf16 a[52:55], v[160:163], v[124:127], a[52:55]
  ds_read_b64_tr_b16 v[68:69], v13 offset:0
  v_mfma_f32_16x16x32_bf16 a[60:63], v[160:163], v[156:159], a[60:63]
  v_mfma_f32_16x16x32_bf16 a[64:67], v[132:135], v[112:115], a[64:67]
  ds_read_b64_tr_b16 v[70:71], v13 offset:2048
  v_mfma_f32_16x16x32_bf16 a[72:75], v[132:135], v[144:147], a[72:75]
  v_mfma_f32_16x16x32_bf16 a[80:83], v[132:135], v[116:119], a[80:83]
  ds_read_b128 v[52:55], v3 offset:2048
  v_mfma_f32_16x16x32_bf16 a[88:91], v[132:135], v[148:151], a[88:91]
  v_mfma_f32_16x16x32_bf16 a[96:99], v[132:135], v[120:123], a[96:99]
  buffer_load_dwordx4 v20, s[92:95], s20 offen offset:2048 lds
  v_mfma_f32_16x16x32_bf16 a[104:107], v[132:135], v[152:155], a[104:107]
  v_mfma_f32_16x16x32_bf16 a[112:115], v[132:135], v[124:127], a[112:115]
  ds_read_b64_tr_b16 v[100:101], v17 offset:0
  v_mfma_f32_16x16x32_bf16 a[120:123], v[132:135], v[156:159], a[120:123]
  ds_read_b64_tr_b16 v[102:103], v17 offset:2048
  v_mfma_f32_16x16x32_bf16 a[68:71], v[164:167], v[112:115], a[68:71]
  v_mfma_f32_16x16x32_bf16 a[76:79], v[164:167], v[144:147], a[76:79]
  ds_read_b128 v[84:87], v3 offset:3072
  v_mfma_f32_16x16x32_bf16 a[84:87], v[164:167], v[116:119], a[84:87]
  v_mfma_f32_16x16x32_bf16 a[92:95], v[164:167], v[148:151], a[92:95]
  buffer_load_dwordx4 v20, s[92:95], s20 offen offset:3072 lds
  s_add_u32 s20, s20, 131072
  v_mfma_f32_16x16x32_bf16 a[100:103], v[164:167], v[120:123], a[100:103]
  v_mfma_f32_16x16x32_bf16 a[108:111], v[164:167], v[152:155], a[108:111]
  ds_read_b64_tr_b16 v[72:73], v14 offset:0
  v_mfma_f32_16x16x32_bf16 a[116:119], v[164:167], v[124:127], a[116:119]
  v_mfma_f32_16x16x32_bf16 a[124:127], v[164:167], v[156:159], a[124:127]
  ds_read_b64_tr_b16 v[74:75], v14 offset:2048
  v_mfma_f32_16x16x32_bf16 a[128:131], v[136:139], v[112:115], a[128:131]
  v_mfma_f32_16x16x32_bf16 a[136:139], v[136:139], v[144:147], a[136:139]
  ds_read_b128 v[56:59], v3 offset:4096
  v_mfma_f32_16x16x32_bf16 a[144:147], v[136:139], v[116:119], a[144:147]
  v_mfma_f32_16x16x32_bf16 a[152:155], v[136:139], v[148:151], a[152:155]
  s_add_u32 m0, s27, 32768
  s_nop 0
  buffer_load_dwordx4 v21, s[12:15], s21 offen offset:0 lds
  v_mfma_f32_16x16x32_bf16 a[160:163], v[136:139], v[120:123], a[160:163]
  ds_read_b64_tr_b16 v[104:105], v18 offset:0
  v_mfma_f32_16x16x32_bf16 a[168:171], v[136:139], v[152:155], a[168:171]
  v_mfma_f32_16x16x32_bf16 a[176:179], v[136:139], v[124:127], a[176:179]
  ds_read_b64_tr_b16 v[106:107], v18 offset:2048
  v_mfma_f32_16x16x32_bf16 a[184:187], v[136:139], v[156:159], a[184:187]
  v_mfma_f32_16x16x32_bf16 a[132:135], v[168:171], v[112:115], a[132:135]
  ds_read_b128 v[88:91], v3 offset:5120
  v_mfma_f32_16x16x32_bf16 a[140:143], v[168:171], v[144:147], a[140:143]
  v_mfma_f32_16x16x32_bf16 a[148:151], v[168:171], v[116:119], a[148:151]
  buffer_load_dwordx4 v22, s[12:15], s21 offen offset:1024 lds
  v_mfma_f32_16x16x32_bf16 a[156:159], v[168:171], v[148:151], a[156:159]
  v_mfma_f32_16x16x32_bf16 a[164:167], v[168:171], v[120:123], a[164:167]
  ds_read_b64_tr_b16 v[76:77], v15 offset:0
  v_mfma_f32_16x16x32_bf16 a[172:175], v[168:171], v[152:155], a[172:175]
  v_mfma_f32_16x16x32_bf16 a[180:183], v[168:171], v[124:127], a[180:183]
  ds_read_b64_tr_b16 v[78:79], v15 offset:2048
  v_mfma_f32_16x16x32_bf16 a[188:191], v[168:171], v[156:159], a[188:191]
  ds_read_b128 v[60:63], v3 offset:6144
  v_mfma_f32_16x16x32_bf16 a[192:195], v[140:143], v[112:115], a[192:195]
  v_mfma_f32_16x16x32_bf16 a[200:203], v[140:143], v[144:147], a[200:203]
  buffer_load_dwordx4 v23, s[12:15], s21 offen offset:2048 lds
  v_mfma_f32_16x16x32_bf16 a[208:211], v[140:143], v[116:119], a[208:211]
  v_mfma_f32_16x16x32_bf16 a[216:219], v[140:143], v[148:151], a[216:219]
  ds_read_b64_tr_b16 v[108:109], v19 offset:0
  v_mfma_f32_16x16x32_bf16 a[224:227], v[140:143], v[120:123], a[224:227]
  v_mfma_f32_16x16x32_bf16 a[232:235], v[140:143], v[152:155], a[232:235]
  ds_read_b64_tr_b16 v[110:111], v19 offset:2048
  v_mfma_f32_16x16x32_bf16 a[240:243], v[140:143], v[124:127], a[240:243]
  v_mfma_f32_16x16x32_bf16 a[248:251], v[140:143], v[156:159], a[248:251]
  ds_read_b128 v[92:95], v3 offset:7168
  v_mfma_f32_16x16x32_bf16 a[196:199], v[172:175], v[112:115], a[196:199]
  v_mfma_f32_16x16x32_bf16 a[204:207], v[172:175], v[144:147], a[204:207]
  buffer_load_dwordx4 v24, s[12:15], s21 offen offset:3072 lds
  s_add_u32 s21, s21, s23
  v_mfma_f32_16x16x32_bf16 a[212:215], v[172:175], v[116:119], a[212:215]
  v_mfma_f32_16x16x32_bf16 a[220:223], v[172:175], v[148:151], a[220:223]
  v_mfma_f32_16x16x32_bf16 a[228:231], v[172:175], v[120:123], a[228:231]
  v_mfma_f32_16x16x32_bf16 a[236:239], v[172:175], v[152:155], a[236:239]
  v_mfma_f32_16x16x32_bf16 a[244:247], v[172:175], v[124:127], a[244:247]
  v_mfma_f32_16x16x32_bf16 a[252:255], v[172:175], v[156:159], a[252:255]
  s_waitcnt vmcnt(16) lgkmcnt(0)
  s_barrier
  v_mfma_f32_16x16x32_bf16 a[0:3], v[64:67], v[48:51], a[0:3]
  ds_read_b64_tr_b16 v[128:129], v12 offset:32768
  v_mfma_f32_16x16x32_bf16 a[8:11], v[64:67], v[80:83], a[8:11]
  ds_read_b64_tr_b16 v[130:131], v12 offset:34816
  v_mfma_f32_16x16x32_bf16 a[16:19], v[64:67], v[52:55], a[16:19]
  v_mfma_f32_16x16x32_bf16 a[24:27], v[64:67], v[84:87], a[24:27]
  ds_read_b128 v[112:115], v3 offset:32768
  v_mfma_f32_16x16x32_bf16 a[32:35], v[64:67], v[56:59], a[32:35]
  v_mfma_f32_16x16x32_bf16 a[40:43], v[64:67], v[88:91], a[40:43]
  s_add_u32 m0, s26, 65536
  s_nop 0
  buffer_load_dwordx4 v20, s[92:95], s20 offen offset:0 lds
  v_mfma_f32_16x16x32_bf16 a[48:51], v[64:67], v[60:63], a[48:51]
  v_mfma_f32_16x16x32_bf16 a[56:59], v[64:67], v[92:95], a[56:59]
  ds_read_b64_tr_b16 v[160:161], v16 offset:32768
  v_mfma_f32_16x16x32_bf16 a[4:7], v[96:99], v[48:51], a[4:7]
  v_mfma_f32_16x16x32_bf16 a[12:15], v[96:99], v[80:83], a[12:15]
  ds_read_b64_tr_b16 v[162:163], v16 offset:34816
  v_mfma_f32_16x16x32_bf16 a[20:23], v[96:99], v[52:55], a[20:23]
  v_mfma_f32_16x16x32_bf16 a[28:31], v[96:99], v[84:87], a[28:31]
  ds_read_b128 v[144:147], v3 offset:33792
  v_mfma_f32_16x16x32_bf16 a[36:39], v[96:99], v[56:59], a[36:39]
  buffer_load_dwordx4 v20, s[92:95], s20 offen offset:1024 lds
  v_mfma_f32_16x16x32_bf16 a[44:47], v[96:99], v[88:91], a[44:47]
  v_mfma_f32_16x16x32_bf16 a[52:55], v[96:99], v[60:63], a[52:55]
  ds_read_b64_tr_b16 v[132:133], v13 offset:32768
  v_mfma_f32_16x16x32_bf16 a[60:63], v[96:99], v[92:95], a[60:63]
  v_mfma_f32_16x16x32_bf16 a[64:67], v[68:71], v[48:51], a[64:67]
  ds_read_b64_tr_b16 v[134:135], v13 offset:34816
  v_mfma_f32_16x16x32_bf16 a[72:75], v[68:71], v[80:83], a[72:75]
  v_mfma_f32_16x16x32_bf16 a[80:83], v[68:71], v[52:55], a[80:83]
  ds_read_b128 v[116:119], v3 offset:34816
  v_mfma_f32_16x16x32_bf16 a[88:91], v[68:71], v[84:87], a[88:91]
  v_mfma_f32_16x16x32_bf16 a[96:99], v[68:71], v[56:59], a[96:99]
  buffer_load_dwordx4 v20, s[92:95], s20 offen offset:2048 lds
  v_mfma_f32_16x16x32_bf16 a[104:107], v[68:71], v[88:91], a[104:107]
  v_mfma_f32_16x16x32_bf16 a[112:115], v[68:71], v[60:63], a[112:115]
  ds_read_b64_tr_b16 v[164:165], v17 offset:32768
  v_mfma_f32_16x16x32_bf16 a[120:123], v[68:71], v[92:95], a[120:123]
  ds_read_b64_tr_b16 v[166:167], v17 offset:34816
  v_mfma_f32_16x16x32_bf16 a[68:71], v[100:103], v[48:51], a[68:71]
  v_mfma_f32_16x16x32_bf16 a[76:79], v[100:103], v[80:83], a[76:79]
  ds_read_b128 v[148:151], v3 offset:35840
  v_mfma_f32_16x16x32_bf16 a[84:87], v[100:103], v[52:55], a[84:87]
  v_mfma_f32_16x16x32_bf16 a[92:95], v[100:103], v[84:87], a[92:95]
  buffer_load_dwordx4 v20, s[92:95], s20 offen offset:3072 lds
  s_add_u32 s20, s20, 131072
  v_mfma_f32_16x16x32_bf16 a[100:103], v[100:103], v[56:59], a[100:103]
  v_mfma_f32_16x16x32_bf16 a[108:111], v[100:103], v[88:91], a[108:111]
  ds_read_b64_tr_b16 v[136:137], v14 offset:32768
  v_mfma_f32_16x16x32_bf16 a[116:119], v[100:103], v[60:63], a[116:119]
  v_mfma_f32_16x16x32_bf16 a[124:127], v[100:103], v[92:95], a[124:127]
  ds_read_b64_tr_b16 v[138:139], v14 offset:34816
  v_mfma_f32_16x16x32_bf16 a[128:131], v[72:75], v[48:51], a[128:131]
  v_mfma_f32_16x16x32_bf16 a[136:139], v[72:75], v[80:83], a[136:139]
  ds_read_b128 v[120:123], v3 offset:36864
  v_mfma_f32_16x16x32_bf16 a[144:147], v[72:75], v[52:55], a[144:147]
  v_mfma_f32_16x16x32_bf16 a[152:155], v[72:75], v[84:87], a[152:155]
  s_add_u32 m0, s27, 65536
  s_nop 0
  buffer_load_dwordx4 v21, s[12:15], s21 offen offset:0 lds
  v_mfma_f32_16x16x32_bf16 a[160:163], v[72:75], v[56:59], a[160:163]
  ds_read_b64_tr_b16 v[168:169], v18 offset:32768
  v_mfma_f32_16x16x32_bf16 a[168:171], v[72:75], v[88:91], a[168:171]
  v_mfma_f32_16x16x32_bf16 a[176:179], v[72:75], v[60:63], a[176:179]
  ds_read_b64_tr_b16 v[170:171], v18 offset:34816
  v_mfma_f32_16x16x32_bf16 a[184:187], v[72:75], v[92:95], a[184:187]
  v_mfma_f32_16x16x32_bf16 a[132:135], v[104:107], v[48:51], a[132:135]
  ds_read_b128 v[152:155], v3 offset:37888
  v_mfma_f32_16x16x32_bf16 a[140:143], v[104:107], v[80:83], a[140:143]
  v_mfma_f32_16x16x32_bf16 a[148:151], v[104:107], v[52:55], a[148:151]
  buffer_load_dwordx4 v22, s[12:15], s21 offen offset:1024 lds
  v_mfma_f32_16x16x32_bf16 a[156:159], v[104:107], v[84:87], a[156:159]
  v_mfma_f32_16x16x32_bf16 a[164:167], v[104:107], v[56:59], a[164:167]
  ds_read_b64_tr_b16 v[140:141], v15 offset:32768
  v_mfma_f32_16x16x32_bf16 a[172:175], v[104:107], v[88:91], a[172:175]
  v_mfma_f32_16x16x32_bf16 a[180:183], v[104:107], v[60:63], a[180:183]
  ds_read_b64_tr_b16 v[142:143], v15 offset:34816
  v_mfma_f32_16x16x32_bf16 a[188:191], v[104:107], v[92:95], a[188:191]
  ds_read_b128 v[124:127], v3 offset:38912
  v_mfma_f32_16x16x32_bf16 a[192:195], v[76:79], v[48:51], a[192:195]
  v_mfma_f32_16x16x32_bf16 a[200:203], v[76:79], v[80:83], a[200:203]
  buffer_load_dwordx4 v23, s[12:15], s21 offen offset:2048 lds
  v_mfma_f32_16x16x32_bf16 a[208:211], v[76:79], v[52:55], a[208:211]
  v_mfma_f32_16x16x32_bf16 a[216:219], v[76:79], v[84:87], a[216:219]
  ds_read_b64_tr_b16 v[172:173], v19 offset:32768
  v_mfma_f32_16x16x32_bf16 a[224:227], v[76:79], v[56:59], a[224:227]
  v_mfma_f32_16x16x32_bf16 a[232:235], v[76:79], v[88:91], a[232:235]
  ds_read_b64_tr_b16 v[174:175], v19 offset:34816
  v_mfma_f32_16x16x32_bf16 a[240:243], v[76:79], v[60:63], a[240:243]
  v_mfma_f32_16x16x32_bf16 a[248:251], v[76:79], v[92:95], a[248:251]
  ds_read_b128 v[156:159], v3 offset:39936
  v_mfma_f32_16x16x32_bf16 a[196:199], v[108:111], v[48:51], a[196:199]
  v_mfma_f32_16x16x32_bf16 a[204:207], v[108:111], v[80:83], a[204:207]
  buffer_load_dwordx4 v24, s[12:15], s21 offen offset:3072 lds
  s_add_u32 s21, s21, s23
  v_mfma_f32_16x16x32_bf16 a[212:215], v[108:111], v[52:55], a[212:215]
  v_mfma_f32_16x16x32_bf16 a[220:223], v[108:111], v[84:87], a[220:223]
  v_mfma_f32_16x16x32_bf16 a[228:231], v[108:111], v[56:59], a[228:231]
  v_mfma_f32_16x16x32_bf16 a[236:239], v[108:111], v[88:91], a[236:239]
  v_mfma_f32_16x16x32_bf16 a[244:247], v[108:111], v[60:63], a[244:247]
  v_mfma_f32_16x16x32_bf16 a[252:255], v[108:111], v[92:95], a[252:255]
  s_waitcnt vmcnt(16) lgkmcnt(0)
  s_barrier
  v_mfma_f32_16x16x32_bf16 a[0:3], v[128:131], v[112:115], a[0:3]
  ds_read_b64_tr_b16 v[64:65], v4 offset:0
  v_mfma_f32_16x16x32_bf16 a[8:11], v[128:131], v[144:147], a[8:11]
  ds_read_b64_tr_b16 v[66:67], v4 offset:2048
  v_mfma_f32_16x16x32_bf16 a[16:19], v[128:131], v[116:119], a[16:19]
  v_mfma_f32_16x16x32_bf16 a[24:27], v[128:131], v[148:151], a[24:27]
  ds_read_b128 v[48:51], v2 offset:0
  v_mfma_f32_16x16x32_bf16 a[32:35], v[128:131], v[120:123], a[32:35]
  v_mfma_f32_16x16x32_bf16 a[40:43], v[128:131], v[152:155], a[40:43]
  s_add_u32 m0, s26, 98304
  s_nop 0
  buffer_load_dwordx4 v20, s[92:95], s20 offen offset:0 lds
  v_mfma_f32_16x16x32_bf16 a[48:51], v[128:131], v[124:127], a[48:51]
  v_mfma_f32_16x16x32_bf16 a[56:59], v[128:131], v[156:159], a[56:59]
  ds_read_b64_tr_b16 v[96:97], v8 offset:0
  v_mfma_f32_16x16x32_bf16 a[4:7], v[160:163], v[112:115], a[4:7]
  v_mfma_f32_16x16x32_bf16 a[12:15], v[160:163], v[144:147], a[12:15]
  ds_read_b64_tr_b16 v[98:99], v8 offset:2048
  v_mfma_f32_16x16x32_bf16 a[20:23], v[160:163], v[116:119], a[20:23]
  v_mfma_f32_16x16x32_bf16 a[28:31], v[160:163], v[148:151], a[28:31]
  ds_read_b128 v[80:83], v2 offset:1024
  v_mfma_f32_16x16x32_bf16 a[36:39], v[160:163], v[120:123], a[36:39]
  buffer_load_dwordx4 v20, s[92:95], s20 offen offset:1024 lds
  v_mfma_f32_16x16x32_bf16 a[44:47], v[160:163], v[152:155], a[44:47]
  v_mfma_f32_16x16x32_bf16 a[52:55], v[160:163], v[124:127], a[52:55]
  ds_read_b64_tr_b16 v[68:69], v5 offset:0
  v_mfma_f32_16x16x32_bf16 a[60:63], v[160:163], v[156:159], a[60:63]
  v_mfma_f32_16x16x32_bf16 a[64:67], v[132:135], v[112:115], a[64:67]
  ds_read_b64_tr_b16 v[70:71], v5 offset:2048
  v_mfma_f32_16x16x32_bf16 a[72:75], v[132:135], v[144:147], a[72:75]
  v_mfma_f32_16x16x32_bf16 a[80:83], v[132:135], v[116:119], a[80:83]
  ds_read_b128 v[52:55], v2 offset:2048
  v_mfma_f32_16x16x32_bf16 a[88:91], v[132:135], v[148:151], a[88:91]
  v_mfma_f32_16x16x32_bf16 a[96:99], v[132:135], v[120:123], a[96:99]
  buffer_load_dwordx4 v20, s[92:95], s20 offen offset:2048 lds
  v_mfma_f32_16x16x32_bf16 a[104:107], v[132:135], v[152:155], a[104:107]
  v_mfma_f32_16x16x32_bf16 a[112:115], v[132:135], v[124:127], a[112:115]
  ds_read_b64_tr_b16 v[100:101], v9 offset:0
  v_mfma_f32_16x16x32_bf16 a[120:123], v[132:135], v[156:159], a[120:123]
  ds_read_b64_tr_b16 v[102:103], v9 offset:2048
  v_mfma_f32_16x16x32_bf16 a[68:71], v[164:167], v[112:115], a[68:71]
  v_mfma_f32_16x16x32_bf16 a[76:79], v[164:167], v[144:147], a[76:79]
  ds_read_b128 v[84:87], v2 offset:3072
  v_mfma_f32_16x16x32_bf16 a[84:87], v[164:167], v[116:119], a[84:87]
  v_mfma_f32_16x16x32_bf16 a[92:95], v[164:167], v[148:151], a[92:95]
  buffer_load_dwordx4 v20, s[92:95], s20 offen offset:3072 lds
  s_add_u32 s20, s20, 131072
  v_mfma_f32_16x16x32_bf16 a[100:103], v[164:167], v[120:123], a[100:103]
  v_mfma_f32_16x16x32_bf16 a[108:111], v[164:167], v[152:155], a[108:111]
  ds_read_b64_tr_b16 v[72:73], v6 offset:0
  v_mfma_f32_16x16x32_bf16 a[116:119], v[164:167], v[124:127], a[116:119]
  v_mfma_f32_16x16x32_bf16 a[124:127], v[164:167], v[156:159], a[124:127]
  ds_read_b64_tr_b16 v[74:75], v6 offset:2048
  v_mfma_f32_16x16x32_bf16 a[128:131], v[136:139], v[112:115], a[128:131]
  v_mfma_f32_16x16x32_bf16 a[136:139], v[136:139], v[144:147], a[136:139]
  ds_read_b128 v[56:59], v2 offset:4096
  v_mfma_f32_16x16x32_bf16 a[144:147], v[136:139], v[116:119], a[144:147]
  v_mfma_f32_16x16x32_bf16 a[152:155], v[136:139], v[148:151], a[152:155]
  s_add_u32 m0, s27, 98304
  s_nop 0
  buffer_load_dwordx4 v21, s[12:15], s21 offen offset:0 lds
  v_mfma_f32_16x16x32_bf16 a[160:163], v[136:139], v[120:123], a[160:163]
  ds_read_b64_tr_b16 v[104:105], v10 offset:0
  v_mfma_f32_16x16x32_bf16 a[168:171], v[136:139], v[152:155], a[168:171]
  v_mfma_f32_16x16x32_bf16 a[176:179], v[136:139], v[124:127], a[176:179]
  ds_read_b64_tr_b16 v[106:107], v10 offset:2048
  v_mfma_f32_16x16x32_bf16 a[184:187], v[136:139], v[156:159], a[184:187]
  v_mfma_f32_16x16x32_bf16 a[132:135], v[168:171], v[112:115], a[132:135]
  ds_read_b128 v[88:91], v2 offset:5120
  v_mfma_f32_16x16x32_bf16 a[140:143], v[168:171], v[144:147], a[140:143]
  v_mfma_f32_16x16x32_bf16 a[148:151], v[168:171], v[116:119], a[148:151]
  buffer_load_dwordx4 v22, s[12:15], s21 offen offset:1024 lds
  v_mfma_f32_16x16x32_bf16 a[156:159], v[168:171], v[148:151], a[156:159]
  v_mfma_f32_16x16x32_bf16 a[164:167], v[168:171], v[120:123], a[164:167]
  ds_read_b64_tr_b16 v[76:77], v7 offset:0
  v_mfma_f32_16x16x32_bf16 a[172:175], v[168:171], v[152:155], a[172:175]
  v_mfma_f32_16x16x32_bf16 a[180:183], v[168:171], v[124:127], a[180:183]
  ds_read_b64_tr_b16 v[78:79], v7 offset:2048
  v_mfma_f32_16x16x32_bf16 a[188:191], v[168:171], v[156:159], a[188:191]
  ds_read_b128 v[60:63], v2 offset:6144
  v_mfma_f32_16x16x32_bf16 a[192:195], v[140:143], v[112:115], a[192:195]
  v_mfma_f32_16x16x32_bf16 a[200:203], v[140:143], v[144:147], a[200:203]
  buffer_load_dwordx4 v23, s[12:15], s21 offen offset:2048 lds
  v_mfma_f32_16x16x32_bf16 a[208:211], v[140:143], v[116:119], a[208:211]
  v_mfma_f32_16x16x32_bf16 a[216:219], v[140:143], v[148:151], a[216:219]
  ds_read_b64_tr_b16 v[108:109], v11 offset:0
  v_mfma_f32_16x16x32_bf16 a[224:227], v[140:143], v[120:123], a[224:227]
  v_mfma_f32_16x16x32_bf16 a[232:235], v[140:143], v[152:155], a[232:235]
  ds_read_b64_tr_b16 v[110:111], v11 offset:2048
  v_mfma_f32_16x16x32_bf16 a[240:243], v[140:143], v[124:127], a[240:243]
  v_mfma_f32_16x16x32_bf16 a[248:251], v[140:143], v[156:159], a[248:251]
  ds_read_b128 v[92:95], v2 offset:7168
  v_mfma_f32_16x16x32_bf16 a[196:199], v[172:175], v[112:115], a[196:199]
  v_mfma_f32_16x16x32_bf16 a[204:207], v[172:175], v[144:147], a[204:207]
  buffer_load_dwordx4 v24, s[12:15], s21 offen offset:3072 lds
  s_add_u32 s21, s21, s23
  v_mfma_f32_16x16x32_bf16 a[212:215], v[172:175], v[116:119], a[212:215]
  v_mfma_f32_16x16x32_bf16 a[220:223], v[172:175], v[148:151], a[220:223]
  v_mfma_f32_16x16x32_bf16 a[228:231], v[172:175], v[120:123], a[228:231]
  v_mfma_f32_16x16x32_bf16 a[236:239], v[172:175], v[152:155], a[236:239]
  v_mfma_f32_16x16x32_bf16 a[244:247], v[172:175], v[124:127], a[244:247]
  v_mfma_f32_16x16x32_bf16 a[252:255], v[172:175], v[156:159], a[252:255]
  s_sub_u32 s22, s22, 1
  s_cmp_lg_u32 s22, 0
  s_cbranch_scc1 mk_gb_loop
  s_and_b32 s5, s76, 3
  s_cmp_eq_u32 s5, 3
  s_cselect_b32 s46, 0, 0x80008000
  s_waitcnt lgkmcnt(0)
  v_and_b32 v36, 15, v1
  v_lshl_add_u32 v36, v36, 6, v34
  s_mul_i32 s40, s32, 524288
  s_mul_i32 s41, s33, 8192
  s_add_u32 s40, s40, s41
  s_add_u32 s40, s40, s79
  v_add_u32 v35, s40, v36
  s_nop 7
  s_mov_b32 s42, 0
  v_accvgpr_read_b32 v120, a0
  v_accvgpr_read_b32 v121, a1
  v_accvgpr_read_b32 v122, a2
  v_accvgpr_read_b32 v123, a3
  v_accvgpr_read_b32 v124, a4
  v_accvgpr_read_b32 v125, a5
  v_accvgpr_read_b32 v126, a6
  v_accvgpr_read_b32 v127, a7
  v_accvgpr_read_b32 v128, a8
  v_accvgpr_read_b32 v129, a9
  v_accvgpr_read_b32 v130, a10
  v_accvgpr_read_b32 v131, a11
  v_accvgpr_read_b32 v132, a12
  v_accvgpr_read_b32 v133, a13
  v_accvgpr_read_b32 v134, a14
  v_accvgpr_read_b32 v135, a15
  v_cvt_pk_bf16_f32 v112, v120, v121
  v_cvt_pk_bf16_f32 v113, v122, v123
  v_cvt_pk_bf16_f32 v114, v124, v125
  v_cvt_pk_bf16_f32 v115, v126, v127
  v_cvt_pk_bf16_f32 v116, v128, v129
  v_cvt_pk_bf16_f32 v117, v130, v131
  v_cvt_pk_bf16_f32 v118, v132, v133
  v_cvt_pk_bf16_f32 v119, v134, v135
  v_pk_max_i16 v112, v112, s46
  v_pk_max_i16 v113, v113, s46
  v_pk_max_i16 v114, v114, s46
  v_pk_max_i16 v115, v115, s46
  v_pk_max_i16 v116, v116, s46
  v_pk_max_i16 v117, v117, s46
  v_pk_max_i16 v118, v118, s46
  v_pk_max_i16 v119, v119, s46
  s_nop 1
  v_permlane16_swap_b32 v112, v114
  v_permlane16_swap_b32 v113, v115
  v_permlane16_swap_b32 v116, v118
  v_permlane16_swap_b32 v117, v119
  buffer_store_dwordx4 v[112:115], v35, s[8:11], s42 offen offset:0 sc1
  buffer_store_dwordx4 v[116:119], v35, s[8:11], s42 offen offset:1024 sc1
  v_accvgpr_read_b32 v144, a16
  v_accvgpr_read_b32 v145, a17
  v_accvgpr_read_b32 v146, a18
  v_accvgpr_read_b32 v147, a19
  v_accvgpr_read_b32 v148, a20
  v_accvgpr_read_b32 v149, a21
  v_accvgpr_read_b32 v150, a22
  v_accvgpr_read_b32 v151, a23
  v_accvgpr_read_b32 v152, a24
  v_accvgpr_read_b32 v153, a25
  v_accvgpr_read_b32 v154, a26
  v_accvgpr_read_b32 v155, a27
  v_accvgpr_read_b32 v156, a28
  v_accvgpr_read_b32 v157, a29
  v_accvgpr_read_b32 v158, a30
  v_accvgpr_read_b32 v159, a31
  v_cvt_pk_bf16_f32 v136, v144, v145
  v_cvt_pk_bf16_f32 v137, v146, v147
  v_cvt_pk_bf16_f32 v138, v148, v149
  v_cvt_pk_bf16_f32 v139, v150, v151
  v_cvt_pk_bf16_f32 v140, v152, v153
  v_cvt_pk_bf16_f32 v141, v154, v155
  v_cvt_pk_bf16_f32 v142, v156, v157
  v_cvt_pk_bf16_f32 v143, v158, v159
  v_pk_max_i16 v136, v136, s46
  v_pk_max_i16 v137, v137, s46
  v_pk_max_i16 v138, v138, s46
  v_pk_max_i16 v139, v139, s46
  v_pk_max_i16 v140, v140, s46
  v_pk_max_i16 v141, v141, s46
  v_pk_max_i16 v142, v142, s46
  v_pk_max_i16 v143, v143, s46
  s_nop 1
  v_permlane16_swap_b32 v136, v138
  v_permlane16_swap_b32 v137, v139
  v_permlane16_swap_b32 v140, v142
  v_permlane16_swap_b32 v141, v143
  buffer_store_dwordx4 v[136:139], v35, s[8:11], s42 offen offset:2048 sc1
  buffer_store_dwordx4 v[140:143], v35, s[8:11], s42 offen offset:3072 sc1
  s_mov_b32 s42, 4096
  v_accvgpr_read_b32 v120, a32
  v_accvgpr_read_b32 v121, a33
  v_accvgpr_read_b32 v122, a34
  v_accvgpr_read_b32 v123, a35
  v_accvgpr_read_b32 v124, a36
  v_accvgpr_read_b32 v125, a37
  v_accvgpr_read_b32 v126, a38
  v_accvgpr_read_b32 v127, a39
  v_accvgpr_read_b32 v128, a40
  v_accvgpr_read_b32 v129, a41
  v_accvgpr_read_b32 v130, a42
  v_accvgpr_read_b32 v131, a43
  v_accvgpr_read_b32 v132, a44
  v_accvgpr_read_b32 v133, a45
  v_accvgpr_read_b32 v134, a46
  v_accvgpr_read_b32 v135, a47
  v_cvt_pk_bf16_f32 v112, v120, v121
  v_cvt_pk_bf16_f32 v113, v122, v123
  v_cvt_pk_bf16_f32 v114, v124, v125
  v_cvt_pk_bf16_f32 v115, v126, v127
  v_cvt_pk_bf16_f32 v116, v128, v129
  v_cvt_pk_bf16_f32 v117, v130, v131
  v_cvt_pk_bf16_f32 v118, v132, v133
  v_cvt_pk_bf16_f32 v119, v134, v135
  v_pk_max_i16 v112, v112, s46
  v_pk_max_i16 v113, v113, s46
  v_pk_max_i16 v114, v114, s46
  v_pk_max_i16 v115, v115, s46
  v_pk_max_i16 v116, v116, s46
  v_pk_max_i16 v117, v117, s46
  v_pk_max_i16 v118, v118, s46
  v_pk_max_i16 v119, v119, s46
  s_nop 1
  v_permlane16_swap_b32 v112, v114
  v_permlane16_swap_b32 v113, v115
  v_permlane16_swap_b32 v116, v118
  v_permlane16_swap_b32 v117, v119
  buffer_store_dwordx4 v[112:115], v35, s[8:11], s42 offen offset:0 sc1
  buffer_store_dwordx4 v[116:119], v35, s[8:11], s42 offen offset:1024 sc1
  v_accvgpr_read_b32 v144, a48
  v_accvgpr_read_b32 v145, a49
  v_accvgpr_read_b32 v146, a50
  v_accvgpr_read_b32 v147, a51
  v_accvgpr_read_b32 v148, a52
  v_accvgpr_read_b32 v149, a53
  v_accvgpr_read_b32 v150, a54
  v_accvgpr_read_b32 v151, a55
  v_accvgpr_read_b32 v152, a56
  v_accvgpr_read_b32 v153, a57
  v_accvgpr_read_b32 v154, a58
  v_accvgpr_read_b32 v155, a59
  v_accvgpr_read_b32 v156, a60
  v_accvgpr_read_b32 v157, a61
  v_accvgpr_read_b32 v158, a62
  v_accvgpr_read_b32 v159, a63
  v_cvt_pk_bf16_f32 v136, v144, v145
  v_cvt_pk_bf16_f32 v137, v146, v147
  v_cvt_pk_bf16_f32 v138, v148, v149
  v_cvt_pk_bf16_f32 v139, v150, v151
  v_cvt_pk_bf16_f32 v140, v152, v153
  v_cvt_pk_bf16_f32 v141, v154, v155
  v_cvt_pk_bf16_f32 v142, v156, v157
  v_cvt_pk_bf16_f32 v143, v158, v159
  v_pk_max_i16 v136, v136, s46
  v_pk_max_i16 v137, v137, s46
  v_pk_max_i16 v138, v138, s46
  v_pk_max_i16 v139, v139, s46
  v_pk_max_i16 v140, v140, s46
  v_pk_max_i16 v141, v141, s46
  v_pk_max_i16 v142, v142, s46
  v_pk_max_i16 v143, v143, s46
  s_nop 1
  v_permlane16_swap_b32 v136, v138
  v_permlane16_swap_b32 v137, v139
  v_permlane16_swap_b32 v140, v142
  v_permlane16_swap_b32 v141, v143
  buffer_store_dwordx4 v[136:139], v35, s[8:11], s42 offen offset:2048 sc1
  buffer_store_dwordx4 v[140:143], v35, s[8:11], s42 offen offset:3072 sc1
  s_mov_b32 s42, 131072
  v_accvgpr_read_b32 v120, a64
  v_accvgpr_read_b32 v121, a65
  v_accvgpr_read_b32 v122, a66
  v_accvgpr_read_b32 v123, a67
  v_accvgpr_read_b32 v124, a68
  v_accvgpr_read_b32 v125, a69
  v_accvgpr_read_b32 v126, a70
  v_accvgpr_read_b32 v127, a71
  v_accvgpr_read_b32 v128, a72
  v_accvgpr_read_b32 v129, a73
  v_accvgpr_read_b32 v130, a74
  v_accvgpr_read_b32 v131, a75
  v_accvgpr_read_b32 v132, a76
  v_accvgpr_read_b32 v133, a77
  v_accvgpr_read_b32 v134, a78
  v_accvgpr_read_b32 v135, a79
  v_cvt_pk_bf16_f32 v112, v120, v121
  v_cvt_pk_bf16_f32 v113, v122, v123
  v_cvt_pk_bf16_f32 v114, v124, v125
  v_cvt_pk_bf16_f32 v115, v126, v127
  v_cvt_pk_bf16_f32 v116, v128, v129
  v_cvt_pk_bf16_f32 v117, v130, v131
  v_cvt_pk_bf16_f32 v118, v132, v133
  v_cvt_pk_bf16_f32 v119, v134, v135
  v_pk_max_i16 v112, v112, s46
  v_pk_max_i16 v113, v113, s46
  v_pk_max_i16 v114, v114, s46
  v_pk_max_i16 v115, v115, s46
  v_pk_max_i16 v116, v116, s46
  v_pk_max_i16 v117, v117, s46
  v_pk_max_i16 v118, v118, s46
  v_pk_max_i16 v119, v119, s46
  s_nop 1
  v_permlane16_swap_b32 v112, v114
  v_permlane16_swap_b32 v113, v115
  v_permlane16_swap_b32 v116, v118
  v_permlane16_swap_b32 v117, v119
  buffer_store_dwordx4 v[112:115], v35, s[8:11], s42 offen offset:0 sc1
  buffer_store_dwordx4 v[116:119], v35, s[8:11], s42 offen offset:1024 sc1
  v_accvgpr_read_b32 v144, a80
  v_accvgpr_read_b32 v145, a81
  v_accvgpr_read_b32 v146, a82
  v_accvgpr_read_b32 v147, a83
  v_accvgpr_read_b32 v148, a84
  v_accvgpr_read_b32 v149, a85
  v_accvgpr_read_b32 v150, a86
  v_accvgpr_read_b32 v151, a87
  v_accvgpr_read_b32 v152, a88
  v_accvgpr_read_b32 v153, a89
  v_accvgpr_read_b32 v154, a90
  v_accvgpr_read_b32 v155, a91
  v_accvgpr_read_b32 v156, a92
  v_accvgpr_read_b32 v157, a93
  v_accvgpr_read_b32 v158, a94
  v_accvgpr_read_b32 v159, a95
  v_cvt_pk_bf16_f32 v136, v144, v145
  v_cvt_pk_bf16_f32 v137, v146, v147
  v_cvt_pk_bf16_f32 v138, v148, v149
  v_cvt_pk_bf16_f32 v139, v150, v151
  v_cvt_pk_bf16_f32 v140, v152, v153
  v_cvt_pk_bf16_f32 v141, v154, v155
  v_cvt_pk_bf16_f32 v142, v156, v157
  v_cvt_pk_bf16_f32 v143, v158, v159
  v_pk_max_i16 v136, v136, s46
  v_pk_max_i16 v137, v137, s46
  v_pk_max_i16 v138, v138, s46
  v_pk_max_i16 v139, v139, s46
  v_pk_max_i16 v140, v140, s46
  v_pk_max_i16 v141, v141, s46
  v_pk_max_i16 v142, v142, s46
  v_pk_max_i16 v143, v143, s46
  s_nop 1
  v_permlane16_swap_b32 v136, v138
  v_permlane16_swap_b32 v137, v139
  v_permlane16_swap_b32 v140, v142
  v_permlane16_swap_b32 v141, v143
  buffer_store_dwordx4 v[136:139], v35, s[8:11], s42 offen offset:2048 sc1
  buffer_store_dwordx4 v[140:143], v35, s[8:11], s42 offen offset:3072 sc1
  s_mov_b32 s42, 135168
  v_accvgpr_read_b32 v120, a96
  v_accvgpr_read_b32 v121, a97
  v_accvgpr_read_b32 v122, a98
  v_accvgpr_read_b32 v123, a99
  v_accvgpr_read_b32 v124, a100
  v_accvgpr_read_b32 v125, a101
  v_accvgpr_read_b32 v126, a102
  v_accvgpr_read_b32 v127, a103
  v_accvgpr_read_b32 v128, a104
  v_accvgpr_read_b32 v129, a105
  v_accvgpr_read_b32 v130, a106
  v_accvgpr_read_b32 v131, a107
  v_accvgpr_read_b32 v132, a108
  v_accvgpr_read_b32 v133, a109
  v_accvgpr_read_b32 v134, a110
  v_accvgpr_read_b32 v135, a111
  v_cvt_pk_bf16_f32 v112, v120, v121
  v_cvt_pk_bf16_f32 v113, v122, v123
  v_cvt_pk_bf16_f32 v114, v124, v125
  v_cvt_pk_bf16_f32 v115, v126, v127
  v_cvt_pk_bf16_f32 v116, v128, v129
  v_cvt_pk_bf16_f32 v117, v130, v131
  v_cvt_pk_bf16_f32 v118, v132, v133
  v_cvt_pk_bf16_f32 v119, v134, v135
  v_pk_max_i16 v112, v112, s46
  v_pk_max_i16 v113, v113, s46
  v_pk_max_i16 v114, v114, s46
  v_pk_max_i16 v115, v115, s46
  v_pk_max_i16 v116, v116, s46
  v_pk_max_i16 v117, v117, s46
  v_pk_max_i16 v118, v118, s46
  v_pk_max_i16 v119, v119, s46
  s_nop 1
  v_permlane16_swap_b32 v112, v114
  v_permlane16_swap_b32 v113, v115
  v_permlane16_swap_b32 v116, v118
  v_permlane16_swap_b32 v117, v119
  buffer_store_dwordx4 v[112:115], v35, s[8:11], s42 offen offset:0 sc1
  buffer_store_dwordx4 v[116:119], v35, s[8:11], s42 offen offset:1024 sc1
  v_accvgpr_read_b32 v144, a112
  v_accvgpr_read_b32 v145, a113
  v_accvgpr_read_b32 v146, a114
  v_accvgpr_read_b32 v147, a115
  v_accvgpr_read_b32 v148, a116
  v_accvgpr_read_b32 v149, a117
  v_accvgpr_read_b32 v150, a118
  v_accvgpr_read_b32 v151, a119
  v_accvgpr_read_b32 v152, a120
  v_accvgpr_read_b32 v153, a121
  v_accvgpr_read_b32 v154, a122
  v_accvgpr_read_b32 v155, a123
  v_accvgpr_read_b32 v156, a124
  v_accvgpr_read_b32 v157, a125
  v_accvgpr_read_b32 v158, a126
  v_accvgpr_read_b32 v159, a127
  v_cvt_pk_bf16_f32 v136, v144, v145
  v_cvt_pk_bf16_f32 v137, v146, v147
  v_cvt_pk_bf16_f32 v138, v148, v149
  v_cvt_pk_bf16_f32 v139, v150, v151
  v_cvt_pk_bf16_f32 v140, v152, v153
  v_cvt_pk_bf16_f32 v141, v154, v155
  v_cvt_pk_bf16_f32 v142, v156, v157
  v_cvt_pk_bf16_f32 v143, v158, v159
  v_pk_max_i16 v136, v136, s46
  v_pk_max_i16 v137, v137, s46
  v_pk_max_i16 v138, v138, s46
  v_pk_max_i16 v139, v139, s46
  v_pk_max_i16 v140, v140, s46
  v_pk_max_i16 v141, v141, s46
  v_pk_max_i16 v142, v142, s46
  v_pk_max_i16 v143, v143, s46
  s_nop 1
  v_permlane16_swap_b32 v136, v138
  v_permlane16_swap_b32 v137, v139
  v_permlane16_swap_b32 v140, v142
  v_permlane16_swap_b32 v141, v143
  buffer_store_dwordx4 v[136:139], v35, s[8:11], s42 offen offset:2048 sc1
  buffer_store_dwordx4 v[140:143], v35, s[8:11], s42 offen offset:3072 sc1
  s_mov_b32 s42, 262144
  v_accvgpr_read_b32 v120, a128
  v_accvgpr_read_b32 v121, a129
  v_accvgpr_read_b32 v122, a130
  v_accvgpr_read_b32 v123, a131
  v_accvgpr_read_b32 v124, a132
  v_accvgpr_read_b32 v125, a133
  v_accvgpr_read_b32 v126, a134
  v_accvgpr_read_b32 v127, a135
  v_accvgpr_read_b32 v128, a136
  v_accvgpr_read_b32 v129, a137
  v_accvgpr_read_b32 v130, a138
  v_accvgpr_read_b32 v131, a139
  v_accvgpr_read_b32 v132, a140
  v_accvgpr_read_b32 v133, a141
  v_accvgpr_read_b32 v134, a142
  v_accvgpr_read_b32 v135, a143
  v_cvt_pk_bf16_f32 v112, v120, v121
  v_cvt_pk_bf16_f32 v113, v122, v123
  v_cvt_pk_bf16_f32 v114, v124, v125
  v_cvt_pk_bf16_f32 v115, v126, v127
  v_cvt_pk_bf16_f32 v116, v128, v129
  v_cvt_pk_bf16_f32 v117, v130, v131
  v_cvt_pk_bf16_f32 v118, v132, v133
  v_cvt_pk_bf16_f32 v119, v134, v135
  v_pk_max_i16 v112, v112, s46
  v_pk_max_i16 v113, v113, s46
  v_pk_max_i16 v114, v114, s46
  v_pk_max_i16 v115, v115, s46
  v_pk_max_i16 v116, v116, s46
  v_pk_max_i16 v117, v117, s46
  v_pk_max_i16 v118, v118, s46
  v_pk_max_i16 v119, v119, s46
  s_nop 1
  v_permlane16_swap_b32 v112, v114
  v_permlane16_swap_b32 v113, v115
  v_permlane16_swap_b32 v116, v118
  v_permlane16_swap_b32 v117, v119
  buffer_store_dwordx4 v[112:115], v35, s[8:11], s42 offen offset:0 sc1
  buffer_store_dwordx4 v[116:119], v35, s[8:11], s42 offen offset:1024 sc1
  v_accvgpr_read_b32 v144, a144
  v_accvgpr_read_b32 v145, a145
  v_accvgpr_read_b32 v146, a146
  v_accvgpr_read_b32 v147, a147
  v_accvgpr_read_b32 v148, a148
  v_accvgpr_read_b32 v149, a149
  v_accvgpr_read_b32 v150, a150
  v_accvgpr_read_b32 v151, a151
  v_accvgpr_read_b32 v152, a152
  v_accvgpr_read_b32 v153, a153
  v_accvgpr_read_b32 v154, a154
  v_accvgpr_read_b32 v155, a155
  v_accvgpr_read_b32 v156, a156
  v_accvgpr_read_b32 v157, a157
  v_accvgpr_read_b32 v158, a158
  v_accvgpr_read_b32 v159, a159
  v_cvt_pk_bf16_f32 v136, v144, v145
  v_cvt_pk_bf16_f32 v137, v146, v147
  v_cvt_pk_bf16_f32 v138, v148, v149
  v_cvt_pk_bf16_f32 v139, v150, v151
  v_cvt_pk_bf16_f32 v140, v152, v153
  v_cvt_pk_bf16_f32 v141, v154, v155
  v_cvt_pk_bf16_f32 v142, v156, v157
  v_cvt_pk_bf16_f32 v143, v158, v159
  v_pk_max_i16 v136, v136, s46
  v_pk_max_i16 v137, v137, s46
  v_pk_max_i16 v138, v138, s46
  v_pk_max_i16 v139, v139, s46
  v_pk_max_i16 v140, v140, s46
  v_pk_max_i16 v141, v141, s46
  v_pk_max_i16 v142, v142, s46
  v_pk_max_i16 v143, v143, s46
  s_nop 1
  v_permlane16_swap_b32 v136, v138
  v_permlane16_swap_b32 v137, v139
  v_permlane16_swap_b32 v140, v142
  v_permlane16_swap_b32 v141, v143
  buffer_store_dwordx4 v[136:139], v35, s[8:11], s42 offen offset:2048 sc1
  buffer_store_dwordx4 v[140:143], v35, s[8:11], s42 offen offset:3072 sc1
  s_mov_b32 s42, 266240
  v_accvgpr_read_b32 v120, a160
  v_accvgpr_read_b32 v121, a161
  v_accvgpr_read_b32 v122, a162
  v_accvgpr_read_b32 v123, a163
  v_accvgpr_read_b32 v124, a164
  v_accvgpr_read_b32 v125, a165
  v_accvgpr_read_b32 v126, a166
  v_accvgpr_read_b32 v127, a167
  v_accvgpr_read_b32 v128, a168
  v_accvgpr_read_b32 v129, a169
  v_accvgpr_read_b32 v130, a170
  v_accvgpr_read_b32 v131, a171
  v_accvgpr_read_b32 v132, a172
  v_accvgpr_read_b32 v133, a173
  v_accvgpr_read_b32 v134, a174
  v_accvgpr_read_b32 v135, a175
  v_cvt_pk_bf16_f32 v112, v120, v121
  v_cvt_pk_bf16_f32 v113, v122, v123
  v_cvt_pk_bf16_f32 v114, v124, v125
  v_cvt_pk_bf16_f32 v115, v126, v127
  v_cvt_pk_bf16_f32 v116, v128, v129
  v_cvt_pk_bf16_f32 v117, v130, v131
  v_cvt_pk_bf16_f32 v118, v132, v133
  v_cvt_pk_bf16_f32 v119, v134, v135
  v_pk_max_i16 v112, v112, s46
  v_pk_max_i16 v113, v113, s46
  v_pk_max_i16 v114, v114, s46
  v_pk_max_i16 v115, v115, s46
  v_pk_max_i16 v116, v116, s46
  v_pk_max_i16 v117, v117, s46
  v_pk_max_i16 v118, v118, s46
  v_pk_max_i16 v119, v119, s46
  s_nop 1
  v_permlane16_swap_b32 v112, v114
  v_permlane16_swap_b32 v113, v115
  v_permlane16_swap_b32 v116, v118
  v_permlane16_swap_b32 v117, v119
  buffer_store_dwordx4 v[112:115], v35, s[8:11], s42 offen offset:0 sc1
  buffer_store_dwordx4 v[116:119], v35, s[8:11], s42 offen offset:1024 sc1
  v_accvgpr_read_b32 v144, a176
  v_accvgpr_read_b32 v145, a177
  v_accvgpr_read_b32 v146, a178
  v_accvgpr_read_b32 v147, a179
  v_accvgpr_read_b32 v148, a180
  v_accvgpr_read_b32 v149, a181
  v_accvgpr_read_b32 v150, a182
  v_accvgpr_read_b32 v151, a183
  v_accvgpr_read_b32 v152, a184
  v_accvgpr_read_b32 v153, a185
  v_accvgpr_read_b32 v154, a186
  v_accvgpr_read_b32 v155, a187
  v_accvgpr_read_b32 v156, a188
  v_accvgpr_read_b32 v157, a189
  v_accvgpr_read_b32 v158, a190
  v_accvgpr_read_b32 v159, a191
  v_cvt_pk_bf16_f32 v136, v144, v145
  v_cvt_pk_bf16_f32 v137, v146, v147
  v_cvt_pk_bf16_f32 v138, v148, v149
  v_cvt_pk_bf16_f32 v139, v150, v151
  v_cvt_pk_bf16_f32 v140, v152, v153
  v_cvt_pk_bf16_f32 v141, v154, v155
  v_cvt_pk_bf16_f32 v142, v156, v157
  v_cvt_pk_bf16_f32 v143, v158, v159
  v_pk_max_i16 v136, v136, s46
  v_pk_max_i16 v137, v137, s46
  v_pk_max_i16 v138, v138, s46
  v_pk_max_i16 v139, v139, s46
  v_pk_max_i16 v140, v140, s46
  v_pk_max_i16 v141, v141, s46
  v_pk_max_i16 v142, v142, s46
  v_pk_max_i16 v143, v143, s46
  s_nop 1
  v_permlane16_swap_b32 v136, v138
  v_permlane16_swap_b32 v137, v139
  v_permlane16_swap_b32 v140, v142
  v_permlane16_swap_b32 v141, v143
  buffer_store_dwordx4 v[136:139], v35, s[8:11], s42 offen offset:2048 sc1
  buffer_store_dwordx4 v[140:143], v35, s[8:11], s42 offen offset:3072 sc1
  s_mov_b32 s42, 393216
  v_accvgpr_read_b32 v120, a192
  v_accvgpr_read_b32 v121, a193
  v_accvgpr_read_b32 v122, a194
  v_accvgpr_read_b32 v123, a195
  v_accvgpr_read_b32 v124, a196
  v_accvgpr_read_b32 v125, a197
  v_accvgpr_read_b32 v126, a198
  v_accvgpr_read_b32 v127, a199
  v_accvgpr_read_b32 v128, a200
  v_accvgpr_read_b32 v129, a201
  v_accvgpr_read_b32 v130, a202
  v_accvgpr_read_b32 v131, a203
  v_accvgpr_read_b32 v132, a204
  v_accvgpr_read_b32 v133, a205
  v_accvgpr_read_b32 v134, a206
  v_accvgpr_read_b32 v135, a207
  v_cvt_pk_bf16_f32 v112, v120, v121
  v_cvt_pk_bf16_f32 v113, v122, v123
  v_cvt_pk_bf16_f32 v114, v124, v125
  v_cvt_pk_bf16_f32 v115, v126, v127
  v_cvt_pk_bf16_f32 v116, v128, v129
  v_cvt_pk_bf16_f32 v117, v130, v131
  v_cvt_pk_bf16_f32 v118, v132, v133
  v_cvt_pk_bf16_f32 v119, v134, v135
  v_pk_max_i16 v112, v112, s46
  v_pk_max_i16 v113, v113, s46
  v_pk_max_i16 v114, v114, s46
  v_pk_max_i16 v115, v115, s46
  v_pk_max_i16 v116, v116, s46
  v_pk_max_i16 v117, v117, s46
  v_pk_max_i16 v118, v118, s46
  v_pk_max_i16 v119, v119, s46
  s_nop 1
  v_permlane16_swap_b32 v112, v114
  v_permlane16_swap_b32 v113, v115
  v_permlane16_swap_b32 v116, v118
  v_permlane16_swap_b32 v117, v119
  buffer_store_dwordx4 v[112:115], v35, s[8:11], s42 offen offset:0 sc1
  buffer_store_dwordx4 v[116:119], v35, s[8:11], s42 offen offset:1024 sc1
  v_accvgpr_read_b32 v144, a208
  v_accvgpr_read_b32 v145, a209
  v_accvgpr_read_b32 v146, a210
  v_accvgpr_read_b32 v147, a211
  v_accvgpr_read_b32 v148, a212
  v_accvgpr_read_b32 v149, a213
  v_accvgpr_read_b32 v150, a214
  v_accvgpr_read_b32 v151, a215
  v_accvgpr_read_b32 v152, a216
  v_accvgpr_read_b32 v153, a217
  v_accvgpr_read_b32 v154, a218
  v_accvgpr_read_b32 v155, a219
  v_accvgpr_read_b32 v156, a220
  v_accvgpr_read_b32 v157, a221
  v_accvgpr_read_b32 v158, a222
  v_accvgpr_read_b32 v159, a223
  v_cvt_pk_bf16_f32 v136, v144, v145
  v_cvt_pk_bf16_f32 v137, v146, v147
  v_cvt_pk_bf16_f32 v138, v148, v149
  v_cvt_pk_bf16_f32 v139, v150, v151
  v_cvt_pk_bf16_f32 v140, v152, v153
  v_cvt_pk_bf16_f32 v141, v154, v155
  v_cvt_pk_bf16_f32 v142, v156, v157
  v_cvt_pk_bf16_f32 v143, v158, v159
  v_pk_max_i16 v136, v136, s46
  v_pk_max_i16 v137, v137, s46
  v_pk_max_i16 v138, v138, s46
  v_pk_max_i16 v139, v139, s46
  v_pk_max_i16 v140, v140, s46
  v_pk_max_i16 v141, v141, s46
  v_pk_max_i16 v142, v142, s46
  v_pk_max_i16 v143, v143, s46
  s_nop 1
  v_permlane16_swap_b32 v136, v138
  v_permlane16_swap_b32 v137, v139
  v_permlane16_swap_b32 v140, v142
  v_permlane16_swap_b32 v141, v143
  buffer_store_dwordx4 v[136:139], v35, s[8:11], s42 offen offset:2048 sc1
  buffer_store_dwordx4 v[140:143], v35, s[8:11], s42 offen offset:3072 sc1
  s_mov_b32 s42, 397312
  v_accvgpr_read_b32 v120, a224
  v_accvgpr_read_b32 v121, a225
  v_accvgpr_read_b32 v122, a226
  v_accvgpr_read_b32 v123, a227
  v_accvgpr_read_b32 v124, a228
  v_accvgpr_read_b32 v125, a229
  v_accvgpr_read_b32 v126, a230
  v_accvgpr_read_b32 v127, a231
  v_accvgpr_read_b32 v128, a232
  v_accvgpr_read_b32 v129, a233
  v_accvgpr_read_b32 v130, a234
  v_accvgpr_read_b32 v131, a235
  v_accvgpr_read_b32 v132, a236
  v_accvgpr_read_b32 v133, a237
  v_accvgpr_read_b32 v134, a238
  v_accvgpr_read_b32 v135, a239
  v_cvt_pk_bf16_f32 v112, v120, v121
  v_cvt_pk_bf16_f32 v113, v122, v123
  v_cvt_pk_bf16_f32 v114, v124, v125
  v_cvt_pk_bf16_f32 v115, v126, v127
  v_cvt_pk_bf16_f32 v116, v128, v129
  v_cvt_pk_bf16_f32 v117, v130, v131
  v_cvt_pk_bf16_f32 v118, v132, v133
  v_cvt_pk_bf16_f32 v119, v134, v135
  v_pk_max_i16 v112, v112, s46
  v_pk_max_i16 v113, v113, s46
  v_pk_max_i16 v114, v114, s46
  v_pk_max_i16 v115, v115, s46
  v_pk_max_i16 v116, v116, s46
  v_pk_max_i16 v117, v117, s46
  v_pk_max_i16 v118, v118, s46
  v_pk_max_i16 v119, v119, s46
  s_nop 1
  v_permlane16_swap_b32 v112, v114
  v_permlane16_swap_b32 v113, v115
  v_permlane16_swap_b32 v116, v118
  v_permlane16_swap_b32 v117, v119
  buffer_store_dwordx4 v[112:115], v35, s[8:11], s42 offen offset:0 sc1
  buffer_store_dwordx4 v[116:119], v35, s[8:11], s42 offen offset:1024 sc1
  v_accvgpr_read_b32 v144, a240
  v_accvgpr_read_b32 v145, a241
  v_accvgpr_read_b32 v146, a242
  v_accvgpr_read_b32 v147, a243
  v_accvgpr_read_b32 v148, a244
  v_accvgpr_read_b32 v149, a245
  v_accvgpr_read_b32 v150, a246
  v_accvgpr_read_b32 v151, a247
  v_accvgpr_read_b32 v152, a248
  v_accvgpr_read_b32 v153, a249
  v_accvgpr_read_b32 v154, a250
  v_accvgpr_read_b32 v155, a251
  v_accvgpr_read_b32 v156, a252
  v_accvgpr_read_b32 v157, a253
  v_accvgpr_read_b32 v158, a254
  v_accvgpr_read_b32 v159, a255
  v_cvt_pk_bf16_f32 v136, v144, v145
  v_cvt_pk_bf16_f32 v137, v146, v147
  v_cvt_pk_bf16_f32 v138, v148, v149
  v_cvt_pk_bf16_f32 v139, v150, v151
  v_cvt_pk_bf16_f32 v140, v152, v153
  v_cvt_pk_bf16_f32 v141, v154, v155
  v_cvt_pk_bf16_f32 v142, v156, v157
  v_cvt_pk_bf16_f32 v143, v158, v159
  v_pk_max_i16 v136, v136, s46
  v_pk_max_i16 v137, v137, s46
  v_pk_max_i16 v138, v138, s46
  v_pk_max_i16 v139, v139, s46
  v_pk_max_i16 v140, v140, s46
  v_pk_max_i16 v141, v141, s46
  v_pk_max_i16 v142, v142, s46
  v_pk_max_i16 v143, v143, s46
  s_nop 1
  v_permlane16_swap_b32 v136, v138
  v_permlane16_swap_b32 v137, v139
  v_permlane16_swap_b32 v140, v142
  v_permlane16_swap_b32 v141, v143
  buffer_store_dwordx4 v[136:139], v35, s[8:11], s42 offen offset:2048 sc1
  buffer_store_dwordx4 v[140:143], v35, s[8:11], s42 offen offset:3072 sc1
  s_mov_b32 s47, s80
  s_mov_b32 s48, s81
  s_mov_b32 s76, s84
  s_mov_b32 s77, s85
  s_mov_b32 s78, s86
  s_mov_b32 s79, s87
  s_mov_b32 s80, s88
  s_mov_b32 s81, s89
  s_mov_b32 s82, s90
  s_mov_b32 s83, s91
  s_add_u32 s70, s70, 32
  s_addc_u32 s71, s71, 0
  s_load_dwordx8 s[84:91], s[70:71], 32
  s_and_b32 s5, s76, 0xf0
  s_cmp_eq_u32 s5, 16
  s_waitcnt lgkmcnt(0)
  s_cbranch_scc1 mk_big
  s_waitcnt vmcnt(0)
  s_barrier
  buffer_store_dword v251, v250, s[8:11], s47 offen sc1
  buffer_store_dword v251, v250, s[8:11], s48 offen sc1
  s_load_dwordx2 s[16:17], s[0:1], 80
  s_mov_b32 s18, 4194304
  s_mov_b32 s19, 0x20000
  s_load_dwordx2 s[56:57], s[0:1], 40
  s_mov_b32 s98, 4194304
mk_next:
  s_waitcnt lgkmcnt(0)
  s_and_b32 s5, s76, 0xf0
  s_cmp_eq_u32 s5, 64
  s_cbranch_scc1 mk_att
  s_cmp_gt_u32 s5, 64
  s_cbranch_scc1 mk_done
  v_lshrrev_b32 v36, 6, v0
  s_nop 0
  v_readfirstlane_b32 s28, v36
  v_and_b32 v1, 63, v0
  s_and_b32 s32, s28, 1
  s_lshr_b32 s33, s28, 1
  v_bfe_u32 v40, v1, 2, 1
  v_bfe_u32 v41, v1, 3, 1
  v_xor_b32 v40, v40, v41
  v_lshl_add_u32 v38, v40, 1, v41
  v_and_b32 v36, 15, v1
  v_lshrrev_b32 v37, 4, v1
  v_xor_b32 v37, v37, v38
  v_lshlrev_b32 v37, 4, v37
  v_lshl_add_u32 v37, v36, 6, v37
  s_mul_i32 s40, s33, 4096
  v_add_u32 v2, s40, v37
  v_add_u32 v3, 65536, v2
  v_bfe_u32 v36, v1, 2, 2
  v_lshrrev_b32 v37, 4, v1
  v_lshl_add_u32 v37, v37, 3, v36
  v_mul_u32_u24 v37, 256, v37
  v_and_b32 v38, 3, v1
  v_lshlrev_b32 v38, 3, v38
  v_bfe_u32 v39, v1, 4, 1
  v_lshl_add_u32 v38, v39, 5, v38
  v_add_u32 v37, v37, v38
  v_add_u32 v37, 8192, v37
  s_mul_i32 s40, s32, 2
  s_add_u32 s41, s40, 0
  v_xor_b32 v38, s41, v36
  v_lshl_add_u32 v4, v38, 6, v37
  v_xor_b32 v8, 32, v4
  v_add_u32 v12, 65536, v4
  v_add_u32 v16, 65536, v8
  s_add_u32 s41, s40, 1
  v_xor_b32 v38, s41, v36
  v_lshl_add_u32 v5, v38, 6, v37
  v_xor_b32 v9, 32, v5
  v_add_u32 v13, 65536, v5
  v_add_u32 v17, 65536, v9
  v_bfe_u32 v40, v1, 4, 1
  v_bfe_u32 v41, v1, 5, 1
  v_xor_b32 v40, v40, v41
  v_lshl_add_u32 v37, v40, 1, v41
  v_and_b32 v36, 3, v1
  v_xor_b32 v36, v36, v37
  v_lshlrev_b32 v36, 4, v36
  v_lshrrev_b32 v37, 2, v1
  v_lshl_add_u32 v36, v37, 6, v36
  s_mul_i32 s26, s28, 2048
  v_add_u32 v33, s26, v36
  s_mul_i32 s40, s28, 8
  s_add_u32 s40, s40, 0
  v_lshrrev_b32 v25, 4, v1
  v_add_u32 v25, s40, v25
  v_and_b32 v37, 3, v25
  v_lshlrev_b32 v37, 2, v37
  v_and_b32 v38, 15, v1
  v_xor_b32 v37, v37, v38
  v_bfe_u32 v38, v25, 3, 1
  v_lshlrev_b32 v38, 1, v38
  v_xor_b32 v37, v37, v38
  v_lshlrev_b32 v29, 4, v37
  v_subrev_u32 v29, 0, v29
  s_mul_i32 s40, s28, 8
  s_add_u32 s40, s40, 4
  v_lshrrev_b32 v26, 4, v1
  v_add_u32 v26, s40, v26
  v_and_b32 v37, 3, v26
  v_lshlrev_b32 v37, 2, v37
  v_and_b32 v38, 15, v1
  v_xor_b32 v37, v37, v38
  v_bfe_u32 v38, v26, 3, 1
  v_lshlrev_b32 v38, 1, v38
  v_xor_b32 v37, v37, v38
  v_lshlrev_b32 v30, 4, v37
  v_subrev_u32 v30, 1024, v30
  s_mul_i32 s27, s28, 2048
  s_add_u32 s27, s27, 8192
  v_bfe_u32 v37, v1, 4, 1
  v_lshlrev_b32 v37, 5, v37
  v_bfe_u32 v38, v1, 5, 1
  v_lshl_add_u32 v34, v38, 4, v37
  s_mov_b32 s12, s68
  s_mov_b32 s13, s69
  s_mov_b32 s14, 7340032
  s_bitcmp1_b32 s76, 0
  s_cbranch_scc0 mk_t_52
  s_mov_b32 s12, s56
  s_mov_b32 s13, s57
  s_mov_b32 s14, 8388608
mk_t_52:
  s_mov_b32 s38, 2048
  s_mov_b32 s36, s77
  s_mov_b32 s37, s78
  s_mov_b32 s94, 268435456
  s_bfe_u32 s22, s76, 0x80008
  v_add_u32 v20, s36, v33
  v_mul_lo_u32 v21, v25, s38
  v_add_u32 v21, v21, v29
  v_add_u32 v21, s37, v21
  v_mul_lo_u32 v22, v26, s38
  v_add_u32 v22, v22, v30
  v_add_u32 v22, s37, v22
  s_mov_b32 s20, 0
  s_mov_b32 s21, 0
  s_lshl_b32 s23, s38, 5
  s_barrier
  s_add_u32 m0, s27, 0
  s_nop 0
  buffer_load_dwordx4 v21, s[12:15], s21 offen offset:0 lds
  buffer_load_dwordx4 v22, s[12:15], s21 offen offset:1024 lds
  s_add_u32 s21, s21, s23
  s_add_u32 m0, s27, 16384
  s_nop 0
  buffer_load_dwordx4 v21, s[12:15], s21 offen offset:0 lds
  buffer_load_dwordx4 v22, s[12:15], s21 offen offset:1024 lds
  s_add_u32 s21, s21, s23
  s_add_u32 m0, s27, 32768
  s_nop 0
  buffer_load_dwordx4 v21, s[12:15], s21 offen offset:0 lds
  buffer_load_dwordx4 v22, s[12:15], s21 offen offset:1024 lds
  s_add_u32 s21, s21, s23
  s_add_u32 m0, s27, 49152
  s_nop 0
  buffer_load_dwordx4 v21, s[12:15], s21 offen offset:0 lds
  buffer_load_dwordx4 v22, s[12:15], s21 offen offset:1024 lds
  s_add_u32 s21, s21, s23
  s_add_u32 m0, s27, 65536
  s_nop 0
  buffer_load_dwordx4 v21, s[12:15], s21 offen offset:0 lds
  buffer_load_dwordx4 v22, s[12:15], s21 offen offset:1024 lds
  s_add_u32 s21, s21, s23
  s_add_u32 m0, s27, 81920
  s_nop 0
  buffer_load_dwordx4 v21, s[12:15], s21 offen offset:0 lds
  buffer_load_dwordx4 v22, s[12:15], s21 offen offset:1024 lds
  s_add_u32 s21, s21, s23
  s_add_u32 m0, s27, 98304
  s_nop 0
  buffer_load_dwordx4 v21, s[12:15], s21 offen offset:0 lds
  buffer_load_dwordx4 v22, s[12:15], s21 offen offset:1024 lds
  s_add_u32 s21, s21, s23
  s_add_u32 m0, s27, 114688
  s_nop 0
  buffer_load_dwordx4 v21, s[12:15], s21 offen offset:0 lds
  buffer_load_dwordx4 v22, s[12:15], s21 offen offset:1024 lds
  s_add_u32 s21, s21, s23
  s_and_b32 s5, s76, 9
  s_cmp_eq_u32 s5, 9
  s_cbranch_scc1 mk_t_53
  v_accvgpr_write_b32 a0, 0
  v_accvgpr_write_b32 a1, 0
  v_accvgpr_write_b32 a2, 0
  v_accvgpr_write_b32 a3, 0
  v_accvgpr_write_b32 a4, 0
  v_accvgpr_write_b32 a5, 0
  v_accvgpr_write_b32 a6, 0
  v_accvgpr_write_b32 a7, 0
  v_accvgpr_write_b32 a8, 0
  v_accvgpr_write_b32 a9, 0
  v_accvgpr_write_b32 a10, 0
  v_accvgpr_write_b32 a11, 0
  v_accvgpr_write_b32 a12, 0
  v_accvgpr_write_b32 a13, 0
  v_accvgpr_write_b32 a14, 0
  v_accvgpr_write_b32 a15, 0
  v_accvgpr_write_b32 a16, 0
  v_accvgpr_write_b32 a17, 0
  v_accvgpr_write_b32 a18, 0
  v_accvgpr_write_b32 a19, 0
  v_accvgpr_write_b32 a20, 0
  v_accvgpr_write_b32 a21, 0
  v_accvgpr_write_b32 a22, 0
  v_accvgpr_write_b32 a23, 0
  v_accvgpr_write_b32 a24, 0
  v_accvgpr_write_b32 a25, 0
  v_accvgpr_write_b32 a26, 0
  v_accvgpr_write_b32 a27, 0
  v_accvgpr_write_b32 a28, 0
  v_accvgpr_write_b32 a29, 0
  v_accvgpr_write_b32 a30, 0
  v_accvgpr_write_b32 a31, 0
  v_accvgpr_write_b32 a32, 0
  v_accvgpr_write_b32 a33, 0
  v_accvgpr_write_b32 a34, 0
  v_accvgpr_write_b32 a35, 0
  v_accvgpr_write_b32 a36, 0
  v_accvgpr_write_b32 a37, 0
  v_accvgpr_write_b32 a38, 0
  v_accvgpr_write_b32 a39, 0
  v_accvgpr_write_b32 a40, 0
  v_accvgpr_write_b32 a41, 0
  v_accvgpr_write_b32 a42, 0
  v_accvgpr_write_b32 a43, 0
  v_accvgpr_write_b32 a44, 0
  v_accvgpr_write_b32 a45, 0
  v_accvgpr_write_b32 a46, 0
  v_accvgpr_write_b32 a47, 0
  v_accvgpr_write_b32 a48, 0
  v_accvgpr_write_b32 a49, 0
  v_accvgpr_write_b32 a50, 0
  v_accvgpr_write_b32 a51, 0
  v_accvgpr_write_b32 a52, 0
  v_accvgpr_write_b32 a53, 0
  v_accvgpr_write_b32 a54, 0
  v_accvgpr_write_b32 a55, 0
  v_accvgpr_write_b32 a56, 0
  v_accvgpr_write_b32 a57, 0
  v_accvgpr_write_b32 a58, 0
  v_accvgpr_write_b32 a59, 0
  v_accvgpr_write_b32 a60, 0
  v_accvgpr_write_b32 a61, 0
  v_accvgpr_write_b32 a62, 0
  v_accvgpr_write_b32 a63, 0
mk_t_53:
  s_and_b32 s5, s83, 0xff
  s_bfe_u32 s6, s83, 0x80008
  s_lshr_b32 s7, s83, 16
  v_and_b32 v36, 15, v1
  v_lshlrev_b32 v36, 1, v36
  v_subrev_u32 v36, s5, v36
  v_cmp_gt_u32 s[24:25], s6, v36
  v_cmp_gt_u32 vcc, s7, v1
  v_lshlrev_b32 v36, 3, v1
  v_mov_b32 v37, 2147483648
  s_and_b64 vcc, vcc, s[24:25]
  v_cndmask_b32 v36, v37, v36, vcc
mk_d_54:
  buffer_load_dwordx2 v[38:39], v36, s[8:11], s82 offen sc1
  s_waitcnt vmcnt(0)
  v_max_u32 v38, v38, v39
  v_cmp_eq_u32 vcc, -1, v38
  s_cbranch_vccz mk_d_55
  s_sub_u32 s98, s98, 1
  s_cbranch_scc1 mk_end
  s_sleep 3
  s_branch mk_d_54
mk_d_55:
  s_add_u32 m0, s26, 0
  s_nop 0
  buffer_load_dwordx4 v20, s[92:95], s20 offen offset:0 lds
  buffer_load_dwordx4 v20, s[92:95], s20 offen offset:1024 lds
  s_add_u32 s20, s20, 131072
  s_add_u32 m0, s26, 16384
  s_nop 0
  buffer_load_dwordx4 v20, s[92:95], s20 offen offset:0 lds
  buffer_load_dwordx4 v20, s[92:95], s20 offen offset:1024 lds
  s_add_u32 s20, s20, 131072
  s_add_u32 m0, s26, 32768
  s_nop 0
  buffer_load_dwordx4 v20, s[92:95], s20 offen offset:0 lds
  buffer_load_dwordx4 v20, s[92:95], s20 offen offset:1024 lds
  s_add_u32 s20, s20, 131072
  s_add_u32 m0, s26, 49152
  s_nop 0
  buffer_load_dwordx4 v20, s[92:95], s20 offen offset:0 lds
  buffer_load_dwordx4 v20, s[92:95], s20 offen offset:1024 lds
  s_add_u32 s20, s20, 131072
  s_add_u32 m0, s26, 65536
  s_nop 0
  buffer_load_dwordx4 v20, s[92:95], s20 offen offset:0 lds
  buffer_load_dwordx4 v20, s[92:95], s20 offen offset:1024 lds
  s_add_u32 s20, s20, 131072
  s_add_u32 m0, s26, 81920
  s_nop 0
  buffer_load_dwordx4 v20, s[92:95], s20 offen offset:0 lds
  buffer_load_dwordx4 v20, s[92:95], s20 offen offset:1024 lds
  s_add_u32 s20, s20, 131072
  s_add_u32 m0, s26, 98304
  s_nop 0
  buffer_load_dwordx4 v20, s[92:95], s20 offen offset:0 lds
  buffer_load_dwordx4 v20, s[92:95], s20 offen offset:1024 lds
  s_add_u32 s20, s20, 131072
  s_add_u32 m0, s26, 114688
  s_nop 0
  buffer_load_dwordx4 v20, s[92:95], s20 offen offset:0 lds
  buffer_load_dwordx4 v20, s[92:95], s20 offen offset:1024 lds
  s_add_u32 s20, s20, 131072
  s_waitcnt vmcnt(0)
  s_barrier
  ds_read_b64_tr_b16 v[56:57], v4 offset:0
  ds_read_b64_tr_b16 v[58:59], v4 offset:1024
  ds_read_b128 v[48:51], v2 offset:0
  ds_read_b64_tr_b16 v[72:73], v8 offset:0
  ds_read_b64_tr_b16 v[74:75], v8 offset:1024
  ds_read_b128 v[64:67], v2 offset:1024
  ds_read_b64_tr_b16 v[60:61], v5 offset:0
  ds_read_b64_tr_b16 v[62:63], v5 offset:1024
  ds_read_b128 v[52:55], v2 offset:2048
  ds_read_b64_tr_b16 v[76:77], v9 offset:0
  ds_read_b64_tr_b16 v[78:79], v9 offset:1024
  ds_read_b128 v[68:71], v2 offset:3072
.p2align 6
mk_gs_loop2:
  s_cmp_eq_u32 s22, 1
  s_cbranch_scc0 mk_h_56
  s_mov_b32 s94, 0
  s_mov_b32 s14, 0
mk_h_56:
  s_waitcnt vmcnt(24) lgkmcnt(0)
  s_barrier
  v_mfma_f32_16x16x32_bf16 a[0:3], v[56:59], v[48:51], a[0:3]
  ds_read_b64_tr_b16 v[88:89], v4 offset:16384
  ds_read_b64_tr_b16 v[90:91], v4 offset:17408
  v_mfma_f32_16x16x32_bf16 a[8:11], v[56:59], v[64:67], a[8:11]
  ds_read_b128 v[80:83], v2 offset:16384
  v_mfma_f32_16x16x32_bf16 a[16:19], v[56:59], v[52:55], a[16:19]
  s_add_u32 m0, s26, 0
  s_nop 0
  buffer_load_dwordx4 v20, s[92:95], s20 offen offset:0 lds
  ds_read_b64_tr_b16 v[104:105], v8 offset:16384
  v_mfma_f32_16x16x32_bf16 a[24:27], v[56:59], v[68:71], a[24:27]
  ds_read_b64_tr_b16 v[106:107], v8 offset:17408
  v_mfma_f32_16x16x32_bf16 a[4:7], v[72:75], v[48:51], a[4:7]
  ds_read_b128 v[96:99], v2 offset:17408
  buffer_load_dwordx4 v20, s[92:95], s20 offen offset:1024 lds
  s_add_u32 s20, s20, 131072
  v_mfma_f32_16x16x32_bf16 a[12:15], v[72:75], v[64:67], a[12:15]
  ds_read_b64_tr_b16 v[92:93], v5 offset:16384
  v_mfma_f32_16x16x32_bf16 a[20:23], v[72:75], v[52:55], a[20:23]
  ds_read_b64_tr_b16 v[94:95], v5 offset:17408
  ds_read_b128 v[84:87], v2 offset:18432
  v_mfma_f32_16x16x32_bf16 a[28:31], v[72:75], v[68:71], a[28:31]
  s_add_u32 m0, s27, 0
  s_nop 0
  buffer_load_dwordx4 v21, s[12:15], s21 offen offset:0 lds
  v_mfma_f32_16x16x32_bf16 a[32:35], v[60:63], v[48:51], a[32:35]
  ds_read_b64_tr_b16 v[108:109], v9 offset:16384
  ds_read_b64_tr_b16 v[110:111], v9 offset:17408
  v_mfma_f32_16x16x32_bf16 a[40:43], v[60:63], v[64:67], a[40:43]
  ds_read_b128 v[100:103], v2 offset:19456
  v_mfma_f32_16x16x32_bf16 a[48:51], v[60:63], v[52:55], a[48:51]
  buffer_load_dwordx4 v22, s[12:15], s21 offen offset:1024 lds
  s_add_u32 s21, s21, s23
  v_mfma_f32_16x16x32_bf16 a[56:59], v[60:63], v[68:71], a[56:59]
  v_mfma_f32_16x16x32_bf16 a[36:39], v[76:79], v[48:51], a[36:39]
  v_mfma_f32_16x16x32_bf16 a[44:47], v[76:79], v[64:67], a[44:47]
  v_mfma_f32_16x16x32_bf16 a[52:55], v[76:79], v[52:55], a[52:55]
  v_mfma_f32_16x16x32_bf16 a[60:63], v[76:79], v[68:71], a[60:63]
  s_waitcnt vmcnt(24) lgkmcnt(0)
  s_barrier
  v_mfma_f32_16x16x32_bf16 a[0:3], v[88:91], v[80:83], a[0:3]
  ds_read_b64_tr_b16 v[56:57], v4 offset:32768
  ds_read_b64_tr_b16 v[58:59], v4 offset:33792
  v_mfma_f32_16x16x32_bf16 a[8:11], v[88:91], v[96:99], a[8:11]
  ds_read_b128 v[48:51], v2 offset:32768
  v_mfma_f32_16x16x32_bf16 a[16:19], v[88:91], v[84:87], a[16:19]
  s_add_u32 m0, s26, 16384
  s_nop 0
  buffer_load_dwordx4 v20, s[92:95], s20 offen offset:0 lds
  ds_read_b64_tr_b16 v[72:73], v8 offset:32768
  v_mfma_f32_16x16x32_bf16 a[24:27], v[88:91], v[100:103], a[24:27]
  ds_read_b64_tr_b16 v[74:75], v8 offset:33792
  v_mfma_f32_16x16x32_bf16 a[4:7], v[104:107], v[80:83], a[4:7]
  ds_read_b128 v[64:67], v2 offset:33792
  buffer_load_dwordx4 v20, s[92:95], s20 offen offset:1024 lds
  s_add_u32 s20, s20, 131072
  v_mfma_f32_16x16x32_bf16 a[12:15], v[104:107], v[96:99], a[12:15]
  ds_read_b64_tr_b16 v[60:61], v5 offset:32768
  v_mfma_f32_16x16x32_bf16 a[20:23], v[104:107], v[84:87], a[20:23]
  ds_read_b64_tr_b16 v[62:63], v5 offset:33792
  ds_read_b128 v[52:55], v2 offset:34816
  v_mfma_f32_16x16x32_bf16 a[28:31], v[104:107], v[100:103], a[28:31]
  s_add_u32 m0, s27, 16384
  s_nop 0
  buffer_load_dwordx4 v21, s[12:15], s21 offen offset:0 lds
  v_mfma_f32_16x16x32_bf16 a[32:35], v[92:95], v[80:83], a[32:35]
  ds_read_b64_tr_b16 v[76:77], v9 offset:32768
  ds_read_b64_tr_b16 v[78:79], v9 offset:33792
  v_mfma_f32_16x16x32_bf16 a[40:43], v[92:95], v[96:99], a[40:43]
  ds_read_b128 v[68:71], v2 offset:35840
  v_mfma_f32_16x16x32_bf16 a[48:51], v[92:95], v[84:87], a[48:51]
  buffer_load_dwordx4 v22, s[12:15], s21 offen offset:1024 lds
  s_add_u32 s21, s21, s23
  v_mfma_f32_16x16x32_bf16 a[56:59], v[92:95], v[100:103], a[56:59]
  v_mfma_f32_16x16x32_bf16 a[36:39], v[108:111], v[80:83], a[36:39]
  v_mfma_f32_16x16x32_bf16 a[44:47], v[108:111], v[96:99], a[44:47]
  v_mfma_f32_16x16x32_bf16 a[52:55], v[108:111], v[84:87], a[52:55]
  v_mfma_f32_16x16x32_bf16 a[60:63], v[108:111], v[100:103], a[60:63]
  s_waitcnt vmcnt(24) lgkmcnt(0)
  s_barrier
  v_mfma_f32_16x16x32_bf16 a[0:3], v[56:59], v[48:51], a[0:3]
  ds_read_b64_tr_b16 v[88:89], v4 offset:49152
  ds_read_b64_tr_b16 v[90:91], v4 offset:50176
  v_mfma_f32_16x16x32_bf16 a[8:11], v[56:59], v[64:67], a[8:11]
  ds_read_b128 v[80:83], v2 offset:49152
  v_mfma_f32_16x16x32_bf16 a[16:19], v[56:59], v[52:55], a[16:19]
  s_add_u32 m0, s26, 32768
  s_nop 0
  buffer_load_dwordx4 v20, s[92:95], s20 offen offset:0 lds
  ds_read_b64_tr_b16 v[104:105], v8 offset:49152
  v_mfma_f32_16x16x32_bf16 a[24:27], v[56:59], v[68:71], a[24:27]
  ds_read_b64_tr_b16 v[106:107], v8 offset:50176
  v_mfma_f32_16x16x32_bf16 a[4:7], v[72:75], v[48:51], a[4:7]
  ds_read_b128 v[96:99], v2 offset:50176
  buffer_load_dwordx4 v20, s[92:95], s20 offen offset:1024 lds
  s_add_u32 s20, s20, 131072
  v_mfma_f32_16x16x32_bf16 a[12:15], v[72:75], v[64:67], a[12:15]
  ds_read_b64_tr_b16 v[92:93], v5 offset:49152
  v_mfma_f32_16x16x32_bf16 a[20:23], v[72:75], v[52:55], a[20:23]
  ds_read_b64_tr_b16 v[94:95], v5 offset:50176
  ds_read_b128 v[84:87], v2 offset:51200
  v_mfma_f32_16x16x32_bf16 a[28:31], v[72:75], v[68:71], a[28:31]
  s_add_u32 m0, s27, 32768
  s_nop 0
  buffer_load_dwordx4 v21, s[12:15], s21 offen offset:0 lds
  v_mfma_f32_16x16x32_bf16 a[32:35], v[60:63], v[48:51], a[32:35]
  ds_read_b64_tr_b16 v[108:109], v9 offset:49152
  ds_read_b64_tr_b16 v[110:111], v9 offset:50176
  v_mfma_f32_16x16x32_bf16 a[40:43], v[60:63], v[64:67], a[40:43]
  ds_read_b128 v[100:103], v2 offset:52224
  v_mfma_f32_16x16x32_bf16 a[48:51], v[60:63], v[52:55], a[48:51]
  buffer_load_dwordx4 v22, s[12:15], s21 offen offset:1024 lds
  s_add_u32 s21, s21, s23
  v_mfma_f32_16x16x32_bf16 a[56:59], v[60:63], v[68:71], a[56:59]
  v_mfma_f32_16x16x32_bf16 a[36:39], v[76:79], v[48:51], a[36:39]
  v_mfma_f32_16x16x32_bf16 a[44:47], v[76:79], v[64:67], a[44:47]
  v_mfma_f32_16x16x32_bf16 a[52:55], v[76:79], v[52:55], a[52:55]
  v_mfma_f32_16x16x32_bf16 a[60:63], v[76:79], v[68:71], a[60:63]
  s_waitcnt vmcnt(24) lgkmcnt(0)
  s_barrier
  v_mfma_f32_16x16x32_bf16 a[0:3], v[88:91], v[80:83], a[0:3]
  ds_read_b64_tr_b16 v[56:57], v12 offset:0
  ds_read_b64_tr_b16 v[58:59], v12 offset:1024
  v_mfma_f32_16x16x32_bf16 a[8:11], v[88:91], v[96:99], a[8:11]
  ds_read_b128 v[48:51], v3 offset:0
  v_mfma_f32_16x16x32_bf16 a[16:19], v[88:91], v[84:87], a[16:19]
  s_add_u32 m0, s26, 49152
  s_nop 0
  buffer_load_dwordx4 v20, s[92:95], s20 offen offset:0 lds
  ds_read_b64_tr_b16 v[72:73], v16 offset:0
  v_mfma_f32_16x16x32_bf16 a[24:27], v[88:91], v[100:103], a[24:27]
  ds_read_b64_tr_b16 v[74:75], v16 offset:1024
  v_mfma_f32_16x16x32_bf16 a[4:7], v[104:107], v[80:83], a[4:7]
  ds_read_b128 v[64:67], v3 offset:1024
  buffer_load_dwordx4 v20, s[92:95], s20 offen offset:1024 lds
  s_add_u32 s20, s20, 131072
  v_mfma_f32_16x16x32_bf16 a[12:15], v[104:107], v[96:99], a[12:15]
  ds_read_b64_tr_b16 v[60:61], v13 offset:0
  v_mfma_f32_16x16x32_bf16 a[20:23], v[104:107], v[84:87], a[20:23]
  ds_read_b64_tr_b16 v[62:63], v13 offset:1024
  ds_read_b128 v[52:55], v3 offset:2048
  v_mfma_f32_16x16x32_bf16 a[28:31], v[104:107], v[100:103], a[28:31]
  s_add_u32 m0, s27, 49152
  s_nop 0
  buffer_load_dwordx4 v21, s[12:15], s21 offen offset:0 lds
  v_mfma_f32_16x16x32_bf16 a[32:35], v[92:95], v[80:83], a[32:35]
  ds_read_b64_tr_b16 v[76:77], v17 offset:0
  ds_read_b64_tr_b16 v[78:79], v17 offset:1024
  v_mfma_f32_16x16x32_bf16 a[40:43], v[92:95], v[96:99], a[40:43]
  ds_read_b128 v[68:71], v3 offset:3072
  v_mfma_f32_16x16x32_bf16 a[48:51], v[92:95], v[84:87], a[48:51]
  buffer_load_dwordx4 v22, s[12:15], s21 offen offset:1024 lds
  s_add_u32 s21, s21, s23
  v_mfma_f32_16x16x32_bf16 a[56:59], v[92:95], v[100:103], a[56:59]
  v_mfma_f32_16x16x32_bf16 a[36:39], v[108:111], v[80:83], a[36:39]
  v_mfma_f32_16x16x32_bf16 a[44:47], v[108:111], v[96:99], a[44:47]
  v_mfma_f32_16x16x32_bf16 a[52:55], v[108:111], v[84:87], a[52:55]
  v_mfma_f32_16x16x32_bf16 a[60:63], v[108:111], v[100:103], a[60:63]
  s_waitcnt vmcnt(24) lgkmcnt(0)
  s_barrier
  v_mfma_f32_16x16x32_bf16 a[0:3], v[56:59], v[48:51], a[0:3]
  ds_read_b64_tr_b16 v[88:89], v12 offset:16384
  ds_read_b64_tr_b16 v[90:91], v12 offset:17408
  v_mfma_f32_16x16x32_bf16 a[8:11], v[56:59], v[64:67], a[8:11]
  ds_read_b128 v[80:83], v3 offset:16384
  v_mfma_f32_16x16x32_bf16 a[16:19], v[56:59], v[52:55], a[16:19]
  s_add_u32 m0, s26, 65536
  s_nop 0
  buffer_load_dwordx4 v20, s[92:95], s20 offen offset:0 lds
  ds_read_b64_tr_b16 v[104:105], v16 offset:16384
  v_mfma_f32_16x16x32_bf16 a[24:27], v[56:59], v[68:71], a[24:27]
  ds_read_b64_tr_b16 v[106:107], v16 offset:17408
  v_mfma_f32_16x16x32_bf16 a[4:7], v[72:75], v[48:51], a[4:7]
  ds_read_b128 v[96:99], v3 offset:17408
  buffer_load_dwordx4 v20, s[92:95], s20 offen offset:1024 lds
  s_add_u32 s20, s20, 131072
  v_mfma_f32_16x16x32_bf16 a[12:15], v[72:75], v[64:67], a[12:15]
  ds_read_b64_tr_b16 v[92:93], v13 offset:16384
  v_mfma_f32_16x16x32_bf16 a[20:23], v[72:75], v[52:55], a[20:23]
  ds_read_b64_tr_b16 v[94:95], v13 offset:17408
  ds_read_b128 v[84:87], v3 offset:18432
  v_mfma_f32_16x16x32_bf16 a[28:31], v[72:75], v[68:71], a[28:31]
  s_add_u32 m0, s27, 65536
  s_nop 0
  buffer_load_dwordx4 v21, s[12:15], s21 offen offset:0 lds
  v_mfma_f32_16x16x32_bf16 a[32:35], v[60:63], v[48:51], a[32:35]
  ds_read_b64_tr_b16 v[108:109], v17 offset:16384
  ds_read_b64_tr_b16 v[110:111], v17 offset:17408
  v_mfma_f32_16x16x32_bf16 a[40:43], v[60:63], v[64:67], a[40:43]
  ds_read_b128 v[100:103], v3 offset:19456
  v_mfma_f32_16x16x32_bf16 a[48:51], v[60:63], v[52:55], a[48:51]
  buffer_load_dwordx4 v22, s[12:15], s21 offen offset:1024 lds
  s_add_u32 s21, s21, s23
  v_mfma_f32_16x16x32_bf16 a[56:59], v[60:63], v[68:71], a[56:59]
  v_mfma_f32_16x16x32_bf16 a[36:39], v[76:79], v[48:51], a[36:39]
  v_mfma_f32_16x16x32_bf16 a[44:47], v[76:79], v[64:67], a[44:47]
  v_mfma_f32_16x16x32_bf16 a[52:55], v[76:79], v[52:55], a[52:55]
  v_mfma_f32_16x16x32_bf16 a[60:63], v[76:79], v[68:71], a[60:63]
  s_waitcnt vmcnt(24) lgkmcnt(0)
  s_barrier
  v_mfma_f32_16x16x32_bf16 a[0:3], v[88:91], v[80:83], a[0:3]
  ds_read_b64_tr_b16 v[56:57], v12 offset:32768
  ds_read_b64_tr_b16 v[58:59], v12 offset:33792
  v_mfma_f32_16x16x32_bf16 a[8:11], v[88:91], v[96:99], a[8:11]
  ds_read_b128 v[48:51], v3 offset:32768
  v_mfma_f32_16x16x32_bf16 a[16:19], v[88:91], v[84:87], a[16:19]
  s_add_u32 m0, s26, 81920
  s_nop 0
  buffer_load_dwordx4 v20, s[92:95], s20 offen offset:0 lds
  ds_read_b64_tr_b16 v[72:73], v16 offset:32768
  v_mfma_f32_16x16x32_bf16 a[24:27], v[88:91], v[100:103], a[24:27]
  ds_read_b64_tr_b16 v[74:75], v16 offset:33792
  v_mfma_f32_16x16x32_bf16 a[4:7], v[104:107], v[80:83], a[4:7]
  ds_read_b128 v[64:67], v3 offset:33792
  buffer_load_dwordx4 v20, s[92:95], s20 offen offset:1024 lds
  s_add_u32 s20, s20, 131072
  v_mfma_f32_16x16x32_bf16 a[12:15], v[104:107], v[96:99], a[12:15]
  ds_read_b64_tr_b16 v[60:61], v13 offset:32768
  v_mfma_f32_16x16x32_bf16 a[20:23], v[104:107], v[84:87], a[20:23]
  ds_read_b64_tr_b16 v[62:63], v13 offset:33792
  ds_read_b128 v[52:55], v3 offset:34816
  v_mfma_f32_16x16x32_bf16 a[28:31], v[104:107], v[100:103], a[28:31]
  s_add_u32 m0, s27, 81920
  s_nop 0
  buffer_load_dwordx4 v21, s[12:15], s21 offen offset:0 lds
  v_mfma_f32_16x16x32_bf16 a[32:35], v[92:95], v[80:83], a[32:35]
  ds_read_b64_tr_b16 v[76:77], v17 offset:32768
  ds_read_b64_tr_b16 v[78:79], v17 offset:33792
  v_mfma_f32_16x16x32_bf16 a[40:43], v[92:95], v[96:99], a[40:43]
  ds_read_b128 v[68:71], v3 offset:35840
  v_mfma_f32_16x16x32_bf16 a[48:51], v[92:95], v[84:87], a[48:51]
  buffer_load_dwordx4 v22, s[12:15], s21 offen offset:1024 lds
  s_add_u32 s21, s21, s23
  v_mfma_f32_16x16x32_bf16 a[56:59], v[92:95], v[100:103], a[56:59]
  v_mfma_f32_16x16x32_bf16 a[36:39], v[108:111], v[80:83], a[36:39]
  v_mfma_f32_16x16x32_bf16 a[44:47], v[108:111], v[96:99], a[44:47]
  v_mfma_f32_16x16x32_bf16 a[52:55], v[108:111], v[84:87], a[52:55]
  v_mfma_f32_16x16x32_bf16 a[60:63], v[108:111], v[100:103], a[60:63]
  s_waitcnt vmcnt(24) lgkmcnt(0)
  s_barrier
  v_mfma_f32_16x16x32_bf16 a[0:3], v[56:59], v[48:51], a[0:3]
  ds_read_b64_tr_b16 v[88:89], v12 offset:49152
  ds_read_b64_tr_b16 v[90:91], v12 offset:50176
  v_mfma_f32_16x16x32_bf16 a[8:11], v[56:59], v[64:67], a[8:11]
  ds_read_b128 v[80:83], v3 offset:49152
  v_mfma_f32_16x16x32_bf16 a[16:19], v[56:59], v[52:55], a[16:19]
  s_add_u32 m0, s26, 98304
  s_nop 0
  buffer_load_dwordx4 v20, s[92:95], s20 offen offset:0 lds
  ds_read_b64_tr_b16 v[104:105], v16 offset:49152
  v_mfma_f32_16x16x32_bf16 a[24:27], v[56:59], v[68:71], a[24:27]
  ds_read_b64_tr_b16 v[106:107], v16 offset:50176
  v_mfma_f32_16x16x32_bf16 a[4:7], v[72:75], v[48:51], a[4:7]
  ds_read_b128 v[96:99], v3 offset:50176
  buffer_load_dwordx4 v20, s[92:95], s20 offen offset:1024 lds
  s_add_u32 s20, s20, 131072
  v_mfma_f32_16x16x32_bf16 a[12:15], v[72:75], v[64:67], a[12:15]
  ds_read_b64_tr_b16 v[92:93], v13 offset:49152
  v_mfma_f32_16x16x32_bf16 a[20:23], v[72:75], v[52:55], a[20:23]
  ds_read_b64_tr_b16 v[94:95], v13 offset:50176
  ds_read_b128 v[84:87], v3 offset:51200
  v_mfma_f32_16x16x32_bf16 a[28:31], v[72:75], v[68:71], a[28:31]
  s_add_u32 m0, s27, 98304
  s_nop 0
  buffer_load_dwordx4 v21, s[12:15], s21 offen offset:0 lds
  v_mfma_f32_16x16x32_bf16 a[32:35], v[60:63], v[48:51], a[32:35]
  ds_read_b64_tr_b16 v[108:109], v17 offset:49152
  ds_read_b64_tr_b16 v[110:111], v17 offset:50176
  v_mfma_f32_16x16x32_bf16 a[40:43], v[60:63], v[64:67], a[40:43]
  ds_read_b128 v[100:103], v3 offset:52224
  v_mfma_f32_16x16x32_bf16 a[48:51], v[60:63], v[52:55], a[48:51]
  buffer_load_dwordx4 v22, s[12:15], s21 offen offset:1024 lds
  s_add_u32 s21, s21, s23
  v_mfma_f32_16x16x32_bf16 a[56:59], v[60:63], v[68:71], a[56:59]
  v_mfma_f32_16x16x32_bf16 a[36:39], v[76:79], v[48:51], a[36:39]
  v_mfma_f32_16x16x32_bf16 a[44:47], v[76:79], v[64:67], a[44:47]
  v_mfma_f32_16x16x32_bf16 a[52:55], v[76:79], v[52:55], a[52:55]
  v_mfma_f32_16x16x32_bf16 a[60:63], v[76:79], v[68:71], a[60:63]
  s_waitcnt vmcnt(24) lgkmcnt(0)
  s_barrier
  v_mfma_f32_16x16x32_bf16 a[0:3], v[88:91], v[80:83], a[0:3]
  ds_read_b64_tr_b16 v[56:57], v4 offset:0
  ds_read_b64_tr_b16 v[58:59], v4 offset:1024
  v_mfma_f32_16x16x32_bf16 a[8:11], v[88:91], v[96:99], a[8:11]
  ds_read_b128 v[48:51], v2 offset:0
  v_mfma_f32_16x16x32_bf16 a[16:19], v[88:91], v[84:87], a[16:19]
  s_add_u32 m0, s26, 114688
  s_nop 0
  buffer_load_dwordx4 v20, s[92:95], s20 offen offset:0 lds
  ds_read_b64_tr_b16 v[72:73], v8 offset:0
  v_mfma_f32_16x16x32_bf16 a[24:27], v[88:91], v[100:103], a[24:27]
  ds_read_b64_tr_b16 v[74:75], v8 offset:1024
  v_mfma_f32_16x16x32_bf16 a[4:7], v[104:107], v[80:83], a[4:7]
  ds_read_b128 v[64:67], v2 offset:1024
  buffer_load_dwordx4 v20, s[92:95], s20 offen offset:1024 lds
  s_add_u32 s20, s20, 131072
  v_mfma_f32_16x16x32_bf16 a[12:15], v[104:107], v[96:99], a[12:15]
  ds_read_b64_tr_b16 v[60:61], v5 offset:0
  v_mfma_f32_16x16x32_bf16 a[20:23], v[104:107], v[84:87], a[20:23]
  ds_read_b64_tr_b16 v[62:63], v5 offset:1024
  ds_read_b128 v[52:55], v2 offset:2048
  v_mfma_f32_16x16x32_bf16 a[28:31], v[104:107], v[100:103], a[28:31]
  s_add_u32 m0, s27, 114688
  s_nop 0
  buffer_load_dwordx4 v21, s[12:15], s21 offen offset:0 lds
  v_mfma_f32_16x16x32_bf16 a[32:35], v[92:95], v[80:83], a[32:35]
  ds_read_b64_tr_b16 v[76:77], v9 offset:0
  ds_read_b64_tr_b16 v[78:79], v9 offset:1024
  v_mfma_f32_16x16x32_bf16 a[40:43], v[92:95], v[96:99], a[40:43]
  ds_read_b128 v[68:71], v2 offset:3072
  v_mfma_f32_16x16x32_bf16 a[48:51], v[92:95], v[84:87], a[48:51]
  buffer_load_dwordx4 v22, s[12:15], s21 offen offset:1024 lds
  s_add_u32 s21, s21, s23
  v_mfma_f32_16x16x32_bf16 a[56:59], v[92:95], v[100:103], a[56:59]
  v_mfma_f32_16x16x32_bf16 a[36:39], v[108:111], v[80:83], a[36:39]
  v_mfma_f32_16x16x32_bf16 a[44:47], v[108:111], v[96:99], a[44:47]
  v_mfma_f32_16x16x32_bf16 a[52:55], v[108:111], v[84:87], a[52:55]
  v_mfma_f32_16x16x32_bf16 a[60:63], v[108:111], v[100:103], a[60:63]
  s_sub_u32 s22, s22, 1
  s_cmp_lg_u32 s22, 0
  s_cbranch_scc1 mk_gs_loop2
  s_lshl_b32 s58, s79, 1
  s_add_u32 s58, s58, 117440512
  s_mov_b32 s47, s80
  s_mov_b32 s48, 2147483648
  s_bitcmp1_b32 s76, 2
  s_cbranch_scc1 mk_split
  s_bitcmp1_b32 s76, 3
  s_cbranch_scc1 mk_hold
  s_bitcmp1_b32 s76, 1
  s_cbranch_scc1 mk_fin
  s_waitcnt lgkmcnt(0)
  v_and_b32 v36, 15, v1
  v_lshl_add_u32 v36, v36, 11, v34
  s_mul_i32 s40, s32, 128
  s_mul_i32 s41, s33, 131072
  s_add_u32 s40, s40, s41
  v_add_u32 v36, s40, v36
  v_add_u32 v35, s79, v36
  v_lshlrev_b32 v36, 1, v36
  v_add_u32 v37, s58, v36
  s_mov_b32 s43, 0xffff0000
  s_mov_b32 s42, 0
  buffer_load_dwordx4 v[96:99], v35, s[72:75], s42 offen offset:0
  buffer_load_dwordx4 v[100:103], v35, s[72:75], s42 offen offset:64
  s_mov_b32 s42, 32768
  buffer_load_dwordx4 v[104:107], v35, s[72:75], s42 offen offset:0
  buffer_load_dwordx4 v[108:111], v35, s[72:75], s42 offen offset:64
  s_mov_b32 s42, 65536
  buffer_load_dwordx4 v[112:115], v35, s[72:75], s42 offen offset:0
  buffer_load_dwordx4 v[116:119], v35, s[72:75], s42 offen offset:64
  s_mov_b32 s42, 98304
  buffer_load_dwordx4 v[120:123], v35, s[72:75], s42 offen offset:0
  buffer_load_dwordx4 v[124:127], v35, s[72:75], s42 offen offset:64
  s_nop 7
  s_mov_b32 s42, 0
  v_accvgpr_read_b32 v48, a0
  v_accvgpr_read_b32 v49, a1
  v_accvgpr_read_b32 v50, a2
  v_accvgpr_read_b32 v51, a3
  v_accvgpr_read_b32 v52, a4
  v_accvgpr_read_b32 v53, a5
  v_accvgpr_read_b32 v54, a6
  v_accvgpr_read_b32 v55, a7
  s_nop 1
  v_permlane16_swap_b32 v48, v52
  v_permlane16_swap_b32 v49, v53
  v_permlane16_swap_b32 v50, v54
  v_permlane16_swap_b32 v51, v55
  s_waitcnt vmcnt(7)
  v_lshlrev_b32 v56, 16, v96
  v_and_b32 v57, s43, v96
  v_add_f32 v48, v48, v56
  v_add_f32 v49, v49, v57
  v_lshlrev_b32 v56, 16, v97
  v_and_b32 v57, s43, v97
  v_add_f32 v50, v50, v56
  v_add_f32 v51, v51, v57
  v_lshlrev_b32 v56, 16, v98
  v_and_b32 v57, s43, v98
  v_add_f32 v52, v52, v56
  v_add_f32 v53, v53, v57
  v_lshlrev_b32 v56, 16, v99
  v_and_b32 v57, s43, v99
  v_add_f32 v54, v54, v56
  v_add_f32 v55, v55, v57
  buffer_store_dwordx4 v[48:51], v37, s[8:11], s42 offen offset:0 sc1
  buffer_store_dwordx4 v[52:55], v37, s[8:11], s42 offen offset:16 sc1
  v_accvgpr_read_b32 v64, a32
  v_accvgpr_read_b32 v65, a33
  v_accvgpr_read_b32 v66, a34
  v_accvgpr_read_b32 v67, a35
  v_accvgpr_read_b32 v68, a36
  v_accvgpr_read_b32 v69, a37
  v_accvgpr_read_b32 v70, a38
  v_accvgpr_read_b32 v71, a39
  s_nop 1
  v_permlane16_swap_b32 v64, v68
  v_permlane16_swap_b32 v65, v69
  v_permlane16_swap_b32 v66, v70
  v_permlane16_swap_b32 v67, v71
  s_waitcnt vmcnt(8)
  v_lshlrev_b32 v72, 16, v100
  v_and_b32 v73, s43, v100
  v_add_f32 v64, v64, v72
  v_add_f32 v65, v65, v73
  v_lshlrev_b32 v72, 16, v101
  v_and_b32 v73, s43, v101
  v_add_f32 v66, v66, v72
  v_add_f32 v67, v67, v73
  v_lshlrev_b32 v72, 16, v102
  v_and_b32 v73, s43, v102
  v_add_f32 v68, v68, v72
  v_add_f32 v69, v69, v73
  v_lshlrev_b32 v72, 16, v103
  v_and_b32 v73, s43, v103
  v_add_f32 v70, v70, v72
  v_add_f32 v71, v71, v73
  buffer_store_dwordx4 v[64:67], v37, s[8:11], s42 offen offset:128 sc1
  buffer_store_dwordx4 v[68:71], v37, s[8:11], s42 offen offset:144 sc1
  s_mov_b32 s42, 65536
  v_accvgpr_read_b32 v48, a8
  v_accvgpr_read_b32 v49, a9
  v_accvgpr_read_b32 v50, a10
  v_accvgpr_read_b32 v51, a11
  v_accvgpr_read_b32 v52, a12
  v_accvgpr_read_b32 v53, a13
  v_accvgpr_read_b32 v54, a14
  v_accvgpr_read_b32 v55, a15
  s_nop 1
  v_permlane16_swap_b32 v48, v52
  v_permlane16_swap_b32 v49, v53
  v_permlane16_swap_b32 v50, v54
  v_permlane16_swap_b32 v51, v55
  s_waitcnt vmcnt(9)
  v_lshlrev_b32 v56, 16, v104
  v_and_b32 v57, s43, v104
  v_add_f32 v48, v48, v56
  v_add_f32 v49, v49, v57
  v_lshlrev_b32 v56, 16, v105
  v_and_b32 v57, s43, v105
  v_add_f32 v50, v50, v56
  v_add_f32 v51, v51, v57
  v_lshlrev_b32 v56, 16, v106
  v_and_b32 v57, s43, v106
  v_add_f32 v52, v52, v56
  v_add_f32 v53, v53, v57
  v_lshlrev_b32 v56, 16, v107
  v_and_b32 v57, s43, v107
  v_add_f32 v54, v54, v56
  v_add_f32 v55, v55, v57
  buffer_store_dwordx4 v[48:51], v37, s[8:11], s42 offen offset:0 sc1
  buffer_store_dwordx4 v[52:55], v37, s[8:11], s42 offen offset:16 sc1
  v_accvgpr_read_b32 v64, a40
  v_accvgpr_read_b32 v65, a41
  v_accvgpr_read_b32 v66, a42
  v_accvgpr_read_b32 v67, a43
  v_accvgpr_read_b32 v68, a44
  v_accvgpr_read_b32 v69, a45
  v_accvgpr_read_b32 v70, a46
  v_accvgpr_read_b32 v71, a47
  s_nop 1
  v_permlane16_swap_b32 v64, v68
  v_permlane16_swap_b32 v65, v69
  v_permlane16_swap_b32 v66, v70
  v_permlane16_swap_b32 v67, v71
  s_waitcnt vmcnt(10)
  v_lshlrev_b32 v72, 16, v108
  v_and_b32 v73, s43, v108
  v_add_f32 v64, v64, v72
  v_add_f32 v65, v65, v73
  v_lshlrev_b32 v72, 16, v109
  v_and_b32 v73, s43, v109
  v_add_f32 v66, v66, v72
  v_add_f32 v67, v67, v73
  v_lshlrev_b32 v72, 16, v110
  v_and_b32 v73, s43, v110
  v_add_f32 v68, v68, v72
  v_add_f32 v69, v69, v73
  v_lshlrev_b32 v72, 16, v111
  v_and_b32 v73, s43, v111
  v_add_f32 v70, v70, v72
  v_add_f32 v71, v71, v73
  buffer_store_dwordx4 v[64:67], v37, s[8:11], s42 offen offset:128 sc1
  buffer_store_dwordx4 v[68:71], v37, s[8:11], s42 offen offset:144 sc1
  s_mov_b32 s42, 131072
  v_accvgpr_read_b32 v48, a16
  v_accvgpr_read_b32 v49, a17
  v_accvgpr_read_b32 v50, a18
  v_accvgpr_read_b32 v51, a19
  v_accvgpr_read_b32 v52, a20
  v_accvgpr_read_b32 v53, a21
  v_accvgpr_read_b32 v54, a22
  v_accvgpr_read_b32 v55, a23
  s_nop 1
  v_permlane16_swap_b32 v48, v52
  v_permlane16_swap_b32 v49, v53
  v_permlane16_swap_b32 v50, v54
  v_permlane16_swap_b32 v51, v55
  s_waitcnt vmcnt(11)
  v_lshlrev_b32 v56, 16, v112
  v_and_b32 v57, s43, v112
  v_add_f32 v48, v48, v56
  v_add_f32 v49, v49, v57
  v_lshlrev_b32 v56, 16, v113
  v_and_b32 v57, s43, v113
  v_add_f32 v50, v50, v56
  v_add_f32 v51, v51, v57
  v_lshlrev_b32 v56, 16, v114
  v_and_b32 v57, s43, v114
  v_add_f32 v52, v52, v56
  v_add_f32 v53, v53, v57
  v_lshlrev_b32 v56, 16, v115
  v_and_b32 v57, s43, v115
  v_add_f32 v54, v54, v56
  v_add_f32 v55, v55, v57
  buffer_store_dwordx4 v[48:51], v37, s[8:11], s42 offen offset:0 sc1
  buffer_store_dwordx4 v[52:55], v37, s[8:11], s42 offen offset:16 sc1
  v_accvgpr_read_b32 v64, a48
  v_accvgpr_read_b32 v65, a49
  v_accvgpr_read_b32 v66, a50
  v_accvgpr_read_b32 v67, a51
  v_accvgpr_read_b32 v68, a52
  v_accvgpr_read_b32 v69, a53
  v_accvgpr_read_b32 v70, a54
  v_accvgpr_read_b32 v71, a55
  s_nop 1
  v_permlane16_swap_b32 v64, v68
  v_permlane16_swap_b32 v65, v69
  v_permlane16_swap_b32 v66, v70
  v_permlane16_swap_b32 v67, v71
  s_waitcnt vmcnt(12)
  v_lshlrev_b32 v72, 16, v116
  v_and_b32 v73, s43, v116
  v_add_f32 v64, v64, v72
  v_add_f32 v65, v65, v73
  v_lshlrev_b32 v72, 16, v117
  v_and_b32 v73, s43, v117
  v_add_f32 v66, v66, v72
  v_add_f32 v67, v67, v73
  v_lshlrev_b32 v72, 16, v118
  v_and_b32 v73, s43, v118
  v_add_f32 v68, v68, v72
  v_add_f32 v69, v69, v73
  v_lshlrev_b32 v72, 16, v119
  v_and_b32 v73, s43, v119
  v_add_f32 v70, v70, v72
  v_add_f32 v71, v71, v73
  buffer_store_dwordx4 v[64:67], v37, s[8:11], s42 offen offset:128 sc1
  buffer_store_dwordx4 v[68:71], v37, s[8:11], s42 offen offset:144 sc1
  s_mov_b32 s42, 196608
  v_accvgpr_read_b32 v48, a24
  v_accvgpr_read_b32 v49, a25
  v_accvgpr_read_b32 v50, a26
  v_accvgpr_read_b32 v51, a27
  v_accvgpr_read_b32 v52, a28
  v_accvgpr_read_b32 v53, a29
  v_accvgpr_read_b32 v54, a30
  v_accvgpr_read_b32 v55, a31
  s_nop 1
  v_permlane16_swap_b32 v48, v52
  v_permlane16_swap_b32 v49, v53
  v_permlane16_swap_b32 v50, v54
  v_permlane16_swap_b32 v51, v55
  s_waitcnt vmcnt(13)
  v_lshlrev_b32 v56, 16, v120
  v_and_b32 v57, s43, v120
  v_add_f32 v48, v48, v56
  v_add_f32 v49, v49, v57
  v_lshlrev_b32 v56, 16, v121
  v_and_b32 v57, s43, v121
  v_add_f32 v50, v50, v56
  v_add_f32 v51, v51, v57
  v_lshlrev_b32 v56, 16, v122
  v_and_b32 v57, s43, v122
  v_add_f32 v52, v52, v56
  v_add_f32 v53, v53, v57
  v_lshlrev_b32 v56, 16, v123
  v_and_b32 v57, s43, v123
  v_add_f32 v54, v54, v56
  v_add_f32 v55, v55, v57
  buffer_store_dwordx4 v[48:51], v37, s[8:11], s42 offen offset:0 sc1
  buffer_store_dwordx4 v[52:55], v37, s[8:11], s42 offen offset:16 sc1
  v_accvgpr_read_b32 v64, a56
  v_accvgpr_read_b32 v65, a57
  v_accvgpr_read_b32 v66, a58
  v_accvgpr_read_b32 v67, a59
  v_accvgpr_read_b32 v68, a60
  v_accvgpr_read_b32 v69, a61
  v_accvgpr_read_b32 v70, a62
  v_accvgpr_read_b32 v71, a63
  s_nop 1
  v_permlane16_swap_b32 v64, v68
  v_permlane16_swap_b32 v65, v69
  v_permlane16_swap_b32 v66, v70
  v_permlane16_swap_b32 v67, v71
  s_waitcnt vmcnt(14)
  v_lshlrev_b32 v72, 16, v124
  v_and_b32 v73, s43, v124
  v_add_f32 v64, v64, v72
  v_add_f32 v65, v65, v73
  v_lshlrev_b32 v72, 16, v125
  v_and_b32 v73, s43, v125
  v_add_f32 v66, v66, v72
  v_add_f32 v67, v67, v73
  v_lshlrev_b32 v72, 16, v126
  v_and_b32 v73, s43, v126
  v_add_f32 v68, v68, v72
  v_add_f32 v69, v69, v73
  v_lshlrev_b32 v72, 16, v127
  v_and_b32 v73, s43, v127
  v_add_f32 v70, v70, v72
  v_add_f32 v71, v71, v73
  buffer_store_dwordx4 v[64:67], v37, s[8:11], s42 offen offset:128 sc1
  buffer_store_dwordx4 v[68:71], v37, s[8:11], s42 offen offset:144 sc1
  s_waitcnt vmcnt(0)
  s_barrier
  buffer_store_dword v251, v250, s[8:11], s47 offen sc1
  buffer_store_dword v251, v250, s[8:11], s48 offen sc1
  s_branch mk_adv
mk_fin:
  v_mov_b32 v36, 0
mk_e_57:
  buffer_load_dword v38, v36, s[8:11], s81 offen sc1
  s_waitcnt vmcnt(0)
  v_cmp_eq_u32 vcc, -1, v38
  s_cbranch_vccz mk_e_58
  s_sub_u32 s98, s98, 1
  s_cbranch_scc1 mk_end
  s_sleep 3
  s_branch mk_e_57
mk_e_58:
  s_waitcnt lgkmcnt(0)
  v_and_b32 v36, 15, v1
  v_lshl_add_u32 v36, v36, 11, v34
  s_mul_i32 s40, s32, 128
  s_mul_i32 s41, s33, 131072
  s_add_u32 s40, s40, s41
  v_add_u32 v36, s40, v36
  v_add_u32 v35, s79, v36
  v_lshlrev_b32 v36, 1, v36
  v_add_u32 v37, s58, v36
  s_mov_b32 s42, 0
  buffer_load_dwordx4 v[96:99], v37, s[8:11], s42 offen offset:0 sc1
  buffer_load_dwordx4 v[100:103], v37, s[8:11], s42 offen offset:16 sc1
  buffer_load_dwordx4 v[104:107], v37, s[8:11], s42 offen offset:128 sc1
  buffer_load_dwordx4 v[108:111], v37, s[8:11], s42 offen offset:144 sc1
  s_mov_b32 s42, 65536
  buffer_load_dwordx4 v[112:115], v37, s[8:11], s42 offen offset:0 sc1
  buffer_load_dwordx4 v[116:119], v37, s[8:11], s42 offen offset:16 sc1
  buffer_load_dwordx4 v[120:123], v37, s[8:11], s42 offen offset:128 sc1
  buffer_load_dwordx4 v[124:127], v37, s[8:11], s42 offen offset:144 sc1
  s_mov_b32 s42, 131072
  buffer_load_dwordx4 v[128:131], v37, s[8:11], s42 offen offset:0 sc1
  buffer_load_dwordx4 v[132:135], v37, s[8:11], s42 offen offset:16 sc1
  buffer_load_dwordx4 v[136:139], v37, s[8:11], s42 offen offset:128 sc1
  buffer_load_dwordx4 v[140:143], v37, s[8:11], s42 offen offset:144 sc1
  s_mov_b32 s42, 196608
  buffer_load_dwordx4 v[144:147], v37, s[8:11], s42 offen offset:0 sc1
  buffer_load_dwordx4 v[148:151], v37, s[8:11], s42 offen offset:16 sc1
  buffer_load_dwordx4 v[152:155], v37, s[8:11], s42 offen offset:128 sc1
  buffer_load_dwordx4 v[156:159], v37, s[8:11], s42 offen offset:144 sc1
  s_nop 7
  s_mov_b32 s42, 0
  v_accvgpr_read_b32 v48, a0
  v_accvgpr_read_b32 v49, a1
  v_accvgpr_read_b32 v50, a2
  v_accvgpr_read_b32 v51, a3
  v_accvgpr_read_b32 v52, a4
  v_accvgpr_read_b32 v53, a5
  v_accvgpr_read_b32 v54, a6
  v_accvgpr_read_b32 v55, a7
  s_nop 1
  v_permlane16_swap_b32 v48, v52
  v_permlane16_swap_b32 v49, v53
  v_permlane16_swap_b32 v50, v54
  v_permlane16_swap_b32 v51, v55
  s_waitcnt vmcnt(14)
  v_add_f32 v48, v48, v96
  v_add_f32 v49, v49, v97
  v_add_f32 v50, v50, v98
  v_add_f32 v51, v51, v99
  v_add_f32 v52, v52, v100
  v_add_f32 v53, v53, v101
  v_add_f32 v54, v54, v102
  v_add_f32 v55, v55, v103
  v_cvt_pk_bf16_f32 v60, v48, v49
  v_cvt_pk_bf16_f32 v61, v50, v51
  v_cvt_pk_bf16_f32 v62, v52, v53
  v_cvt_pk_bf16_f32 v63, v54, v55
  buffer_store_dwordx4 v[60:63], v35, s[16:19], s42 offen offset:0
  v_accvgpr_read_b32 v64, a32
  v_accvgpr_read_b32 v65, a33
  v_accvgpr_read_b32 v66, a34
  v_accvgpr_read_b32 v67, a35
  v_accvgpr_read_b32 v68, a36
  v_accvgpr_read_b32 v69, a37
  v_accvgpr_read_b32 v70, a38
  v_accvgpr_read_b32 v71, a39
  s_nop 1
  v_permlane16_swap_b32 v64, v68
  v_permlane16_swap_b32 v65, v69
  v_permlane16_swap_b32 v66, v70
  v_permlane16_swap_b32 v67, v71
  s_waitcnt vmcnt(13)
  v_add_f32 v64, v64, v104
  v_add_f32 v65, v65, v105
  v_add_f32 v66, v66, v106
  v_add_f32 v67, v67, v107
  v_add_f32 v68, v68, v108
  v_add_f32 v69, v69, v109
  v_add_f32 v70, v70, v110
  v_add_f32 v71, v71, v111
  v_cvt_pk_bf16_f32 v76, v64, v65
  v_cvt_pk_bf16_f32 v77, v66, v67
  v_cvt_pk_bf16_f32 v78, v68, v69
  v_cvt_pk_bf16_f32 v79, v70, v71
  buffer_store_dwordx4 v[76:79], v35, s[16:19], s42 offen offset:64
  s_mov_b32 s42, 32768
  v_accvgpr_read_b32 v48, a8
  v_accvgpr_read_b32 v49, a9
  v_accvgpr_read_b32 v50, a10
  v_accvgpr_read_b32 v51, a11
  v_accvgpr_read_b32 v52, a12
  v_accvgpr_read_b32 v53, a13
  v_accvgpr_read_b32 v54, a14
  v_accvgpr_read_b32 v55, a15
  s_nop 1
  v_permlane16_swap_b32 v48, v52
  v_permlane16_swap_b32 v49, v53
  v_permlane16_swap_b32 v50, v54
  v_permlane16_swap_b32 v51, v55
  s_waitcnt vmcnt(12)
  v_add_f32 v48, v48, v112
  v_add_f32 v49, v49, v113
  v_add_f32 v50, v50, v114
  v_add_f32 v51, v51, v115
  v_add_f32 v52, v52, v116
  v_add_f32 v53, v53, v117
  v_add_f32 v54, v54, v118
  v_add_f32 v55, v55, v119
  v_cvt_pk_bf16_f32 v60, v48, v49
  v_cvt_pk_bf16_f32 v61, v50, v51
  v_cvt_pk_bf16_f32 v62, v52, v53
  v_cvt_pk_bf16_f32 v63, v54, v55
  buffer_store_dwordx4 v[60:63], v35, s[16:19], s42 offen offset:0
  v_accvgpr_read_b32 v64, a40
  v_accvgpr_read_b32 v65, a41
  v_accvgpr_read_b32 v66, a42
  v_accvgpr_read_b32 v67, a43
  v_accvgpr_read_b32 v68, a44
  v_accvgpr_read_b32 v69, a45
  v_accvgpr_read_b32 v70, a46
  v_accvgpr_read_b32 v71, a47
  s_nop 1
  v_permlane16_swap_b32 v64, v68
  v_permlane16_swap_b32 v65, v69
  v_permlane16_swap_b32 v66, v70
  v_permlane16_swap_b32 v67, v71
  s_waitcnt vmcnt(11)
  v_add_f32 v64, v64, v120
  v_add_f32 v65, v65, v121
  v_add_f32 v66, v66, v122
  v_add_f32 v67, v67, v123
  v_add_f32 v68, v68, v124
  v_add_f32 v69, v69, v125
  v_add_f32 v70, v70, v126
  v_add_f32 v71, v71, v127
  v_cvt_pk_bf16_f32 v76, v64, v65
  v_cvt_pk_bf16_f32 v77, v66, v67
  v_cvt_pk_bf16_f32 v78, v68, v69
  v_cvt_pk_bf16_f32 v79, v70, v71
  buffer_store_dwordx4 v[76:79], v35, s[16:19], s42 offen offset:64
  s_mov_b32 s42, 65536
  v_accvgpr_read_b32 v48, a16
  v_accvgpr_read_b32 v49, a17
  v_accvgpr_read_b32 v50, a18
  v_accvgpr_read_b32 v51, a19
  v_accvgpr_read_b32 v52, a20
  v_accvgpr_read_b32 v53, a21
  v_accvgpr_read_b32 v54, a22
  v_accvgpr_read_b32 v55, a23
  s_nop 1
  v_permlane16_swap_b32 v48, v52
  v_permlane16_swap_b32 v49, v53
  v_permlane16_swap_b32 v50, v54
  v_permlane16_swap_b32 v51, v55
  s_waitcnt vmcnt(10)
  v_add_f32 v48, v48, v128
  v_add_f32 v49, v49, v129
  v_add_f32 v50, v50, v130
  v_add_f32 v51, v51, v131
  v_add_f32 v52, v52, v132
  v_add_f32 v53, v53, v133
  v_add_f32 v54, v54, v134
  v_add_f32 v55, v55, v135
  v_cvt_pk_bf16_f32 v60, v48, v49
  v_cvt_pk_bf16_f32 v61, v50, v51
  v_cvt_pk_bf16_f32 v62, v52, v53
  v_cvt_pk_bf16_f32 v63, v54, v55
  buffer_store_dwordx4 v[60:63], v35, s[16:19], s42 offen offset:0
  v_accvgpr_read_b32 v64, a48
  v_accvgpr_read_b32 v65, a49
  v_accvgpr_read_b32 v66, a50
  v_accvgpr_read_b32 v67, a51
  v_accvgpr_read_b32 v68, a52
  v_accvgpr_read_b32 v69, a53
  v_accvgpr_read_b32 v70, a54
  v_accvgpr_read_b32 v71, a55
  s_nop 1
  v_permlane16_swap_b32 v64, v68
  v_permlane16_swap_b32 v65, v69
  v_permlane16_swap_b32 v66, v70
  v_permlane16_swap_b32 v67, v71
  s_waitcnt vmcnt(9)
  v_add_f32 v64, v64, v136
  v_add_f32 v65, v65, v137
  v_add_f32 v66, v66, v138
  v_add_f32 v67, v67, v139
  v_add_f32 v68, v68, v140
  v_add_f32 v69, v69, v141
  v_add_f32 v70, v70, v142
  v_add_f32 v71, v71, v143
  v_cvt_pk_bf16_f32 v76, v64, v65
  v_cvt_pk_bf16_f32 v77, v66, v67
  v_cvt_pk_bf16_f32 v78, v68, v69
  v_cvt_pk_bf16_f32 v79, v70, v71
  buffer_store_dwordx4 v[76:79], v35, s[16:19], s42 offen offset:64
  s_mov_b32 s42, 98304
  v_accvgpr_read_b32 v48, a24
  v_accvgpr_read_b32 v49, a25
  v_accvgpr_read_b32 v50, a26
  v_accvgpr_read_b32 v51, a27
  v_accvgpr_read_b32 v52, a28
  v_accvgpr_read_b32 v53, a29
  v_accvgpr_read_b32 v54, a30
  v_accvgpr_read_b32 v55, a31
  s_nop 1
  v_permlane16_swap_b32 v48, v52
  v_permlane16_swap_b32 v49, v53
  v_permlane16_swap_b32 v50, v54
  v_permlane16_swap_b32 v51, v55
  s_waitcnt vmcnt(8)
  v_add_f32 v48, v48, v144
  v_add_f32 v49, v49, v145
  v_add_f32 v50, v50, v146
  v_add_f32 v51, v51, v147
  v_add_f32 v52, v52, v148
  v_add_f32 v53, v53, v149
  v_add_f32 v54, v54, v150
  v_add_f32 v55, v55, v151
  v_cvt_pk_bf16_f32 v60, v48, v49
  v_cvt_pk_bf16_f32 v61, v50, v51
  v_cvt_pk_bf16_f32 v62, v52, v53
  v_cvt_pk_bf16_f32 v63, v54, v55
  buffer_store_dwordx4 v[60:63], v35, s[16:19], s42 offen offset:0
  v_accvgpr_read_b32 v64, a56
  v_accvgpr_read_b32 v65, a57
  v_accvgpr_read_b32 v66, a58
  v_accvgpr_read_b32 v67, a59
  v_accvgpr_read_b32 v68, a60
  v_accvgpr_read_b32 v69, a61
  v_accvgpr_read_b32 v70, a62
  v_accvgpr_read_b32 v71, a63
  s_nop 1
  v_permlane16_swap_b32 v64, v68
  v_permlane16_swap_b32 v65, v69
  v_permlane16_swap_b32 v66, v70
  v_permlane16_swap_b32 v67, v71
  s_waitcnt vmcnt(7)
  v_add_f32 v64, v64, v152
  v_add_f32 v65, v65, v153
  v_add_f32 v66, v66, v154
  v_add_f32 v67, v67, v155
  v_add_f32 v68, v68, v156
  v_add_f32 v69, v69, v157
  v_add_f32 v70, v70, v158
  v_add_f32 v71, v71, v159
  v_cvt_pk_bf16_f32 v76, v64, v65
  v_cvt_pk_bf16_f32 v77, v66, v67
  v_cvt_pk_bf16_f32 v78, v68, v69
  v_cvt_pk_bf16_f32 v79, v70, v71
  buffer_store_dwordx4 v[76:79], v35, s[16:19], s42 offen offset:64
  s_branch mk_adv
mk_hold:
  s_waitcnt vmcnt(0) lgkmcnt(0)
  s_bitcmp1_b32 s76, 0
  s_cbranch_scc0 mk_adv
  s_waitcnt lgkmcnt(0)
  v_and_b32 v36, 15, v1
  v_lshl_add_u32 v36, v36, 11, v34
  s_mul_i32 s40, s32, 128
  s_mul_i32 s41, s33, 131072
  s_add_u32 s40, s40, s41
  s_add_u32 s40, s40, s79
  v_add_u32 v35, s40, v36
  s_mov_b32 s43, 0xffff0000
  s_mov_b32 s42, 0
  buffer_load_dwordx4 v[96:99], v35, s[72:75], s42 offen offset:0
  buffer_load_dwordx4 v[100:103], v35, s[72:75], s42 offen offset:64
  s_mov_b32 s42, 32768
  buffer_load_dwordx4 v[104:107], v35, s[72:75], s42 offen offset:0
  buffer_load_dwordx4 v[108:111], v35, s[72:75], s42 offen offset:64
  s_mov_b32 s42, 65536
  buffer_load_dwordx4 v[112:115], v35, s[72:75], s42 offen offset:0
  buffer_load_dwordx4 v[116:119], v35, s[72:75], s42 offen offset:64
  s_mov_b32 s42, 98304
  buffer_load_dwordx4 v[120:123], v35, s[72:75], s42 offen offset:0
  buffer_load_dwordx4 v[124:127], v35, s[72:75], s42 offen offset:64
  s_nop 7
  s_mov_b32 s42, 0
  v_accvgpr_read_b32 v48, a0
  v_accvgpr_read_b32 v49, a1
  v_accvgpr_read_b32 v50, a2
  v_accvgpr_read_b32 v51, a3
  v_accvgpr_read_b32 v52, a4
  v_accvgpr_read_b32 v53, a5
  v_accvgpr_read_b32 v54, a6
  v_accvgpr_read_b32 v55, a7
  s_nop 1
  v_permlane16_swap_b32 v48, v52
  v_permlane16_swap_b32 v49, v53
  v_permlane16_swap_b32 v50, v54
  v_permlane16_swap_b32 v51, v55
  s_waitcnt vmcnt(7)
  v_lshlrev_b32 v56, 16, v96
  v_and_b32 v57, s43, v96
  v_add_f32 v48, v48, v56
  v_add_f32 v49, v49, v57
  v_cvt_pk_bf16_f32 v60, v48, v49
  v_lshlrev_b32 v56, 16, v97
  v_and_b32 v57, s43, v97
  v_add_f32 v50, v50, v56
  v_add_f32 v51, v51, v57
  v_cvt_pk_bf16_f32 v61, v50, v51
  v_lshlrev_b32 v56, 16, v98
  v_and_b32 v57, s43, v98
  v_add_f32 v52, v52, v56
  v_add_f32 v53, v53, v57
  v_cvt_pk_bf16_f32 v62, v52, v53
  v_lshlrev_b32 v56, 16, v99
  v_and_b32 v57, s43, v99
  v_add_f32 v54, v54, v56
  v_add_f32 v55, v55, v57
  v_cvt_pk_bf16_f32 v63, v54, v55
  buffer_store_dwordx4 v[60:63], v35, s[16:19], s42 offen offset:0
  v_accvgpr_read_b32 v64, a32
  v_accvgpr_read_b32 v65, a33
  v_accvgpr_read_b32 v66, a34
  v_accvgpr_read_b32 v67, a35
  v_accvgpr_read_b32 v68, a36
  v_accvgpr_read_b32 v69, a37
  v_accvgpr_read_b32 v70, a38
  v_accvgpr_read_b32 v71, a39
  s_nop 1
  v_permlane16_swap_b32 v64, v68
  v_permlane16_swap_b32 v65, v69
  v_permlane16_swap_b32 v66, v70
  v_permlane16_swap_b32 v67, v71
  s_waitcnt vmcnt(7)
  v_lshlrev_b32 v72, 16, v100
  v_and_b32 v73, s43, v100
  v_add_f32 v64, v64, v72
  v_add_f32 v65, v65, v73
  v_cvt_pk_bf16_f32 v76, v64, v65
  v_lshlrev_b32 v72, 16, v101
  v_and_b32 v73, s43, v101
  v_add_f32 v66, v66, v72
  v_add_f32 v67, v67, v73
  v_cvt_pk_bf16_f32 v77, v66, v67
  v_lshlrev_b32 v72, 16, v102
  v_and_b32 v73, s43, v102
  v_add_f32 v68, v68, v72
  v_add_f32 v69, v69, v73
  v_cvt_pk_bf16_f32 v78, v68, v69
  v_lshlrev_b32 v72, 16, v103
  v_and_b32 v73, s43, v103
  v_add_f32 v70, v70, v72
  v_add_f32 v71, v71, v73
  v_cvt_pk_bf16_f32 v79, v70, v71
  buffer_store_dwordx4 v[76:79], v35, s[16:19], s42 offen offset:64
  s_mov_b32 s42, 32768
  v_accvgpr_read_b32 v48, a8
  v_accvgpr_read_b32 v49, a9
  v_accvgpr_read_b32 v50, a10
  v_accvgpr_read_b32 v51, a11
  v_accvgpr_read_b32 v52, a12
  v_accvgpr_read_b32 v53, a13
  v_accvgpr_read_b32 v54, a14
  v_accvgpr_read_b32 v55, a15
  s_nop 1
  v_permlane16_swap_b32 v48, v52
  v_permlane16_swap_b32 v49, v53
  v_permlane16_swap_b32 v50, v54
  v_permlane16_swap_b32 v51, v55
  s_waitcnt vmcnt(7)
  v_lshlrev_b32 v56, 16, v104
  v_and_b32 v57, s43, v104
  v_add_f32 v48, v48, v56
  v_add_f32 v49, v49, v57
  v_cvt_pk_bf16_f32 v60, v48, v49
  v_lshlrev_b32 v56, 16, v105
  v_and_b32 v57, s43, v105
  v_add_f32 v50, v50, v56
  v_add_f32 v51, v51, v57
  v_cvt_pk_bf16_f32 v61, v50, v51
  v_lshlrev_b32 v56, 16, v106
  v_and_b32 v57, s43, v106
  v_add_f32 v52, v52, v56
  v_add_f32 v53, v53, v57
  v_cvt_pk_bf16_f32 v62, v52, v53
  v_lshlrev_b32 v56, 16, v107
  v_and_b32 v57, s43, v107
  v_add_f32 v54, v54, v56
  v_add_f32 v55, v55, v57
  v_cvt_pk_bf16_f32 v63, v54, v55
  buffer_store_dwordx4 v[60:63], v35, s[16:19], s42 offen offset:0
  v_accvgpr_read_b32 v64, a40
  v_accvgpr_read_b32 v65, a41
  v_accvgpr_read_b32 v66, a42
  v_accvgpr_read_b32 v67, a43
  v_accvgpr_read_b32 v68, a44
  v_accvgpr_read_b32 v69, a45
  v_accvgpr_read_b32 v70, a46
  v_accvgpr_read_b32 v71, a47
  s_nop 1
  v_permlane16_swap_b32 v64, v68
  v_permlane16_swap_b32 v65, v69
  v_permlane16_swap_b32 v66, v70
  v_permlane16_swap_b32 v67, v71
  s_waitcnt vmcnt(7)
  v_lshlrev_b32 v72, 16, v108
  v_and_b32 v73, s43, v108
  v_add_f32 v64, v64, v72
  v_add_f32 v65, v65, v73
  v_cvt_pk_bf16_f32 v76, v64, v65
  v_lshlrev_b32 v72, 16, v109
  v_and_b32 v73, s43, v109
  v_add_f32 v66, v66, v72
  v_add_f32 v67, v67, v73
  v_cvt_pk_bf16_f32 v77, v66, v67
  v_lshlrev_b32 v72, 16, v110
  v_and_b32 v73, s43, v110
  v_add_f32 v68, v68, v72
  v_add_f32 v69, v69, v73
  v_cvt_pk_bf16_f32 v78, v68, v69
  v_lshlrev_b32 v72, 16, v111
  v_and_b32 v73, s43, v111
  v_add_f32 v70, v70, v72
  v_add_f32 v71, v71, v73
  v_cvt_pk_bf16_f32 v79, v70, v71
  buffer_store_dwordx4 v[76:79], v35, s[16:19], s42 offen offset:64
  s_mov_b32 s42, 65536
  v_accvgpr_read_b32 v48, a16
  v_accvgpr_read_b32 v49, a17
  v_accvgpr_read_b32 v50, a18
  v_accvgpr_read_b32 v51, a19
  v_accvgpr_read_b32 v52, a20
  v_accvgpr_read_b32 v53, a21
  v_accvgpr_read_b32 v54, a22
  v_accvgpr_read_b32 v55, a23
  s_nop 1
  v_permlane16_swap_b32 v48, v52
  v_permlane16_swap_b32 v49, v53
  v_permlane16_swap_b32 v50, v54
  v_permlane16_swap_b32 v51, v55
  s_waitcnt vmcnt(7)
  v_lshlrev_b32 v56, 16, v112
  v_and_b32 v57, s43, v112
  v_add_f32 v48, v48, v56
  v_add_f32 v49, v49, v57
  v_cvt_pk_bf16_f32 v60, v48, v49
  v_lshlrev_b32 v56, 16, v113
  v_and_b32 v57, s43, v113
  v_add_f32 v50, v50, v56
  v_add_f32 v51, v51, v57
  v_cvt_pk_bf16_f32 v61, v50, v51
  v_lshlrev_b32 v56, 16, v114
  v_and_b32 v57, s43, v114
  v_add_f32 v52, v52, v56
  v_add_f32 v53, v53, v57
  v_cvt_pk_bf16_f32 v62, v52, v53
  v_lshlrev_b32 v56, 16, v115
  v_and_b32 v57, s43, v115
  v_add_f32 v54, v54, v56
  v_add_f32 v55, v55, v57
  v_cvt_pk_bf16_f32 v63, v54, v55
  buffer_store_dwordx4 v[60:63], v35, s[16:19], s42 offen offset:0
  v_accvgpr_read_b32 v64, a48
  v_accvgpr_read_b32 v65, a49
  v_accvgpr_read_b32 v66, a50
  v_accvgpr_read_b32 v67, a51
  v_accvgpr_read_b32 v68, a52
  v_accvgpr_read_b32 v69, a53
  v_accvgpr_read_b32 v70, a54
  v_accvgpr_read_b32 v71, a55
  s_nop 1
  v_permlane16_swap_b32 v64, v68
  v_permlane16_swap_b32 v65, v69
  v_permlane16_swap_b32 v66, v70
  v_permlane16_swap_b32 v67, v71
  s_waitcnt vmcnt(7)
  v_lshlrev_b32 v72, 16, v116
  v_and_b32 v73, s43, v116
  v_add_f32 v64, v64, v72
  v_add_f32 v65, v65, v73
  v_cvt_pk_bf16_f32 v76, v64, v65
  v_lshlrev_b32 v72, 16, v117
  v_and_b32 v73, s43, v117
  v_add_f32 v66, v66, v72
  v_add_f32 v67, v67, v73
  v_cvt_pk_bf16_f32 v77, v66, v67
  v_lshlrev_b32 v72, 16, v118
  v_and_b32 v73, s43, v118
  v_add_f32 v68, v68, v72
  v_add_f32 v69, v69, v73
  v_cvt_pk_bf16_f32 v78, v68, v69
  v_lshlrev_b32 v72, 16, v119
  v_and_b32 v73, s43, v119
  v_add_f32 v70, v70, v72
  v_add_f32 v71, v71, v73
  v_cvt_pk_bf16_f32 v79, v70, v71
  buffer_store_dwordx4 v[76:79], v35, s[16:19], s42 offen offset:64
  s_mov_b32 s42, 98304
  v_accvgpr_read_b32 v48, a24
  v_accvgpr_read_b32 v49, a25
  v_accvgpr_read_b32 v50, a26
  v_accvgpr_read_b32 v51, a27
  v_accvgpr_read_b32 v52, a28
  v_accvgpr_read_b32 v53, a29
  v_accvgpr_read_b32 v54, a30
  v_accvgpr_read_b32 v55, a31
  s_nop 1
  v_permlane16_swap_b32 v48, v52
  v_permlane16_swap_b32 v49, v53
  v_permlane16_swap_b32 v50, v54
  v_permlane16_swap_b32 v51, v55
  s_waitcnt vmcnt(7)
  v_lshlrev_b32 v56, 16, v120
  v_and_b32 v57, s43, v120
  v_add_f32 v48, v48, v56
  v_add_f32 v49, v49, v57
  v_cvt_pk_bf16_f32 v60, v48, v49
  v_lshlrev_b32 v56, 16, v121
  v_and_b32 v57, s43, v121
  v_add_f32 v50, v50, v56
  v_add_f32 v51, v51, v57
  v_cvt_pk_bf16_f32 v61, v50, v51
  v_lshlrev_b32 v56, 16, v122
  v_and_b32 v57, s43, v122
  v_add_f32 v52, v52, v56
  v_add_f32 v53, v53, v57
  v_cvt_pk_bf16_f32 v62, v52, v53
  v_lshlrev_b32 v56, 16, v123
  v_and_b32 v57, s43, v123
  v_add_f32 v54, v54, v56
  v_add_f32 v55, v55, v57
  v_cvt_pk_bf16_f32 v63, v54, v55
  buffer_store_dwordx4 v[60:63], v35, s[16:19], s42 offen offset:0
  v_accvgpr_read_b32 v64, a56
  v_accvgpr_read_b32 v65, a57
  v_accvgpr_read_b32 v66, a58
  v_accvgpr_read_b32 v67, a59
  v_accvgpr_read_b32 v68, a60
  v_accvgpr_read_b32 v69, a61
  v_accvgpr_read_b32 v70, a62
  v_accvgpr_read_b32 v71, a63
  s_nop 1
  v_permlane16_swap_b32 v64, v68
  v_permlane16_swap_b32 v65, v69
  v_permlane16_swap_b32 v66, v70
  v_permlane16_swap_b32 v67, v71
  s_waitcnt vmcnt(7)
  v_lshlrev_b32 v72, 16, v124
  v_and_b32 v73, s43, v124
  v_add_f32 v64, v64, v72
  v_add_f32 v65, v65, v73
  v_cvt_pk_bf16_f32 v76, v64, v65
  v_lshlrev_b32 v72, 16, v125
  v_and_b32 v73, s43, v125
  v_add_f32 v66, v66, v72
  v_add_f32 v67, v67, v73
  v_cvt_pk_bf16_f32 v77, v66, v67
  v_lshlrev_b32 v72, 16, v126
  v_and_b32 v73, s43, v126
  v_add_f32 v68, v68, v72
  v_add_f32 v69, v69, v73
  v_cvt_pk_bf16_f32 v78, v68, v69
  v_lshlrev_b32 v72, 16, v127
  v_and_b32 v73, s43, v127
  v_add_f32 v70, v70, v72
  v_add_f32 v71, v71, v73
  v_cvt_pk_bf16_f32 v79, v70, v71
  buffer_store_dwordx4 v[76:79], v35, s[16:19], s42 offen offset:64
  s_branch mk_adv
mk_split:
  s_sub_u32 s59, s81, 5718016
  s_lshl_b32 s59, s59, 13
  s_add_u32 s59, s59, 134217728
  s_bfe_u32 s55, s76, 0x40014
  s_lshl_b32 s5, s55, 16
  s_add_u32 s5, s5, s59
  s_waitcnt lgkmcnt(0)
  s_lshl_b32 s40, s28, 14
  s_add_u32 s40, s40, s5
  v_lshlrev_b32 v36, 4, v1
  s_nop 7
  buffer_store_dwordx4 a[0:3], v36, s[8:11], s40 offen offset:0 sc1
  buffer_store_dwordx4 a[4:7], v36, s[8:11], s40 offen offset:1024 sc1
  buffer_store_dwordx4 a[8:11], v36, s[8:11], s40 offen offset:2048 sc1
  buffer_store_dwordx4 a[12:15], v36, s[8:11], s40 offen offset:3072 sc1
  s_add_u32 s40, s40, 4096
  buffer_store_dwordx4 a[16:19], v36, s[8:11], s40 offen offset:0 sc1
  buffer_store_dwordx4 a[20:23], v36, s[8:11], s40 offen offset:1024 sc1
  buffer_store_dwordx4 a[24:27], v36, s[8:11], s40 offen offset:2048 sc1
  buffer_store_dwordx4 a[28:31], v36, s[8:11], s40 offen offset:3072 sc1
  s_add_u32 s40, s40, 4096
  buffer_store_dwordx4 a[32:35], v36, s[8:11], s40 offen offset:0 sc1
  buffer_store_dwordx4 a[36:39], v36, s[8:11], s40 offen offset:1024 sc1
  buffer_store_dwordx4 a[40:43], v36, s[8:11], s40 offen offset:2048 sc1
  buffer_store_dwordx4 a[44:47], v36, s[8:11], s40 offen offset:3072 sc1
  s_add_u32 s40, s40, 4096
  buffer_store_dwordx4 a[48:51], v36, s[8:11], s40 offen offset:0 sc1
  buffer_store_dwordx4 a[52:55], v36, s[8:11], s40 offen offset:1024 sc1
  buffer_store_dwordx4 a[56:59], v36, s[8:11], s40 offen offset:2048 sc1
  buffer_store_dwordx4 a[60:63], v36, s[8:11], s40 offen offset:3072 sc1
  s_waitcnt vmcnt(0)
  s_barrier
  buffer_store_dword v251, v250, s[8:11], s47 offen sc1
  buffer_store_dword v251, v250, s[8:11], s48 offen sc1
  s_bfe_u32 s6, s76, 0x40010
  v_cmp_ge_u32 vcc, s6, v1
  v_lshlrev_b32 v36, 2, v1
  v_mov_b32 v37, 2147483648
  s_nop 0
  v_cndmask_b32 v36, v37, v36, vcc
mk_g_59:
  buffer_load_dword v38, v36, s[8:11], s81 offen sc1
  s_waitcnt vmcnt(0)
  v_cmp_eq_u32 vcc, -1, v38
  s_cbranch_vccz mk_g_60
  s_sub_u32 s98, s98, 1
  s_cbranch_scc1 mk_end
  s_sleep 3
  s_branch mk_g_59
mk_g_60:
  s_cmp_eq_u32 s6, 2
  s_cbranch_scc0 mk_c_61
  v_and_b32 v36, 15, v1
  v_lshl_add_u32 v36, v36, 11, v34
  v_lshlrev_b32 v37, 1, v36
  v_lshlrev_b32 v38, 4, v1
  s_mul_i32 s40, s55, 4
  s_add_u32 s40, s40, 0
  s_lshl_b32 s41, s28, 3
  s_add_u32 s41, s41, s40
  s_lshl_b32 s41, s41, 11
  s_add_u32 s41, s41, s59
  buffer_load_dwordx4 v[48:51], v38, s[8:11], s41 offen sc1
  buffer_load_dwordx4 v[52:55], v38, s[8:11], s41 offen offset:1024 sc1
  s_add_u32 s41, s41, 65536
  buffer_load_dwordx4 v[56:59], v38, s[8:11], s41 offen sc1
  buffer_load_dwordx4 v[60:63], v38, s[8:11], s41 offen offset:1024 sc1
  s_add_u32 s41, s41, 65536
  s_and_b32 s41, s40, 3
  s_lshl_b32 s41, s41, 15
  s_lshl_b32 s42, s33, 17
  s_add_u32 s41, s41, s42
  s_lshr_b32 s40, s40, 2
  s_lshl_b32 s40, s40, 6
  s_add_u32 s41, s41, s40
  s_lshl_b32 s40, s32, 7
  s_add_u32 s24, s41, s40
  s_lshl_b32 s40, s24, 1
  s_add_u32 s40, s40, s58
  s_add_u32 s24, s24, s79
  buffer_load_dwordx4 v[64:67], v37, s[8:11], s40 offen sc1
  buffer_load_dwordx4 v[68:71], v37, s[8:11], s40 offen offset:16 sc1
  s_mul_i32 s40, s55, 4
  s_add_u32 s40, s40, 1
  s_lshl_b32 s41, s28, 3
  s_add_u32 s41, s41, s40
  s_lshl_b32 s41, s41, 11
  s_add_u32 s41, s41, s59
  buffer_load_dwordx4 v[72:75], v38, s[8:11], s41 offen sc1
  buffer_load_dwordx4 v[76:79], v38, s[8:11], s41 offen offset:1024 sc1
  s_add_u32 s41, s41, 65536
  buffer_load_dwordx4 v[80:83], v38, s[8:11], s41 offen sc1
  buffer_load_dwordx4 v[84:87], v38, s[8:11], s41 offen offset:1024 sc1
  s_add_u32 s41, s41, 65536
  s_and_b32 s41, s40, 3
  s_lshl_b32 s41, s41, 15
  s_lshl_b32 s42, s33, 17
  s_add_u32 s41, s41, s42
  s_lshr_b32 s40, s40, 2
  s_lshl_b32 s40, s40, 6
  s_add_u32 s41, s41, s40
  s_lshl_b32 s40, s32, 7
  s_add_u32 s25, s41, s40
  s_lshl_b32 s40, s25, 1
  s_add_u32 s40, s40, s58
  s_add_u32 s25, s25, s79
  buffer_load_dwordx4 v[88:91], v37, s[8:11], s40 offen sc1
  buffer_load_dwordx4 v[92:95], v37, s[8:11], s40 offen offset:16 sc1
  s_waitcnt vmcnt(6)
  v_add_f32 v48, v48, v56
  v_add_f32 v49, v49, v57
  v_add_f32 v50, v50, v58
  v_add_f32 v51, v51, v59
  v_add_f32 v52, v52, v60
  v_add_f32 v53, v53, v61
  v_add_f32 v54, v54, v62
  v_add_f32 v55, v55, v63
  s_nop 1
  v_permlane16_swap_b32 v48, v52
  v_permlane16_swap_b32 v49, v53
  v_permlane16_swap_b32 v50, v54
  v_permlane16_swap_b32 v51, v55
  v_add_f32 v48, v48, v64
  v_add_f32 v49, v49, v65
  v_add_f32 v50, v50, v66
  v_add_f32 v51, v51, v67
  v_add_f32 v52, v52, v68
  v_add_f32 v53, v53, v69
  v_add_f32 v54, v54, v70
  v_add_f32 v55, v55, v71
  v_cvt_pk_bf16_f32 v56, v48, v49
  v_cvt_pk_bf16_f32 v57, v50, v51
  v_cvt_pk_bf16_f32 v58, v52, v53
  v_cvt_pk_bf16_f32 v59, v54, v55
  buffer_store_dwordx4 v[56:59], v36, s[16:19], s24 offen
  s_waitcnt vmcnt(1)
  v_add_f32 v72, v72, v80
  v_add_f32 v73, v73, v81
  v_add_f32 v74, v74, v82
  v_add_f32 v75, v75, v83
  v_add_f32 v76, v76, v84
  v_add_f32 v77, v77, v85
  v_add_f32 v78, v78, v86
  v_add_f32 v79, v79, v87
  s_nop 1
  v_permlane16_swap_b32 v72, v76
  v_permlane16_swap_b32 v73, v77
  v_permlane16_swap_b32 v74, v78
  v_permlane16_swap_b32 v75, v79
  v_add_f32 v72, v72, v88
  v_add_f32 v73, v73, v89
  v_add_f32 v74, v74, v90
  v_add_f32 v75, v75, v91
  v_add_f32 v76, v76, v92
  v_add_f32 v77, v77, v93
  v_add_f32 v78, v78, v94
  v_add_f32 v79, v79, v95
  v_cvt_pk_bf16_f32 v80, v72, v73
  v_cvt_pk_bf16_f32 v81, v74, v75
  v_cvt_pk_bf16_f32 v82, v76, v77
  v_cvt_pk_bf16_f32 v83, v78, v79
  buffer_store_dwordx4 v[80:83], v36, s[16:19], s25 offen
  s_mul_i32 s40, s55, 4
  s_add_u32 s40, s40, 2
  s_lshl_b32 s41, s28, 3
  s_add_u32 s41, s41, s40
  s_lshl_b32 s41, s41, 11
  s_add_u32 s41, s41, s59
  buffer_load_dwordx4 v[96:99], v38, s[8:11], s41 offen sc1
  buffer_load_dwordx4 v[100:103], v38, s[8:11], s41 offen offset:1024 sc1
  s_add_u32 s41, s41, 65536
  buffer_load_dwordx4 v[104:107], v38, s[8:11], s41 offen sc1
  buffer_load_dwordx4 v[108:111], v38, s[8:11], s41 offen offset:1024 sc1
  s_add_u32 s41, s41, 65536
  s_and_b32 s41, s40, 3
  s_lshl_b32 s41, s41, 15
  s_lshl_b32 s42, s33, 17
  s_add_u32 s41, s41, s42
  s_lshr_b32 s40, s40, 2
  s_lshl_b32 s40, s40, 6
  s_add_u32 s41, s41, s40
  s_lshl_b32 s40, s32, 7
  s_add_u32 s24, s41, s40
  s_lshl_b32 s40, s24, 1
  s_add_u32 s40, s40, s58
  s_add_u32 s24, s24, s79
  buffer_load_dwordx4 v[112:115], v37, s[8:11], s40 offen sc1
  buffer_load_dwordx4 v[116:119], v37, s[8:11], s40 offen offset:16 sc1
  s_mul_i32 s40, s55, 4
  s_add_u32 s40, s40, 3
  s_lshl_b32 s41, s28, 3
  s_add_u32 s41, s41, s40
  s_lshl_b32 s41, s41, 11
  s_add_u32 s41, s41, s59
  buffer_load_dwordx4 v[120:123], v38, s[8:11], s41 offen sc1
  buffer_load_dwordx4 v[124:127], v38, s[8:11], s41 offen offset:1024 sc1
  s_add_u32 s41, s41, 65536
  buffer_load_dwordx4 v[128:131], v38, s[8:11], s41 offen sc1
  buffer_load_dwordx4 v[132:135], v38, s[8:11], s41 offen offset:1024 sc1
  s_add_u32 s41, s41, 65536
  s_and_b32 s41, s40, 3
  s_lshl_b32 s41, s41, 15
  s_lshl_b32 s42, s33, 17
  s_add_u32 s41, s41, s42
  s_lshr_b32 s40, s40, 2
  s_lshl_b32 s40, s40, 6
  s_add_u32 s41, s41, s40
  s_lshl_b32 s40, s32, 7
  s_add_u32 s25, s41, s40
  s_lshl_b32 s40, s25, 1
  s_add_u32 s40, s40, s58
  s_add_u32 s25, s25, s79
  buffer_load_dwordx4 v[136:139], v37, s[8:11], s40 offen sc1
  buffer_load_dwordx4 v[140:143], v37, s[8:11], s40 offen offset:16 sc1
  s_waitcnt vmcnt(6)
  v_add_f32 v96, v96, v104
  v_add_f32 v97, v97, v105
  v_add_f32 v98, v98, v106
  v_add_f32 v99, v99, v107
  v_add_f32 v100, v100, v108
  v_add_f32 v101, v101, v109
  v_add_f32 v102, v102, v110
  v_add_f32 v103, v103, v111
  s_nop 1
  v_permlane16_swap_b32 v96, v100
  v_permlane16_swap_b32 v97, v101
  v_permlane16_swap_b32 v98, v102
  v_permlane16_swap_b32 v99, v103
  v_add_f32 v96, v96, v112
  v_add_f32 v97, v97, v113
  v_add_f32 v98, v98, v114
  v_add_f32 v99, v99, v115
  v_add_f32 v100, v100, v116
  v_add_f32 v101, v101, v117
  v_add_f32 v102, v102, v118
  v_add_f32 v103, v103, v119
  v_cvt_pk_bf16_f32 v104, v96, v97
  v_cvt_pk_bf16_f32 v105, v98, v99
  v_cvt_pk_bf16_f32 v106, v100, v101
  v_cvt_pk_bf16_f32 v107, v102, v103
  buffer_store_dwordx4 v[104:107], v36, s[16:19], s24 offen
  s_waitcnt vmcnt(1)
  v_add_f32 v120, v120, v128
  v_add_f32 v121, v121, v129
  v_add_f32 v122, v122, v130
  v_add_f32 v123, v123, v131
  v_add_f32 v124, v124, v132
  v_add_f32 v125, v125, v133
  v_add_f32 v126, v126, v134
  v_add_f32 v127, v127, v135
  s_nop 1
  v_permlane16_swap_b32 v120, v124
  v_permlane16_swap_b32 v121, v125
  v_permlane16_swap_b32 v122, v126
  v_permlane16_swap_b32 v123, v127
  v_add_f32 v120, v120, v136
  v_add_f32 v121, v121, v137
  v_add_f32 v122, v122, v138
  v_add_f32 v123, v123, v139
  v_add_f32 v124, v124, v140
  v_add_f32 v125, v125, v141
  v_add_f32 v126, v126, v142
  v_add_f32 v127, v127, v143
  v_cvt_pk_bf16_f32 v128, v120, v121
  v_cvt_pk_bf16_f32 v129, v122, v123
  v_cvt_pk_bf16_f32 v130, v124, v125
  v_cvt_pk_bf16_f32 v131, v126, v127
  buffer_store_dwordx4 v[128:131], v36, s[16:19], s25 offen
  s_branch mk_adv
mk_c_61:
  s_cmp_eq_u32 s6, 4
  s_cbranch_scc0 mk_c_62
  v_and_b32 v36, 15, v1
  v_lshl_add_u32 v36, v36, 11, v34
  v_lshlrev_b32 v37, 1, v36
  v_lshlrev_b32 v38, 4, v1
  s_mul_i32 s40, s55, 2
  s_add_u32 s40, s40, 0
  s_lshl_b32 s41, s28, 3
  s_add_u32 s41, s41, s40
  s_lshl_b32 s41, s41, 11
  s_add_u32 s41, s41, s59
  buffer_load_dwordx4 v[48:51], v38, s[8:11], s41 offen sc1
  buffer_load_dwordx4 v[52:55], v38, s[8:11], s41 offen offset:1024 sc1
  s_add_u32 s41, s41, 65536
  buffer_load_dwordx4 v[56:59], v38, s[8:11], s41 offen sc1
  buffer_load_dwordx4 v[60:63], v38, s[8:11], s41 offen offset:1024 sc1
  s_add_u32 s41, s41, 65536
  buffer_load_dwordx4 v[64:67], v38, s[8:11], s41 offen sc1
  buffer_load_dwordx4 v[68:71], v38, s[8:11], s41 offen offset:1024 sc1
  s_add_u32 s41, s41, 65536
  buffer_load_dwordx4 v[72:75], v38, s[8:11], s41 offen sc1
  buffer_load_dwordx4 v[76:79], v38, s[8:11], s41 offen offset:1024 sc1
  s_add_u32 s41, s41, 65536
  s_and_b32 s41, s40, 3
  s_lshl_b32 s41, s41, 15
  s_lshl_b32 s42, s33, 17
  s_add_u32 s41, s41, s42
  s_lshr_b32 s40, s40, 2
  s_lshl_b32 s40, s40, 6
  s_add_u32 s41, s41, s40
  s_lshl_b32 s40, s32, 7
  s_add_u32 s24, s41, s40
  s_lshl_b32 s40, s24, 1
  s_add_u32 s40, s40, s58
  s_add_u32 s24, s24, s79
  buffer_load_dwordx4 v[80:83], v37, s[8:11], s40 offen sc1
  buffer_load_dwordx4 v[84:87], v37, s[8:11], s40 offen offset:16 sc1
  s_mul_i32 s40, s55, 2
  s_add_u32 s40, s40, 1
  s_lshl_b32 s41, s28, 3
  s_add_u32 s41, s41, s40
  s_lshl_b32 s41, s41, 11
  s_add_u32 s41, s41, s59
  buffer_load_dwordx4 v[88:91], v38, s[8:11], s41 offen sc1
  buffer_load_dwordx4 v[92:95], v38, s[8:11], s41 offen offset:1024 sc1
  s_add_u32 s41, s41, 65536
  buffer_load_dwordx4 v[96:99], v38, s[8:11], s41 offen sc1
  buffer_load_dwordx4 v[100:103], v38, s[8:11], s41 offen offset:1024 sc1
  s_add_u32 s41, s41, 65536
  buffer_load_dwordx4 v[104:107], v38, s[8:11], s41 offen sc1
  buffer_load_dwordx4 v[108:111], v38, s[8:11], s41 offen offset:1024 sc1
  s_add_u32 s41, s41, 65536
  buffer_load_dwordx4 v[112:115], v38, s[8:11], s41 offen sc1
  buffer_load_dwordx4 v[116:119], v38, s[8:11], s41 offen offset:1024 sc1
  s_add_u32 s41, s41, 65536
  s_and_b32 s41, s40, 3
  s_lshl_b32 s41, s41, 15
  s_lshl_b32 s42, s33, 17
  s_add_u32 s41, s41, s42
  s_lshr_b32 s40, s40, 2
  s_lshl_b32 s40, s40, 6
  s_add_u32 s41, s41, s40
  s_lshl_b32 s40, s32, 7
  s_add_u32 s25, s41, s40
  s_lshl_b32 s40, s25, 1
  s_add_u32 s40, s40, s58
  s_add_u32 s25, s25, s79
  buffer_load_dwordx4 v[120:123], v37, s[8:11], s40 offen sc1
  buffer_load_dwordx4 v[124:127], v37, s[8:11], s40 offen offset:16 sc1
  s_waitcnt vmcnt(10)
  v_add_f32 v48, v48, v56
  v_add_f32 v49, v49, v57
  v_add_f32 v50, v50, v58
  v_add_f32 v51, v51, v59
  v_add_f32 v52, v52, v60
  v_add_f32 v53, v53, v61
  v_add_f32 v54, v54, v62
  v_add_f32 v55, v55, v63
  v_add_f32 v48, v48, v64
  v_add_f32 v49, v49, v65
  v_add_f32 v50, v50, v66
  v_add_f32 v51, v51, v67
  v_add_f32 v52, v52, v68
  v_add_f32 v53, v53, v69
  v_add_f32 v54, v54, v70
  v_add_f32 v55, v55, v71
  v_add_f32 v48, v48, v72
  v_add_f32 v49, v49, v73
  v_add_f32 v50, v50, v74
  v_add_f32 v51, v51, v75
  v_add_f32 v52, v52, v76
  v_add_f32 v53, v53, v77
  v_add_f32 v54, v54, v78
  v_add_f32 v55, v55, v79
  s_nop 1
  v_permlane16_swap_b32 v48, v52
  v_permlane16_swap_b32 v49, v53
  v_permlane16_swap_b32 v50, v54
  v_permlane16_swap_b32 v51, v55
  v_add_f32 v48, v48, v80
  v_add_f32 v49, v49, v81
  v_add_f32 v50, v50, v82
  v_add_f32 v51, v51, v83
  v_add_f32 v52, v52, v84
  v_add_f32 v53, v53, v85
  v_add_f32 v54, v54, v86
  v_add_f32 v55, v55, v87
  v_cvt_pk_bf16_f32 v56, v48, v49
  v_cvt_pk_bf16_f32 v57, v50, v51
  v_cvt_pk_bf16_f32 v58, v52, v53
  v_cvt_pk_bf16_f32 v59, v54, v55
  buffer_store_dwordx4 v[56:59], v36, s[16:19], s24 offen
  s_waitcnt vmcnt(1)
  v_add_f32 v88, v88, v96
  v_add_f32 v89, v89, v97
  v_add_f32 v90, v90, v98
  v_add_f32 v91, v91, v99
  v_add_f32 v92, v92, v100
  v_add_f32 v93, v93, v101
  v_add_f32 v94, v94, v102
  v_add_f32 v95, v95, v103
  v_add_f32 v88, v88, v104
  v_add_f32 v89, v89, v105
  v_add_f32 v90, v90, v106
  v_add_f32 v91, v91, v107
  v_add_f32 v92, v92, v108
  v_add_f32 v93, v93, v109
  v_add_f32 v94, v94, v110
  v_add_f32 v95, v95, v111
  v_add_f32 v88, v88, v112
  v_add_f32 v89, v89, v113
  v_add_f32 v90, v90, v114
  v_add_f32 v91, v91, v115
  v_add_f32 v92, v92, v116
  v_add_f32 v93, v93, v117
  v_add_f32 v94, v94, v118
  v_add_f32 v95, v95, v119
  s_nop 1
  v_permlane16_swap_b32 v88, v92
  v_permlane16_swap_b32 v89, v93
  v_permlane16_swap_b32 v90, v94
  v_permlane16_swap_b32 v91, v95
  v_add_f32 v88, v88, v120
  v_add_f32 v89, v89, v121
  v_add_f32 v90, v90, v122
  v_add_f32 v91, v91, v123
  v_add_f32 v92, v92, v124
  v_add_f32 v93, v93, v125
  v_add_f32 v94, v94, v126
  v_add_f32 v95, v95, v127
  v_cvt_pk_bf16_f32 v96, v88, v89
  v_cvt_pk_bf16_f32 v97, v90, v91
  v_cvt_pk_bf16_f32 v98, v92, v93
  v_cvt_pk_bf16_f32 v99, v94, v95
  buffer_store_dwordx4 v[96:99], v36, s[16:19], s25 offen
  s_branch mk_adv
mk_c_62:
  v_and_b32 v36, 15, v1
  v_lshl_add_u32 v36, v36, 11, v34
  v_lshlrev_b32 v37, 1, v36
  v_lshlrev_b32 v38, 4, v1
  s_mul_i32 s40, s55, 1
  s_add_u32 s40, s40, 0
  s_lshl_b32 s41, s28, 3
  s_add_u32 s41, s41, s40
  s_lshl_b32 s41, s41, 11
  s_add_u32 s41, s41, s59
  buffer_load_dwordx4 v[48:51], v38, s[8:11], s41 offen sc1
  buffer_load_dwordx4 v[52:55], v38, s[8:11], s41 offen offset:1024 sc1
  s_add_u32 s41, s41, 65536
  buffer_load_dwordx4 v[56:59], v38, s[8:11], s41 offen sc1
  buffer_load_dwordx4 v[60:63], v38, s[8:11], s41 offen offset:1024 sc1
  s_add_u32 s41, s41, 65536
  buffer_load_dwordx4 v[64:67], v38, s[8:11], s41 offen sc1
  buffer_load_dwordx4 v[68:71], v38, s[8:11], s41 offen offset:1024 sc1
  s_add_u32 s41, s41, 65536
  buffer_load_dwordx4 v[72:75], v38, s[8:11], s41 offen sc1
  buffer_load_dwordx4 v[76:79], v38, s[8:11], s41 offen offset:1024 sc1
  s_add_u32 s41, s41, 65536
  buffer_load_dwordx4 v[80:83], v38, s[8:11], s41 offen sc1
  buffer_load_dwordx4 v[84:87], v38, s[8:11], s41 offen offset:1024 sc1
  s_add_u32 s41, s41, 65536
  buffer_load_dwordx4 v[88:91], v38, s[8:11], s41 offen sc1
  buffer_load_dwordx4 v[92:95], v38, s[8:11], s41 offen offset:1024 sc1
  s_add_u32 s41, s41, 65536
  buffer_load_dwordx4 v[96:99], v38, s[8:11], s41 offen sc1
  buffer_load_dwordx4 v[100:103], v38, s[8:11], s41 offen offset:1024 sc1
  s_add_u32 s41, s41, 65536
  buffer_load_dwordx4 v[104:107], v38, s[8:11], s41 offen sc1
  buffer_load_dwordx4 v[108:111], v38, s[8:11], s41 offen offset:1024 sc1
  s_add_u32 s41, s41, 65536
  s_and_b32 s41, s40, 3
  s_lshl_b32 s41, s41, 15
  s_lshl_b32 s42, s33, 17
  s_add_u32 s41, s41, s42
  s_lshr_b32 s40, s40, 2
  s_lshl_b32 s40, s40, 6
  s_add_u32 s41, s41, s40
  s_lshl_b32 s40, s32, 7
  s_add_u32 s24, s41, s40
  s_lshl_b32 s40, s24, 1
  s_add_u32 s40, s40, s58
  s_add_u32 s24, s24, s79
  buffer_load_dwordx4 v[112:115], v37, s[8:11], s40 offen sc1
  buffer_load_dwordx4 v[116:119], v37, s[8:11], s40 offen offset:16 sc1
  s_waitcnt vmcnt(0)
  v_add_f32 v48, v48, v56
  v_add_f32 v49, v49, v57
  v_add_f32 v50, v50, v58
  v_add_f32 v51, v51, v59
  v_add_f32 v52, v52, v60
  v_add_f32 v53, v53, v61
  v_add_f32 v54, v54, v62
  v_add_f32 v55, v55, v63
  v_add_f32 v48, v48, v64
  v_add_f32 v49, v49, v65
  v_add_f32 v50, v50, v66
  v_add_f32 v51, v51, v67
  v_add_f32 v52, v52, v68
  v_add_f32 v53, v53, v69
  v_add_f32 v54, v54, v70
  v_add_f32 v55, v55, v71
  v_add_f32 v48, v48, v72
  v_add_f32 v49, v49, v73
  v_add_f32 v50, v50, v74
  v_add_f32 v51, v51, v75
  v_add_f32 v52, v52, v76
  v_add_f32 v53, v53, v77
  v_add_f32 v54, v54, v78
  v_add_f32 v55, v55, v79
  v_add_f32 v48, v48, v80
  v_add_f32 v49, v49, v81
  v_add_f32 v50, v50, v82
  v_add_f32 v51, v51, v83
  v_add_f32 v52, v52, v84
  v_add_f32 v53, v53, v85
  v_add_f32 v54, v54, v86
  v_add_f32 v55, v55, v87
  v_add_f32 v48, v48, v88
  v_add_f32 v49, v49, v89
  v_add_f32 v50, v50, v90
  v_add_f32 v51, v51, v91
  v_add_f32 v52, v52, v92
  v_add_f32 v53, v53, v93
  v_add_f32 v54, v54, v94
  v_add_f32 v55, v55, v95
  v_add_f32 v48, v48, v96
  v_add_f32 v49, v49, v97
  v_add_f32 v50, v50, v98
  v_add_f32 v51, v51, v99
  v_add_f32 v52, v52, v100
  v_add_f32 v53, v53, v101
  v_add_f32 v54, v54, v102
  v_add_f32 v55, v55, v103
  v_add_f32 v48, v48, v104
  v_add_f32 v49, v49, v105
  v_add_f32 v50, v50, v106
  v_add_f32 v51, v51, v107
  v_add_f32 v52, v52, v108
  v_add_f32 v53, v53, v109
  v_add_f32 v54, v54, v110
  v_add_f32 v55, v55, v111
  s_nop 1
  v_permlane16_swap_b32 v48, v52
  v_permlane16_swap_b32 v49, v53
  v_permlane16_swap_b32 v50, v54
  v_permlane16_swap_b32 v51, v55
  v_add_f32 v48, v48, v112
  v_add_f32 v49, v49, v113
  v_add_f32 v50, v50, v114
  v_add_f32 v51, v51, v115
  v_add_f32 v52, v52, v116
  v_add_f32 v53, v53, v117
  v_add_f32 v54, v54, v118
  v_add_f32 v55, v55, v119
  v_cvt_pk_bf16_f32 v56, v48, v49
  v_cvt_pk_bf16_f32 v57, v50, v51
  v_cvt_pk_bf16_f32 v58, v52, v53
  v_cvt_pk_bf16_f32 v59, v54, v55
  buffer_store_dwordx4 v[56:59], v36, s[16:19], s24 offen
  s_branch mk_adv
mk_att:
  v_lshrrev_b32 v2, 6, v0
  s_nop 0
  v_readfirstlane_b32 s5, v2
  s_mul_i32 s22, s5, 10240
  s_mul_i32 s6, s5, s81
  s_add_u32 s21, s79, s6
  s_mul_i32 s6, s5, s82
  s_add_u32 s20, s77, s6
  s_mov_b32 s44, s78
  s_barrier
  s_cmp_ge_u32 s5, s80
  s_cbranch_scc1 mk_adv
  v_and_b32 v1, 63, v0
  v_and_b32 v8, 15, v1
  v_lshrrev_b32 v9, 4, v1
  v_lshlrev_b32 v10, 4, v9
  v_lshl_add_u32 v2, v8, 6, v10
  v_lshl_add_u32 v11, v9, 2, 0
  v_cmp_le_u32 s[32:33], v11, v8
  v_lshl_add_u32 v11, v9, 2, 1
  v_cmp_le_u32 s[34:35], v11, v8
  v_lshl_add_u32 v11, v9, 2, 2
  v_cmp_le_u32 s[36:37], v11, v8
  v_lshl_add_u32 v11, v9, 2, 3
  v_cmp_le_u32 s[38:39], v11, v8
  v_cmp_gt_u32 s[40:41], 2, v9
  v_mov_b32 v11, 2147483648
  v_cmp_gt_u32 vcc, 8, v8
  s_nop 1
  v_cndmask_b32 v3, v11, v2, vcc
  v_lshrrev_b32 v11, 5, v1
  v_lshlrev_b32 v11, 15, v11
  v_and_b32 v10, 31, v1
  v_lshl_add_u32 v4, v10, 4, v11
  v_bfe_u32 v10, v1, 2, 2
  v_lshl_add_u32 v10, v9, 2, v10
  v_lshlrev_b32 v10, 6, v10
  v_and_b32 v11, 3, v1
  v_lshl_add_u32 v5, v11, 3, v10
  v_and_b32 v6, 0x1ff, v5
  v_add_u32 v6, 8192, v6
  v_add_u32 v5, s22, v5
  v_add_u32 v6, s22, v6
  v_bfe_u32 v10, v1, 4, 1
  v_lshlrev_b32 v10, 5, v10
  v_bfe_u32 v11, v1, 5, 1
  v_lshl_add_u32 v10, v11, 4, v10
  v_lshl_add_u32 v7, v8, 6, v10
  v_mov_b32 v128, 0x3f803f80
  v_mov_b32 v129, 0x3f803f80
  v_mov_b32 v130, 0x3f803f80
  v_mov_b32 v131, 0x3f803f80
  v_mov_b32 v118, 0
  v_mov_b32 v119, 0
  v_mov_b32 v126, 0
  v_mov_b32 v127, 0
  v_mov_b32 v114, 0
  v_mov_b32 v115, 0
  s_mov_b32 s23, 0x3e0293ee
mk_atl:
  s_lshl_b32 s5, s21, 7
  s_add_u32 s5, s5, 5705728
  s_lshr_b32 s6, s20, 3
  s_lshl_b32 s6, s6, 6
  s_lshr_b32 s7, s21, 1
  s_lshl_b32 s7, s7, 2
  s_add_u32 s6, s6, s7
  s_add_u32 s6, s6, 5704704
  v_mov_b32 v240, 0
  s_sub_i32 s45, s20, 2
  s_max_i32 s45, s45, -1
mk_a_64:
  buffer_load_dwordx4 v[244:247], v240, s[8:11], s5 offen sc1
  buffer_load_dword v241, v240, s[8:11], s6 offen sc1
  s_waitcnt vmcnt(0)
  v_min3_i32 v244, v244, v245, v246
  v_min_i32 v244, v244, v247
  v_cmp_ge_i32 vcc, s45, v244
  v_cmp_eq_u32 s[42:43], -1, v241
  s_or_b64 vcc, vcc, s[42:43]
  s_cbranch_vccz mk_a_65
  s_sub_u32 s98, s98, 1
  s_cbranch_scc1 mk_end
  s_sleep 2
  s_branch mk_a_64
mk_a_65:
  s_lshl_b32 s24, s21, 19
  s_lshl_b32 s25, s20, 11
  s_add_u32 s24, s24, s25
  s_lshl_b32 s25, s21, 17
  s_lshl_b32 s26, s20, 9
  s_add_u32 s25, s25, s26
  v_lshlrev_b32 v8, 4, v1
  s_add_u32 s26, s24, 50331648
  s_add_u32 s27, s24, 16777216
  buffer_load_dwordx4 v[12:15], v2, s[8:11], s26 offen offset:0 sc1
  buffer_load_dwordx4 v[28:31], v2, s[8:11], s26 offen offset:1024 sc1
  buffer_load_dwordx4 v[44:47], v2, s[8:11], s27 offen offset:0 sc1
  buffer_load_dwordx4 v[60:63], v2, s[8:11], s27 offen offset:1024 sc1
  s_add_u32 s26, s24, 50462720
  s_add_u32 s27, s24, 16908288
  buffer_load_dwordx4 v[16:19], v2, s[8:11], s26 offen offset:0 sc1
  buffer_load_dwordx4 v[32:35], v2, s[8:11], s26 offen offset:1024 sc1
  buffer_load_dwordx4 v[48:51], v2, s[8:11], s27 offen offset:0 sc1
  buffer_load_dwordx4 v[64:67], v2, s[8:11], s27 offen offset:1024 sc1
  s_add_u32 s26, s24, 50593792
  s_add_u32 s27, s24, 17039360
  buffer_load_dwordx4 v[20:23], v2, s[8:11], s26 offen offset:0 sc1
  buffer_load_dwordx4 v[36:39], v2, s[8:11], s26 offen offset:1024 sc1
  buffer_load_dwordx4 v[52:55], v2, s[8:11], s27 offen offset:0 sc1
  buffer_load_dwordx4 v[68:71], v2, s[8:11], s27 offen offset:1024 sc1
  s_add_u32 s26, s24, 50724864
  s_add_u32 s27, s24, 17170432
  buffer_load_dwordx4 v[24:27], v2, s[8:11], s26 offen offset:0 sc1
  buffer_load_dwordx4 v[40:43], v2, s[8:11], s26 offen offset:1024 sc1
  buffer_load_dwordx4 v[56:59], v2, s[8:11], s27 offen offset:0 sc1
  buffer_load_dwordx4 v[72:75], v2, s[8:11], s27 offen offset:1024 sc1
  s_add_u32 m0, s22, 0
  s_add_u32 s26, s24, 33554432
  buffer_load_dwordx4 v8, s[8:11], s26 offen offset:0 sc1 lds
  buffer_load_dwordx4 v8, s[8:11], s26 offen offset:1024 sc1 lds
  s_add_u32 m0, s22, 2048
  s_add_u32 s26, s24, 33685504
  buffer_load_dwordx4 v8, s[8:11], s26 offen offset:0 sc1 lds
  buffer_load_dwordx4 v8, s[8:11], s26 offen offset:1024 sc1 lds
  s_add_u32 m0, s22, 4096
  s_add_u32 s26, s24, 33816576
  buffer_load_dwordx4 v8, s[8:11], s26 offen offset:0 sc1 lds
  buffer_load_dwordx4 v8, s[8:11], s26 offen offset:1024 sc1 lds
  s_add_u32 m0, s22, 6144
  s_add_u32 s26, s24, 33947648
  buffer_load_dwordx4 v8, s[8:11], s26 offen offset:0 sc1 lds
  buffer_load_dwordx4 v8, s[8:11], s26 offen offset:1024 sc1 lds
  s_lshl_b32 s5, s21, 7
  s_add_u32 s5, s5, 5705728
  s_lshr_b32 s6, s20, 3
  s_lshl_b32 s6, s6, 6
  s_lshr_b32 s7, s21, 1
  s_lshl_b32 s7, s7, 2
  s_add_u32 s6, s6, s7
  s_add_u32 s6, s6, 5704704
  v_mov_b32 v240, 0
  s_sub_i32 s45, s20, 0
  s_max_i32 s45, s45, -1
mk_a_66:
  buffer_load_dwordx4 v[244:247], v240, s[8:11], s5 offen sc1
  s_waitcnt vmcnt(0)
  v_min3_i32 v244, v244, v245, v246
  v_min_i32 v244, v244, v247
  v_cmp_ge_i32 vcc, s45, v244
  s_cbranch_vccz mk_a_67
  s_sub_u32 s98, s98, 1
  s_cbranch_scc1 mk_end
  s_sleep 2
  s_branch mk_a_66
mk_a_67:
  s_add_u32 s28, s25, 100663296
  buffer_load_dwordx4 v[76:79], v3, s[8:11], s28 offen sc1
  s_add_u32 s28, s25, 100696064
  buffer_load_dwordx4 v[80:83], v3, s[8:11], s28 offen sc1
  s_add_u32 s28, s25, 100728832
  buffer_load_dwordx4 v[84:87], v3, s[8:11], s28 offen sc1
  s_add_u32 s28, s25, 100761600
  buffer_load_dwordx4 v[88:91], v3, s[8:11], s28 offen sc1
  s_add_u32 m0, s22, 8192
  s_add_u32 s26, s25, 104857600
  buffer_load_dwordx4 v4, s[8:11], s26 offen sc1 lds
  s_add_u32 m0, s22, 9216
  s_add_u32 s26, s25, 104923136
  buffer_load_dwordx4 v4, s[8:11], s26 offen sc1 lds
  s_waitcnt vmcnt(14)
  v_mfma_f32_16x16x32_bf16 v[96:99], v[44:47], v[12:15], 0
  v_mfma_f32_16x16x32_bf16 v[104:107], v[44:47], v[28:31], 0
  v_mfma_f32_16x16x32_bf16 v[108:111], v[60:63], v[28:31], 0
  v_mfma_f32_16x16x32_bf16 v[96:99], v[48:51], v[16:19], v[96:99]
  v_mfma_f32_16x16x32_bf16 v[104:107], v[48:51], v[32:35], v[104:107]
  v_mfma_f32_16x16x32_bf16 v[108:111], v[64:67], v[32:35], v[108:111]
  v_mfma_f32_16x16x32_bf16 v[96:99], v[52:55], v[20:23], v[96:99]
  v_mfma_f32_16x16x32_bf16 v[104:107], v[52:55], v[36:39], v[104:107]
  v_mfma_f32_16x16x32_bf16 v[108:111], v[68:71], v[36:39], v[108:111]
  v_mfma_f32_16x16x32_bf16 v[96:99], v[56:59], v[24:27], v[96:99]
  v_mfma_f32_16x16x32_bf16 v[104:107], v[56:59], v[40:43], v[104:107]
  v_mfma_f32_16x16x32_bf16 v[108:111], v[72:75], v[40:43], v[108:111]
  s_waitcnt vmcnt(5)
  v_mfma_f32_16x16x32_bf16 v[92:95], v[76:79], v[12:15], 0
  v_mfma_f32_16x16x32_bf16 v[100:103], v[76:79], v[28:31], 0
  s_waitcnt vmcnt(4)
  v_mfma_f32_16x16x32_bf16 v[92:95], v[80:83], v[16:19], v[92:95]
  v_mfma_f32_16x16x32_bf16 v[100:103], v[80:83], v[32:35], v[100:103]
  s_waitcnt vmcnt(3)
  v_mfma_f32_16x16x32_bf16 v[92:95], v[84:87], v[20:23], v[92:95]
  v_mfma_f32_16x16x32_bf16 v[100:103], v[84:87], v[36:39], v[100:103]
  s_waitcnt vmcnt(2)
  v_mfma_f32_16x16x32_bf16 v[92:95], v[88:91], v[24:27], v[92:95]
  v_mfma_f32_16x16x32_bf16 v[100:103], v[88:91], v[40:43], v[100:103]
  s_waitcnt vmcnt(0)
  ds_read_b64_tr_b16 v[12:13], v5 offset:0
  ds_read_b64_tr_b16 v[14:15], v5 offset:1024
  ds_read_b64_tr_b16 v[16:17], v5 offset:32
  ds_read_b64_tr_b16 v[18:19], v5 offset:1056
  ds_read_b64_tr_b16 v[20:21], v5 offset:2048
  ds_read_b64_tr_b16 v[22:23], v5 offset:3072
  ds_read_b64_tr_b16 v[24:25], v5 offset:2080
  ds_read_b64_tr_b16 v[26:27], v5 offset:3104
  s_waitcnt lgkmcnt(4)
  ds_read_b64_tr_b16 v[28:29], v5 offset:4096
  ds_read_b64_tr_b16 v[30:31], v5 offset:5120
  ds_read_b64_tr_b16 v[32:33], v5 offset:4128
  ds_read_b64_tr_b16 v[34:35], v5 offset:5152
  ds_read_b64_tr_b16 v[36:37], v5 offset:6144
  ds_read_b64_tr_b16 v[38:39], v5 offset:7168
  ds_read_b64_tr_b16 v[40:41], v5 offset:6176
  ds_read_b64_tr_b16 v[42:43], v5 offset:7200
  s_waitcnt lgkmcnt(4)
  ds_read_b64_tr_b16 v[44:45], v6 offset:0
  v_mov_b32 v46, 0
  v_mov_b32 v47, 0
  ds_read_b64_tr_b16 v[48:49], v6 offset:32
  v_mov_b32 v50, 0
  v_mov_b32 v51, 0
  ds_read_b64_tr_b16 v[52:53], v6 offset:512
  v_mov_b32 v54, 0
  v_mov_b32 v55, 0
  ds_read_b64_tr_b16 v[56:57], v6 offset:544
  v_mov_b32 v58, 0
  v_mov_b32 v59, 0
  ds_read_b64_tr_b16 v[60:61], v6 offset:1024
  v_mov_b32 v62, 0
  v_mov_b32 v63, 0
  ds_read_b64_tr_b16 v[64:65], v6 offset:1056
  v_mov_b32 v66, 0
  v_mov_b32 v67, 0
  ds_read_b64_tr_b16 v[68:69], v6 offset:1536
  v_mov_b32 v70, 0
  v_mov_b32 v71, 0
  ds_read_b64_tr_b16 v[72:73], v6 offset:1568
  v_mov_b32 v74, 0
  v_mov_b32 v75, 0
  v_mov_b32 v11, 0xff800000
  v_cndmask_b32 v92, v11, v92, s[40:41]
  v_cndmask_b32 v96, v11, v96, s[32:33]
  v_cndmask_b32 v93, v11, v93, s[40:41]
  v_cndmask_b32 v97, v11, v97, s[34:35]
  v_cndmask_b32 v94, v11, v94, s[40:41]
  v_cndmask_b32 v98, v11, v98, s[36:37]
  v_cndmask_b32 v95, v11, v95, s[40:41]
  v_cndmask_b32 v99, v11, v99, s[38:39]
  v_max3_f32 v8, v92, v93, v94
  v_max3_f32 v8, v8, v95, v96
  v_max3_f32 v8, v8, v97, v98
  v_max_f32 v8, v8, v99
  v_mov_b32 v9, v8
  s_nop 1
  v_permlane16_swap_b32 v8, v9
  v_max_f32 v8, v8, v9
  v_mov_b32 v9, v8
  s_nop 1
  v_permlane32_swap_b32 v8, v9
  v_max_f32 v8, v8, v9
  v_mul_f32 v8, s23, v8
  v_fma_f32 v92, v92, s23, -v8
  v_fma_f32 v93, v93, s23, -v8
  v_fma_f32 v94, v94, s23, -v8
  v_fma_f32 v95, v95, s23, -v8
  v_fma_f32 v96, v96, s23, -v8
  v_fma_f32 v97, v97, s23, -v8
  v_fma_f32 v98, v98, s23, -v8
  v_fma_f32 v99, v99, s23, -v8
  v_exp_f32 v92, v92
  v_exp_f32 v93, v93
  v_exp_f32 v94, v94
  v_exp_f32 v95, v95
  v_exp_f32 v96, v96
  v_exp_f32 v97, v97
  v_exp_f32 v98, v98
  v_exp_f32 v99, v99
  s_nop 0
  v_cvt_pk_bf16_f32 v116, v92, v93
  v_cvt_pk_bf16_f32 v117, v94, v95
  v_cvt_pk_bf16_f32 v112, v96, v97
  v_cvt_pk_bf16_f32 v113, v98, v99
  v_cndmask_b32 v100, v11, v100, s[40:41]
  v_cndmask_b32 v108, v11, v108, s[32:33]
  v_cndmask_b32 v101, v11, v101, s[40:41]
  v_cndmask_b32 v109, v11, v109, s[34:35]
  v_cndmask_b32 v102, v11, v102, s[40:41]
  v_cndmask_b32 v110, v11, v110, s[36:37]
  v_cndmask_b32 v103, v11, v103, s[40:41]
  v_cndmask_b32 v111, v11, v111, s[38:39]
  v_max3_f32 v8, v100, v101, v102
  v_max3_f32 v8, v8, v103, v104
  v_max3_f32 v8, v8, v105, v106
  v_max3_f32 v8, v8, v107, v108
  v_max3_f32 v8, v8, v109, v110
  v_max_f32 v8, v8, v111
  v_mov_b32 v9, v8
  s_nop 1
  v_permlane16_swap_b32 v8, v9
  v_max_f32 v8, v8, v9
  v_mov_b32 v9, v8
  s_nop 1
  v_permlane32_swap_b32 v8, v9
  v_max_f32 v8, v8, v9
  v_mul_f32 v8, s23, v8
  v_fma_f32 v100, v100, s23, -v8
  v_fma_f32 v101, v101, s23, -v8
  v_fma_f32 v102, v102, s23, -v8
  v_fma_f32 v103, v103, s23, -v8
  v_fma_f32 v104, v104, s23, -v8
  v_fma_f32 v105, v105, s23, -v8
  v_fma_f32 v106, v106, s23, -v8
  v_fma_f32 v107, v107, s23, -v8
  v_fma_f32 v108, v108, s23, -v8
  v_fma_f32 v109, v109, s23, -v8
  v_fma_f32 v110, v110, s23, -v8
  v_fma_f32 v111, v111, s23, -v8
  v_exp_f32 v100, v100
  v_exp_f32 v101, v101
  v_exp_f32 v102, v102
  v_exp_f32 v103, v103
  v_exp_f32 v104, v104
  v_exp_f32 v105, v105
  v_exp_f32 v106, v106
  v_exp_f32 v107, v107
  v_exp_f32 v108, v108
  v_exp_f32 v109, v109
  v_exp_f32 v110, v110
  v_exp_f32 v111, v111
  s_nop 0
  v_cvt_pk_bf16_f32 v124, v100, v101
  v_cvt_pk_bf16_f32 v125, v102, v103
  v_cvt_pk_bf16_f32 v120, v104, v105
  v_cvt_pk_bf16_f32 v121, v106, v107
  v_cvt_pk_bf16_f32 v122, v108, v109
  v_cvt_pk_bf16_f32 v123, v110, v111
  s_nop 1
  v_mfma_f32_16x16x32_bf16 v[136:139], v[128:131], v[112:115], 0
  v_mfma_f32_16x16x32_bf16 v[136:139], v[128:131], v[116:119], v[136:139]
  v_mfma_f32_16x16x32_bf16 v[140:143], v[128:131], v[120:123], 0
  v_mfma_f32_16x16x32_bf16 v[140:143], v[128:131], v[124:127], v[140:143]
  s_waitcnt lgkmcnt(0)
  s_add_u32 s24, s24, 81788928
  v_mfma_f32_16x16x32_bf16 v[144:147], v[12:15], v[112:115], 0
  v_mfma_f32_16x16x32_bf16 v[144:147], v[44:47], v[116:119], v[144:147]
  v_mfma_f32_16x16x32_bf16 v[148:151], v[16:19], v[112:115], 0
  v_mfma_f32_16x16x32_bf16 v[148:151], v[48:51], v[116:119], v[148:151]
  v_mfma_f32_16x16x32_bf16 v[152:155], v[12:15], v[120:123], 0
  v_mfma_f32_16x16x32_bf16 v[152:155], v[44:47], v[124:127], v[152:155]
  v_mfma_f32_16x16x32_bf16 v[156:159], v[16:19], v[120:123], 0
  v_mfma_f32_16x16x32_bf16 v[156:159], v[48:51], v[124:127], v[156:159]
  v_rcp_f32 v8, v136
  v_rcp_f32 v9, v140
  s_nop 3
  v_mul_f32 v144, v144, v8
  v_mul_f32 v145, v145, v8
  v_mul_f32 v146, v146, v8
  v_mul_f32 v147, v147, v8
  v_mul_f32 v148, v148, v8
  v_mul_f32 v149, v149, v8
  v_mul_f32 v150, v150, v8
  v_mul_f32 v151, v151, v8
  v_cvt_pk_bf16_f32 v160, v144, v145
  v_cvt_pk_bf16_f32 v161, v146, v147
  v_cvt_pk_bf16_f32 v162, v148, v149
  v_cvt_pk_bf16_f32 v163, v150, v151
  s_nop 1
  v_permlane16_swap_b32 v160, v162
  v_permlane16_swap_b32 v161, v163
  buffer_store_dwordx4 v[160:163], v7, s[8:11], s24 offen offset:0 sc1
  v_mul_f32 v152, v152, v9
  v_mul_f32 v153, v153, v9
  v_mul_f32 v154, v154, v9
  v_mul_f32 v155, v155, v9
  v_mul_f32 v156, v156, v9
  v_mul_f32 v157, v157, v9
  v_mul_f32 v158, v158, v9
  v_mul_f32 v159, v159, v9
  v_cvt_pk_bf16_f32 v164, v152, v153
  v_cvt_pk_bf16_f32 v165, v154, v155
  v_cvt_pk_bf16_f32 v166, v156, v157
  v_cvt_pk_bf16_f32 v167, v158, v159
  s_nop 1
  v_permlane16_swap_b32 v164, v166
  v_permlane16_swap_b32 v165, v167
  buffer_store_dwordx4 v[164:167], v7, s[8:11], s24 offen offset:1024 sc1
  s_add_u32 s24, s24, 131072
  v_mfma_f32_16x16x32_bf16 v[144:147], v[20:23], v[112:115], 0
  v_mfma_f32_16x16x32_bf16 v[144:147], v[52:55], v[116:119], v[144:147]
  v_mfma_f32_16x16x32_bf16 v[148:151], v[24:27], v[112:115], 0
  v_mfma_f32_16x16x32_bf16 v[148:151], v[56:59], v[116:119], v[148:151]
  v_mfma_f32_16x16x32_bf16 v[152:155], v[20:23], v[120:123], 0
  v_mfma_f32_16x16x32_bf16 v[152:155], v[52:55], v[124:127], v[152:155]
  v_mfma_f32_16x16x32_bf16 v[156:159], v[24:27], v[120:123], 0
  v_mfma_f32_16x16x32_bf16 v[156:159], v[56:59], v[124:127], v[156:159]
  s_nop 3
  v_mul_f32 v144, v144, v8
  v_mul_f32 v145, v145, v8
  v_mul_f32 v146, v146, v8
  v_mul_f32 v147, v147, v8
  v_mul_f32 v148, v148, v8
  v_mul_f32 v149, v149, v8
  v_mul_f32 v150, v150, v8
  v_mul_f32 v151, v151, v8
  v_cvt_pk_bf16_f32 v160, v144, v145
  v_cvt_pk_bf16_f32 v161, v146, v147
  v_cvt_pk_bf16_f32 v162, v148, v149
  v_cvt_pk_bf16_f32 v163, v150, v151
  s_nop 1
  v_permlane16_swap_b32 v160, v162
  v_permlane16_swap_b32 v161, v163
  buffer_store_dwordx4 v[160:163], v7, s[8:11], s24 offen offset:0 sc1
  v_mul_f32 v152, v152, v9
  v_mul_f32 v153, v153, v9
  v_mul_f32 v154, v154, v9
  v_mul_f32 v155, v155, v9
  v_mul_f32 v156, v156, v9
  v_mul_f32 v157, v157, v9
  v_mul_f32 v158, v158, v9
  v_mul_f32 v159, v159, v9
  v_cvt_pk_bf16_f32 v164, v152, v153
  v_cvt_pk_bf16_f32 v165, v154, v155
  v_cvt_pk_bf16_f32 v166, v156, v157
  v_cvt_pk_bf16_f32 v167, v158, v159
  s_nop 1
  v_permlane16_swap_b32 v164, v166
  v_permlane16_swap_b32 v165, v167
  buffer_store_dwordx4 v[164:167], v7, s[8:11], s24 offen offset:1024 sc1
  s_add_u32 s24, s24, 131072
  v_mfma_f32_16x16x32_bf16 v[144:147], v[28:31], v[112:115], 0
  v_mfma_f32_16x16x32_bf16 v[144:147], v[60:63], v[116:119], v[144:147]
  v_mfma_f32_16x16x32_bf16 v[148:151], v[32:35], v[112:115], 0
  v_mfma_f32_16x16x32_bf16 v[148:151], v[64:67], v[116:119], v[148:151]
  v_mfma_f32_16x16x32_bf16 v[152:155], v[28:31], v[120:123], 0
  v_mfma_f32_16x16x32_bf16 v[152:155], v[60:63], v[124:127], v[152:155]
  v_mfma_f32_16x16x32_bf16 v[156:159], v[32:35], v[120:123], 0
  v_mfma_f32_16x16x32_bf16 v[156:159], v[64:67], v[124:127], v[156:159]
  s_nop 3
  v_mul_f32 v144, v144, v8
  v_mul_f32 v145, v145, v8
  v_mul_f32 v146, v146, v8
  v_mul_f32 v147, v147, v8
  v_mul_f32 v148, v148, v8
  v_mul_f32 v149, v149, v8
  v_mul_f32 v150, v150, v8
  v_mul_f32 v151, v151, v8
  v_cvt_pk_bf16_f32 v160, v144, v145
  v_cvt_pk_bf16_f32 v161, v146, v147
  v_cvt_pk_bf16_f32 v162, v148, v149
  v_cvt_pk_bf16_f32 v163, v150, v151
  s_nop 1
  v_permlane16_swap_b32 v160, v162
  v_permlane16_swap_b32 v161, v163
  buffer_store_dwordx4 v[160:163], v7, s[8:11], s24 offen offset:0 sc1
  v_mul_f32 v152, v152, v9
  v_mul_f32 v153, v153, v9
  v_mul_f32 v154, v154, v9
  v_mul_f32 v155, v155, v9
  v_mul_f32 v156, v156, v9
  v_mul_f32 v157, v157, v9
  v_mul_f32 v158, v158, v9
  v_mul_f32 v159, v159, v9
  v_cvt_pk_bf16_f32 v164, v152, v153
  v_cvt_pk_bf16_f32 v165, v154, v155
  v_cvt_pk_bf16_f32 v166, v156, v157
  v_cvt_pk_bf16_f32 v167, v158, v159
  s_nop 1
  v_permlane16_swap_b32 v164, v166
  v_permlane16_swap_b32 v165, v167
  buffer_store_dwordx4 v[164:167], v7, s[8:11], s24 offen offset:1024 sc1
  s_add_u32 s24, s24, 131072
  v_mfma_f32_16x16x32_bf16 v[144:147], v[36:39], v[112:115], 0
  v_mfma_f32_16x16x32_bf16 v[144:147], v[68:71], v[116:119], v[144:147]
  v_mfma_f32_16x16x32_bf16 v[148:151], v[40:43], v[112:115], 0
  v_mfma_f32_16x16x32_bf16 v[148:151], v[72:75], v[116:119], v[148:151]
  v_mfma_f32_16x16x32_bf16 v[152:155], v[36:39], v[120:123], 0
  v_mfma_f32_16x16x32_bf16 v[152:155], v[68:71], v[124:127], v[152:155]
  v_mfma_f32_16x16x32_bf16 v[156:159], v[40:43], v[120:123], 0
  v_mfma_f32_16x16x32_bf16 v[156:159], v[72:75], v[124:127], v[156:159]
  s_nop 3
  v_mul_f32 v144, v144, v8
  v_mul_f32 v145, v145, v8
  v_mul_f32 v146, v146, v8
  v_mul_f32 v147, v147, v8
  v_mul_f32 v148, v148, v8
  v_mul_f32 v149, v149, v8
  v_mul_f32 v150, v150, v8
  v_mul_f32 v151, v151, v8
  v_cvt_pk_bf16_f32 v160, v144, v145
  v_cvt_pk_bf16_f32 v161, v146, v147
  v_cvt_pk_bf16_f32 v162, v148, v149
  v_cvt_pk_bf16_f32 v163, v150, v151
  s_nop 1
  v_permlane16_swap_b32 v160, v162
  v_permlane16_swap_b32 v161, v163
  buffer_store_dwordx4 v[160:163], v7, s[8:11], s24 offen offset:0 sc1
  v_mul_f32 v152, v152, v9
  v_mul_f32 v153, v153, v9
  v_mul_f32 v154, v154, v9
  v_mul_f32 v155, v155, v9
  v_mul_f32 v156, v156, v9
  v_mul_f32 v157, v157, v9
  v_mul_f32 v158, v158, v9
  v_mul_f32 v159, v159, v9
  v_cvt_pk_bf16_f32 v164, v152, v153
  v_cvt_pk_bf16_f32 v165, v154, v155
  v_cvt_pk_bf16_f32 v166, v156, v157
  v_cvt_pk_bf16_f32 v167, v158, v159
  s_nop 1
  v_permlane16_swap_b32 v164, v166
  v_permlane16_swap_b32 v165, v167
  buffer_store_dwordx4 v[164:167], v7, s[8:11], s24 offen offset:1024 sc1
  s_add_u32 s24, s24, 131072
  s_lshl_b32 s5, s20, 7
  s_lshl_b32 s6, s21, 2
  s_add_u32 s5, s5, s6
  s_add_u32 s5, s5, 5709824
  v_mov_b32 v240, 0
  s_waitcnt vmcnt(0)
  buffer_store_dword v240, v240, s[8:11], s5 offen sc1
  s_add_u32 s20, s20, s83
  s_sub_u32 s44, s44, 1
  s_cmp_lg_u32 s44, 0
  s_cbranch_scc1 mk_atl
mk_adv:
  s_mov_b32 s76, s84
  s_mov_b32 s77, s85
  s_mov_b32 s78, s86
  s_mov_b32 s79, s87
  s_mov_b32 s80, s88
  s_mov_b32 s81, s89
  s_mov_b32 s82, s90
  s_mov_b32 s83, s91
  s_add_u32 s70, s70, 32
  s_addc_u32 s71, s71, 0
  s_load_dwordx8 s[84:91], s[70:71], 32
  s_branch mk_next
mk_done:
mk_end:
  s_endpgm
.p2align 6
mk_jobs:
.long 0x0, 0x800000, 0x0, 0x1000000, 0x570000, 0x80000000, 0x0, 0x0
.long 0x0, 0x804000, 0x0, 0x1004000, 0x570100, 0x80000000, 0x0, 0x0
.long 0x10, 0x808000, 0x0, 0x1008000, 0x570200, 0x570208, 0x0, 0x0
.long 0x12, 0x800000, 0x0, 0x3000000, 0x570c00, 0x80000000, 0x0, 0x0
.long 0x10, 0x818000, 0x0, 0x1018000, 0x570600, 0x570608, 0x0, 0x0
.long 0x10, 0x818000, 0x800, 0x1418000, 0x570640, 0x570648, 0x0, 0x0
.long 0xe28, 0x4000000, 0x0, 0x0, 0x574000, 0x574000, 0x570a00, 0x100e00
.long 0x1102b, 0x4e00000, 0x0, 0x0, 0x80000000, 0x574000, 0x572000, 0x402000
.long 0x40425, 0x4e1a000, 0x400, 0x340400, 0x575b04, 0x575b00, 0x573a00, 0x400800
.long 0xff, 0x0, 0x0, 0x0, 0x0, 0x0, 0x0, 0x0
.long 0xff, 0x0, 0x0, 0x0, 0x0, 0x0, 0x0, 0x0
.long 0xff, 0x0, 0x0, 0x0, 0x0, 0x0, 0x0, 0x0
.long 0xff, 0x0, 0x0, 0x0, 0x0, 0x0, 0x0, 0x0
.long 0xff, 0x0, 0x0, 0x0, 0x0, 0x0, 0x0, 0x0
.long 0xff, 0x0, 0x0, 0x0, 0x0, 0x0, 0x0, 0x0
.long 0xff, 0x0, 0x0, 0x0, 0x0, 0x0, 0x0, 0x0
.long 0xff, 0x0, 0x0, 0x0, 0x0, 0x0, 0x0, 0x0
.long 0xff, 0x0, 0x0, 0x0, 0x0, 0x0, 0x0, 0x0
.long 0xff, 0x0, 0x0, 0x0, 0x0, 0x0, 0x0, 0x0
.long 0xff, 0x0, 0x0, 0x0, 0x0, 0x0, 0x0, 0x0
.long 0x0, 0x802000, 0x0, 0x1002000, 0x570800, 0x80000000, 0x0, 0x0
.long 0x0, 0x806000, 0x0, 0x1006000, 0x570900, 0x80000000, 0x0, 0x0
.long 0x10, 0x80c000, 0x0, 0x100c000, 0x570300, 0x570308, 0x0, 0x0
.long 0x12, 0x804000, 0x0, 0x3004000, 0x570c40, 0x80000000, 0x0, 0x0
.long 0x10, 0x818000, 0x200, 0x1118000, 0x570610, 0x570618, 0x0, 0x0
.long 0x10, 0x818000, 0xa00, 0x1518000, 0x570650, 0x570658, 0x0, 0x0
.long 0xe28, 0x4000000, 0x100, 0x100, 0x574040, 0x574040, 0x570a00, 0x100e00
.long 0x1102b, 0x4e00000, 0x100, 0x100, 0x80000000, 0x574040, 0x572000, 0x402000
.long 0x40425, 0x4e1a000, 0x500, 0x340500, 0x575b44, 0x575b40, 0x573a00, 0x400800
.long 0xff, 0x0, 0x0, 0x0, 0x0, 0x0, 0x0, 0x0
.long 0xff, 0x0, 0x0, 0x0, 0x0, 0x0, 0x0, 0x0
.long 0xff, 0x0, 0x0, 0x0, 0x0, 0x0, 0x0, 0x0
.long 0xff, 0x0, 0x0, 0x0, 0x0, 0x0, 0x0, 0x0
.long 0xff, 0x0, 0x0, 0x0, 0x0, 0x0, 0x0, 0x0
.long 0xff, 0x0, 0x0, 0x0, 0x0, 0x0, 0x0, 0x0
.long 0xff, 0x0, 0x0, 0x0, 0x0, 0x0, 0x0, 0x0
.long 0xff, 0x0, 0x0, 0x0, 0x0, 0x0, 0x0, 0x0
.long 0xff, 0x0, 0x0, 0x0, 0x0, 0x0, 0x0, 0x0
.long 0xff, 0x0, 0x0, 0x0, 0x0, 0x0, 0x0, 0x0
.long 0xff, 0x0, 0x0, 0x0, 0x0, 0x0, 0x0, 0x0
.long 0x0, 0x800000, 0x100, 0x1080000, 0x570008, 0x80000000, 0x0, 0x0
.long 0x0, 0x804000, 0x100, 0x1084000, 0x570108, 0x80000000, 0x0, 0x0
.long 0x10, 0x810000, 0x0, 0x1010000, 0x570400, 0x570408, 0x0, 0x0
.long 0x12, 0x808000, 0x0, 0x3008000, 0x570c80, 0x80000000, 0x0, 0x0
.long 0x10, 0x818000, 0x400, 0x1218000, 0x570620, 0x570628, 0x0, 0x0
.long 0x10, 0x818000, 0xc00, 0x1618000, 0x570660, 0x570668, 0x0, 0x0
.long 0xe28, 0x4000000, 0x200, 0x200, 0x574080, 0x574080, 0x570a00, 0x100e00
.long 0x1102b, 0x4e00000, 0x200, 0x200, 0x80000000, 0x574080, 0x572000, 0x402000
.long 0x40425, 0x4e1a000, 0x600, 0x340600, 0x575b84, 0x575b80, 0x573a00, 0x400800
.long 0xff, 0x0, 0x0, 0x0, 0x0, 0x0, 0x0, 0x0
.long 0xff, 0x0, 0x0, 0x0, 0x0, 0x0, 0x0, 0x0
.long 0xff, 0x0, 0x0, 0x0, 0x0, 0x0, 0x0, 0x0
.long 0xff, 0x0, 0x0, 0x0, 0x0, 0x0, 0x0, 0x0
.long 0xff, 0x0, 0x0, 0x0, 0x0, 0x0, 0x0, 0x0
.long 0xff, 0x0, 0x0, 0x0, 0x0, 0x0, 0x0, 0x0
.long 0xff, 0x0, 0x0, 0x0, 0x0, 0x0, 0x0, 0x0
.long 0xff, 0x0, 0x0, 0x0, 0x0, 0x0, 0x0, 0x0
.long 0xff, 0x0, 0x0, 0x0, 0x0, 0x0, 0x0, 0x0
.long 0xff, 0x0, 0x0, 0x0, 0x0, 0x0, 0x0, 0x0
.long 0xff, 0x0, 0x0, 0x0, 0x0, 0x0, 0x0, 0x0
.long 0x0, 0x802000, 0x100, 0x1082000, 0x570808, 0x80000000, 0x0, 0x0
.long 0x0, 0x806000, 0x100, 0x1086000, 0x570908, 0x80000000, 0x0, 0x0
.long 0x10, 0x814000, 0x0, 0x1014000, 0x570500, 0x570508, 0x0, 0x0
.long 0x12, 0x80c000, 0x0, 0x300c000, 0x570cc0, 0x80000000, 0x0, 0x0
.long 0x10, 0x818000, 0x600, 0x1318000, 0x570630, 0x570638, 0x0, 0x0
.long 0x10, 0x818000, 0xe00, 0x1718000, 0x570670, 0x570678, 0x0, 0x0
.long 0xe28, 0x4000000, 0x300, 0x300, 0x5740c0, 0x5740c0, 0x570a00, 0x100e00
.long 0x1102b, 0x4e00000, 0x300, 0x300, 0x80000000, 0x5740c0, 0x572000, 0x402000
.long 0x40425, 0x4e1a000, 0x700, 0x340700, 0x575bc4, 0x575bc0, 0x573a00, 0x400800
.long 0xff, 0x0, 0x0, 0x0, 0x0, 0x0, 0x0, 0x0
.long 0xff, 0x0, 0x0, 0x0, 0x0, 0x0, 0x0, 0x0
.long 0xff, 0x0, 0x0, 0x0, 0x0, 0x0, 0x0, 0x0
.long 0xff, 0x0, 0x0, 0x0, 0x0, 0x0, 0x0, 0x0
.long 0xff, 0x0, 0x0, 0x0, 0x0, 0x0, 0x0, 0x0
.long 0xff, 0x0, 0x0, 0x0, 0x0, 0x0, 0x0, 0x0
.long 0xff, 0x0, 0x0, 0x0, 0x0, 0x0, 0x0, 0x0
.long 0xff, 0x0, 0x0, 0x0, 0x0, 0x0, 0x0, 0x0
.long 0xff, 0x0, 0x0, 0x0, 0x0, 0x0, 0x0, 0x0
.long 0xff, 0x0, 0x0, 0x0, 0x0, 0x0, 0x0, 0x0
.long 0xff, 0x0, 0x0, 0x0, 0x0, 0x0, 0x0, 0x0
.long 0x0, 0x800000, 0x200, 0x1100000, 0x570010, 0x80000000, 0x0, 0x0
.long 0x0, 0x804000, 0x200, 0x1104000, 0x570110, 0x80000000, 0x0, 0x0
.long 0x10, 0x808000, 0x200, 0x1108000, 0x570210, 0x570218, 0x0, 0x0
.long 0x12, 0x810000, 0x0, 0x3010000, 0x570d00, 0x80000000, 0x0, 0x0
.long 0x13, 0x800000, 0x0, 0x4000000, 0x570a00, 0x80000000, 0x0, 0x0
.long 0x10, 0x81c000, 0x0, 0x101c000, 0x570700, 0x570708, 0x0, 0x0
.long 0xe28, 0x4000000, 0x400, 0x400, 0x574100, 0x574100, 0x570a00, 0x100e00
.long 0x1102b, 0x4e00000, 0x400, 0x400, 0x80000000, 0x574100, 0x572000, 0x402000
.long 0x140425, 0x521a000, 0x200000, 0x340000, 0x575a08, 0x575a00, 0x573a00, 0x400808
.long 0xff, 0x0, 0x0, 0x0, 0x0, 0x0, 0x0, 0x0
.long 0xff, 0x0, 0x0, 0x0, 0x0, 0x0, 0x0, 0x0
.long 0xff, 0x0, 0x0, 0x0, 0x0, 0x0, 0x0, 0x0
.long 0xff, 0x0, 0x0, 0x0, 0x0, 0x0, 0x0, 0x0
.long 0xff, 0x0, 0x0, 0x0, 0x0, 0x0, 0x0, 0x0
.long 0xff, 0x0, 0x0, 0x0, 0x0, 0x0, 0x0, 0x0
.long 0xff, 0x0, 0x0, 0x0, 0x0, 0x0, 0x0, 0x0
.long 0xff, 0x0, 0x0, 0x0, 0x0, 0x0, 0x0, 0x0
.long 0xff, 0x0, 0x0, 0x0, 0x0, 0x0, 0x0, 0x0
.long 0xff, 0x0, 0x0, 0x0, 0x0, 0x0, 0x0, 0x0
.long 0xff, 0x0, 0x0, 0x0, 0x0, 0x0, 0x0, 0x0
.long 0x0, 0x802000, 0x200, 0x1102000, 0x570810, 0x80000000, 0x0, 0x0
.long 0x0, 0x806000, 0x200, 0x1106000, 0x570910, 0x80000000, 0x0, 0x0
.long 0x10, 0x80c000, 0x200, 0x110c000, 0x570310, 0x570318, 0x0, 0x0
.long 0x12, 0x814000, 0x0, 0x3014000, 0x570d40, 0x80000000, 0x0, 0x0
.long 0x13, 0x804000, 0x0, 0x4004000, 0x570a40, 0x80000000, 0x0, 0x0
.long 0x10, 0x81c000, 0x200, 0x111c000, 0x570710, 0x570718, 0x0, 0x0
.long 0xe28, 0x4000000, 0x500, 0x500, 0x574140, 0x574140, 0x570a00, 0x100e00
.long 0x1102b, 0x4e00000, 0x500, 0x500, 0x80000000, 0x574140, 0x572000, 0x402000
.long 0x140425, 0x521a000, 0x200100, 0x340100, 0x575a48, 0x575a40, 0x573a00, 0x400808
.long 0xff, 0x0, 0x0, 0x0, 0x0, 0x0, 0x0, 0x0
.long 0xff, 0x0, 0x0, 0x0, 0x0, 0x0, 0x0, 0x0
.long 0xff, 0x0, 0x0, 0x0, 0x0, 0x0, 0x0, 0x0
.long 0xff, 0x0, 0x0, 0x0, 0x0, 0x0, 0x0, 0x0
.long 0xff, 0x0, 0x0, 0x0, 0x0, 0x0, 0x0, 0x0
.long 0xff, 0x0, 0x0, 0x0, 0x0, 0x0, 0x0, 0x0
.long 0xff, 0x0, 0x0, 0x0, 0x0, 0x0, 0x0, 0x0
.long 0xff, 0x0, 0x0, 0x0, 0x0, 0x0, 0x0, 0x0
.long 0xff, 0x0, 0x0, 0x0, 0x0, 0x0, 0x0, 0x0
.long 0xff, 0x0, 0x0, 0x0, 0x0, 0x0, 0x0, 0x0
.long 0xff, 0x0, 0x0, 0x0, 0x0, 0x0, 0x0, 0x0
.long 0x0, 0x800000, 0x300, 0x1180000, 0x570018, 0x80000000, 0x0, 0x0
.long 0x0, 0x804000, 0x300, 0x1184000, 0x570118, 0x80000000, 0x0, 0x0
.long 0x10, 0x810000, 0x200, 0x1110000, 0x570410, 0x570418, 0x0, 0x0
.long 0x12, 0x818000, 0x0, 0x3018000, 0x570d80, 0x80000000, 0x0, 0x0
.long 0x13, 0x808000, 0x0, 0x4008000, 0x570a80, 0x80000000, 0x0, 0x0
.long 0x10, 0x81c000, 0x400, 0x121c000, 0x570720, 0x570728, 0x0, 0x0
.long 0xe28, 0x4000000, 0x600, 0x600, 0x574180, 0x574180, 0x570a00, 0x100e00
.long 0x1102b, 0x4e00000, 0x600, 0x600, 0x80000000, 0x574180, 0x572000, 0x402000
.long 0x140425, 0x521a000, 0x200200, 0x340200, 0x575a88, 0x575a80, 0x573a00, 0x400808
.long 0xff, 0x0, 0x0, 0x0, 0x0, 0x0, 0x0, 0x0
.long 0xff, 0x0, 0x0, 0x0, 0x0, 0x0, 0x0, 0x0
.long 0xff, 0x0, 0x0, 0x0, 0x0, 0x0, 0x0, 0x0
.long 0xff, 0x0, 0x0, 0x0, 0x0, 0x0, 0x0, 0x0
.long 0xff, 0x0, 0x0, 0x0, 0x0, 0x0, 0x0, 0x0
.long 0xff, 0x0, 0x0, 0x0, 0x0, 0x0, 0x0, 0x0
.long 0xff, 0x0, 0x0, 0x0, 0x0, 0x0, 0x0, 0x0
.long 0xff, 0x0, 0x0, 0x0, 0x0, 0x0, 0x0, 0x0
.long 0xff, 0x0, 0x0, 0x0, 0x0, 0x0, 0x0, 0x0
.long 0xff, 0x0, 0x0, 0x0, 0x0, 0x0, 0x0, 0x0
.long 0xff, 0x0, 0x0, 0x0, 0x0, 0x0, 0x0, 0x0
.long 0x0, 0x802000, 0x300, 0x1182000, 0x570818, 0x80000000, 0x0, 0x0
.long 0x0, 0x806000, 0x300, 0x1186000, 0x570918, 0x80000000, 0x0, 0x0
.long 0x10, 0x814000, 0x200, 0x1114000, 0x570510, 0x570518, 0x0, 0x0
.long 0x12, 0x81c000, 0x0, 0x301c000, 0x570dc0, 0x80000000, 0x0, 0x0
.long 0x13, 0x80c000, 0x0, 0x400c000, 0x570ac0, 0x80000000, 0x0, 0x0
.long 0x10, 0x81c000, 0x600, 0x131c000, 0x570730, 0x570738, 0x0, 0x0
.long 0xe28, 0x4000000, 0x700, 0x700, 0x5741c0, 0x5741c0, 0x570a00, 0x100e00
.long 0x1102b, 0x4e00000, 0x700, 0x700, 0x80000000, 0x5741c0, 0x572000, 0x402000
.long 0x140425, 0x521a000, 0x200300, 0x340300, 0x575ac8, 0x575ac0, 0x573a00, 0x400808
.long 0xff, 0x0, 0x0, 0x0, 0x0, 0x0, 0x0, 0x0
.long 0xff, 0x0, 0x0, 0x0, 0x0, 0x0, 0x0, 0x0
.long 0xff, 0x0, 0x0, 0x0, 0x0, 0x0, 0x0, 0x0
.long 0xff, 0x0, 0x0, 0x0, 0x0, 0x0, 0x0, 0x0
.long 0xff, 0x0, 0x0, 0x0, 0x0, 0x0, 0x0, 0x0
.long 0xff, 0x0, 0x0, 0x0, 0x0, 0x0, 0x0, 0x0
.long 0xff, 0x0, 0x0, 0x0, 0x0, 0x0, 0x0, 0x0
.long 0xff, 0x0, 0x0, 0x0, 0x0, 0x0, 0x0, 0x0
.long 0xff, 0x0, 0x0, 0x0, 0x0, 0x0, 0x0, 0x0
.long 0xff, 0x0, 0x0, 0x0, 0x0, 0x0, 0x0, 0x0
.long 0xff, 0x0, 0x0, 0x0, 0x0, 0x0, 0x0, 0x0
.long 0x0, 0x800000, 0x400, 0x1200000, 0x570020, 0x80000000, 0x0, 0x0
.long 0x0, 0x804000, 0x400, 0x1204000, 0x570120, 0x80000000, 0x0, 0x0
.long 0x10, 0x808000, 0x400, 0x1208000, 0x570220, 0x570228, 0x0, 0x0
.long 0x12, 0x800000, 0x200, 0x3100000, 0x570c04, 0x80000000, 0x0, 0x0
.long 0x13, 0x810000, 0x0, 0x4010000, 0x570b00, 0x80000000, 0x0, 0x0
.long 0x10, 0x81c000, 0x800, 0x141c000, 0x570740, 0x570748, 0x0, 0x0
.long 0xe28, 0x4008000, 0x0, 0x100000, 0x574800, 0x574800, 0x570a80, 0x100e00
.long 0x1102b, 0x4e08000, 0x0, 0x100000, 0x80000000, 0x574800, 0x572800, 0x402000
.long 0x140425, 0x521a000, 0x200400, 0x340400, 0x575b08, 0x575b00, 0x573a00, 0x400808
.long 0xff, 0x0, 0x0, 0x0, 0x0, 0x0, 0x0, 0x0
.long 0xff, 0x0, 0x0, 0x0, 0x0, 0x0, 0x0, 0x0
.long 0xff, 0x0, 0x0, 0x0, 0x0, 0x0, 0x0, 0x0
.long 0xff, 0x0, 0x0, 0x0, 0x0, 0x0, 0x0, 0x0
.long 0xff, 0x0, 0x0, 0x0, 0x0, 0x0, 0x0, 0x0
.long 0xff, 0x0, 0x0, 0x0, 0x0, 0x0, 0x0, 0x0
.long 0xff, 0x0, 0x0, 0x0, 0x0, 0x0, 0x0, 0x0
.long 0xff, 0x0, 0x0, 0x0, 0x0, 0x0, 0x0, 0x0
.long 0xff, 0x0, 0x0, 0x0, 0x0, 0x0, 0x0, 0x0
.long 0xff, 0x0, 0x0, 0x0, 0x0, 0x0, 0x0, 0x0
.long 0xff, 0x0, 0x0, 0x0, 0x0, 0x0, 0x0, 0x0
.long 0x0, 0x802000, 0x400, 0x1202000, 0x570820, 0x80000000, 0x0, 0x0
.long 0x0, 0x806000, 0x400, 0x1206000, 0x570920, 0x80000000, 0x0, 0x0
.long 0x10, 0x80c000, 0x400, 0x120c000, 0x570320, 0x570328, 0x0, 0x0
.long 0x12, 0x804000, 0x200, 0x3104000, 0x570c44, 0x80000000, 0x0, 0x0
.long 0x13, 0x814000, 0x0, 0x4014000, 0x570b40, 0x80000000, 0x0, 0x0
.long 0x10, 0x81c000, 0xa00, 0x151c000, 0x570750, 0x570758, 0x0, 0x0
.long 0xe28, 0x4008000, 0x100, 0x100100, 0x574840, 0x574840, 0x570a80, 0x100e00
.long 0x1102b, 0x4e08000, 0x100, 0x100100, 0x80000000, 0x574840, 0x572800, 0x402000
.long 0x140425, 0x521a000, 0x200500, 0x340500, 0x575b48, 0x575b40, 0x573a00, 0x400808
.long 0xff, 0x0, 0x0, 0x0, 0x0, 0x0, 0x0, 0x0
.long 0xff, 0x0, 0x0, 0x0, 0x0, 0x0, 0x0, 0x0
.long 0xff, 0x0, 0x0, 0x0, 0x0, 0x0, 0x0, 0x0
.long 0xff, 0x0, 0x0, 0x0, 0x0, 0x0, 0x0, 0x0
.long 0xff, 0x0, 0x0, 0x0, 0x0, 0x0, 0x0, 0x0
.long 0xff, 0x0, 0x0, 0x0, 0x0, 0x0, 0x0, 0x0
.long 0xff, 0x0, 0x0, 0x0, 0x0, 0x0, 0x0, 0x0
.long 0xff, 0x0, 0x0, 0x0, 0x0, 0x0, 0x0, 0x0
.long 0xff, 0x0, 0x0, 0x0, 0x0, 0x0, 0x0, 0x0
.long 0xff, 0x0, 0x0, 0x0, 0x0, 0x0, 0x0, 0x0
.long 0xff, 0x0, 0x0, 0x0, 0x0, 0x0, 0x0, 0x0
.long 0x0, 0x800000, 0x500, 0x1280000, 0x570028, 0x80000000, 0x0, 0x0
.long 0x0, 0x804000, 0x500, 0x1284000, 0x570128, 0x80000000, 0x0, 0x0
.long 0x10, 0x810000, 0x400, 0x1210000, 0x570420, 0x570428, 0x0, 0x0
.long 0x12, 0x808000, 0x200, 0x3108000, 0x570c84, 0x80000000, 0x0, 0x0
.long 0x13, 0x818000, 0x0, 0x4018000, 0x570b80, 0x80000000, 0x0, 0x0
.long 0x10, 0x81c000, 0xc00, 0x161c000, 0x570760, 0x570768, 0x0, 0x0
.long 0xe28, 0x4008000, 0x200, 0x100200, 0x574880, 0x574880, 0x570a80, 0x100e00
.long 0x1102b, 0x4e08000, 0x200, 0x100200, 0x80000000, 0x574880, 0x572800, 0x402000
.long 0x140425, 0x521a000, 0x200600, 0x340600, 0x575b88, 0x575b80, 0x573a00, 0x400808
.long 0xff, 0x0, 0x0, 0x0, 0x0, 0x0, 0x0, 0x0
.long 0xff, 0x0, 0x0, 0x0, 0x0, 0x0, 0x0, 0x0
.long 0xff, 0x0, 0x0, 0x0, 0x0, 0x0, 0x0, 0x0
.long 0xff, 0x0, 0x0, 0x0, 0x0, 0x0, 0x0, 0x0
.long 0xff, 0x0, 0x0, 0x0, 0x0, 0x0, 0x0, 0x0
.long 0xff, 0x0, 0x0, 0x0, 0x0, 0x0, 0x0, 0x0
.long 0xff, 0x0, 0x0, 0x0, 0x0, 0x0, 0x0, 0x0
.long 0xff, 0x0, 0x0, 0x0, 0x0, 0x0, 0x0, 0x0
.long 0xff, 0x0, 0x0, 0x0, 0x0, 0x0, 0x0, 0x0
.long 0xff, 0x0, 0x0, 0x0, 0x0, 0x0, 0x0, 0x0
.long 0xff, 0x0, 0x0, 0x0, 0x0, 0x0, 0x0, 0x0
.long 0x0, 0x802000, 0x500, 0x1282000, 0x570828, 0x80000000, 0x0, 0x0
.long 0x0, 0x806000, 0x500, 0x1286000, 0x570928, 0x80000000, 0x0, 0x0
.long 0x10, 0x814000, 0x400, 0x1214000, 0x570520, 0x570528, 0x0, 0x0
.long 0x12, 0x80c000, 0x200, 0x310c000, 0x570cc4, 0x80000000, 0x0, 0x0
.long 0x13, 0x81c000, 0x0, 0x401c000, 0x570bc0, 0x80000000, 0x0, 0x0
.long 0x10, 0x81c000, 0xe00, 0x171c000, 0x570770, 0x570778, 0x0, 0x0
.long 0xe28, 0x4008000, 0x300, 0x100300, 0x5748c0, 0x5748c0, 0x570a80, 0x100e00
.long 0x1102b, 0x4e08000, 0x300, 0x100300, 0x80000000, 0x5748c0, 0x572800, 0x402000
.long 0x140425, 0x521a000, 0x200700, 0x340700, 0x575bc8, 0x575bc0, 0x573a00, 0x400808
.long 0xff, 0x0, 0x0, 0x0, 0x0, 0x0, 0x0, 0x0
.long 0xff, 0x0, 0x0, 0x0, 0x0, 0x0, 0x0, 0x0
.long 0xff, 0x0, 0x0, 0x0, 0x0, 0x0, 0x0, 0x0
.long 0xff, 0x0, 0x0, 0x0, 0x0, 0x0, 0x0, 0x0
.long 0xff, 0x0, 0x0, 0x0, 0x0, 0x0, 0x0, 0x0
.long 0xff, 0x0, 0x0, 0x0, 0x0, 0x0, 0x0, 0x0
.long 0xff, 0x0, 0x0, 0x0, 0x0, 0x0, 0x0, 0x0
.long 0xff, 0x0, 0x0, 0x0, 0x0, 0x0, 0x0, 0x0
.long 0xff, 0x0, 0x0, 0x0, 0x0, 0x0, 0x0, 0x0
.long 0xff, 0x0, 0x0, 0x0, 0x0, 0x0, 0x0, 0x0
.long 0xff, 0x0, 0x0, 0x0, 0x0, 0x0, 0x0, 0x0
.long 0x0, 0x800000, 0x600, 0x1300000, 0x570030, 0x80000000, 0x0, 0x0
.long 0x0, 0x804000, 0x600, 0x1304000, 0x570130, 0x80000000, 0x0, 0x0
.long 0x10, 0x808000, 0x600, 0x1308000, 0x570230, 0x570238, 0x0, 0x0
.long 0x12, 0x810000, 0x200, 0x3110000, 0x570d04, 0x80000000, 0x0, 0x0
.long 0x13, 0x800000, 0x200, 0x4100000, 0x570a04, 0x80000000, 0x0, 0x0
.long 0x40, 0x0, 0x2, 0x0, 0x4, 0x1, 0x0, 0x1
.long 0x40, 0x14, 0x2, 0x0, 0x4, 0x1, 0x0, 0x1
.long 0xe28, 0x4008000, 0x400, 0x100400, 0x574900, 0x574900, 0x570a80, 0x100e00
.long 0x1102b, 0x4e08000, 0x400, 0x100400, 0x80000000, 0x574900, 0x572800, 0x402000
.long 0x40425, 0x4e18000, 0x0, 0x300000, 0x575804, 0x575800, 0x573800, 0x400800
.long 0x240425, 0x561c000, 0x400000, 0x380000, 0x575c0c, 0x575c00, 0x573c00, 0x400810
.long 0xff, 0x0, 0x0, 0x0, 0x0, 0x0, 0x0, 0x0
.long 0xff, 0x0, 0x0, 0x0, 0x0, 0x0, 0x0, 0x0
.long 0xff, 0x0, 0x0, 0x0, 0x0, 0x0, 0x0, 0x0
.long 0xff, 0x0, 0x0, 0x0, 0x0, 0x0, 0x0, 0x0
.long 0xff, 0x0, 0x0, 0x0, 0x0, 0x0, 0x0, 0x0
.long 0xff, 0x0, 0x0, 0x0, 0x0, 0x0, 0x0, 0x0
.long 0xff, 0x0, 0x0, 0x0, 0x0, 0x0, 0x0, 0x0
.long 0xff, 0x0, 0x0, 0x0, 0x0, 0x0, 0x0, 0x0
.long 0xff, 0x0, 0x0, 0x0, 0x0, 0x0, 0x0, 0x0
.long 0x0, 0x802000, 0x600, 0x1302000, 0x570830, 0x80000000, 0x0, 0x0
.long 0x0, 0x806000, 0x600, 0x1306000, 0x570930, 0x80000000, 0x0, 0x0
.long 0x10, 0x80c000, 0x600, 0x130c000, 0x570330, 0x570338, 0x0, 0x0
.long 0x12, 0x814000, 0x200, 0x3114000, 0x570d44, 0x80000000, 0x0, 0x0
.long 0x13, 0x804000, 0x200, 0x4104000, 0x570a44, 0x80000000, 0x0, 0x0
.long 0x40, 0x0, 0x2, 0x4, 0x4, 0x1, 0x0, 0x1
.long 0x40, 0x14, 0x2, 0x4, 0x4, 0x1, 0x0, 0x1
.long 0xe28, 0x4008000, 0x500, 0x100500, 0x574940, 0x574940, 0x570a80, 0x100e00
.long 0x1102b, 0x4e08000, 0x500, 0x100500, 0x80000000, 0x574940, 0x572800, 0x402000
.long 0x40425, 0x4e18000, 0x100, 0x300100, 0x575844, 0x575840, 0x573800, 0x400800
.long 0x240425, 0x561c000, 0x400100, 0x380100, 0x575c4c, 0x575c40, 0x573c00, 0x400810
.long 0xff, 0x0, 0x0, 0x0, 0x0, 0x0, 0x0, 0x0
.long 0xff, 0x0, 0x0, 0x0, 0x0, 0x0, 0x0, 0x0
.long 0xff, 0x0, 0x0, 0x0, 0x0, 0x0, 0x0, 0x0
.long 0xff, 0x0, 0x0, 0x0, 0x0, 0x0, 0x0, 0x0
.long 0xff, 0x0, 0x0, 0x0, 0x0, 0x0, 0x0, 0x0
.long 0xff, 0x0, 0x0, 0x0, 0x0, 0x0, 0x0, 0x0
.long 0xff, 0x0, 0x0, 0x0, 0x0, 0x0, 0x0, 0x0
.long 0xff, 0x0, 0x0, 0x0, 0x0, 0x0, 0x0, 0x0
.long 0xff, 0x0, 0x0, 0x0, 0x0, 0x0, 0x0, 0x0
.long 0x0, 0x800000, 0x700, 0x1380000, 0x570038, 0x80000000, 0x0, 0x0
.long 0x0, 0x804000, 0x700, 0x1384000, 0x570138, 0x80000000, 0x0, 0x0
.long 0x10, 0x810000, 0x600, 0x1310000, 0x570430, 0x570438, 0x0, 0x0
.long 0x12, 0x818000, 0x200, 0x3118000, 0x570d84, 0x80000000, 0x0, 0x0
.long 0x13, 0x808000, 0x200, 0x4108000, 0x570a84, 0x80000000, 0x0, 0x0
.long 0x40, 0x0, 0x2, 0x8, 0x4, 0x1, 0x0, 0x1
.long 0x40, 0x14, 0x2, 0x8, 0x4, 0x1, 0x0, 0x1
.long 0xe28, 0x4008000, 0x600, 0x100600, 0x574980, 0x574980, 0x570a80, 0x100e00
.long 0x1102b, 0x4e08000, 0x600, 0x100600, 0x80000000, 0x574980, 0x572800, 0x402000
.long 0x40425, 0x4e18000, 0x200, 0x300200, 0x575884, 0x575880, 0x573800, 0x400800
.long 0x240425, 0x561c000, 0x400200, 0x380200, 0x575c8c, 0x575c80, 0x573c00, 0x400810
.long 0xff, 0x0, 0x0, 0x0, 0x0, 0x0, 0x0, 0x0
.long 0xff, 0x0, 0x0, 0x0, 0x0, 0x0, 0x0, 0x0
.long 0xff, 0x0, 0x0, 0x0, 0x0, 0x0, 0x0, 0x0
.long 0xff, 0x0, 0x0, 0x0, 0x0, 0x0, 0x0, 0x0
.long 0xff, 0x0, 0x0, 0x0, 0x0, 0x0, 0x0, 0x0
.long 0xff, 0x0, 0x0, 0x0, 0x0, 0x0, 0x0, 0x0
.long 0xff, 0x0, 0x0, 0x0, 0x0, 0x0, 0x0, 0x0
.long 0xff, 0x0, 0x0, 0x0, 0x0, 0x0, 0x0, 0x0
.long 0xff, 0x0, 0x0, 0x0, 0x0, 0x0, 0x0, 0x0
.long 0x0, 0x802000, 0x700, 0x1382000, 0x570838, 0x80000000, 0x0, 0x0
.long 0x0, 0x806000, 0x700, 0x1386000, 0x570938, 0x80000000, 0x0, 0x0
.long 0x10, 0x814000, 0x600, 0x1314000, 0x570530, 0x570538, 0x0, 0x0
.long 0x12, 0x81c000, 0x200, 0x311c000, 0x570dc4, 0x80000000, 0x0, 0x0
.long 0x13, 0x80c000, 0x200, 0x410c000, 0x570ac4, 0x80000000, 0x0, 0x0
.long 0x40, 0x0, 0x2, 0xc, 0x4, 0x1, 0x0, 0x1
.long 0x40, 0x14, 0x2, 0xc, 0x4, 0x1, 0x0, 0x1
.long 0xe28, 0x4008000, 0x700, 0x100700, 0x5749c0, 0x5749c0, 0x570a80, 0x100e00
.long 0x1102b, 0x4e08000, 0x700, 0x100700, 0x80000000, 0x5749c0, 0x572800, 0x402000
.long 0x40425, 0x4e18000, 0x300, 0x300300, 0x5758c4, 0x5758c0, 0x573800, 0x400800
.long 0x240425, 0x561c000, 0x400300, 0x380300, 0x575ccc, 0x575cc0, 0x573c00, 0x400810
.long 0xff, 0x0, 0x0, 0x0, 0x0, 0x0, 0x0, 0x0
.long 0xff, 0x0, 0x0, 0x0, 0x0, 0x0, 0x0, 0x0
.long 0xff, 0x0, 0x0, 0x0, 0x0, 0x0, 0x0, 0x0
.long 0xff, 0x0, 0x0, 0x0, 0x0, 0x0, 0x0, 0x0
.long 0xff, 0x0, 0x0, 0x0, 0x0, 0x0, 0x0, 0x0
.long 0xff, 0x0, 0x0, 0x0, 0x0, 0x0, 0x0, 0x0
.long 0xff, 0x0, 0x0, 0x0, 0x0, 0x0, 0x0, 0x0
.long 0xff, 0x0, 0x0, 0x0, 0x0, 0x0, 0x0, 0x0
.long 0xff, 0x0, 0x0, 0x0, 0x0, 0x0, 0x0, 0x0
.long 0x0, 0x800000, 0x800, 0x1400000, 0x570040, 0x80000000, 0x0, 0x0
.long 0x0, 0x804000, 0x800, 0x1404000, 0x570140, 0x80000000, 0x0, 0x0
.long 0x10, 0x808000, 0x800, 0x1408000, 0x570240, 0x570248, 0x0, 0x0
.long 0x12, 0x800000, 0x400, 0x3200000, 0x570c08, 0x80000000, 0x0, 0x0
.long 0x13, 0x810000, 0x200, 0x4110000, 0x570b04, 0x80000000, 0x0, 0x0
.long 0x40, 0x0, 0x2, 0x10, 0x4, 0x1, 0x0, 0x1
.long 0x40, 0x14, 0x2, 0x10, 0x4, 0x1, 0x0, 0x1
.long 0xe28, 0x4010000, 0x0, 0x200000, 0x575000, 0x575000, 0x570b00, 0x100e00
.long 0x1102b, 0x4e10000, 0x0, 0x200000, 0x80000000, 0x575000, 0x573000, 0x402000
.long 0x40425, 0x4e18000, 0x400, 0x300400, 0x575904, 0x575900, 0x573800, 0x400800
.long 0x240425, 0x561c000, 0x400400, 0x380400, 0x575d0c, 0x575d00, 0x573c00, 0x400810
.long 0xff, 0x0, 0x0, 0x0, 0x0, 0x0, 0x0, 0x0
.long 0xff, 0x0, 0x0, 0x0, 0x0, 0x0, 0x0, 0x0
.long 0xff, 0x0, 0x0, 0x0, 0x0, 0x0, 0x0, 0x0
.long 0xff, 0x0, 0x0, 0x0, 0x0, 0x0, 0x0, 0x0
.long 0xff, 0x0, 0x0, 0x0, 0x0, 0x0, 0x0, 0x0
.long 0xff, 0x0, 0x0, 0x0, 0x0, 0x0, 0x0, 0x0
.long 0xff, 0x0, 0x0, 0x0, 0x0, 0x0, 0x0, 0x0
.long 0xff, 0x0, 0x0, 0x0, 0x0, 0x0, 0x0, 0x0
.long 0xff, 0x0, 0x0, 0x0, 0x0, 0x0, 0x0, 0x0
.long 0x0, 0x802000, 0x800, 0x1402000, 0x570840, 0x80000000, 0x0, 0x0
.long 0x0, 0x806000, 0x800, 0x1406000, 0x570940, 0x80000000, 0x0, 0x0
.long 0x10, 0x80c000, 0x800, 0x140c000, 0x570340, 0x570348, 0x0, 0x0
.long 0x12, 0x804000, 0x400, 0x3204000, 0x570c48, 0x80000000, 0x0, 0x0
.long 0x13, 0x814000, 0x200, 0x4114000, 0x570b44, 0x80000000, 0x0, 0x0
.long 0x40, 0x0, 0x2, 0x14, 0x4, 0x1, 0x0, 0x1
.long 0x40, 0x14, 0x2, 0x14, 0x4, 0x1, 0x0, 0x1
.long 0xe28, 0x4010000, 0x100, 0x200100, 0x575040, 0x575040, 0x570b00, 0x100e00
.long 0x1102b, 0x4e10000, 0x100, 0x200100, 0x80000000, 0x575040, 0x573000, 0x402000
.long 0x40425, 0x4e18000, 0x500, 0x300500, 0x575944, 0x575940, 0x573800, 0x400800
.long 0x240425, 0x561c000, 0x400500, 0x380500, 0x575d4c, 0x575d40, 0x573c00, 0x400810
.long 0xff, 0x0, 0x0, 0x0, 0x0, 0x0, 0x0, 0x0
.long 0xff, 0x0, 0x0, 0x0, 0x0, 0x0, 0x0, 0x0
.long 0xff, 0x0, 0x0, 0x0, 0x0, 0x0, 0x0, 0x0
.long 0xff, 0x0, 0x0, 0x0, 0x0, 0x0, 0x0, 0x0
.long 0xff, 0x0, 0x0, 0x0, 0x0, 0x0, 0x0, 0x0
.long 0xff, 0x0, 0x0, 0x0, 0x0, 0x0, 0x0, 0x0
.long 0xff, 0x0, 0x0, 0x0, 0x0, 0x0, 0x0, 0x0
.long 0xff, 0x0, 0x0, 0x0, 0x0, 0x0, 0x0, 0x0
.long 0xff, 0x0, 0x0, 0x0, 0x0, 0x0, 0x0, 0x0
.long 0x0, 0x800000, 0x900, 0x1480000, 0x570048, 0x80000000, 0x0, 0x0
.long 0x0, 0x804000, 0x900, 0x1484000, 0x570148, 0x80000000, 0x0, 0x0
.long 0x10, 0x810000, 0x800, 0x1410000, 0x570440, 0x570448, 0x0, 0x0
.long 0x12, 0x808000, 0x400, 0x3208000, 0x570c88, 0x80000000, 0x0, 0x0
.long 0x13, 0x818000, 0x200, 0x4118000, 0x570b84, 0x80000000, 0x0, 0x0
.long 0x40, 0x0, 0x2, 0x18, 0x4, 0x1, 0x0, 0x1
.long 0x40, 0x14, 0x2, 0x18, 0x4, 0x1, 0x0, 0x1
.long 0xe28, 0x4010000, 0x200, 0x200200, 0x575080, 0x575080, 0x570b00, 0x100e00
.long 0x1102b, 0x4e10000, 0x200, 0x200200, 0x80000000, 0x575080, 0x573000, 0x402000
.long 0x40425, 0x4e18000, 0x600, 0x300600, 0x575984, 0x575980, 0x573800, 0x400800
.long 0x240425, 0x561c000, 0x400600, 0x380600, 0x575d8c, 0x575d80, 0x573c00, 0x400810
.long 0xff, 0x0, 0x0, 0x0, 0x0, 0x0, 0x0, 0x0
.long 0xff, 0x0, 0x0, 0x0, 0x0, 0x0, 0x0, 0x0
.long 0xff, 0x0, 0x0, 0x0, 0x0, 0x0, 0x0, 0x0
.long 0xff, 0x0, 0x0, 0x0, 0x0, 0x0, 0x0, 0x0
.long 0xff, 0x0, 0x0, 0x0, 0x0, 0x0, 0x0, 0x0
.long 0xff, 0x0, 0x0, 0x0, 0x0, 0x0, 0x0, 0x0
.long 0xff, 0x0, 0x0, 0x0, 0x0, 0x0, 0x0, 0x0
.long 0xff, 0x0, 0x0, 0x0, 0x0, 0x0, 0x0, 0x0
.long 0xff, 0x0, 0x0, 0x0, 0x0, 0x0, 0x0, 0x0
.long 0x0, 0x802000, 0x900, 0x1482000, 0x570848, 0x80000000, 0x0, 0x0
.long 0x0, 0x806000, 0x900, 0x1486000, 0x570948, 0x80000000, 0x0, 0x0
.long 0x10, 0x814000, 0x800, 0x1414000, 0x570540, 0x570548, 0x0, 0x0
.long 0x12, 0x80c000, 0x400, 0x320c000, 0x570cc8, 0x80000000, 0x0, 0x0
.long 0x13, 0x81c000, 0x200, 0x411c000, 0x570bc4, 0x80000000, 0x0, 0x0
.long 0x40, 0x0, 0x2, 0x1c, 0x4, 0x1, 0x0, 0x1
.long 0x40, 0x14, 0x2, 0x1c, 0x4, 0x1, 0x0, 0x1
.long 0xe28, 0x4010000, 0x300, 0x200300, 0x5750c0, 0x5750c0, 0x570b00, 0x100e00
.long 0x1102b, 0x4e10000, 0x300, 0x200300, 0x80000000, 0x5750c0, 0x573000, 0x402000
.long 0x40425, 0x4e18000, 0x700, 0x300700, 0x5759c4, 0x5759c0, 0x573800, 0x400800
.long 0x240425, 0x561c000, 0x400700, 0x380700, 0x575dcc, 0x575dc0, 0x573c00, 0x400810
.long 0xff, 0x0, 0x0, 0x0, 0x0, 0x0, 0x0, 0x0
.long 0xff, 0x0, 0x0, 0x0, 0x0, 0x0, 0x0, 0x0
.long 0xff, 0x0, 0x0, 0x0, 0x0, 0x0, 0x0, 0x0
.long 0xff, 0x0, 0x0, 0x0, 0x0, 0x0, 0x0, 0x0
.long 0xff, 0x0, 0x0, 0x0, 0x0, 0x0, 0x0, 0x0
.long 0xff, 0x0, 0x0, 0x0, 0x0, 0x0, 0x0, 0x0
.long 0xff, 0x0, 0x0, 0x0, 0x0, 0x0, 0x0, 0x0
.long 0xff, 0x0, 0x0, 0x0, 0x0, 0x0, 0x0, 0x0
.long 0xff, 0x0, 0x0, 0x0, 0x0, 0x0, 0x0, 0x0
.long 0x0, 0x800000, 0xa00, 0x1500000, 0x570050, 0x80000000, 0x0, 0x0
.long 0x0, 0x804000, 0xa00, 0x1504000, 0x570150, 0x80000000, 0x0, 0x0
.long 0x10, 0x808000, 0xa00, 0x1508000, 0x570250, 0x570258, 0x0, 0x0
.long 0x12, 0x810000, 0x400, 0x3210000, 0x570d08, 0x80000000, 0x0, 0x0
.long 0x13, 0x800000, 0x400, 0x4200000, 0x570a08, 0x80000000, 0x0, 0x0
.long 0x40, 0x2, 0x2, 0x0, 0x4, 0x1, 0x0, 0x1
.long 0x40, 0x16, 0x2, 0x0, 0x4, 0x1, 0x0, 0x1
.long 0xe28, 0x4010000, 0x400, 0x200400, 0x575100, 0x575100, 0x570b00, 0x100e00
.long 0x1102b, 0x4e10000, 0x400, 0x200400, 0x80000000, 0x575100, 0x573000, 0x402000
.long 0x40425, 0x4e1a000, 0x0, 0x340000, 0x575a04, 0x575a00, 0x573a00, 0x400800
.long 0xff, 0x0, 0x0, 0x0, 0x0, 0x0, 0x0, 0x0
.long 0xff, 0x0, 0x0, 0x0, 0x0, 0x0, 0x0, 0x0
.long 0xff, 0x0, 0x0, 0x0, 0x0, 0x0, 0x0, 0x0
.long 0xff, 0x0, 0x0, 0x0, 0x0, 0x0, 0x0, 0x0
.long 0xff, 0x0, 0x0, 0x0, 0x0, 0x0, 0x0, 0x0
.long 0xff, 0x0, 0x0, 0x0, 0x0, 0x0, 0x0, 0x0
.long 0xff, 0x0, 0x0, 0x0, 0x0, 0x0, 0x0, 0x0
.long 0xff, 0x0, 0x0, 0x0, 0x0, 0x0, 0x0, 0x0
.long 0xff, 0x0, 0x0, 0x0, 0x0, 0x0, 0x0, 0x0
.long 0xff, 0x0, 0x0, 0x0, 0x0, 0x0, 0x0, 0x0
.long 0x0, 0x802000, 0xa00, 0x1502000, 0x570850, 0x80000000, 0x0, 0x0
.long 0x0, 0x806000, 0xa00, 0x1506000, 0x570950, 0x80000000, 0x0, 0x0
.long 0x10, 0x80c000, 0xa00, 0x150c000, 0x570350, 0x570358, 0x0, 0x0
.long 0x12, 0x814000, 0x400, 0x3214000, 0x570d48, 0x80000000, 0x0, 0x0
.long 0x13, 0x804000, 0x400, 0x4204000, 0x570a48, 0x80000000, 0x0, 0x0
.long 0x40, 0x2, 0x2, 0x4, 0x4, 0x1, 0x0, 0x1
.long 0x40, 0x16, 0x2, 0x4, 0x4, 0x1, 0x0, 0x1
.long 0xe28, 0x4010000, 0x500, 0x200500, 0x575140, 0x575140, 0x570b00, 0x100e00
.long 0x1102b, 0x4e10000, 0x500, 0x200500, 0x80000000, 0x575140, 0x573000, 0x402000
.long 0x40425, 0x4e1a000, 0x100, 0x340100, 0x575a44, 0x575a40, 0x573a00, 0x400800
.long 0xff, 0x0, 0x0, 0x0, 0x0, 0x0, 0x0, 0x0
.long 0xff, 0x0, 0x0, 0x0, 0x0, 0x0, 0x0, 0x0
.long 0xff, 0x0, 0x0, 0x0, 0x0, 0x0, 0x0, 0x0
.long 0xff, 0x0, 0x0, 0x0, 0x0, 0x0, 0x0, 0x0
.long 0xff, 0x0, 0x0, 0x0, 0x0, 0x0, 0x0, 0x0
.long 0xff, 0x0, 0x0, 0x0, 0x0, 0x0, 0x0, 0x0
.long 0xff, 0x0, 0x0, 0x0, 0x0, 0x0, 0x0, 0x0
.long 0xff, 0x0, 0x0, 0x0, 0x0, 0x0, 0x0, 0x0
.long 0xff, 0x0, 0x0, 0x0, 0x0, 0x0, 0x0, 0x0
.long 0xff, 0x0, 0x0, 0x0, 0x0, 0x0, 0x0, 0x0
.long 0x0, 0x800000, 0xb00, 0x1580000, 0x570058, 0x80000000, 0x0, 0x0
.long 0x0, 0x804000, 0xb00, 0x1584000, 0x570158, 0x80000000, 0x0, 0x0
.long 0x10, 0x810000, 0xa00, 0x1510000, 0x570450, 0x570458, 0x0, 0x0
.long 0x12, 0x818000, 0x400, 0x3218000, 0x570d88, 0x80000000, 0x0, 0x0
.long 0x13, 0x808000, 0x400, 0x4208000, 0x570a88, 0x80000000, 0x0, 0x0
.long 0x40, 0x2, 0x2, 0x8, 0x4, 0x1, 0x0, 0x1
.long 0x40, 0x16, 0x2, 0x8, 0x4, 0x1, 0x0, 0x1
.long 0xe28, 0x4010000, 0x600, 0x200600, 0x575180, 0x575180, 0x570b00, 0x100e00
.long 0x1102b, 0x4e10000, 0x600, 0x200600, 0x80000000, 0x575180, 0x573000, 0x402000
.long 0x40425, 0x4e1a000, 0x200, 0x340200, 0x575a84, 0x575a80, 0x573a00, 0x400800
.long 0xff, 0x0, 0x0, 0x0, 0x0, 0x0, 0x0, 0x0
.long 0xff, 0x0, 0x0, 0x0, 0x0, 0x0, 0x0, 0x0
.long 0xff, 0x0, 0x0, 0x0, 0x0, 0x0, 0x0, 0x0
.long 0xff, 0x0, 0x0, 0x0, 0x0, 0x0, 0x0, 0x0
.long 0xff, 0x0, 0x0, 0x0, 0x0, 0x0, 0x0, 0x0
.long 0xff, 0x0, 0x0, 0x0, 0x0, 0x0, 0x0, 0x0
.long 0xff, 0x0, 0x0, 0x0, 0x0, 0x0, 0x0, 0x0
.long 0xff, 0x0, 0x0, 0x0, 0x0, 0x0, 0x0, 0x0
.long 0xff, 0x0, 0x0, 0x0, 0x0, 0x0, 0x0, 0x0
.long 0xff, 0x0, 0x0, 0x0, 0x0, 0x0, 0x0, 0x0
.long 0x0, 0x802000, 0xb00, 0x1582000, 0x570858, 0x80000000, 0x0, 0x0
.long 0x0, 0x806000, 0xb00, 0x1586000, 0x570958, 0x80000000, 0x0, 0x0
.long 0x10, 0x814000, 0xa00, 0x1514000, 0x570550, 0x570558, 0x0, 0x0
.long 0x12, 0x81c000, 0x400, 0x321c000, 0x570dc8, 0x80000000, 0x0, 0x0
.long 0x13, 0x80c000, 0x400, 0x420c000, 0x570ac8, 0x80000000, 0x0, 0x0
.long 0x40, 0x2, 0x2, 0xc, 0x4, 0x1, 0x0, 0x1
.long 0x40, 0x16, 0x2, 0xc, 0x4, 0x1, 0x0, 0x1
.long 0xe28, 0x4010000, 0x700, 0x200700, 0x5751c0, 0x5751c0, 0x570b00, 0x100e00
.long 0x1102b, 0x4e10000, 0x700, 0x200700, 0x80000000, 0x5751c0, 0x573000, 0x402000
.long 0x40425, 0x4e1a000, 0x300, 0x340300, 0x575ac4, 0x575ac0, 0x573a00, 0x400800
.long 0xff, 0x0, 0x0, 0x0, 0x0, 0x0, 0x0, 0x0
.long 0xff, 0x0, 0x0, 0x0, 0x0, 0x0, 0x0, 0x0
.long 0xff, 0x0, 0x0, 0x0, 0x0, 0x0, 0x0, 0x0
.long 0xff, 0x0, 0x0, 0x0, 0x0, 0x0, 0x0, 0x0
.long 0xff, 0x0, 0x0, 0x0, 0x0, 0x0, 0x0, 0x0
.long 0xff, 0x0, 0x0, 0x0, 0x0, 0x0, 0x0, 0x0
.long 0xff, 0x0, 0x0, 0x0, 0x0, 0x0, 0x0, 0x0
.long 0xff, 0x0, 0x0, 0x0, 0x0, 0x0, 0x0, 0x0
.long 0xff, 0x0, 0x0, 0x0, 0x0, 0x0, 0x0, 0x0
.long 0xff, 0x0, 0x0, 0x0, 0x0, 0x0, 0x0, 0x0
.long 0x0, 0x800000, 0xc00, 0x1600000, 0x570060, 0x80000000, 0x0, 0x0
.long 0x0, 0x804000, 0xc00, 0x1604000, 0x570160, 0x80000000, 0x0, 0x0
.long 0x10, 0x808000, 0xc00, 0x1608000, 0x570260, 0x570268, 0x0, 0x0
.long 0x12, 0x800000, 0x600, 0x3300000, 0x570c0c, 0x80000000, 0x0, 0x0
.long 0x13, 0x810000, 0x400, 0x4210000, 0x570b08, 0x80000000, 0x0, 0x0
.long 0x40, 0x2, 0x2, 0x10, 0x4, 0x1, 0x0, 0x1
.long 0x40, 0x16, 0x2, 0x10, 0x4, 0x1, 0x0, 0x1
.long 0xe20, 0x4018000, 0x0, 0x300000, 0x575800, 0x575800, 0x570b80, 0x100e00
.long 0x40, 0x28, 0x6, 0x0, 0x4, 0x0, 0x1, 0x4
.long 0x80225, 0x4e1e000, 0x0, 0x3c0000, 0x575e04, 0x575e00, 0x573e00, 0x400400
.long 0xff, 0x0, 0x0, 0x0, 0x0, 0x0, 0x0, 0x0
.long 0xff, 0x0, 0x0, 0x0, 0x0, 0x0, 0x0, 0x0
.long 0xff, 0x0, 0x0, 0x0, 0x0, 0x0, 0x0, 0x0
.long 0xff, 0x0, 0x0, 0x0, 0x0, 0x0, 0x0, 0x0
.long 0xff, 0x0, 0x0, 0x0, 0x0, 0x0, 0x0, 0x0
.long 0xff, 0x0, 0x0, 0x0, 0x0, 0x0, 0x0, 0x0
.long 0xff, 0x0, 0x0, 0x0, 0x0, 0x0, 0x0, 0x0
.long 0xff, 0x0, 0x0, 0x0, 0x0, 0x0, 0x0, 0x0
.long 0xff, 0x0, 0x0, 0x0, 0x0, 0x0, 0x0, 0x0
.long 0xff, 0x0, 0x0, 0x0, 0x0, 0x0, 0x0, 0x0
.long 0x0, 0x802000, 0xc00, 0x1602000, 0x570860, 0x80000000, 0x0, 0x0
.long 0x0, 0x806000, 0xc00, 0x1606000, 0x570960, 0x80000000, 0x0, 0x0
.long 0x10, 0x80c000, 0xc00, 0x160c000, 0x570360, 0x570368, 0x0, 0x0
.long 0x12, 0x804000, 0x600, 0x3304000, 0x570c4c, 0x80000000, 0x0, 0x0
.long 0x13, 0x814000, 0x400, 0x4214000, 0x570b48, 0x80000000, 0x0, 0x0
.long 0x40, 0x2, 0x2, 0x14, 0x4, 0x1, 0x0, 0x1
.long 0x40, 0x16, 0x2, 0x14, 0x4, 0x1, 0x0, 0x1
.long 0xe20, 0x4018000, 0x100, 0x300100, 0x575840, 0x575840, 0x570b80, 0x100e00
.long 0x40, 0x28, 0x6, 0x1, 0x4, 0x0, 0x1, 0x4
.long 0x80225, 0x4e1e000, 0x100, 0x3c0100, 0x575e44, 0x575e40, 0x573e00, 0x400400
.long 0xff, 0x0, 0x0, 0x0, 0x0, 0x0, 0x0, 0x0
.long 0xff, 0x0, 0x0, 0x0, 0x0, 0x0, 0x0, 0x0
.long 0xff, 0x0, 0x0, 0x0, 0x0, 0x0, 0x0, 0x0
.long 0xff, 0x0, 0x0, 0x0, 0x0, 0x0, 0x0, 0x0
.long 0xff, 0x0, 0x0, 0x0, 0x0, 0x0, 0x0, 0x0
.long 0xff, 0x0, 0x0, 0x0, 0x0, 0x0, 0x0, 0x0
.long 0xff, 0x0, 0x0, 0x0, 0x0, 0x0, 0x0, 0x0
.long 0xff, 0x0, 0x0, 0x0, 0x0, 0x0, 0x0, 0x0
.long 0xff, 0x0, 0x0, 0x0, 0x0, 0x0, 0x0, 0x0
.long 0xff, 0x0, 0x0, 0x0, 0x0, 0x0, 0x0, 0x0
.long 0x0, 0x800000, 0xd00, 0x1680000, 0x570068, 0x80000000, 0x0, 0x0
.long 0x0, 0x804000, 0xd00, 0x1684000, 0x570168, 0x80000000, 0x0, 0x0
.long 0x10, 0x810000, 0xc00, 0x1610000, 0x570460, 0x570468, 0x0, 0x0
.long 0x12, 0x808000, 0x600, 0x3308000, 0x570c8c, 0x80000000, 0x0, 0x0
.long 0x13, 0x818000, 0x400, 0x4218000, 0x570b88, 0x80000000, 0x0, 0x0
.long 0x40, 0x2, 0x2, 0x18, 0x4, 0x1, 0x0, 0x1
.long 0x40, 0x16, 0x2, 0x18, 0x4, 0x1, 0x0, 0x1
.long 0xe20, 0x4018000, 0x200, 0x300200, 0x575880, 0x575880, 0x570b80, 0x100e00
.long 0x40, 0x28, 0x6, 0x2, 0x4, 0x0, 0x1, 0x4
.long 0x80225, 0x4e1e000, 0x200, 0x3c0200, 0x575e84, 0x575e80, 0x573e00, 0x400400
.long 0xff, 0x0, 0x0, 0x0, 0x0, 0x0, 0x0, 0x0
.long 0xff, 0x0, 0x0, 0x0, 0x0, 0x0, 0x0, 0x0
.long 0xff, 0x0, 0x0, 0x0, 0x0, 0x0, 0x0, 0x0
.long 0xff, 0x0, 0x0, 0x0, 0x0, 0x0, 0x0, 0x0
.long 0xff, 0x0, 0x0, 0x0, 0x0, 0x0, 0x0, 0x0
.long 0xff, 0x0, 0x0, 0x0, 0x0, 0x0, 0x0, 0x0
.long 0xff, 0x0, 0x0, 0x0, 0x0, 0x0, 0x0, 0x0
.long 0xff, 0x0, 0x0, 0x0, 0x0, 0x0, 0x0, 0x0
.long 0xff, 0x0, 0x0, 0x0, 0x0, 0x0, 0x0, 0x0
.long 0xff, 0x0, 0x0, 0x0, 0x0, 0x0, 0x0, 0x0
.long 0x0, 0x802000, 0xd00, 0x1682000, 0x570868, 0x80000000, 0x0, 0x0
.long 0x0, 0x806000, 0xd00, 0x1686000, 0x570968, 0x80000000, 0x0, 0x0
.long 0x10, 0x814000, 0xc00, 0x1614000, 0x570560, 0x570568, 0x0, 0x0
.long 0x12, 0x80c000, 0x600, 0x330c000, 0x570ccc, 0x80000000, 0x0, 0x0
.long 0x13, 0x81c000, 0x400, 0x421c000, 0x570bc8, 0x80000000, 0x0, 0x0
.long 0x40, 0x2, 0x2, 0x1c, 0x4, 0x1, 0x0, 0x1
.long 0x40, 0x16, 0x2, 0x1c, 0x4, 0x1, 0x0, 0x1
.long 0xe20, 0x4018000, 0x300, 0x300300, 0x5758c0, 0x5758c0, 0x570b80, 0x100e00
.long 0x40, 0x28, 0x6, 0x3, 0x4, 0x0, 0x1, 0x4
.long 0x80225, 0x4e1e000, 0x300, 0x3c0300, 0x575ec4, 0x575ec0, 0x573e00, 0x400400
.long 0xff, 0x0, 0x0, 0x0, 0x0, 0x0, 0x0, 0x0
.long 0xff, 0x0, 0x0, 0x0, 0x0, 0x0, 0x0, 0x0
.long 0xff, 0x0, 0x0, 0x0, 0x0, 0x0, 0x0, 0x0
.long 0xff, 0x0, 0x0, 0x0, 0x0, 0x0, 0x0, 0x0
.long 0xff, 0x0, 0x0, 0x0, 0x0, 0x0, 0x0, 0x0
.long 0xff, 0x0, 0x0, 0x0, 0x0, 0x0, 0x0, 0x0
.long 0xff, 0x0, 0x0, 0x0, 0x0, 0x0, 0x0, 0x0
.long 0xff, 0x0, 0x0, 0x0, 0x0, 0x0, 0x0, 0x0
.long 0xff, 0x0, 0x0, 0x0, 0x0, 0x0, 0x0, 0x0
.long 0xff, 0x0, 0x0, 0x0, 0x0, 0x0, 0x0, 0x0
.long 0x0, 0x800000, 0xe00, 0x1700000, 0x570070, 0x80000000, 0x0, 0x0
.long 0x0, 0x804000, 0xe00, 0x1704000, 0x570170, 0x80000000, 0x0, 0x0
.long 0x10, 0x808000, 0xe00, 0x1708000, 0x570270, 0x570278, 0x0, 0x0
.long 0x12, 0x810000, 0x600, 0x3310000, 0x570d0c, 0x80000000, 0x0, 0x0
.long 0x13, 0x800000, 0x600, 0x4300000, 0x570a0c, 0x80000000, 0x0, 0x0
.long 0x40, 0x4, 0x2, 0x0, 0x4, 0x1, 0x0, 0x1
.long 0x40, 0x18, 0x2, 0x0, 0x4, 0x1, 0x0, 0x1
.long 0xe20, 0x4018000, 0x400, 0x300400, 0x575900, 0x575900, 0x570b80, 0x100e00
.long 0x40, 0x28, 0x6, 0x4, 0x4, 0x0, 0x1, 0x4
.long 0x80225, 0x4e1e000, 0x400, 0x3c0400, 0x575f04, 0x575f00, 0x573e00, 0x400400
.long 0xff, 0x0, 0x0, 0x0, 0x0, 0x0, 0x0, 0x0
.long 0xff, 0x0, 0x0, 0x0, 0x0, 0x0, 0x0, 0x0
.long 0xff, 0x0, 0x0, 0x0, 0x0, 0x0, 0x0, 0x0
.long 0xff, 0x0, 0x0, 0x0, 0x0, 0x0, 0x0, 0x0
.long 0xff, 0x0, 0x0, 0x0, 0x0, 0x0, 0x0, 0x0
.long 0xff, 0x0, 0x0, 0x0, 0x0, 0x0, 0x0, 0x0
.long 0xff, 0x0, 0x0, 0x0, 0x0, 0x0, 0x0, 0x0
.long 0xff, 0x0, 0x0, 0x0, 0x0, 0x0, 0x0, 0x0
.long 0xff, 0x0, 0x0, 0x0, 0x0, 0x0, 0x0, 0x0
.long 0xff, 0x0, 0x0, 0x0, 0x0, 0x0, 0x0, 0x0
.long 0x0, 0x802000, 0xe00, 0x1702000, 0x570870, 0x80000000, 0x0, 0x0
.long 0x0, 0x806000, 0xe00, 0x1706000, 0x570970, 0x80000000, 0x0, 0x0
.long 0x10, 0x80c000, 0xe00, 0x170c000, 0x570370, 0x570378, 0x0, 0x0
.long 0x12, 0x814000, 0x600, 0x3314000, 0x570d4c, 0x80000000, 0x0, 0x0
.long 0x13, 0x804000, 0x600, 0x4304000, 0x570a4c, 0x80000000, 0x0, 0x0
.long 0x40, 0x4, 0x2, 0x4, 0x4, 0x1, 0x0, 0x1
.long 0x40, 0x18, 0x2, 0x4, 0x4, 0x1, 0x0, 0x1
.long 0xe20, 0x4018000, 0x500, 0x300500, 0x575940, 0x575940, 0x570b80, 0x100e00
.long 0x40, 0x28, 0x6, 0x5, 0x4, 0x0, 0x1, 0x4
.long 0x80225, 0x4e1e000, 0x500, 0x3c0500, 0x575f44, 0x575f40, 0x573e00, 0x400400
.long 0xff, 0x0, 0x0, 0x0, 0x0, 0x0, 0x0, 0x0
.long 0xff, 0x0, 0x0, 0x0, 0x0, 0x0, 0x0, 0x0
.long 0xff, 0x0, 0x0, 0x0, 0x0, 0x0, 0x0, 0x0
.long 0xff, 0x0, 0x0, 0x0, 0x0, 0x0, 0x0, 0x0
.long 0xff, 0x0, 0x0, 0x0, 0x0, 0x0, 0x0, 0x0
.long 0xff, 0x0, 0x0, 0x0, 0x0, 0x0, 0x0, 0x0
.long 0xff, 0x0, 0x0, 0x0, 0x0, 0x0, 0x0, 0x0
.long 0xff, 0x0, 0x0, 0x0, 0x0, 0x0, 0x0, 0x0
.long 0xff, 0x0, 0x0, 0x0, 0x0, 0x0, 0x0, 0x0
.long 0xff, 0x0, 0x0, 0x0, 0x0, 0x0, 0x0, 0x0
.long 0x0, 0x800000, 0xf00, 0x1780000, 0x570078, 0x80000000, 0x0, 0x0
.long 0x0, 0x804000, 0xf00, 0x1784000, 0x570178, 0x80000000, 0x0, 0x0
.long 0x10, 0x810000, 0xe00, 0x1710000, 0x570470, 0x570478, 0x0, 0x0
.long 0x12, 0x818000, 0x600, 0x3318000, 0x570d8c, 0x80000000, 0x0, 0x0
.long 0x13, 0x808000, 0x600, 0x4308000, 0x570a8c, 0x80000000, 0x0, 0x0
.long 0x40, 0x4, 0x2, 0x8, 0x4, 0x1, 0x0, 0x1
.long 0x40, 0x18, 0x2, 0x8, 0x4, 0x1, 0x0, 0x1
.long 0xe20, 0x4018000, 0x600, 0x300600, 0x575980, 0x575980, 0x570b80, 0x100e00
.long 0x40, 0x28, 0x6, 0x6, 0x4, 0x0, 0x1, 0x4
.long 0x80225, 0x4e1e000, 0x600, 0x3c0600, 0x575f84, 0x575f80, 0x573e00, 0x400400
.long 0xff, 0x0, 0x0, 0x0, 0x0, 0x0, 0x0, 0x0
.long 0xff, 0x0, 0x0, 0x0, 0x0, 0x0, 0x0, 0x0
.long 0xff, 0x0, 0x0, 0x0, 0x0, 0x0, 0x0, 0x0
.long 0xff, 0x0, 0x0, 0x0, 0x0, 0x0, 0x0, 0x0
.long 0xff, 0x0, 0x0, 0x0, 0x0, 0x0, 0x0, 0x0
.long 0xff, 0x0, 0x0, 0x0, 0x0, 0x0, 0x0, 0x0
.long 0xff, 0x0, 0x0, 0x0, 0x0, 0x0, 0x0, 0x0
.long 0xff, 0x0, 0x0, 0x0, 0x0, 0x0, 0x0, 0x0
.long 0xff, 0x0, 0x0, 0x0, 0x0, 0x0, 0x0, 0x0
.long 0xff, 0x0, 0x0, 0x0, 0x0, 0x0, 0x0, 0x0
.long 0x0, 0x802000, 0xf00, 0x1782000, 0x570878, 0x80000000, 0x0, 0x0
.long 0x0, 0x806000, 0xf00, 0x1786000, 0x570978, 0x80000000, 0x0, 0x0
.long 0x10, 0x814000, 0xe00, 0x1714000, 0x570570, 0x570578, 0x0, 0x0
.long 0x12, 0x81c000, 0x600, 0x331c000, 0x570dcc, 0x80000000, 0x0, 0x0
.long 0x13, 0x80c000, 0x600, 0x430c000, 0x570acc, 0x80000000, 0x0, 0x0
.long 0x40, 0x4, 0x2, 0xc, 0x4, 0x1, 0x0, 0x1
.long 0x40, 0x18, 0x2, 0xc, 0x4, 0x1, 0x0, 0x1
.long 0xe20, 0x4018000, 0x700, 0x300700, 0x5759c0, 0x5759c0, 0x570b80, 0x100e00
.long 0x40, 0x28, 0x6, 0x7, 0x4, 0x0, 0x1, 0x4
.long 0x80225, 0x4e1e000, 0x700, 0x3c0700, 0x575fc4, 0x575fc0, 0x573e00, 0x400400
.long 0xff, 0x0, 0x0, 0x0, 0x0, 0x0, 0x0, 0x0
.long 0xff, 0x0, 0x0, 0x0, 0x0, 0x0, 0x0, 0x0
.long 0xff, 0x0, 0x0, 0x0, 0x0, 0x0, 0x0, 0x0
.long 0xff, 0x0, 0x0, 0x0, 0x0, 0x0, 0x0, 0x0
.long 0xff, 0x0, 0x0, 0x0, 0x0, 0x0, 0x0, 0x0
.long 0xff, 0x0, 0x0, 0x0, 0x0, 0x0, 0x0, 0x0
.long 0xff, 0x0, 0x0, 0x0, 0x0, 0x0, 0x0, 0x0
.long 0xff, 0x0, 0x0, 0x0, 0x0, 0x0, 0x0, 0x0
.long 0xff, 0x0, 0x0, 0x0, 0x0, 0x0, 0x0, 0x0
.long 0xff, 0x0, 0x0, 0x0, 0x0, 0x0, 0x0, 0x0
.long 0x0, 0x800000, 0x1000, 0x1800000, 0x570080, 0x80000000, 0x0, 0x0
.long 0x0, 0x804000, 0x1000, 0x1804000, 0x570180, 0x80000000, 0x0, 0x0
.long 0x10, 0x808000, 0x1000, 0x1808000, 0x570280, 0x570288, 0x0, 0x0
.long 0x12, 0x800000, 0x800, 0x3400000, 0x570c10, 0x80000000, 0x0, 0x0
.long 0x10, 0x818000, 0x1000, 0x1818000, 0x570680, 0x570688, 0x0, 0x0
.long 0x10, 0x818000, 0x1800, 0x1c18000, 0x5706c0, 0x5706c8, 0x0, 0x0
.long 0xe28, 0x4002000, 0x0, 0x40000, 0x574200, 0x574200, 0x570a00, 0x100e00
.long 0x1102b, 0x4e02000, 0x0, 0x40000, 0x80000000, 0x574200, 0x572200, 0x402000
.long 0x240425, 0x561a000, 0x400400, 0x340400, 0x575b0c, 0x575b00, 0x573a00, 0x400810
.long 0xff, 0x0, 0x0, 0x0, 0x0, 0x0, 0x0, 0x0
.long 0xff, 0x0, 0x0, 0x0, 0x0, 0x0, 0x0, 0x0
.long 0xff, 0x0, 0x0, 0x0, 0x0, 0x0, 0x0, 0x0
.long 0xff, 0x0, 0x0, 0x0, 0x0, 0x0, 0x0, 0x0
.long 0xff, 0x0, 0x0, 0x0, 0x0, 0x0, 0x0, 0x0
.long 0xff, 0x0, 0x0, 0x0, 0x0, 0x0, 0x0, 0x0
.long 0xff, 0x0, 0x0, 0x0, 0x0, 0x0, 0x0, 0x0
.long 0xff, 0x0, 0x0, 0x0, 0x0, 0x0, 0x0, 0x0
.long 0xff, 0x0, 0x0, 0x0, 0x0, 0x0, 0x0, 0x0
.long 0xff, 0x0, 0x0, 0x0, 0x0, 0x0, 0x0, 0x0
.long 0xff, 0x0, 0x0, 0x0, 0x0, 0x0, 0x0, 0x0
.long 0x0, 0x802000, 0x1000, 0x1802000, 0x570880, 0x80000000, 0x0, 0x0
.long 0x0, 0x806000, 0x1000, 0x1806000, 0x570980, 0x80000000, 0x0, 0x0
.long 0x10, 0x80c000, 0x1000, 0x180c000, 0x570380, 0x570388, 0x0, 0x0
.long 0x12, 0x804000, 0x800, 0x3404000, 0x570c50, 0x80000000, 0x0, 0x0
.long 0x10, 0x818000, 0x1200, 0x1918000, 0x570690, 0x570698, 0x0, 0x0
.long 0x10, 0x818000, 0x1a00, 0x1d18000, 0x5706d0, 0x5706d8, 0x0, 0x0
.long 0xe28, 0x4002000, 0x100, 0x40100, 0x574240, 0x574240, 0x570a00, 0x100e00
.long 0x1102b, 0x4e02000, 0x100, 0x40100, 0x80000000, 0x574240, 0x572200, 0x402000
.long 0x240425, 0x561a000, 0x400500, 0x340500, 0x575b4c, 0x575b40, 0x573a00, 0x400810
.long 0xff, 0x0, 0x0, 0x0, 0x0, 0x0, 0x0, 0x0
.long 0xff, 0x0, 0x0, 0x0, 0x0, 0x0, 0x0, 0x0
.long 0xff, 0x0, 0x0, 0x0, 0x0, 0x0, 0x0, 0x0
.long 0xff, 0x0, 0x0, 0x0, 0x0, 0x0, 0x0, 0x0
.long 0xff, 0x0, 0x0, 0x0, 0x0, 0x0, 0x0, 0x0
.long 0xff, 0x0, 0x0, 0x0, 0x0, 0x0, 0x0, 0x0
.long 0xff, 0x0, 0x0, 0x0, 0x0, 0x0, 0x0, 0x0
.long 0xff, 0x0, 0x0, 0x0, 0x0, 0x0, 0x0, 0x0
.long 0xff, 0x0, 0x0, 0x0, 0x0, 0x0, 0x0, 0x0
.long 0xff, 0x0, 0x0, 0x0, 0x0, 0x0, 0x0, 0x0
.long 0xff, 0x0, 0x0, 0x0, 0x0, 0x0, 0x0, 0x0
.long 0x0, 0x800000, 0x1100, 0x1880000, 0x570088, 0x80000000, 0x0, 0x0
.long 0x0, 0x804000, 0x1100, 0x1884000, 0x570188, 0x80000000, 0x0, 0x0
.long 0x10, 0x810000, 0x1000, 0x1810000, 0x570480, 0x570488, 0x0, 0x0
.long 0x12, 0x808000, 0x800, 0x3408000, 0x570c90, 0x80000000, 0x0, 0x0
.long 0x10, 0x818000, 0x1400, 0x1a18000, 0x5706a0, 0x5706a8, 0x0, 0x0
.long 0x10, 0x818000, 0x1c00, 0x1e18000, 0x5706e0, 0x5706e8, 0x0, 0x0
.long 0xe28, 0x4002000, 0x200, 0x40200, 0x574280, 0x574280, 0x570a00, 0x100e00
.long 0x1102b, 0x4e02000, 0x200, 0x40200, 0x80000000, 0x574280, 0x572200, 0x402000
.long 0x240425, 0x561a000, 0x400600, 0x340600, 0x575b8c, 0x575b80, 0x573a00, 0x400810
.long 0xff, 0x0, 0x0, 0x0, 0x0, 0x0, 0x0, 0x0
.long 0xff, 0x0, 0x0, 0x0, 0x0, 0x0, 0x0, 0x0
.long 0xff, 0x0, 0x0, 0x0, 0x0, 0x0, 0x0, 0x0
.long 0xff, 0x0, 0x0, 0x0, 0x0, 0x0, 0x0, 0x0
.long 0xff, 0x0, 0x0, 0x0, 0x0, 0x0, 0x0, 0x0
.long 0xff, 0x0, 0x0, 0x0, 0x0, 0x0, 0x0, 0x0
.long 0xff, 0x0, 0x0, 0x0, 0x0, 0x0, 0x0, 0x0
.long 0xff, 0x0, 0x0, 0x0, 0x0, 0x0, 0x0, 0x0
.long 0xff, 0x0, 0x0, 0x0, 0x0, 0x0, 0x0, 0x0
.long 0xff, 0x0, 0x0, 0x0, 0x0, 0x0, 0x0, 0x0
.long 0xff, 0x0, 0x0, 0x0, 0x0, 0x0, 0x0, 0x0
.long 0x0, 0x802000, 0x1100, 0x1882000, 0x570888, 0x80000000, 0x0, 0x0
.long 0x0, 0x806000, 0x1100, 0x1886000, 0x570988, 0x80000000, 0x0, 0x0
.long 0x10, 0x814000, 0x1000, 0x1814000, 0x570580, 0x570588, 0x0, 0x0
.long 0x12, 0x80c000, 0x800, 0x340c000, 0x570cd0, 0x80000000, 0x0, 0x0
.long 0x10, 0x818000, 0x1600, 0x1b18000, 0x5706b0, 0x5706b8, 0x0, 0x0
.long 0x10, 0x818000, 0x1e00, 0x1f18000, 0x5706f0, 0x5706f8, 0x0, 0x0
.long 0xe28, 0x4002000, 0x300, 0x40300, 0x5742c0, 0x5742c0, 0x570a00, 0x100e00
.long 0x1102b, 0x4e02000, 0x300, 0x40300, 0x80000000, 0x5742c0, 0x572200, 0x402000
.long 0x240425, 0x561a000, 0x400700, 0x340700, 0x575bcc, 0x575bc0, 0x573a00, 0x400810
.long 0xff, 0x0, 0x0, 0x0, 0x0, 0x0, 0x0, 0x0
.long 0xff, 0x0, 0x0, 0x0, 0x0, 0x0, 0x0, 0x0
.long 0xff, 0x0, 0x0, 0x0, 0x0, 0x0, 0x0, 0x0
.long 0xff, 0x0, 0x0, 0x0, 0x0, 0x0, 0x0, 0x0
.long 0xff, 0x0, 0x0, 0x0, 0x0, 0x0, 0x0, 0x0
.long 0xff, 0x0, 0x0, 0x0, 0x0, 0x0, 0x0, 0x0
.long 0xff, 0x0, 0x0, 0x0, 0x0, 0x0, 0x0, 0x0
.long 0xff, 0x0, 0x0, 0x0, 0x0, 0x0, 0x0, 0x0
.long 0xff, 0x0, 0x0, 0x0, 0x0, 0x0, 0x0, 0x0
.long 0xff, 0x0, 0x0, 0x0, 0x0, 0x0, 0x0, 0x0
.long 0xff, 0x0, 0x0, 0x0, 0x0, 0x0, 0x0, 0x0
.long 0x0, 0x800000, 0x1200, 0x1900000, 0x570090, 0x80000000, 0x0, 0x0
.long 0x0, 0x804000, 0x1200, 0x1904000, 0x570190, 0x80000000, 0x0, 0x0
.long 0x10, 0x808000, 0x1200, 0x1908000, 0x570290, 0x570298, 0x0, 0x0
.long 0x12, 0x810000, 0x800, 0x3410000, 0x570d10, 0x80000000, 0x0, 0x0
.long 0x13, 0x810000, 0x600, 0x4310000, 0x570b0c, 0x80000000, 0x0, 0x0
.long 0x10, 0x81c000, 0x1000, 0x181c000, 0x570780, 0x570788, 0x0, 0x0
.long 0xe28, 0x4002000, 0x400, 0x40400, 0x574300, 0x574300, 0x570a00, 0x100e00
.long 0x1102b, 0x4e02000, 0x400, 0x40400, 0x80000000, 0x574300, 0x572200, 0x402000
.long 0x340425, 0x5a1a000, 0x600000, 0x340000, 0x575a10, 0x575a00, 0x573a00, 0x400818
.long 0xff, 0x0, 0x0, 0x0, 0x0, 0x0, 0x0, 0x0
.long 0xff, 0x0, 0x0, 0x0, 0x0, 0x0, 0x0, 0x0
.long 0xff, 0x0, 0x0, 0x0, 0x0, 0x0, 0x0, 0x0
.long 0xff, 0x0, 0x0, 0x0, 0x0, 0x0, 0x0, 0x0
.long 0xff, 0x0, 0x0, 0x0, 0x0, 0x0, 0x0, 0x0
.long 0xff, 0x0, 0x0, 0x0, 0x0, 0x0, 0x0, 0x0
.long 0xff, 0x0, 0x0, 0x0, 0x0, 0x0, 0x0, 0x0
.long 0xff, 0x0, 0x0, 0x0, 0x0, 0x0, 0x0, 0x0
.long 0xff, 0x0, 0x0, 0x0, 0x0, 0x0, 0x0, 0x0
.long 0xff, 0x0, 0x0, 0x0, 0x0, 0x0, 0x0, 0x0
.long 0xff, 0x0, 0x0, 0x0, 0x0, 0x0, 0x0, 0x0
.long 0x0, 0x802000, 0x1200, 0x1902000, 0x570890, 0x80000000, 0x0, 0x0
.long 0x0, 0x806000, 0x1200, 0x1906000, 0x570990, 0x80000000, 0x0, 0x0
.long 0x10, 0x80c000, 0x1200, 0x190c000, 0x570390, 0x570398, 0x0, 0x0
.long 0x12, 0x814000, 0x800, 0x3414000, 0x570d50, 0x80000000, 0x0, 0x0
.long 0x13, 0x814000, 0x600, 0x4314000, 0x570b4c, 0x80000000, 0x0, 0x0
.long 0x10, 0x81c000, 0x1200, 0x191c000, 0x570790, 0x570798, 0x0, 0x0
.long 0xe28, 0x4002000, 0x500, 0x40500, 0x574340, 0x574340, 0x570a00, 0x100e00
.long 0x1102b, 0x4e02000, 0x500, 0x40500, 0x80000000, 0x574340, 0x572200, 0x402000
.long 0x340425, 0x5a1a000, 0x600100, 0x340100, 0x575a50, 0x575a40, 0x573a00, 0x400818
.long 0xff, 0x0, 0x0, 0x0, 0x0, 0x0, 0x0, 0x0
.long 0xff, 0x0, 0x0, 0x0, 0x0, 0x0, 0x0, 0x0
.long 0xff, 0x0, 0x0, 0x0, 0x0, 0x0, 0x0, 0x0
.long 0xff, 0x0, 0x0, 0x0, 0x0, 0x0, 0x0, 0x0
.long 0xff, 0x0, 0x0, 0x0, 0x0, 0x0, 0x0, 0x0
.long 0xff, 0x0, 0x0, 0x0, 0x0, 0x0, 0x0, 0x0
.long 0xff, 0x0, 0x0, 0x0, 0x0, 0x0, 0x0, 0x0
.long 0xff, 0x0, 0x0, 0x0, 0x0, 0x0, 0x0, 0x0
.long 0xff, 0x0, 0x0, 0x0, 0x0, 0x0, 0x0, 0x0
.long 0xff, 0x0, 0x0, 0x0, 0x0, 0x0, 0x0, 0x0
.long 0xff, 0x0, 0x0, 0x0, 0x0, 0x0, 0x0, 0x0
.long 0x0, 0x800000, 0x1300, 0x1980000, 0x570098, 0x80000000, 0x0, 0x0
.long 0x0, 0x804000, 0x1300, 0x1984000, 0x570198, 0x80000000, 0x0, 0x0
.long 0x10, 0x810000, 0x1200, 0x1910000, 0x570490, 0x570498, 0x0, 0x0
.long 0x12, 0x818000, 0x800, 0x3418000, 0x570d90, 0x80000000, 0x0, 0x0
.long 0x13, 0x818000, 0x600, 0x4318000, 0x570b8c, 0x80000000, 0x0, 0x0
.long 0x10, 0x81c000, 0x1400, 0x1a1c000, 0x5707a0, 0x5707a8, 0x0, 0x0
.long 0xe28, 0x4002000, 0x600, 0x40600, 0x574380, 0x574380, 0x570a00, 0x100e00
.long 0x1102b, 0x4e02000, 0x600, 0x40600, 0x80000000, 0x574380, 0x572200, 0x402000
.long 0x340425, 0x5a1a000, 0x600200, 0x340200, 0x575a90, 0x575a80, 0x573a00, 0x400818
.long 0xff, 0x0, 0x0, 0x0, 0x0, 0x0, 0x0, 0x0
.long 0xff, 0x0, 0x0, 0x0, 0x0, 0x0, 0x0, 0x0
.long 0xff, 0x0, 0x0, 0x0, 0x0, 0x0, 0x0, 0x0
.long 0xff, 0x0, 0x0, 0x0, 0x0, 0x0, 0x0, 0x0
.long 0xff, 0x0, 0x0, 0x0, 0x0, 0x0, 0x0, 0x0
.long 0xff, 0x0, 0x0, 0x0, 0x0, 0x0, 0x0, 0x0
.long 0xff, 0x0, 0x0, 0x0, 0x0, 0x0, 0x0, 0x0
.long 0xff, 0x0, 0x0, 0x0, 0x0, 0x0, 0x0, 0x0
.long 0xff, 0x0, 0x0, 0x0, 0x0, 0x0, 0x0, 0x0
.long 0xff, 0x0, 0x0, 0x0, 0x0, 0x0, 0x0, 0x0
.long 0xff, 0x0, 0x0, 0x0, 0x0, 0x0, 0x0, 0x0
.long 0x0, 0x802000, 0x1300, 0x1982000, 0x570898, 0x80000000, 0x0, 0x0
.long 0x0, 0x806000, 0x1300, 0x1986000, 0x570998, 0x80000000, 0x0, 0x0
.long 0x10, 0x814000, 0x1200, 0x1914000, 0x570590, 0x570598, 0x0, 0x0
.long 0x12, 0x81c000, 0x800, 0x341c000, 0x570dd0, 0x80000000, 0x0, 0x0
.long 0x13, 0x81c000, 0x600, 0x431c000, 0x570bcc, 0x80000000, 0x0, 0x0
.long 0x10, 0x81c000, 0x1600, 0x1b1c000, 0x5707b0, 0x5707b8, 0x0, 0x0
.long 0xe28, 0x4002000, 0x700, 0x40700, 0x5743c0, 0x5743c0, 0x570a00, 0x100e00
.long 0x1102b, 0x4e02000, 0x700, 0x40700, 0x80000000, 0x5743c0, 0x572200, 0x402000
.long 0x340425, 0x5a1a000, 0x600300, 0x340300, 0x575ad0, 0x575ac0, 0x573a00, 0x400818
.long 0xff, 0x0, 0x0, 0x0, 0x0, 0x0, 0x0, 0x0
.long 0xff, 0x0, 0x0, 0x0, 0x0, 0x0, 0x0, 0x0
.long 0xff, 0x0, 0x0, 0x0, 0x0, 0x0, 0x0, 0x0
.long 0xff, 0x0, 0x0, 0x0, 0x0, 0x0, 0x0, 0x0
.long 0xff, 0x0, 0x0, 0x0, 0x0, 0x0, 0x0, 0x0
.long 0xff, 0x0, 0x0, 0x0, 0x0, 0x0, 0x0, 0x0
.long 0xff, 0x0, 0x0, 0x0, 0x0, 0x0, 0x0, 0x0
.long 0xff, 0x0, 0x0, 0x0, 0x0, 0x0, 0x0, 0x0
.long 0xff, 0x0, 0x0, 0x0, 0x0, 0x0, 0x0, 0x0
.long 0xff, 0x0, 0x0, 0x0, 0x0, 0x0, 0x0, 0x0
.long 0xff, 0x0, 0x0, 0x0, 0x0, 0x0, 0x0, 0x0
.long 0x0, 0x800000, 0x1400, 0x1a00000, 0x5700a0, 0x80000000, 0x0, 0x0
.long 0x0, 0x804000, 0x1400, 0x1a04000, 0x5701a0, 0x80000000, 0x0, 0x0
.long 0x10, 0x808000, 0x1400, 0x1a08000, 0x5702a0, 0x5702a8, 0x0, 0x0
.long 0x12, 0x800000, 0xa00, 0x3500000, 0x570c14, 0x80000000, 0x0, 0x0
.long 0x13, 0x800000, 0x800, 0x4400000, 0x570a10, 0x80000000, 0x0, 0x0
.long 0x10, 0x81c000, 0x1800, 0x1c1c000, 0x5707c0, 0x5707c8, 0x0, 0x0
.long 0xe28, 0x400a000, 0x0, 0x140000, 0x574a00, 0x574a00, 0x570a80, 0x100e00
.long 0x1102b, 0x4e0a000, 0x0, 0x140000, 0x80000000, 0x574a00, 0x572a00, 0x402000
.long 0x340425, 0x5a1a000, 0x600400, 0x340400, 0x575b10, 0x575b00, 0x573a00, 0x400818
.long 0xff, 0x0, 0x0, 0x0, 0x0, 0x0, 0x0, 0x0
.long 0xff, 0x0, 0x0, 0x0, 0x0, 0x0, 0x0, 0x0
.long 0xff, 0x0, 0x0, 0x0, 0x0, 0x0, 0x0, 0x0
.long 0xff, 0x0, 0x0, 0x0, 0x0, 0x0, 0x0, 0x0
.long 0xff, 0x0, 0x0, 0x0, 0x0, 0x0, 0x0, 0x0
.long 0xff, 0x0, 0x0, 0x0, 0x0, 0x0, 0x0, 0x0
.long 0xff, 0x0, 0x0, 0x0, 0x0, 0x0, 0x0, 0x0
.long 0xff, 0x0, 0x0, 0x0, 0x0, 0x0, 0x0, 0x0
.long 0xff, 0x0, 0x0, 0x0, 0x0, 0x0, 0x0, 0x0
.long 0xff, 0x0, 0x0, 0x0, 0x0, 0x0, 0x0, 0x0
.long 0xff, 0x0, 0x0, 0x0, 0x0, 0x0, 0x0, 0x0
.long 0x0, 0x802000, 0x1400, 0x1a02000, 0x5708a0, 0x80000000, 0x0, 0x0
.long 0x0, 0x806000, 0x1400, 0x1a06000, 0x5709a0, 0x80000000, 0x0, 0x0
.long 0x10, 0x80c000, 0x1400, 0x1a0c000, 0x5703a0, 0x5703a8, 0x0, 0x0
.long 0x12, 0x804000, 0xa00, 0x3504000, 0x570c54, 0x80000000, 0x0, 0x0
.long 0x13, 0x804000, 0x800, 0x4404000, 0x570a50, 0x80000000, 0x0, 0x0
.long 0x10, 0x81c000, 0x1a00, 0x1d1c000, 0x5707d0, 0x5707d8, 0x0, 0x0
.long 0xe28, 0x400a000, 0x100, 0x140100, 0x574a40, 0x574a40, 0x570a80, 0x100e00
.long 0x1102b, 0x4e0a000, 0x100, 0x140100, 0x80000000, 0x574a40, 0x572a00, 0x402000
.long 0x340425, 0x5a1a000, 0x600500, 0x340500, 0x575b50, 0x575b40, 0x573a00, 0x400818
.long 0xff, 0x0, 0x0, 0x0, 0x0, 0x0, 0x0, 0x0
.long 0xff, 0x0, 0x0, 0x0, 0x0, 0x0, 0x0, 0x0
.long 0xff, 0x0, 0x0, 0x0, 0x0, 0x0, 0x0, 0x0
.long 0xff, 0x0, 0x0, 0x0, 0x0, 0x0, 0x0, 0x0
.long 0xff, 0x0, 0x0, 0x0, 0x0, 0x0, 0x0, 0x0
.long 0xff, 0x0, 0x0, 0x0, 0x0, 0x0, 0x0, 0x0
.long 0xff, 0x0, 0x0, 0x0, 0x0, 0x0, 0x0, 0x0
.long 0xff, 0x0, 0x0, 0x0, 0x0, 0x0, 0x0, 0x0
.long 0xff, 0x0, 0x0, 0x0, 0x0, 0x0, 0x0, 0x0
.long 0xff, 0x0, 0x0, 0x0, 0x0, 0x0, 0x0, 0x0
.long 0xff, 0x0, 0x0, 0x0, 0x0, 0x0, 0x0, 0x0
.long 0x0, 0x800000, 0x1500, 0x1a80000, 0x5700a8, 0x80000000, 0x0, 0x0
.long 0x0, 0x804000, 0x1500, 0x1a84000, 0x5701a8, 0x80000000, 0x0, 0x0
.long 0x10, 0x810000, 0x1400, 0x1a10000, 0x5704a0, 0x5704a8, 0x0, 0x0
.long 0x12, 0x808000, 0xa00, 0x3508000, 0x570c94, 0x80000000, 0x0, 0x0
.long 0x13, 0x808000, 0x800, 0x4408000, 0x570a90, 0x80000000, 0x0, 0x0
.long 0x10, 0x81c000, 0x1c00, 0x1e1c000, 0x5707e0, 0x5707e8, 0x0, 0x0
.long 0xe28, 0x400a000, 0x200, 0x140200, 0x574a80, 0x574a80, 0x570a80, 0x100e00
.long 0x1102b, 0x4e0a000, 0x200, 0x140200, 0x80000000, 0x574a80, 0x572a00, 0x402000
.long 0x340425, 0x5a1a000, 0x600600, 0x340600, 0x575b90, 0x575b80, 0x573a00, 0x400818
.long 0xff, 0x0, 0x0, 0x0, 0x0, 0x0, 0x0, 0x0
.long 0xff, 0x0, 0x0, 0x0, 0x0, 0x0, 0x0, 0x0
.long 0xff, 0x0, 0x0, 0x0, 0x0, 0x0, 0x0, 0x0
.long 0xff, 0x0, 0x0, 0x0, 0x0, 0x0, 0x0, 0x0
.long 0xff, 0x0, 0x0, 0x0, 0x0, 0x0, 0x0, 0x0
.long 0xff, 0x0, 0x0, 0x0, 0x0, 0x0, 0x0, 0x0
.long 0xff, 0x0, 0x0, 0x0, 0x0, 0x0, 0x0, 0x0
.long 0xff, 0x0, 0x0, 0x0, 0x0, 0x0, 0x0, 0x0
.long 0xff, 0x0, 0x0, 0x0, 0x0, 0x0, 0x0, 0x0
.long 0xff, 0x0, 0x0, 0x0, 0x0, 0x0, 0x0, 0x0
.long 0xff, 0x0, 0x0, 0x0, 0x0, 0x0, 0x0, 0x0
.long 0x0, 0x802000, 0x1500, 0x1a82000, 0x5708a8, 0x80000000, 0x0, 0x0
.long 0x0, 0x806000, 0x1500, 0x1a86000, 0x5709a8, 0x80000000, 0x0, 0x0
.long 0x10, 0x814000, 0x1400, 0x1a14000, 0x5705a0, 0x5705a8, 0x0, 0x0
.long 0x12, 0x80c000, 0xa00, 0x350c000, 0x570cd4, 0x80000000, 0x0, 0x0
.long 0x13, 0x80c000, 0x800, 0x440c000, 0x570ad0, 0x80000000, 0x0, 0x0
.long 0x10, 0x81c000, 0x1e00, 0x1f1c000, 0x5707f0, 0x5707f8, 0x0, 0x0
.long 0xe28, 0x400a000, 0x300, 0x140300, 0x574ac0, 0x574ac0, 0x570a80, 0x100e00
.long 0x1102b, 0x4e0a000, 0x300, 0x140300, 0x80000000, 0x574ac0, 0x572a00, 0x402000
.long 0x340425, 0x5a1a000, 0x600700, 0x340700, 0x575bd0, 0x575bc0, 0x573a00, 0x400818
.long 0xff, 0x0, 0x0, 0x0, 0x0, 0x0, 0x0, 0x0
.long 0xff, 0x0, 0x0, 0x0, 0x0, 0x0, 0x0, 0x0
.long 0xff, 0x0, 0x0, 0x0, 0x0, 0x0, 0x0, 0x0
.long 0xff, 0x0, 0x0, 0x0, 0x0, 0x0, 0x0, 0x0
.long 0xff, 0x0, 0x0, 0x0, 0x0, 0x0, 0x0, 0x0
.long 0xff, 0x0, 0x0, 0x0, 0x0, 0x0, 0x0, 0x0
.long 0xff, 0x0, 0x0, 0x0, 0x0, 0x0, 0x0, 0x0
.long 0xff, 0x0, 0x0, 0x0, 0x0, 0x0, 0x0, 0x0
.long 0xff, 0x0, 0x0, 0x0, 0x0, 0x0, 0x0, 0x0
.long 0xff, 0x0, 0x0, 0x0, 0x0, 0x0, 0x0, 0x0
.long 0xff, 0x0, 0x0, 0x0, 0x0, 0x0, 0x0, 0x0
.long 0x0, 0x800000, 0x1600, 0x1b00000, 0x5700b0, 0x80000000, 0x0, 0x0
.long 0x0, 0x804000, 0x1600, 0x1b04000, 0x5701b0, 0x80000000, 0x0, 0x0
.long 0x10, 0x808000, 0x1600, 0x1b08000, 0x5702b0, 0x5702b8, 0x0, 0x0
.long 0x12, 0x810000, 0xa00, 0x3510000, 0x570d14, 0x80000000, 0x0, 0x0
.long 0x13, 0x810000, 0x800, 0x4410000, 0x570b10, 0x80000000, 0x0, 0x0
.long 0x40, 0x4, 0x2, 0x10, 0x4, 0x1, 0x0, 0x1
.long 0x40, 0x18, 0x2, 0x10, 0x4, 0x1, 0x0, 0x1
.long 0xe28, 0x400a000, 0x400, 0x140400, 0x574b00, 0x574b00, 0x570a80, 0x100e00
.long 0x1102b, 0x4e0a000, 0x400, 0x140400, 0x80000000, 0x574b00, 0x572a00, 0x402000
.long 0x140425, 0x5218000, 0x200000, 0x300000, 0x575808, 0x575800, 0x573800, 0x400808
.long 0x340425, 0x5a1c000, 0x600000, 0x380000, 0x575c10, 0x575c00, 0x573c00, 0x400818
.long 0xff, 0x0, 0x0, 0x0, 0x0, 0x0, 0x0, 0x0
.long 0xff, 0x0, 0x0, 0x0, 0x0, 0x0, 0x0, 0x0
.long 0xff, 0x0, 0x0, 0x0, 0x0, 0x0, 0x0, 0x0
.long 0xff, 0x0, 0x0, 0x0, 0x0, 0x0, 0x0, 0x0
.long 0xff, 0x0, 0x0, 0x0, 0x0, 0x0, 0x0, 0x0
.long 0xff, 0x0, 0x0, 0x0, 0x0, 0x0, 0x0, 0x0
.long 0xff, 0x0, 0x0, 0x0, 0x0, 0x0, 0x0, 0x0
.long 0xff, 0x0, 0x0, 0x0, 0x0, 0x0, 0x0, 0x0
.long 0xff, 0x0, 0x0, 0x0, 0x0, 0x0, 0x0, 0x0
.long 0x0, 0x802000, 0x1600, 0x1b02000, 0x5708b0, 0x80000000, 0x0, 0x0
.long 0x0, 0x806000, 0x1600, 0x1b06000, 0x5709b0, 0x80000000, 0x0, 0x0
.long 0x10, 0x80c000, 0x1600, 0x1b0c000, 0x5703b0, 0x5703b8, 0x0, 0x0
.long 0x12, 0x814000, 0xa00, 0x3514000, 0x570d54, 0x80000000, 0x0, 0x0
.long 0x13, 0x814000, 0x800, 0x4414000, 0x570b50, 0x80000000, 0x0, 0x0
.long 0x40, 0x4, 0x2, 0x14, 0x4, 0x1, 0x0, 0x1
.long 0x40, 0x18, 0x2, 0x14, 0x4, 0x1, 0x0, 0x1
.long 0xe28, 0x400a000, 0x500, 0x140500, 0x574b40, 0x574b40, 0x570a80, 0x100e00
.long 0x1102b, 0x4e0a000, 0x500, 0x140500, 0x80000000, 0x574b40, 0x572a00, 0x402000
.long 0x140425, 0x5218000, 0x200100, 0x300100, 0x575848, 0x575840, 0x573800, 0x400808
.long 0x340425, 0x5a1c000, 0x600100, 0x380100, 0x575c50, 0x575c40, 0x573c00, 0x400818
.long 0xff, 0x0, 0x0, 0x0, 0x0, 0x0, 0x0, 0x0
.long 0xff, 0x0, 0x0, 0x0, 0x0, 0x0, 0x0, 0x0
.long 0xff, 0x0, 0x0, 0x0, 0x0, 0x0, 0x0, 0x0
.long 0xff, 0x0, 0x0, 0x0, 0x0, 0x0, 0x0, 0x0
.long 0xff, 0x0, 0x0, 0x0, 0x0, 0x0, 0x0, 0x0
.long 0xff, 0x0, 0x0, 0x0, 0x0, 0x0, 0x0, 0x0
.long 0xff, 0x0, 0x0, 0x0, 0x0, 0x0, 0x0, 0x0
.long 0xff, 0x0, 0x0, 0x0, 0x0, 0x0, 0x0, 0x0
.long 0xff, 0x0, 0x0, 0x0, 0x0, 0x0, 0x0, 0x0
.long 0x0, 0x800000, 0x1700, 0x1b80000, 0x5700b8, 0x80000000, 0x0, 0x0
.long 0x0, 0x804000, 0x1700, 0x1b84000, 0x5701b8, 0x80000000, 0x0, 0x0
.long 0x10, 0x810000, 0x1600, 0x1b10000, 0x5704b0, 0x5704b8, 0x0, 0x0
.long 0x12, 0x818000, 0xa00, 0x3518000, 0x570d94, 0x80000000, 0x0, 0x0
.long 0x13, 0x818000, 0x800, 0x4418000, 0x570b90, 0x80000000, 0x0, 0x0
.long 0x40, 0x4, 0x2, 0x18, 0x4, 0x1, 0x0, 0x1
.long 0x40, 0x18, 0x2, 0x18, 0x4, 0x1, 0x0, 0x1
.long 0xe28, 0x400a000, 0x600, 0x140600, 0x574b80, 0x574b80, 0x570a80, 0x100e00
.long 0x1102b, 0x4e0a000, 0x600, 0x140600, 0x80000000, 0x574b80, 0x572a00, 0x402000
.long 0x140425, 0x5218000, 0x200200, 0x300200, 0x575888, 0x575880, 0x573800, 0x400808
.long 0x340425, 0x5a1c000, 0x600200, 0x380200, 0x575c90, 0x575c80, 0x573c00, 0x400818
.long 0xff, 0x0, 0x0, 0x0, 0x0, 0x0, 0x0, 0x0
.long 0xff, 0x0, 0x0, 0x0, 0x0, 0x0, 0x0, 0x0
.long 0xff, 0x0, 0x0, 0x0, 0x0, 0x0, 0x0, 0x0
.long 0xff, 0x0, 0x0, 0x0, 0x0, 0x0, 0x0, 0x0
.long 0xff, 0x0, 0x0, 0x0, 0x0, 0x0, 0x0, 0x0
.long 0xff, 0x0, 0x0, 0x0, 0x0, 0x0, 0x0, 0x0
.long 0xff, 0x0, 0x0, 0x0, 0x0, 0x0, 0x0, 0x0
.long 0xff, 0x0, 0x0, 0x0, 0x0, 0x0, 0x0, 0x0
.long 0xff, 0x0, 0x0, 0x0, 0x0, 0x0, 0x0, 0x0
.long 0x0, 0x802000, 0x1700, 0x1b82000, 0x5708b8, 0x80000000, 0x0, 0x0
.long 0x0, 0x806000, 0x1700, 0x1b86000, 0x5709b8, 0x80000000, 0x0, 0x0
.long 0x10, 0x814000, 0x1600, 0x1b14000, 0x5705b0, 0x5705b8, 0x0, 0x0
.long 0x12, 0x81c000, 0xa00, 0x351c000, 0x570dd4, 0x80000000, 0x0, 0x0
.long 0x13, 0x81c000, 0x800, 0x441c000, 0x570bd0, 0x80000000, 0x0, 0x0
.long 0x40, 0x4, 0x2, 0x1c, 0x4, 0x1, 0x0, 0x1
.long 0x40, 0x18, 0x2, 0x1c, 0x4, 0x1, 0x0, 0x1
.long 0xe28, 0x400a000, 0x700, 0x140700, 0x574bc0, 0x574bc0, 0x570a80, 0x100e00
.long 0x1102b, 0x4e0a000, 0x700, 0x140700, 0x80000000, 0x574bc0, 0x572a00, 0x402000
.long 0x140425, 0x5218000, 0x200300, 0x300300, 0x5758c8, 0x5758c0, 0x573800, 0x400808
.long 0x340425, 0x5a1c000, 0x600300, 0x380300, 0x575cd0, 0x575cc0, 0x573c00, 0x400818
.long 0xff, 0x0, 0x0, 0x0, 0x0, 0x0, 0x0, 0x0
.long 0xff, 0x0, 0x0, 0x0, 0x0, 0x0, 0x0, 0x0
.long 0xff, 0x0, 0x0, 0x0, 0x0, 0x0, 0x0, 0x0
.long 0xff, 0x0, 0x0, 0x0, 0x0, 0x0, 0x0, 0x0
.long 0xff, 0x0, 0x0, 0x0, 0x0, 0x0, 0x0, 0x0
.long 0xff, 0x0, 0x0, 0x0, 0x0, 0x0, 0x0, 0x0
.long 0xff, 0x0, 0x0, 0x0, 0x0, 0x0, 0x0, 0x0
.long 0xff, 0x0, 0x0, 0x0, 0x0, 0x0, 0x0, 0x0
.long 0xff, 0x0, 0x0, 0x0, 0x0, 0x0, 0x0, 0x0
.long 0x0, 0x800000, 0x1800, 0x1c00000, 0x5700c0, 0x80000000, 0x0, 0x0
.long 0x0, 0x804000, 0x1800, 0x1c04000, 0x5701c0, 0x80000000, 0x0, 0x0
.long 0x10, 0x808000, 0x1800, 0x1c08000, 0x5702c0, 0x5702c8, 0x0, 0x0
.long 0x12, 0x800000, 0xc00, 0x3600000, 0x570c18, 0x80000000, 0x0, 0x0
.long 0x13, 0x800000, 0xa00, 0x4500000, 0x570a14, 0x80000000, 0x0, 0x0
.long 0x40, 0x6, 0x2, 0x0, 0x4, 0x1, 0x0, 0x1
.long 0x40, 0x1a, 0x2, 0x0, 0x4, 0x1, 0x0, 0x1
.long 0xe28, 0x4012000, 0x0, 0x240000, 0x575200, 0x575200, 0x570b00, 0x100e00
.long 0x1102b, 0x4e12000, 0x0, 0x240000, 0x80000000, 0x575200, 0x573200, 0x402000
.long 0x140425, 0x5218000, 0x200400, 0x300400, 0x575908, 0x575900, 0x573800, 0x400808
.long 0x340425, 0x5a1c000, 0x600400, 0x380400, 0x575d10, 0x575d00, 0x573c00, 0x400818
.long 0xff, 0x0, 0x0, 0x0, 0x0, 0x0, 0x0, 0x0
.long 0xff, 0x0, 0x0, 0x0, 0x0, 0x0, 0x0, 0x0
.long 0xff, 0x0, 0x0, 0x0, 0x0, 0x0, 0x0, 0x0
.long 0xff, 0x0, 0x0, 0x0, 0x0, 0x0, 0x0, 0x0
.long 0xff, 0x0, 0x0, 0x0, 0x0, 0x0, 0x0, 0x0
.long 0xff, 0x0, 0x0, 0x0, 0x0, 0x0, 0x0, 0x0
.long 0xff, 0x0, 0x0, 0x0, 0x0, 0x0, 0x0, 0x0
.long 0xff, 0x0, 0x0, 0x0, 0x0, 0x0, 0x0, 0x0
.long 0xff, 0x0, 0x0, 0x0, 0x0, 0x0, 0x0, 0x0
.long 0x0, 0x802000, 0x1800, 0x1c02000, 0x5708c0, 0x80000000, 0x0, 0x0
.long 0x0, 0x806000, 0x1800, 0x1c06000, 0x5709c0, 0x80000000, 0x0, 0x0
.long 0x10, 0x80c000, 0x1800, 0x1c0c000, 0x5703c0, 0x5703c8, 0x0, 0x0
.long 0x12, 0x804000, 0xc00, 0x3604000, 0x570c58, 0x80000000, 0x0, 0x0
.long 0x13, 0x804000, 0xa00, 0x4504000, 0x570a54, 0x80000000, 0x0, 0x0
.long 0x40, 0x6, 0x2, 0x4, 0x4, 0x1, 0x0, 0x1
.long 0x40, 0x1a, 0x2, 0x4, 0x4, 0x1, 0x0, 0x1
.long 0xe28, 0x4012000, 0x100, 0x240100, 0x575240, 0x575240, 0x570b00, 0x100e00
.long 0x1102b, 0x4e12000, 0x100, 0x240100, 0x80000000, 0x575240, 0x573200, 0x402000
.long 0x140425, 0x5218000, 0x200500, 0x300500, 0x575948, 0x575940, 0x573800, 0x400808
.long 0x340425, 0x5a1c000, 0x600500, 0x380500, 0x575d50, 0x575d40, 0x573c00, 0x400818
.long 0xff, 0x0, 0x0, 0x0, 0x0, 0x0, 0x0, 0x0
.long 0xff, 0x0, 0x0, 0x0, 0x0, 0x0, 0x0, 0x0
.long 0xff, 0x0, 0x0, 0x0, 0x0, 0x0, 0x0, 0x0
.long 0xff, 0x0, 0x0, 0x0, 0x0, 0x0, 0x0, 0x0
.long 0xff, 0x0, 0x0, 0x0, 0x0, 0x0, 0x0, 0x0
.long 0xff, 0x0, 0x0, 0x0, 0x0, 0x0, 0x0, 0x0
.long 0xff, 0x0, 0x0, 0x0, 0x0, 0x0, 0x0, 0x0
.long 0xff, 0x0, 0x0, 0x0, 0x0, 0x0, 0x0, 0x0
.long 0xff, 0x0, 0x0, 0x0, 0x0, 0x0, 0x0, 0x0
.long 0x0, 0x800000, 0x1900, 0x1c80000, 0x5700c8, 0x80000000, 0x0, 0x0
.long 0x0, 0x804000, 0x1900, 0x1c84000, 0x5701c8, 0x80000000, 0x0, 0x0
.long 0x10, 0x810000, 0x1800, 0x1c10000, 0x5704c0, 0x5704c8, 0x0, 0x0
.long 0x12, 0x808000, 0xc00, 0x3608000, 0x570c98, 0x80000000, 0x0, 0x0
.long 0x13, 0x808000, 0xa00, 0x4508000, 0x570a94, 0x80000000, 0x0, 0x0
.long 0x40, 0x6, 0x2, 0x8, 0x4, 0x1, 0x0, 0x1
.long 0x40, 0x1a, 0x2, 0x8, 0x4, 0x1, 0x0, 0x1
.long 0xe28, 0x4012000, 0x200, 0x240200, 0x575280, 0x575280, 0x570b00, 0x100e00
.long 0x1102b, 0x4e12000, 0x200, 0x240200, 0x80000000, 0x575280, 0x573200, 0x402000
.long 0x140425, 0x5218000, 0x200600, 0x300600, 0x575988, 0x575980, 0x573800, 0x400808
.long 0x340425, 0x5a1c000, 0x600600, 0x380600, 0x575d90, 0x575d80, 0x573c00, 0x400818
.long 0xff, 0x0, 0x0, 0x0, 0x0, 0x0, 0x0, 0x0
.long 0xff, 0x0, 0x0, 0x0, 0x0, 0x0, 0x0, 0x0
.long 0xff, 0x0, 0x0, 0x0, 0x0, 0x0, 0x0, 0x0
.long 0xff, 0x0, 0x0, 0x0, 0x0, 0x0, 0x0, 0x0
.long 0xff, 0x0, 0x0, 0x0, 0x0, 0x0, 0x0, 0x0
.long 0xff, 0x0, 0x0, 0x0, 0x0, 0x0, 0x0, 0x0
.long 0xff, 0x0, 0x0, 0x0, 0x0, 0x0, 0x0, 0x0
.long 0xff, 0x0, 0x0, 0x0, 0x0, 0x0, 0x0, 0x0
.long 0xff, 0x0, 0x0, 0x0, 0x0, 0x0, 0x0, 0x0
.long 0x0, 0x802000, 0x1900, 0x1c82000, 0x5708c8, 0x80000000, 0x0, 0x0
.long 0x0, 0x806000, 0x1900, 0x1c86000, 0x5709c8, 0x80000000, 0x0, 0x0
.long 0x10, 0x814000, 0x1800, 0x1c14000, 0x5705c0, 0x5705c8, 0x0, 0x0
.long 0x12, 0x80c000, 0xc00, 0x360c000, 0x570cd8, 0x80000000, 0x0, 0x0
.long 0x13, 0x80c000, 0xa00, 0x450c000, 0x570ad4, 0x80000000, 0x0, 0x0
.long 0x40, 0x6, 0x2, 0xc, 0x4, 0x1, 0x0, 0x1
.long 0x40, 0x1a, 0x2, 0xc, 0x4, 0x1, 0x0, 0x1
.long 0xe28, 0x4012000, 0x300, 0x240300, 0x5752c0, 0x5752c0, 0x570b00, 0x100e00
.long 0x1102b, 0x4e12000, 0x300, 0x240300, 0x80000000, 0x5752c0, 0x573200, 0x402000
.long 0x140425, 0x5218000, 0x200700, 0x300700, 0x5759c8, 0x5759c0, 0x573800, 0x400808
.long 0x340425, 0x5a1c000, 0x600700, 0x380700, 0x575dd0, 0x575dc0, 0x573c00, 0x400818
.long 0xff, 0x0, 0x0, 0x0, 0x0, 0x0, 0x0, 0x0
.long 0xff, 0x0, 0x0, 0x0, 0x0, 0x0, 0x0, 0x0
.long 0xff, 0x0, 0x0, 0x0, 0x0, 0x0, 0x0, 0x0
.long 0xff, 0x0, 0x0, 0x0, 0x0, 0x0, 0x0, 0x0
.long 0xff, 0x0, 0x0, 0x0, 0x0, 0x0, 0x0, 0x0
.long 0xff, 0x0, 0x0, 0x0, 0x0, 0x0, 0x0, 0x0
.long 0xff, 0x0, 0x0, 0x0, 0x0, 0x0, 0x0, 0x0
.long 0xff, 0x0, 0x0, 0x0, 0x0, 0x0, 0x0, 0x0
.long 0xff, 0x0, 0x0, 0x0, 0x0, 0x0, 0x0, 0x0
.long 0x0, 0x800000, 0x1a00, 0x1d00000, 0x5700d0, 0x80000000, 0x0, 0x0
.long 0x0, 0x804000, 0x1a00, 0x1d04000, 0x5701d0, 0x80000000, 0x0, 0x0
.long 0x10, 0x808000, 0x1a00, 0x1d08000, 0x5702d0, 0x5702d8, 0x0, 0x0
.long 0x12, 0x810000, 0xc00, 0x3610000, 0x570d18, 0x80000000, 0x0, 0x0
.long 0x13, 0x810000, 0xa00, 0x4510000, 0x570b14, 0x80000000, 0x0, 0x0
.long 0x40, 0x6, 0x2, 0x10, 0x4, 0x1, 0x0, 0x1
.long 0x40, 0x1a, 0x2, 0x10, 0x4, 0x1, 0x0, 0x1
.long 0xe28, 0x4012000, 0x400, 0x240400, 0x575300, 0x575300, 0x570b00, 0x100e00
.long 0x1102b, 0x4e12000, 0x400, 0x240400, 0x80000000, 0x575300, 0x573200, 0x402000
.long 0x240425, 0x561a000, 0x400000, 0x340000, 0x575a0c, 0x575a00, 0x573a00, 0x400810
.long 0xff, 0x0, 0x0, 0x0, 0x0, 0x0, 0x0, 0x0
.long 0xff, 0x0, 0x0, 0x0, 0x0, 0x0, 0x0, 0x0
.long 0xff, 0x0, 0x0, 0x0, 0x0, 0x0, 0x0, 0x0
.long 0xff, 0x0, 0x0, 0x0, 0x0, 0x0, 0x0, 0x0
.long 0xff, 0x0, 0x0, 0x0, 0x0, 0x0, 0x0, 0x0
.long 0xff, 0x0, 0x0, 0x0, 0x0, 0x0, 0x0, 0x0
.long 0xff, 0x0, 0x0, 0x0, 0x0, 0x0, 0x0, 0x0
.long 0xff, 0x0, 0x0, 0x0, 0x0, 0x0, 0x0, 0x0
.long 0xff, 0x0, 0x0, 0x0, 0x0, 0x0, 0x0, 0x0
.long 0xff, 0x0, 0x0, 0x0, 0x0, 0x0, 0x0, 0x0
.long 0x0, 0x802000, 0x1a00, 0x1d02000, 0x5708d0, 0x80000000, 0x0, 0x0
.long 0x0, 0x806000, 0x1a00, 0x1d06000, 0x5709d0, 0x80000000, 0x0, 0x0
.long 0x10, 0x80c000, 0x1a00, 0x1d0c000, 0x5703d0, 0x5703d8, 0x0, 0x0
.long 0x12, 0x814000, 0xc00, 0x3614000, 0x570d58, 0x80000000, 0x0, 0x0
.long 0x13, 0x814000, 0xa00, 0x4514000, 0x570b54, 0x80000000, 0x0, 0x0
.long 0x40, 0x6, 0x2, 0x14, 0x4, 0x1, 0x0, 0x1
.long 0x40, 0x1a, 0x2, 0x14, 0x4, 0x1, 0x0, 0x1
.long 0xe28, 0x4012000, 0x500, 0x240500, 0x575340, 0x575340, 0x570b00, 0x100e00
.long 0x1102b, 0x4e12000, 0x500, 0x240500, 0x80000000, 0x575340, 0x573200, 0x402000
.long 0x240425, 0x561a000, 0x400100, 0x340100, 0x575a4c, 0x575a40, 0x573a00, 0x400810
.long 0xff, 0x0, 0x0, 0x0, 0x0, 0x0, 0x0, 0x0
.long 0xff, 0x0, 0x0, 0x0, 0x0, 0x0, 0x0, 0x0
.long 0xff, 0x0, 0x0, 0x0, 0x0, 0x0, 0x0, 0x0
.long 0xff, 0x0, 0x0, 0x0, 0x0, 0x0, 0x0, 0x0
.long 0xff, 0x0, 0x0, 0x0, 0x0, 0x0, 0x0, 0x0
.long 0xff, 0x0, 0x0, 0x0, 0x0, 0x0, 0x0, 0x0
.long 0xff, 0x0, 0x0, 0x0, 0x0, 0x0, 0x0, 0x0
.long 0xff, 0x0, 0x0, 0x0, 0x0, 0x0, 0x0, 0x0
.long 0xff, 0x0, 0x0, 0x0, 0x0, 0x0, 0x0, 0x0
.long 0xff, 0x0, 0x0, 0x0, 0x0, 0x0, 0x0, 0x0
.long 0x0, 0x800000, 0x1b00, 0x1d80000, 0x5700d8, 0x80000000, 0x0, 0x0
.long 0x0, 0x804000, 0x1b00, 0x1d84000, 0x5701d8, 0x80000000, 0x0, 0x0
.long 0x10, 0x810000, 0x1a00, 0x1d10000, 0x5704d0, 0x5704d8, 0x0, 0x0
.long 0x12, 0x818000, 0xc00, 0x3618000, 0x570d98, 0x80000000, 0x0, 0x0
.long 0x13, 0x818000, 0xa00, 0x4518000, 0x570b94, 0x80000000, 0x0, 0x0
.long 0x40, 0x6, 0x2, 0x18, 0x4, 0x1, 0x0, 0x1
.long 0x40, 0x1a, 0x2, 0x18, 0x4, 0x1, 0x0, 0x1
.long 0xe28, 0x4012000, 0x600, 0x240600, 0x575380, 0x575380, 0x570b00, 0x100e00
.long 0x1102b, 0x4e12000, 0x600, 0x240600, 0x80000000, 0x575380, 0x573200, 0x402000
.long 0x240425, 0x561a000, 0x400200, 0x340200, 0x575a8c, 0x575a80, 0x573a00, 0x400810
.long 0xff, 0x0, 0x0, 0x0, 0x0, 0x0, 0x0, 0x0
.long 0xff, 0x0, 0x0, 0x0, 0x0, 0x0, 0x0, 0x0
.long 0xff, 0x0, 0x0, 0x0, 0x0, 0x0, 0x0, 0x0
.long 0xff, 0x0, 0x0, 0x0, 0x0, 0x0, 0x0, 0x0
.long 0xff, 0x0, 0x0, 0x0, 0x0, 0x0, 0x0, 0x0
.long 0xff, 0x0, 0x0, 0x0, 0x0, 0x0, 0x0, 0x0
.long 0xff, 0x0, 0x0, 0x0, 0x0, 0x0, 0x0, 0x0
.long 0xff, 0x0, 0x0, 0x0, 0x0, 0x0, 0x0, 0x0
.long 0xff, 0x0, 0x0, 0x0, 0x0, 0x0, 0x0, 0x0
.long 0xff, 0x0, 0x0, 0x0, 0x0, 0x0, 0x0, 0x0
.long 0x0, 0x802000, 0x1b00, 0x1d82000, 0x5708d8, 0x80000000, 0x0, 0x0
.long 0x0, 0x806000, 0x1b00, 0x1d86000, 0x5709d8, 0x80000000, 0x0, 0x0
.long 0x10, 0x814000, 0x1a00, 0x1d14000, 0x5705d0, 0x5705d8, 0x0, 0x0
.long 0x12, 0x81c000, 0xc00, 0x361c000, 0x570dd8, 0x80000000, 0x0, 0x0
.long 0x13, 0x81c000, 0xa00, 0x451c000, 0x570bd4, 0x80000000, 0x0, 0x0
.long 0x40, 0x6, 0x2, 0x1c, 0x4, 0x1, 0x0, 0x1
.long 0x40, 0x1a, 0x2, 0x1c, 0x4, 0x1, 0x0, 0x1
.long 0xe28, 0x4012000, 0x700, 0x240700, 0x5753c0, 0x5753c0, 0x570b00, 0x100e00
.long 0x1102b, 0x4e12000, 0x700, 0x240700, 0x80000000, 0x5753c0, 0x573200, 0x402000
.long 0x240425, 0x561a000, 0x400300, 0x340300, 0x575acc, 0x575ac0, 0x573a00, 0x400810
.long 0xff, 0x0, 0x0, 0x0, 0x0, 0x0, 0x0, 0x0
.long 0xff, 0x0, 0x0, 0x0, 0x0, 0x0, 0x0, 0x0
.long 0xff, 0x0, 0x0, 0x0, 0x0, 0x0, 0x0, 0x0
.long 0xff, 0x0, 0x0, 0x0, 0x0, 0x0, 0x0, 0x0
.long 0xff, 0x0, 0x0, 0x0, 0x0, 0x0, 0x0, 0x0
.long 0xff, 0x0, 0x0, 0x0, 0x0, 0x0, 0x0, 0x0
.long 0xff, 0x0, 0x0, 0x0, 0x0, 0x0, 0x0, 0x0
.long 0xff, 0x0, 0x0, 0x0, 0x0, 0x0, 0x0, 0x0
.long 0xff, 0x0, 0x0, 0x0, 0x0, 0x0, 0x0, 0x0
.long 0xff, 0x0, 0x0, 0x0, 0x0, 0x0, 0x0, 0x0
.long 0x0, 0x800000, 0x1c00, 0x1e00000, 0x5700e0, 0x80000000, 0x0, 0x0
.long 0x0, 0x804000, 0x1c00, 0x1e04000, 0x5701e0, 0x80000000, 0x0, 0x0
.long 0x10, 0x808000, 0x1c00, 0x1e08000, 0x5702e0, 0x5702e8, 0x0, 0x0
.long 0x12, 0x800000, 0xe00, 0x3700000, 0x570c1c, 0x80000000, 0x0, 0x0
.long 0x13, 0x800000, 0xc00, 0x4600000, 0x570a18, 0x80000000, 0x0, 0x0
.long 0x40, 0x8, 0x2, 0x0, 0x4, 0x1, 0x0, 0x1
.long 0x40, 0x1c, 0x2, 0x0, 0x4, 0x1, 0x0, 0x1
.long 0xe20, 0x401a000, 0x0, 0x340000, 0x575a00, 0x575a00, 0x570b80, 0x100e00
.long 0x40, 0x28, 0x6, 0x8, 0x4, 0x0, 0x1, 0x4
.long 0x180225, 0x501e000, 0x100000, 0x3c0000, 0x575e08, 0x575e00, 0x573e00, 0x400404
.long 0xff, 0x0, 0x0, 0x0, 0x0, 0x0, 0x0, 0x0
.long 0xff, 0x0, 0x0, 0x0, 0x0, 0x0, 0x0, 0x0
.long 0xff, 0x0, 0x0, 0x0, 0x0, 0x0, 0x0, 0x0
.long 0xff, 0x0, 0x0, 0x0, 0x0, 0x0, 0x0, 0x0
.long 0xff, 0x0, 0x0, 0x0, 0x0, 0x0, 0x0, 0x0
.long 0xff, 0x0, 0x0, 0x0, 0x0, 0x0, 0x0, 0x0
.long 0xff, 0x0, 0x0, 0x0, 0x0, 0x0, 0x0, 0x0
.long 0xff, 0x0, 0x0, 0x0, 0x0, 0x0, 0x0, 0x0
.long 0xff, 0x0, 0x0, 0x0, 0x0, 0x0, 0x0, 0x0
.long 0xff, 0x0, 0x0, 0x0, 0x0, 0x0, 0x0, 0x0
.long 0x0, 0x802000, 0x1c00, 0x1e02000, 0x5708e0, 0x80000000, 0x0, 0x0
.long 0x0, 0x806000, 0x1c00, 0x1e06000, 0x5709e0, 0x80000000, 0x0, 0x0
.long 0x10, 0x80c000, 0x1c00, 0x1e0c000, 0x5703e0, 0x5703e8, 0x0, 0x0
.long 0x12, 0x804000, 0xe00, 0x3704000, 0x570c5c, 0x80000000, 0x0, 0x0
.long 0x13, 0x804000, 0xc00, 0x4604000, 0x570a58, 0x80000000, 0x0, 0x0
.long 0x40, 0x8, 0x2, 0x4, 0x4, 0x1, 0x0, 0x1
.long 0x40, 0x1c, 0x2, 0x4, 0x4, 0x1, 0x0, 0x1
.long 0xe20, 0x401a000, 0x100, 0x340100, 0x575a40, 0x575a40, 0x570b80, 0x100e00
.long 0x40, 0x28, 0x6, 0x9, 0x4, 0x0, 0x1, 0x4
.long 0x180225, 0x501e000, 0x100100, 0x3c0100, 0x575e48, 0x575e40, 0x573e00, 0x400404
.long 0xff, 0x0, 0x0, 0x0, 0x0, 0x0, 0x0, 0x0
.long 0xff, 0x0, 0x0, 0x0, 0x0, 0x0, 0x0, 0x0
.long 0xff, 0x0, 0x0, 0x0, 0x0, 0x0, 0x0, 0x0
.long 0xff, 0x0, 0x0, 0x0, 0x0, 0x0, 0x0, 0x0
.long 0xff, 0x0, 0x0, 0x0, 0x0, 0x0, 0x0, 0x0
.long 0xff, 0x0, 0x0, 0x0, 0x0, 0x0, 0x0, 0x0
.long 0xff, 0x0, 0x0, 0x0, 0x0, 0x0, 0x0, 0x0
.long 0xff, 0x0, 0x0, 0x0, 0x0, 0x0, 0x0, 0x0
.long 0xff, 0x0, 0x0, 0x0, 0x0, 0x0, 0x0, 0x0
.long 0xff, 0x0, 0x0, 0x0, 0x0, 0x0, 0x0, 0x0
.long 0x0, 0x800000, 0x1d00, 0x1e80000, 0x5700e8, 0x80000000, 0x0, 0x0
.long 0x0, 0x804000, 0x1d00, 0x1e84000, 0x5701e8, 0x80000000, 0x0, 0x0
.long 0x10, 0x810000, 0x1c00, 0x1e10000, 0x5704e0, 0x5704e8, 0x0, 0x0
.long 0x12, 0x808000, 0xe00, 0x3708000, 0x570c9c, 0x80000000, 0x0, 0x0
.long 0x13, 0x808000, 0xc00, 0x4608000, 0x570a98, 0x80000000, 0x0, 0x0
.long 0x40, 0x8, 0x2, 0x8, 0x4, 0x1, 0x0, 0x1
.long 0x40, 0x1c, 0x2, 0x8, 0x4, 0x1, 0x0, 0x1
.long 0xe20, 0x401a000, 0x200, 0x340200, 0x575a80, 0x575a80, 0x570b80, 0x100e00
.long 0x40, 0x28, 0x6, 0xa, 0x4, 0x0, 0x1, 0x4
.long 0x180225, 0x501e000, 0x100200, 0x3c0200, 0x575e88, 0x575e80, 0x573e00, 0x400404
.long 0xff, 0x0, 0x0, 0x0, 0x0, 0x0, 0x0, 0x0
.long 0xff, 0x0, 0x0, 0x0, 0x0, 0x0, 0x0, 0x0
.long 0xff, 0x0, 0x0, 0x0, 0x0, 0x0, 0x0, 0x0
.long 0xff, 0x0, 0x0, 0x0, 0x0, 0x0, 0x0, 0x0
.long 0xff, 0x0, 0x0, 0x0, 0x0, 0x0, 0x0, 0x0
.long 0xff, 0x0, 0x0, 0x0, 0x0, 0x0, 0x0, 0x0
.long 0xff, 0x0, 0x0, 0x0, 0x0, 0x0, 0x0, 0x0
.long 0xff, 0x0, 0x0, 0x0, 0x0, 0x0, 0x0, 0x0
.long 0xff, 0x0, 0x0, 0x0, 0x0, 0x0, 0x0, 0x0
.long 0xff, 0x0, 0x0, 0x0, 0x0, 0x0, 0x0, 0x0
.long 0x0, 0x802000, 0x1d00, 0x1e82000, 0x5708e8, 0x80000000, 0x0, 0x0
.long 0x0, 0x806000, 0x1d00, 0x1e86000, 0x5709e8, 0x80000000, 0x0, 0x0
.long 0x10, 0x814000, 0x1c00, 0x1e14000, 0x5705e0, 0x5705e8, 0x0, 0x0
.long 0x12, 0x80c000, 0xe00, 0x370c000, 0x570cdc, 0x80000000, 0x0, 0x0
.long 0x13, 0x80c000, 0xc00, 0x460c000, 0x570ad8, 0x80000000, 0x0, 0x0
.long 0x40, 0x8, 0x2, 0xc, 0x4, 0x1, 0x0, 0x1
.long 0x40, 0x1c, 0x2, 0xc, 0x4, 0x1, 0x0, 0x1
.long 0xe20, 0x401a000, 0x300, 0x340300, 0x575ac0, 0x575ac0, 0x570b80, 0x100e00
.long 0x40, 0x28, 0x6, 0xb, 0x4, 0x0, 0x1, 0x4
.long 0x180225, 0x501e000, 0x100300, 0x3c0300, 0x575ec8, 0x575ec0, 0x573e00, 0x400404
.long 0xff, 0x0, 0x0, 0x0, 0x0, 0x0, 0x0, 0x0
.long 0xff, 0x0, 0x0, 0x0, 0x0, 0x0, 0x0, 0x0
.long 0xff, 0x0, 0x0, 0x0, 0x0, 0x0, 0x0, 0x0
.long 0xff, 0x0, 0x0, 0x0, 0x0, 0x0, 0x0, 0x0
.long 0xff, 0x0, 0x0, 0x0, 0x0, 0x0, 0x0, 0x0
.long 0xff, 0x0, 0x0, 0x0, 0x0, 0x0, 0x0, 0x0
.long 0xff, 0x0, 0x0, 0x0, 0x0, 0x0, 0x0, 0x0
.long 0xff, 0x0, 0x0, 0x0, 0x0, 0x0, 0x0, 0x0
.long 0xff, 0x0, 0x0, 0x0, 0x0, 0x0, 0x0, 0x0
.long 0xff, 0x0, 0x0, 0x0, 0x0, 0x0, 0x0, 0x0
.long 0x0, 0x800000, 0x1e00, 0x1f00000, 0x5700f0, 0x80000000, 0x0, 0x0
.long 0x0, 0x804000, 0x1e00, 0x1f04000, 0x5701f0, 0x80000000, 0x0, 0x0
.long 0x10, 0x808000, 0x1e00, 0x1f08000, 0x5702f0, 0x5702f8, 0x0, 0x0
.long 0x12, 0x810000, 0xe00, 0x3710000, 0x570d1c, 0x80000000, 0x0, 0x0
.long 0x13, 0x810000, 0xc00, 0x4610000, 0x570b18, 0x80000000, 0x0, 0x0
.long 0x40, 0x8, 0x2, 0x10, 0x4, 0x1, 0x0, 0x1
.long 0x40, 0x1c, 0x2, 0x10, 0x4, 0x1, 0x0, 0x1
.long 0xe20, 0x401a000, 0x400, 0x340400, 0x575b00, 0x575b00, 0x570b80, 0x100e00
.long 0x40, 0x28, 0x6, 0xc, 0x4, 0x0, 0x1, 0x4
.long 0x180225, 0x501e000, 0x100400, 0x3c0400, 0x575f08, 0x575f00, 0x573e00, 0x400404
.long 0xff, 0x0, 0x0, 0x0, 0x0, 0x0, 0x0, 0x0
.long 0xff, 0x0, 0x0, 0x0, 0x0, 0x0, 0x0, 0x0
.long 0xff, 0x0, 0x0, 0x0, 0x0, 0x0, 0x0, 0x0
.long 0xff, 0x0, 0x0, 0x0, 0x0, 0x0, 0x0, 0x0
.long 0xff, 0x0, 0x0, 0x0, 0x0, 0x0, 0x0, 0x0
.long 0xff, 0x0, 0x0, 0x0, 0x0, 0x0, 0x0, 0x0
.long 0xff, 0x0, 0x0, 0x0, 0x0, 0x0, 0x0, 0x0
.long 0xff, 0x0, 0x0, 0x0, 0x0, 0x0, 0x0, 0x0
.long 0xff, 0x0, 0x0, 0x0, 0x0, 0x0, 0x0, 0x0
.long 0xff, 0x0, 0x0, 0x0, 0x0, 0x0, 0x0, 0x0
.long 0x0, 0x802000, 0x1e00, 0x1f02000, 0x5708f0, 0x80000000, 0x0, 0x0
.long 0x0, 0x806000, 0x1e00, 0x1f06000, 0x5709f0, 0x80000000, 0x0, 0x0
.long 0x10, 0x80c000, 0x1e00, 0x1f0c000, 0x5703f0, 0x5703f8, 0x0, 0x0
.long 0x12, 0x814000, 0xe00, 0x3714000, 0x570d5c, 0x80000000, 0x0, 0x0
.long 0x13, 0x814000, 0xc00, 0x4614000, 0x570b58, 0x80000000, 0x0, 0x0
.long 0x40, 0x8, 0x2, 0x14, 0x4, 0x1, 0x0, 0x1
.long 0x40, 0x1c, 0x2, 0x14, 0x4, 0x1, 0x0, 0x1
.long 0xe20, 0x401a000, 0x500, 0x340500, 0x575b40, 0x575b40, 0x570b80, 0x100e00
.long 0x40, 0x28, 0x6, 0xd, 0x4, 0x0, 0x1, 0x4
.long 0x180225, 0x501e000, 0x100500, 0x3c0500, 0x575f48, 0x575f40, 0x573e00, 0x400404
.long 0xff, 0x0, 0x0, 0x0, 0x0, 0x0, 0x0, 0x0
.long 0xff, 0x0, 0x0, 0x0, 0x0, 0x0, 0x0, 0x0
.long 0xff, 0x0, 0x0, 0x0, 0x0, 0x0, 0x0, 0x0
.long 0xff, 0x0, 0x0, 0x0, 0x0, 0x0, 0x0, 0x0
.long 0xff, 0x0, 0x0, 0x0, 0x0, 0x0, 0x0, 0x0
.long 0xff, 0x0, 0x0, 0x0, 0x0, 0x0, 0x0, 0x0
.long 0xff, 0x0, 0x0, 0x0, 0x0, 0x0, 0x0, 0x0
.long 0xff, 0x0, 0x0, 0x0, 0x0, 0x0, 0x0, 0x0
.long 0xff, 0x0, 0x0, 0x0, 0x0, 0x0, 0x0, 0x0
.long 0xff, 0x0, 0x0, 0x0, 0x0, 0x0, 0x0, 0x0
.long 0x0, 0x800000, 0x1f00, 0x1f80000, 0x5700f8, 0x80000000, 0x0, 0x0
.long 0x0, 0x804000, 0x1f00, 0x1f84000, 0x5701f8, 0x80000000, 0x0, 0x0
.long 0x10, 0x810000, 0x1e00, 0x1f10000, 0x5704f0, 0x5704f8, 0x0, 0x0
.long 0x12, 0x818000, 0xe00, 0x3718000, 0x570d9c, 0x80000000, 0x0, 0x0
.long 0x13, 0x818000, 0xc00, 0x4618000, 0x570b98, 0x80000000, 0x0, 0x0
.long 0x40, 0x8, 0x2, 0x18, 0x4, 0x1, 0x0, 0x1
.long 0x40, 0x1c, 0x2, 0x18, 0x4, 0x1, 0x0, 0x1
.long 0xe20, 0x401a000, 0x600, 0x340600, 0x575b80, 0x575b80, 0x570b80, 0x100e00
.long 0x40, 0x28, 0x6, 0xe, 0x4, 0x0, 0x1, 0x4
.long 0x180225, 0x501e000, 0x100600, 0x3c0600, 0x575f88, 0x575f80, 0x573e00, 0x400404
.long 0xff, 0x0, 0x0, 0x0, 0x0, 0x0, 0x0, 0x0
.long 0xff, 0x0, 0x0, 0x0, 0x0, 0x0, 0x0, 0x0
.long 0xff, 0x0, 0x0, 0x0, 0x0, 0x0, 0x0, 0x0
.long 0xff, 0x0, 0x0, 0x0, 0x0, 0x0, 0x0, 0x0
.long 0xff, 0x0, 0x0, 0x0, 0x0, 0x0, 0x0, 0x0
.long 0xff, 0x0, 0x0, 0x0, 0x0, 0x0, 0x0, 0x0
.long 0xff, 0x0, 0x0, 0x0, 0x0, 0x0, 0x0, 0x0
.long 0xff, 0x0, 0x0, 0x0, 0x0, 0x0, 0x0, 0x0
.long 0xff, 0x0, 0x0, 0x0, 0x0, 0x0, 0x0, 0x0
.long 0xff, 0x0, 0x0, 0x0, 0x0, 0x0, 0x0, 0x0
.long 0x0, 0x802000, 0x1f00, 0x1f82000, 0x5708f8, 0x80000000, 0x0, 0x0
.long 0x0, 0x806000, 0x1f00, 0x1f86000, 0x5709f8, 0x80000000, 0x0, 0x0
.long 0x10, 0x814000, 0x1e00, 0x1f14000, 0x5705f0, 0x5705f8, 0x0, 0x0
.long 0x12, 0x81c000, 0xe00, 0x371c000, 0x570ddc, 0x80000000, 0x0, 0x0
.long 0x13, 0x81c000, 0xc00, 0x461c000, 0x570bd8, 0x80000000, 0x0, 0x0
.long 0x40, 0x8, 0x2, 0x1c, 0x4, 0x1, 0x0, 0x1
.long 0x40, 0x1c, 0x2, 0x1c, 0x4, 0x1, 0x0, 0x1
.long 0xe20, 0x401a000, 0x700, 0x340700, 0x575bc0, 0x575bc0, 0x570b80, 0x100e00
.long 0x40, 0x28, 0x6, 0xf, 0x4, 0x0, 0x1, 0x4
.long 0x180225, 0x501e000, 0x100700, 0x3c0700, 0x575fc8, 0x575fc0, 0x573e00, 0x400404
.long 0xff, 0x0, 0x0, 0x0, 0x0, 0x0, 0x0, 0x0
.long 0xff, 0x0, 0x0, 0x0, 0x0, 0x0, 0x0, 0x0
.long 0xff, 0x0, 0x0, 0x0, 0x0, 0x0, 0x0, 0x0
.long 0xff, 0x0, 0x0, 0x0, 0x0, 0x0, 0x0, 0x0
.long 0xff, 0x0, 0x0, 0x0, 0x0, 0x0, 0x0, 0x0
.long 0xff, 0x0, 0x0, 0x0, 0x0, 0x0, 0x0, 0x0
.long 0xff, 0x0, 0x0, 0x0, 0x0, 0x0, 0x0, 0x0
.long 0xff, 0x0, 0x0, 0x0, 0x0, 0x0, 0x0, 0x0
.long 0xff, 0x0, 0x0, 0x0, 0x0, 0x0, 0x0, 0x0
.long 0xff, 0x0, 0x0, 0x0, 0x0, 0x0, 0x0, 0x0
.long 0x1, 0x800000, 0x0, 0x2000000, 0x570004, 0x80000000, 0x0, 0x0
.long 0x1, 0x804000, 0x0, 0x2004000, 0x570104, 0x80000000, 0x0, 0x0
.long 0x11, 0x808000, 0x0, 0x2008000, 0x570204, 0x57020c, 0x0, 0x0
.long 0x12, 0x800000, 0x1000, 0x3800000, 0x570c20, 0x80000000, 0x0, 0x0
.long 0x11, 0x818000, 0x0, 0x2018000, 0x570604, 0x57060c, 0x0, 0x0
.long 0x11, 0x818000, 0x800, 0x2418000, 0x570644, 0x57064c, 0x0, 0x0
.long 0xe28, 0x4004000, 0x0, 0x80000, 0x574400, 0x574400, 0x570a40, 0x100e00
.long 0x1102b, 0x4e04000, 0x0, 0x80000, 0x80000000, 0x574400, 0x572400, 0x402000
.long 0x240425, 0x5618000, 0x400400, 0x300400, 0x57590c, 0x575900, 0x573800, 0x400810
.long 0x680225, 0x5a1e000, 0x600400, 0x3c0400, 0x575f1c, 0x575f00, 0x573e00, 0x400418
.long 0xff, 0x0, 0x0, 0x0, 0x0, 0x0, 0x0, 0x0
.long 0xff, 0x0, 0x0, 0x0, 0x0, 0x0, 0x0, 0x0
.long 0xff, 0x0, 0x0, 0x0, 0x0, 0x0, 0x0, 0x0
.long 0xff, 0x0, 0x0, 0x0, 0x0, 0x0, 0x0, 0x0
.long 0xff, 0x0, 0x0, 0x0, 0x0, 0x0, 0x0, 0x0
.long 0xff, 0x0, 0x0, 0x0, 0x0, 0x0, 0x0, 0x0
.long 0xff, 0x0, 0x0, 0x0, 0x0, 0x0, 0x0, 0x0
.long 0xff, 0x0, 0x0, 0x0, 0x0, 0x0, 0x0, 0x0
.long 0xff, 0x0, 0x0, 0x0, 0x0, 0x0, 0x0, 0x0
.long 0xff, 0x0, 0x0, 0x0, 0x0, 0x0, 0x0, 0x0
.long 0x1, 0x802000, 0x0, 0x2002000, 0x570804, 0x80000000, 0x0, 0x0
.long 0x1, 0x806000, 0x0, 0x2006000, 0x570904, 0x80000000, 0x0, 0x0
.long 0x11, 0x80c000, 0x0, 0x200c000, 0x570304, 0x57030c, 0x0, 0x0
.long 0x12, 0x804000, 0x1000, 0x3804000, 0x570c60, 0x80000000, 0x0, 0x0
.long 0x11, 0x818000, 0x200, 0x2118000, 0x570614, 0x57061c, 0x0, 0x0
.long 0x11, 0x818000, 0xa00, 0x2518000, 0x570654, 0x57065c, 0x0, 0x0
.long 0xe28, 0x4004000, 0x100, 0x80100, 0x574440, 0x574440, 0x570a40, 0x100e00
.long 0x1102b, 0x4e04000, 0x100, 0x80100, 0x80000000, 0x574440, 0x572400, 0x402000
.long 0x240425, 0x5618000, 0x400500, 0x300500, 0x57594c, 0x575940, 0x573800, 0x400810
.long 0x680225, 0x5a1e000, 0x600500, 0x3c0500, 0x575f5c, 0x575f40, 0x573e00, 0x400418
.long 0xff, 0x0, 0x0, 0x0, 0x0, 0x0, 0x0, 0x0
.long 0xff, 0x0, 0x0, 0x0, 0x0, 0x0, 0x0, 0x0
.long 0xff, 0x0, 0x0, 0x0, 0x0, 0x0, 0x0, 0x0
.long 0xff, 0x0, 0x0, 0x0, 0x0, 0x0, 0x0, 0x0
.long 0xff, 0x0, 0x0, 0x0, 0x0, 0x0, 0x0, 0x0
.long 0xff, 0x0, 0x0, 0x0, 0x0, 0x0, 0x0, 0x0
.long 0xff, 0x0, 0x0, 0x0, 0x0, 0x0, 0x0, 0x0
.long 0xff, 0x0, 0x0, 0x0, 0x0, 0x0, 0x0, 0x0
.long 0xff, 0x0, 0x0, 0x0, 0x0, 0x0, 0x0, 0x0
.long 0xff, 0x0, 0x0, 0x0, 0x0, 0x0, 0x0, 0x0
.long 0x1, 0x800000, 0x100, 0x2080000, 0x57000c, 0x80000000, 0x0, 0x0
.long 0x1, 0x804000, 0x100, 0x2084000, 0x57010c, 0x80000000, 0x0, 0x0
.long 0x11, 0x810000, 0x0, 0x2010000, 0x570404, 0x57040c, 0x0, 0x0
.long 0x12, 0x808000, 0x1000, 0x3808000, 0x570ca0, 0x80000000, 0x0, 0x0
.long 0x11, 0x818000, 0x400, 0x2218000, 0x570624, 0x57062c, 0x0, 0x0
.long 0x11, 0x818000, 0xc00, 0x2618000, 0x570664, 0x57066c, 0x0, 0x0
.long 0xe28, 0x4004000, 0x200, 0x80200, 0x574480, 0x574480, 0x570a40, 0x100e00
.long 0x1102b, 0x4e04000, 0x200, 0x80200, 0x80000000, 0x574480, 0x572400, 0x402000
.long 0x240425, 0x5618000, 0x400600, 0x300600, 0x57598c, 0x575980, 0x573800, 0x400810
.long 0x680225, 0x5a1e000, 0x600600, 0x3c0600, 0x575f9c, 0x575f80, 0x573e00, 0x400418
.long 0xff, 0x0, 0x0, 0x0, 0x0, 0x0, 0x0, 0x0
.long 0xff, 0x0, 0x0, 0x0, 0x0, 0x0, 0x0, 0x0
.long 0xff, 0x0, 0x0, 0x0, 0x0, 0x0, 0x0, 0x0
.long 0xff, 0x0, 0x0, 0x0, 0x0, 0x0, 0x0, 0x0
.long 0xff, 0x0, 0x0, 0x0, 0x0, 0x0, 0x0, 0x0
.long 0xff, 0x0, 0x0, 0x0, 0x0, 0x0, 0x0, 0x0
.long 0xff, 0x0, 0x0, 0x0, 0x0, 0x0, 0x0, 0x0
.long 0xff, 0x0, 0x0, 0x0, 0x0, 0x0, 0x0, 0x0
.long 0xff, 0x0, 0x0, 0x0, 0x0, 0x0, 0x0, 0x0
.long 0xff, 0x0, 0x0, 0x0, 0x0, 0x0, 0x0, 0x0
.long 0x1, 0x802000, 0x100, 0x2082000, 0x57080c, 0x80000000, 0x0, 0x0
.long 0x1, 0x806000, 0x100, 0x2086000, 0x57090c, 0x80000000, 0x0, 0x0
.long 0x11, 0x814000, 0x0, 0x2014000, 0x570504, 0x57050c, 0x0, 0x0
.long 0x12, 0x80c000, 0x1000, 0x380c000, 0x570ce0, 0x80000000, 0x0, 0x0
.long 0x11, 0x818000, 0x600, 0x2318000, 0x570634, 0x57063c, 0x0, 0x0
.long 0x11, 0x818000, 0xe00, 0x2718000, 0x570674, 0x57067c, 0x0, 0x0
.long 0xe28, 0x4004000, 0x300, 0x80300, 0x5744c0, 0x5744c0, 0x570a40, 0x100e00
.long 0x1102b, 0x4e04000, 0x300, 0x80300, 0x80000000, 0x5744c0, 0x572400, 0x402000
.long 0x240425, 0x5618000, 0x400700, 0x300700, 0x5759cc, 0x5759c0, 0x573800, 0x400810
.long 0x680225, 0x5a1e000, 0x600700, 0x3c0700, 0x575fdc, 0x575fc0, 0x573e00, 0x400418
.long 0xff, 0x0, 0x0, 0x0, 0x0, 0x0, 0x0, 0x0
.long 0xff, 0x0, 0x0, 0x0, 0x0, 0x0, 0x0, 0x0
.long 0xff, 0x0, 0x0, 0x0, 0x0, 0x0, 0x0, 0x0
.long 0xff, 0x0, 0x0, 0x0, 0x0, 0x0, 0x0, 0x0
.long 0xff, 0x0, 0x0, 0x0, 0x0, 0x0, 0x0, 0x0
.long 0xff, 0x0, 0x0, 0x0, 0x0, 0x0, 0x0, 0x0
.long 0xff, 0x0, 0x0, 0x0, 0x0, 0x0, 0x0, 0x0
.long 0xff, 0x0, 0x0, 0x0, 0x0, 0x0, 0x0, 0x0
.long 0xff, 0x0, 0x0, 0x0, 0x0, 0x0, 0x0, 0x0
.long 0xff, 0x0, 0x0, 0x0, 0x0, 0x0, 0x0, 0x0
.long 0x1, 0x800000, 0x200, 0x2100000, 0x570014, 0x80000000, 0x0, 0x0
.long 0x1, 0x804000, 0x200, 0x2104000, 0x570114, 0x80000000, 0x0, 0x0
.long 0x11, 0x808000, 0x200, 0x2108000, 0x570214, 0x57021c, 0x0, 0x0
.long 0x12, 0x810000, 0x1000, 0x3810000, 0x570d20, 0x80000000, 0x0, 0x0
.long 0x13, 0x800000, 0xe00, 0x4700000, 0x570a1c, 0x80000000, 0x0, 0x0
.long 0x11, 0x81c000, 0x0, 0x201c000, 0x570704, 0x57070c, 0x0, 0x0
.long 0xe28, 0x4004000, 0x400, 0x80400, 0x574500, 0x574500, 0x570a40, 0x100e00
.long 0x1102b, 0x4e04000, 0x400, 0x80400, 0x80000000, 0x574500, 0x572400, 0x402000
.long 0x340425, 0x5a18000, 0x600000, 0x300000, 0x575810, 0x575800, 0x573800, 0x400818
.long 0x780225, 0x5c1e000, 0x700000, 0x3c0000, 0x575e20, 0x575e00, 0x573e00, 0x40041c
.long 0xff, 0x0, 0x0, 0x0, 0x0, 0x0, 0x0, 0x0
.long 0xff, 0x0, 0x0, 0x0, 0x0, 0x0, 0x0, 0x0
.long 0xff, 0x0, 0x0, 0x0, 0x0, 0x0, 0x0, 0x0
.long 0xff, 0x0, 0x0, 0x0, 0x0, 0x0, 0x0, 0x0
.long 0xff, 0x0, 0x0, 0x0, 0x0, 0x0, 0x0, 0x0
.long 0xff, 0x0, 0x0, 0x0, 0x0, 0x0, 0x0, 0x0
.long 0xff, 0x0, 0x0, 0x0, 0x0, 0x0, 0x0, 0x0
.long 0xff, 0x0, 0x0, 0x0, 0x0, 0x0, 0x0, 0x0
.long 0xff, 0x0, 0x0, 0x0, 0x0, 0x0, 0x0, 0x0
.long 0xff, 0x0, 0x0, 0x0, 0x0, 0x0, 0x0, 0x0
.long 0x1, 0x802000, 0x200, 0x2102000, 0x570814, 0x80000000, 0x0, 0x0
.long 0x1, 0x806000, 0x200, 0x2106000, 0x570914, 0x80000000, 0x0, 0x0
.long 0x11, 0x80c000, 0x200, 0x210c000, 0x570314, 0x57031c, 0x0, 0x0
.long 0x12, 0x814000, 0x1000, 0x3814000, 0x570d60, 0x80000000, 0x0, 0x0
.long 0x13, 0x804000, 0xe00, 0x4704000, 0x570a5c, 0x80000000, 0x0, 0x0
.long 0x11, 0x81c000, 0x200, 0x211c000, 0x570714, 0x57071c, 0x0, 0x0
.long 0xe28, 0x4004000, 0x500, 0x80500, 0x574540, 0x574540, 0x570a40, 0x100e00
.long 0x1102b, 0x4e04000, 0x500, 0x80500, 0x80000000, 0x574540, 0x572400, 0x402000
.long 0x340425, 0x5a18000, 0x600100, 0x300100, 0x575850, 0x575840, 0x573800, 0x400818
.long 0x780225, 0x5c1e000, 0x700100, 0x3c0100, 0x575e60, 0x575e40, 0x573e00, 0x40041c
.long 0xff, 0x0, 0x0, 0x0, 0x0, 0x0, 0x0, 0x0
.long 0xff, 0x0, 0x0, 0x0, 0x0, 0x0, 0x0, 0x0
.long 0xff, 0x0, 0x0, 0x0, 0x0, 0x0, 0x0, 0x0
.long 0xff, 0x0, 0x0, 0x0, 0x0, 0x0, 0x0, 0x0
.long 0xff, 0x0, 0x0, 0x0, 0x0, 0x0, 0x0, 0x0
.long 0xff, 0x0, 0x0, 0x0, 0x0, 0x0, 0x0, 0x0
.long 0xff, 0x0, 0x0, 0x0, 0x0, 0x0, 0x0, 0x0
.long 0xff, 0x0, 0x0, 0x0, 0x0, 0x0, 0x0, 0x0
.long 0xff, 0x0, 0x0, 0x0, 0x0, 0x0, 0x0, 0x0
.long 0xff, 0x0, 0x0, 0x0, 0x0, 0x0, 0x0, 0x0
.long 0x1, 0x800000, 0x300, 0x2180000, 0x57001c, 0x80000000, 0x0, 0x0
.long 0x1, 0x804000, 0x300, 0x2184000, 0x57011c, 0x80000000, 0x0, 0x0
.long 0x11, 0x810000, 0x200, 0x2110000, 0x570414, 0x57041c, 0x0, 0x0
.long 0x12, 0x818000, 0x1000, 0x3818000, 0x570da0, 0x80000000, 0x0, 0x0
.long 0x13, 0x808000, 0xe00, 0x4708000, 0x570a9c, 0x80000000, 0x0, 0x0
.long 0x11, 0x81c000, 0x400, 0x221c000, 0x570724, 0x57072c, 0x0, 0x0
.long 0xe28, 0x4004000, 0x600, 0x80600, 0x574580, 0x574580, 0x570a40, 0x100e00
.long 0x1102b, 0x4e04000, 0x600, 0x80600, 0x80000000, 0x574580, 0x572400, 0x402000
.long 0x340425, 0x5a18000, 0x600200, 0x300200, 0x575890, 0x575880, 0x573800, 0x400818
.long 0x780225, 0x5c1e000, 0x700200, 0x3c0200, 0x575ea0, 0x575e80, 0x573e00, 0x40041c
.long 0xff, 0x0, 0x0, 0x0, 0x0, 0x0, 0x0, 0x0
.long 0xff, 0x0, 0x0, 0x0, 0x0, 0x0, 0x0, 0x0
.long 0xff, 0x0, 0x0, 0x0, 0x0, 0x0, 0x0, 0x0
.long 0xff, 0x0, 0x0, 0x0, 0x0, 0x0, 0x0, 0x0
.long 0xff, 0x0, 0x0, 0x0, 0x0, 0x0, 0x0, 0x0
.long 0xff, 0x0, 0x0, 0x0, 0x0, 0x0, 0x0, 0x0
.long 0xff, 0x0, 0x0, 0x0, 0x0, 0x0, 0x0, 0x0
.long 0xff, 0x0, 0x0, 0x0, 0x0, 0x0, 0x0, 0x0
.long 0xff, 0x0, 0x0, 0x0, 0x0, 0x0, 0x0, 0x0
.long 0xff, 0x0, 0x0, 0x0, 0x0, 0x0, 0x0, 0x0
.long 0x1, 0x802000, 0x300, 0x2182000, 0x57081c, 0x80000000, 0x0, 0x0
.long 0x1, 0x806000, 0x300, 0x2186000, 0x57091c, 0x80000000, 0x0, 0x0
.long 0x11, 0x814000, 0x200, 0x2114000, 0x570514, 0x57051c, 0x0, 0x0
.long 0x12, 0x81c000, 0x1000, 0x381c000, 0x570de0, 0x80000000, 0x0, 0x0
.long 0x13, 0x80c000, 0xe00, 0x470c000, 0x570adc, 0x80000000, 0x0, 0x0
.long 0x11, 0x81c000, 0x600, 0x231c000, 0x570734, 0x57073c, 0x0, 0x0
.long 0xe28, 0x4004000, 0x700, 0x80700, 0x5745c0, 0x5745c0, 0x570a40, 0x100e00
.long 0x1102b, 0x4e04000, 0x700, 0x80700, 0x80000000, 0x5745c0, 0x572400, 0x402000
.long 0x340425, 0x5a18000, 0x600300, 0x300300, 0x5758d0, 0x5758c0, 0x573800, 0x400818
.long 0x780225, 0x5c1e000, 0x700300, 0x3c0300, 0x575ee0, 0x575ec0, 0x573e00, 0x40041c
.long 0xff, 0x0, 0x0, 0x0, 0x0, 0x0, 0x0, 0x0
.long 0xff, 0x0, 0x0, 0x0, 0x0, 0x0, 0x0, 0x0
.long 0xff, 0x0, 0x0, 0x0, 0x0, 0x0, 0x0, 0x0
.long 0xff, 0x0, 0x0, 0x0, 0x0, 0x0, 0x0, 0x0
.long 0xff, 0x0, 0x0, 0x0, 0x0, 0x0, 0x0, 0x0
.long 0xff, 0x0, 0x0, 0x0, 0x0, 0x0, 0x0, 0x0
.long 0xff, 0x0, 0x0, 0x0, 0x0, 0x0, 0x0, 0x0
.long 0xff, 0x0, 0x0, 0x0, 0x0, 0x0, 0x0, 0x0
.long 0xff, 0x0, 0x0, 0x0, 0x0, 0x0, 0x0, 0x0
.long 0xff, 0x0, 0x0, 0x0, 0x0, 0x0, 0x0, 0x0
.long 0x1, 0x800000, 0x400, 0x2200000, 0x570024, 0x80000000, 0x0, 0x0
.long 0x1, 0x804000, 0x400, 0x2204000, 0x570124, 0x80000000, 0x0, 0x0
.long 0x11, 0x808000, 0x400, 0x2208000, 0x570224, 0x57022c, 0x0, 0x0
.long 0x12, 0x800000, 0x1200, 0x3900000, 0x570c24, 0x80000000, 0x0, 0x0
.long 0x13, 0x810000, 0xe00, 0x4710000, 0x570b1c, 0x80000000, 0x0, 0x0
.long 0x11, 0x81c000, 0x800, 0x241c000, 0x570744, 0x57074c, 0x0, 0x0
.long 0xe28, 0x400c000, 0x0, 0x180000, 0x574c00, 0x574c00, 0x570ac0, 0x100e00
.long 0x1102b, 0x4e0c000, 0x0, 0x180000, 0x80000000, 0x574c00, 0x572c00, 0x402000
.long 0x340425, 0x5a18000, 0x600400, 0x300400, 0x575910, 0x575900, 0x573800, 0x400818
.long 0x780225, 0x5c1e000, 0x700400, 0x3c0400, 0x575f20, 0x575f00, 0x573e00, 0x40041c
.long 0xff, 0x0, 0x0, 0x0, 0x0, 0x0, 0x0, 0x0
.long 0xff, 0x0, 0x0, 0x0, 0x0, 0x0, 0x0, 0x0
.long 0xff, 0x0, 0x0, 0x0, 0x0, 0x0, 0x0, 0x0
.long 0xff, 0x0, 0x0, 0x0, 0x0, 0x0, 0x0, 0x0
.long 0xff, 0x0, 0x0, 0x0, 0x0, 0x0, 0x0, 0x0
.long 0xff, 0x0, 0x0, 0x0, 0x0, 0x0, 0x0, 0x0
.long 0xff, 0x0, 0x0, 0x0, 0x0, 0x0, 0x0, 0x0
.long 0xff, 0x0, 0x0, 0x0, 0x0, 0x0, 0x0, 0x0
.long 0xff, 0x0, 0x0, 0x0, 0x0, 0x0, 0x0, 0x0
.long 0xff, 0x0, 0x0, 0x0, 0x0, 0x0, 0x0, 0x0
.long 0x1, 0x802000, 0x400, 0x2202000, 0x570824, 0x80000000, 0x0, 0x0
.long 0x1, 0x806000, 0x400, 0x2206000, 0x570924, 0x80000000, 0x0, 0x0
.long 0x11, 0x80c000, 0x400, 0x220c000, 0x570324, 0x57032c, 0x0, 0x0
.long 0x12, 0x804000, 0x1200, 0x3904000, 0x570c64, 0x80000000, 0x0, 0x0
.long 0x13, 0x814000, 0xe00, 0x4714000, 0x570b5c, 0x80000000, 0x0, 0x0
.long 0x11, 0x81c000, 0xa00, 0x251c000, 0x570754, 0x57075c, 0x0, 0x0
.long 0xe28, 0x400c000, 0x100, 0x180100, 0x574c40, 0x574c40, 0x570ac0, 0x100e00
.long 0x1102b, 0x4e0c000, 0x100, 0x180100, 0x80000000, 0x574c40, 0x572c00, 0x402000
.long 0x340425, 0x5a18000, 0x600500, 0x300500, 0x575950, 0x575940, 0x573800, 0x400818
.long 0x780225, 0x5c1e000, 0x700500, 0x3c0500, 0x575f60, 0x575f40, 0x573e00, 0x40041c
.long 0xff, 0x0, 0x0, 0x0, 0x0, 0x0, 0x0, 0x0
.long 0xff, 0x0, 0x0, 0x0, 0x0, 0x0, 0x0, 0x0
.long 0xff, 0x0, 0x0, 0x0, 0x0, 0x0, 0x0, 0x0
.long 0xff, 0x0, 0x0, 0x0, 0x0, 0x0, 0x0, 0x0
.long 0xff, 0x0, 0x0, 0x0, 0x0, 0x0, 0x0, 0x0
.long 0xff, 0x0, 0x0, 0x0, 0x0, 0x0, 0x0, 0x0
.long 0xff, 0x0, 0x0, 0x0, 0x0, 0x0, 0x0, 0x0
.long 0xff, 0x0, 0x0, 0x0, 0x0, 0x0, 0x0, 0x0
.long 0xff, 0x0, 0x0, 0x0, 0x0, 0x0, 0x0, 0x0
.long 0xff, 0x0, 0x0, 0x0, 0x0, 0x0, 0x0, 0x0
.long 0x1, 0x800000, 0x500, 0x2280000, 0x57002c, 0x80000000, 0x0, 0x0
.long 0x1, 0x804000, 0x500, 0x2284000, 0x57012c, 0x80000000, 0x0, 0x0
.long 0x11, 0x810000, 0x400, 0x2210000, 0x570424, 0x57042c, 0x0, 0x0
.long 0x12, 0x808000, 0x1200, 0x3908000, 0x570ca4, 0x80000000, 0x0, 0x0
.long 0x13, 0x818000, 0xe00, 0x4718000, 0x570b9c, 0x80000000, 0x0, 0x0
.long 0x11, 0x81c000, 0xc00, 0x261c000, 0x570764, 0x57076c, 0x0, 0x0
.long 0xe28, 0x400c000, 0x200, 0x180200, 0x574c80, 0x574c80, 0x570ac0, 0x100e00
.long 0x1102b, 0x4e0c000, 0x200, 0x180200, 0x80000000, 0x574c80, 0x572c00, 0x402000
.long 0x340425, 0x5a18000, 0x600600, 0x300600, 0x575990, 0x575980, 0x573800, 0x400818
.long 0x780225, 0x5c1e000, 0x700600, 0x3c0600, 0x575fa0, 0x575f80, 0x573e00, 0x40041c
.long 0xff, 0x0, 0x0, 0x0, 0x0, 0x0, 0x0, 0x0
.long 0xff, 0x0, 0x0, 0x0, 0x0, 0x0, 0x0, 0x0
.long 0xff, 0x0, 0x0, 0x0, 0x0, 0x0, 0x0, 0x0
.long 0xff, 0x0, 0x0, 0x0, 0x0, 0x0, 0x0, 0x0
.long 0xff, 0x0, 0x0, 0x0, 0x0, 0x0, 0x0, 0x0
.long 0xff, 0x0, 0x0, 0x0, 0x0, 0x0, 0x0, 0x0
.long 0xff, 0x0, 0x0, 0x0, 0x0, 0x0, 0x0, 0x0
.long 0xff, 0x0, 0x0, 0x0, 0x0, 0x0, 0x0, 0x0
.long 0xff, 0x0, 0x0, 0x0, 0x0, 0x0, 0x0, 0x0
.long 0xff, 0x0, 0x0, 0x0, 0x0, 0x0, 0x0, 0x0
.long 0x1, 0x802000, 0x500, 0x2282000, 0x57082c, 0x80000000, 0x0, 0x0
.long 0x1, 0x806000, 0x500, 0x2286000, 0x57092c, 0x80000000, 0x0, 0x0
.long 0x11, 0x814000, 0x400, 0x2214000, 0x570524, 0x57052c, 0x0, 0x0
.long 0x12, 0x80c000, 0x1200, 0x390c000, 0x570ce4, 0x80000000, 0x0, 0x0
.long 0x13, 0x81c000, 0xe00, 0x471c000, 0x570bdc, 0x80000000, 0x0, 0x0
.long 0x11, 0x81c000, 0xe00, 0x271c000, 0x570774, 0x57077c, 0x0, 0x0
.long 0xe28, 0x400c000, 0x300, 0x180300, 0x574cc0, 0x574cc0, 0x570ac0, 0x100e00
.long 0x1102b, 0x4e0c000, 0x300, 0x180300, 0x80000000, 0x574cc0, 0x572c00, 0x402000
.long 0x340425, 0x5a18000, 0x600700, 0x300700, 0x5759d0, 0x5759c0, 0x573800, 0x400818
.long 0x780225, 0x5c1e000, 0x700700, 0x3c0700, 0x575fe0, 0x575fc0, 0x573e00, 0x40041c
.long 0xff, 0x0, 0x0, 0x0, 0x0, 0x0, 0x0, 0x0
.long 0xff, 0x0, 0x0, 0x0, 0x0, 0x0, 0x0, 0x0
.long 0xff, 0x0, 0x0, 0x0, 0x0, 0x0, 0x0, 0x0
.long 0xff, 0x0, 0x0, 0x0, 0x0, 0x0, 0x0, 0x0
.long 0xff, 0x0, 0x0, 0x0, 0x0, 0x0, 0x0, 0x0
.long 0xff, 0x0, 0x0, 0x0, 0x0, 0x0, 0x0, 0x0
.long 0xff, 0x0, 0x0, 0x0, 0x0, 0x0, 0x0, 0x0
.long 0xff, 0x0, 0x0, 0x0, 0x0, 0x0, 0x0, 0x0
.long 0xff, 0x0, 0x0, 0x0, 0x0, 0x0, 0x0, 0x0
.long 0xff, 0x0, 0x0, 0x0, 0x0, 0x0, 0x0, 0x0
.long 0x1, 0x800000, 0x600, 0x2300000, 0x570034, 0x80000000, 0x0, 0x0
.long 0x1, 0x804000, 0x600, 0x2304000, 0x570134, 0x80000000, 0x0, 0x0
.long 0x11, 0x808000, 0x600, 0x2308000, 0x570234, 0x57023c, 0x0, 0x0
.long 0x12, 0x810000, 0x1200, 0x3910000, 0x570d24, 0x80000000, 0x0, 0x0
.long 0x13, 0x800000, 0x1000, 0x4800000, 0x570a20, 0x80000000, 0x0, 0x0
.long 0x40, 0xa, 0x2, 0x0, 0x4, 0x1, 0x0, 0x1
.long 0x40, 0x1e, 0x2, 0x0, 0x4, 0x1, 0x0, 0x1
.long 0xe28, 0x4014000, 0x0, 0x280000, 0x575400, 0x575400, 0x570b40, 0x100e00
.long 0x1102b, 0x4e14000, 0x0, 0x280000, 0x80000000, 0x575400, 0x573400, 0x402000
.long 0x140425, 0x521c000, 0x200000, 0x380000, 0x575c08, 0x575c00, 0x573c00, 0x400808
.long 0xff, 0x0, 0x0, 0x0, 0x0, 0x0, 0x0, 0x0
.long 0xff, 0x0, 0x0, 0x0, 0x0, 0x0, 0x0, 0x0
.long 0xff, 0x0, 0x0, 0x0, 0x0, 0x0, 0x0, 0x0
.long 0xff, 0x0, 0x0, 0x0, 0x0, 0x0, 0x0, 0x0
.long 0xff, 0x0, 0x0, 0x0, 0x0, 0x0, 0x0, 0x0
.long 0xff, 0x0, 0x0, 0x0, 0x0, 0x0, 0x0, 0x0
.long 0xff, 0x0, 0x0, 0x0, 0x0, 0x0, 0x0, 0x0
.long 0xff, 0x0, 0x0, 0x0, 0x0, 0x0, 0x0, 0x0
.long 0xff, 0x0, 0x0, 0x0, 0x0, 0x0, 0x0, 0x0
.long 0xff, 0x0, 0x0, 0x0, 0x0, 0x0, 0x0, 0x0
.long 0x1, 0x802000, 0x600, 0x2302000, 0x570834, 0x80000000, 0x0, 0x0
.long 0x1, 0x806000, 0x600, 0x2306000, 0x570934, 0x80000000, 0x0, 0x0
.long 0x11, 0x80c000, 0x600, 0x230c000, 0x570334, 0x57033c, 0x0, 0x0
.long 0x12, 0x814000, 0x1200, 0x3914000, 0x570d64, 0x80000000, 0x0, 0x0
.long 0x13, 0x804000, 0x1000, 0x4804000, 0x570a60, 0x80000000, 0x0, 0x0
.long 0x40, 0xa, 0x2, 0x4, 0x4, 0x1, 0x0, 0x1
.long 0x40, 0x1e, 0x2, 0x4, 0x4, 0x1, 0x0, 0x1
.long 0xe28, 0x4014000, 0x100, 0x280100, 0x575440, 0x575440, 0x570b40, 0x100e00
.long 0x1102b, 0x4e14000, 0x100, 0x280100, 0x80000000, 0x575440, 0x573400, 0x402000
.long 0x140425, 0x521c000, 0x200100, 0x380100, 0x575c48, 0x575c40, 0x573c00, 0x400808
.long 0xff, 0x0, 0x0, 0x0, 0x0, 0x0, 0x0, 0x0
.long 0xff, 0x0, 0x0, 0x0, 0x0, 0x0, 0x0, 0x0
.long 0xff, 0x0, 0x0, 0x0, 0x0, 0x0, 0x0, 0x0
.long 0xff, 0x0, 0x0, 0x0, 0x0, 0x0, 0x0, 0x0
.long 0xff, 0x0, 0x0, 0x0, 0x0, 0x0, 0x0, 0x0
.long 0xff, 0x0, 0x0, 0x0, 0x0, 0x0, 0x0, 0x0
.long 0xff, 0x0, 0x0, 0x0, 0x0, 0x0, 0x0, 0x0
.long 0xff, 0x0, 0x0, 0x0, 0x0, 0x0, 0x0, 0x0
.long 0xff, 0x0, 0x0, 0x0, 0x0, 0x0, 0x0, 0x0
.long 0xff, 0x0, 0x0, 0x0, 0x0, 0x0, 0x0, 0x0
.long 0x1, 0x800000, 0x700, 0x2380000, 0x57003c, 0x80000000, 0x0, 0x0
.long 0x1, 0x804000, 0x700, 0x2384000, 0x57013c, 0x80000000, 0x0, 0x0
.long 0x11, 0x810000, 0x600, 0x2310000, 0x570434, 0x57043c, 0x0, 0x0
.long 0x12, 0x818000, 0x1200, 0x3918000, 0x570da4, 0x80000000, 0x0, 0x0
.long 0x13, 0x808000, 0x1000, 0x4808000, 0x570aa0, 0x80000000, 0x0, 0x0
.long 0x40, 0xa, 0x2, 0x8, 0x4, 0x1, 0x0, 0x1
.long 0x40, 0x1e, 0x2, 0x8, 0x4, 0x1, 0x0, 0x1
.long 0xe28, 0x4014000, 0x200, 0x280200, 0x575480, 0x575480, 0x570b40, 0x100e00
.long 0x1102b, 0x4e14000, 0x200, 0x280200, 0x80000000, 0x575480, 0x573400, 0x402000
.long 0x140425, 0x521c000, 0x200200, 0x380200, 0x575c88, 0x575c80, 0x573c00, 0x400808
.long 0xff, 0x0, 0x0, 0x0, 0x0, 0x0, 0x0, 0x0
.long 0xff, 0x0, 0x0, 0x0, 0x0, 0x0, 0x0, 0x0
.long 0xff, 0x0, 0x0, 0x0, 0x0, 0x0, 0x0, 0x0
.long 0xff, 0x0, 0x0, 0x0, 0x0, 0x0, 0x0, 0x0
.long 0xff, 0x0, 0x0, 0x0, 0x0, 0x0, 0x0, 0x0
.long 0xff, 0x0, 0x0, 0x0, 0x0, 0x0, 0x0, 0x0
.long 0xff, 0x0, 0x0, 0x0, 0x0, 0x0, 0x0, 0x0
.long 0xff, 0x0, 0x0, 0x0, 0x0, 0x0, 0x0, 0x0
.long 0xff, 0x0, 0x0, 0x0, 0x0, 0x0, 0x0, 0x0
.long 0xff, 0x0, 0x0, 0x0, 0x0, 0x0, 0x0, 0x0
.long 0x1, 0x802000, 0x700, 0x2382000, 0x57083c, 0x80000000, 0x0, 0x0
.long 0x1, 0x806000, 0x700, 0x2386000, 0x57093c, 0x80000000, 0x0, 0x0
.long 0x11, 0x814000, 0x600, 0x2314000, 0x570534, 0x57053c, 0x0, 0x0
.long 0x12, 0x81c000, 0x1200, 0x391c000, 0x570de4, 0x80000000, 0x0, 0x0
.long 0x13, 0x80c000, 0x1000, 0x480c000, 0x570ae0, 0x80000000, 0x0, 0x0
.long 0x40, 0xa, 0x2, 0xc, 0x4, 0x1, 0x0, 0x1
.long 0x40, 0x1e, 0x2, 0xc, 0x4, 0x1, 0x0, 0x1
.long 0xe28, 0x4014000, 0x300, 0x280300, 0x5754c0, 0x5754c0, 0x570b40, 0x100e00
.long 0x1102b, 0x4e14000, 0x300, 0x280300, 0x80000000, 0x5754c0, 0x573400, 0x402000
.long 0x140425, 0x521c000, 0x200300, 0x380300, 0x575cc8, 0x575cc0, 0x573c00, 0x400808
.long 0xff, 0x0, 0x0, 0x0, 0x0, 0x0, 0x0, 0x0
.long 0xff, 0x0, 0x0, 0x0, 0x0, 0x0, 0x0, 0x0
.long 0xff, 0x0, 0x0, 0x0, 0x0, 0x0, 0x0, 0x0
.long 0xff, 0x0, 0x0, 0x0, 0x0, 0x0, 0x0, 0x0
.long 0xff, 0x0, 0x0, 0x0, 0x0, 0x0, 0x0, 0x0
.long 0xff, 0x0, 0x0, 0x0, 0x0, 0x0, 0x0, 0x0
.long 0xff, 0x0, 0x0, 0x0, 0x0, 0x0, 0x0, 0x0
.long 0xff, 0x0, 0x0, 0x0, 0x0, 0x0, 0x0, 0x0
.long 0xff, 0x0, 0x0, 0x0, 0x0, 0x0, 0x0, 0x0
.long 0xff, 0x0, 0x0, 0x0, 0x0, 0x0, 0x0, 0x0
.long 0x1, 0x800000, 0x800, 0x2400000, 0x570044, 0x80000000, 0x0, 0x0
.long 0x1, 0x804000, 0x800, 0x2404000, 0x570144, 0x80000000, 0x0, 0x0
.long 0x11, 0x808000, 0x800, 0x2408000, 0x570244, 0x57024c, 0x0, 0x0
.long 0x12, 0x800000, 0x1400, 0x3a00000, 0x570c28, 0x80000000, 0x0, 0x0
.long 0x13, 0x810000, 0x1000, 0x4810000, 0x570b20, 0x80000000, 0x0, 0x0
.long 0x40, 0xa, 0x2, 0x10, 0x4, 0x1, 0x0, 0x1
.long 0x40, 0x1e, 0x2, 0x10, 0x4, 0x1, 0x0, 0x1
.long 0xe28, 0x4014000, 0x400, 0x280400, 0x575500, 0x575500, 0x570b40, 0x100e00
.long 0x1102b, 0x4e14000, 0x400, 0x280400, 0x80000000, 0x575500, 0x573400, 0x402000
.long 0x140425, 0x521c000, 0x200400, 0x380400, 0x575d08, 0x575d00, 0x573c00, 0x400808
.long 0xff, 0x0, 0x0, 0x0, 0x0, 0x0, 0x0, 0x0
.long 0xff, 0x0, 0x0, 0x0, 0x0, 0x0, 0x0, 0x0
.long 0xff, 0x0, 0x0, 0x0, 0x0, 0x0, 0x0, 0x0
.long 0xff, 0x0, 0x0, 0x0, 0x0, 0x0, 0x0, 0x0
.long 0xff, 0x0, 0x0, 0x0, 0x0, 0x0, 0x0, 0x0
.long 0xff, 0x0, 0x0, 0x0, 0x0, 0x0, 0x0, 0x0
.long 0xff, 0x0, 0x0, 0x0, 0x0, 0x0, 0x0, 0x0
.long 0xff, 0x0, 0x0, 0x0, 0x0, 0x0, 0x0, 0x0
.long 0xff, 0x0, 0x0, 0x0, 0x0, 0x0, 0x0, 0x0
.long 0xff, 0x0, 0x0, 0x0, 0x0, 0x0, 0x0, 0x0
.long 0x1, 0x802000, 0x800, 0x2402000, 0x570844, 0x80000000, 0x0, 0x0
.long 0x1, 0x806000, 0x800, 0x2406000, 0x570944, 0x80000000, 0x0, 0x0
.long 0x11, 0x80c000, 0x800, 0x240c000, 0x570344, 0x57034c, 0x0, 0x0
.long 0x12, 0x804000, 0x1400, 0x3a04000, 0x570c68, 0x80000000, 0x0, 0x0
.long 0x13, 0x814000, 0x1000, 0x4814000, 0x570b60, 0x80000000, 0x0, 0x0
.long 0x40, 0xa, 0x2, 0x14, 0x4, 0x1, 0x0, 0x1
.long 0x40, 0x1e, 0x2, 0x14, 0x4, 0x1, 0x0, 0x1
.long 0xe28, 0x4014000, 0x500, 0x280500, 0x575540, 0x575540, 0x570b40, 0x100e00
.long 0x1102b, 0x4e14000, 0x500, 0x280500, 0x80000000, 0x575540, 0x573400, 0x402000
.long 0x140425, 0x521c000, 0x200500, 0x380500, 0x575d48, 0x575d40, 0x573c00, 0x400808
.long 0xff, 0x0, 0x0, 0x0, 0x0, 0x0, 0x0, 0x0
.long 0xff, 0x0, 0x0, 0x0, 0x0, 0x0, 0x0, 0x0
.long 0xff, 0x0, 0x0, 0x0, 0x0, 0x0, 0x0, 0x0
.long 0xff, 0x0, 0x0, 0x0, 0x0, 0x0, 0x0, 0x0
.long 0xff, 0x0, 0x0, 0x0, 0x0, 0x0, 0x0, 0x0
.long 0xff, 0x0, 0x0, 0x0, 0x0, 0x0, 0x0, 0x0
.long 0xff, 0x0, 0x0, 0x0, 0x0, 0x0, 0x0, 0x0
.long 0xff, 0x0, 0x0, 0x0, 0x0, 0x0, 0x0, 0x0
.long 0xff, 0x0, 0x0, 0x0, 0x0, 0x0, 0x0, 0x0
.long 0xff, 0x0, 0x0, 0x0, 0x0, 0x0, 0x0, 0x0
.long 0x1, 0x800000, 0x900, 0x2480000, 0x57004c, 0x80000000, 0x0, 0x0
.long 0x1, 0x804000, 0x900, 0x2484000, 0x57014c, 0x80000000, 0x0, 0x0
.long 0x11, 0x810000, 0x800, 0x2410000, 0x570444, 0x57044c, 0x0, 0x0
.long 0x12, 0x808000, 0x1400, 0x3a08000, 0x570ca8, 0x80000000, 0x0, 0x0
.long 0x13, 0x818000, 0x1000, 0x4818000, 0x570ba0, 0x80000000, 0x0, 0x0
.long 0x40, 0xa, 0x2, 0x18, 0x4, 0x1, 0x0, 0x1
.long 0x40, 0x1e, 0x2, 0x18, 0x4, 0x1, 0x0, 0x1
.long 0xe28, 0x4014000, 0x600, 0x280600, 0x575580, 0x575580, 0x570b40, 0x100e00
.long 0x1102b, 0x4e14000, 0x600, 0x280600, 0x80000000, 0x575580, 0x573400, 0x402000
.long 0x140425, 0x521c000, 0x200600, 0x380600, 0x575d88, 0x575d80, 0x573c00, 0x400808
.long 0xff, 0x0, 0x0, 0x0, 0x0, 0x0, 0x0, 0x0
.long 0xff, 0x0, 0x0, 0x0, 0x0, 0x0, 0x0, 0x0
.long 0xff, 0x0, 0x0, 0x0, 0x0, 0x0, 0x0, 0x0
.long 0xff, 0x0, 0x0, 0x0, 0x0, 0x0, 0x0, 0x0
.long 0xff, 0x0, 0x0, 0x0, 0x0, 0x0, 0x0, 0x0
.long 0xff, 0x0, 0x0, 0x0, 0x0, 0x0, 0x0, 0x0
.long 0xff, 0x0, 0x0, 0x0, 0x0, 0x0, 0x0, 0x0
.long 0xff, 0x0, 0x0, 0x0, 0x0, 0x0, 0x0, 0x0
.long 0xff, 0x0, 0x0, 0x0, 0x0, 0x0, 0x0, 0x0
.long 0xff, 0x0, 0x0, 0x0, 0x0, 0x0, 0x0, 0x0
.long 0x1, 0x802000, 0x900, 0x2482000, 0x57084c, 0x80000000, 0x0, 0x0
.long 0x1, 0x806000, 0x900, 0x2486000, 0x57094c, 0x80000000, 0x0, 0x0
.long 0x11, 0x814000, 0x800, 0x2414000, 0x570544, 0x57054c, 0x0, 0x0
.long 0x12, 0x80c000, 0x1400, 0x3a0c000, 0x570ce8, 0x80000000, 0x0, 0x0
.long 0x13, 0x81c000, 0x1000, 0x481c000, 0x570be0, 0x80000000, 0x0, 0x0
.long 0x40, 0xa, 0x2, 0x1c, 0x4, 0x1, 0x0, 0x1
.long 0x40, 0x1e, 0x2, 0x1c, 0x4, 0x1, 0x0, 0x1
.long 0xe28, 0x4014000, 0x700, 0x280700, 0x5755c0, 0x5755c0, 0x570b40, 0x100e00
.long 0x1102b, 0x4e14000, 0x700, 0x280700, 0x80000000, 0x5755c0, 0x573400, 0x402000
.long 0x140425, 0x521c000, 0x200700, 0x380700, 0x575dc8, 0x575dc0, 0x573c00, 0x400808
.long 0xff, 0x0, 0x0, 0x0, 0x0, 0x0, 0x0, 0x0
.long 0xff, 0x0, 0x0, 0x0, 0x0, 0x0, 0x0, 0x0
.long 0xff, 0x0, 0x0, 0x0, 0x0, 0x0, 0x0, 0x0
.long 0xff, 0x0, 0x0, 0x0, 0x0, 0x0, 0x0, 0x0
.long 0xff, 0x0, 0x0, 0x0, 0x0, 0x0, 0x0, 0x0
.long 0xff, 0x0, 0x0, 0x0, 0x0, 0x0, 0x0, 0x0
.long 0xff, 0x0, 0x0, 0x0, 0x0, 0x0, 0x0, 0x0
.long 0xff, 0x0, 0x0, 0x0, 0x0, 0x0, 0x0, 0x0
.long 0xff, 0x0, 0x0, 0x0, 0x0, 0x0, 0x0, 0x0
.long 0xff, 0x0, 0x0, 0x0, 0x0, 0x0, 0x0, 0x0
.long 0x1, 0x800000, 0xa00, 0x2500000, 0x570054, 0x80000000, 0x0, 0x0
.long 0x1, 0x804000, 0xa00, 0x2504000, 0x570154, 0x80000000, 0x0, 0x0
.long 0x11, 0x808000, 0xa00, 0x2508000, 0x570254, 0x57025c, 0x0, 0x0
.long 0x12, 0x810000, 0x1400, 0x3a10000, 0x570d28, 0x80000000, 0x0, 0x0
.long 0x13, 0x800000, 0x1200, 0x4900000, 0x570a24, 0x80000000, 0x0, 0x0
.long 0x40, 0xc, 0x2, 0x0, 0x4, 0x1, 0x0, 0x1
.long 0x40, 0x20, 0x2, 0x0, 0x4, 0x1, 0x0, 0x1
.long 0xe20, 0x401c000, 0x0, 0x380000, 0x575c00, 0x575c00, 0x570bc0, 0x100e00
.long 0x40, 0x28, 0x6, 0x10, 0x4, 0x0, 0x1, 0x4
.long 0x280225, 0x521e000, 0x200000, 0x3c0000, 0x575e0c, 0x575e00, 0x573e00, 0x400408
.long 0xff, 0x0, 0x0, 0x0, 0x0, 0x0, 0x0, 0x0
.long 0xff, 0x0, 0x0, 0x0, 0x0, 0x0, 0x0, 0x0
.long 0xff, 0x0, 0x0, 0x0, 0x0, 0x0, 0x0, 0x0
.long 0xff, 0x0, 0x0, 0x0, 0x0, 0x0, 0x0, 0x0
.long 0xff, 0x0, 0x0, 0x0, 0x0, 0x0, 0x0, 0x0
.long 0xff, 0x0, 0x0, 0x0, 0x0, 0x0, 0x0, 0x0
.long 0xff, 0x0, 0x0, 0x0, 0x0, 0x0, 0x0, 0x0
.long 0xff, 0x0, 0x0, 0x0, 0x0, 0x0, 0x0, 0x0
.long 0xff, 0x0, 0x0, 0x0, 0x0, 0x0, 0x0, 0x0
.long 0xff, 0x0, 0x0, 0x0, 0x0, 0x0, 0x0, 0x0
.long 0x1, 0x802000, 0xa00, 0x2502000, 0x570854, 0x80000000, 0x0, 0x0
.long 0x1, 0x806000, 0xa00, 0x2506000, 0x570954, 0x80000000, 0x0, 0x0
.long 0x11, 0x80c000, 0xa00, 0x250c000, 0x570354, 0x57035c, 0x0, 0x0
.long 0x12, 0x814000, 0x1400, 0x3a14000, 0x570d68, 0x80000000, 0x0, 0x0
.long 0x13, 0x804000, 0x1200, 0x4904000, 0x570a64, 0x80000000, 0x0, 0x0
.long 0x40, 0xc, 0x2, 0x4, 0x4, 0x1, 0x0, 0x1
.long 0x40, 0x20, 0x2, 0x4, 0x4, 0x1, 0x0, 0x1
.long 0xe20, 0x401c000, 0x100, 0x380100, 0x575c40, 0x575c40, 0x570bc0, 0x100e00
.long 0x40, 0x28, 0x6, 0x11, 0x4, 0x0, 0x1, 0x4
.long 0x280225, 0x521e000, 0x200100, 0x3c0100, 0x575e4c, 0x575e40, 0x573e00, 0x400408
.long 0xff, 0x0, 0x0, 0x0, 0x0, 0x0, 0x0, 0x0
.long 0xff, 0x0, 0x0, 0x0, 0x0, 0x0, 0x0, 0x0
.long 0xff, 0x0, 0x0, 0x0, 0x0, 0x0, 0x0, 0x0
.long 0xff, 0x0, 0x0, 0x0, 0x0, 0x0, 0x0, 0x0
.long 0xff, 0x0, 0x0, 0x0, 0x0, 0x0, 0x0, 0x0
.long 0xff, 0x0, 0x0, 0x0, 0x0, 0x0, 0x0, 0x0
.long 0xff, 0x0, 0x0, 0x0, 0x0, 0x0, 0x0, 0x0
.long 0xff, 0x0, 0x0, 0x0, 0x0, 0x0, 0x0, 0x0
.long 0xff, 0x0, 0x0, 0x0, 0x0, 0x0, 0x0, 0x0
.long 0xff, 0x0, 0x0, 0x0, 0x0, 0x0, 0x0, 0x0
.long 0x1, 0x800000, 0xb00, 0x2580000, 0x57005c, 0x80000000, 0x0, 0x0
.long 0x1, 0x804000, 0xb00, 0x2584000, 0x57015c, 0x80000000, 0x0, 0x0
.long 0x11, 0x810000, 0xa00, 0x2510000, 0x570454, 0x57045c, 0x0, 0x0
.long 0x12, 0x818000, 0x1400, 0x3a18000, 0x570da8, 0x80000000, 0x0, 0x0
.long 0x13, 0x808000, 0x1200, 0x4908000, 0x570aa4, 0x80000000, 0x0, 0x0
.long 0x40, 0xc, 0x2, 0x8, 0x4, 0x1, 0x0, 0x1
.long 0x40, 0x20, 0x2, 0x8, 0x4, 0x1, 0x0, 0x1
.long 0xe20, 0x401c000, 0x200, 0x380200, 0x575c80, 0x575c80, 0x570bc0, 0x100e00
.long 0x40, 0x28, 0x6, 0x12, 0x4, 0x0, 0x1, 0x4
.long 0x280225, 0x521e000, 0x200200, 0x3c0200, 0x575e8c, 0x575e80, 0x573e00, 0x400408
.long 0xff, 0x0, 0x0, 0x0, 0x0, 0x0, 0x0, 0x0
.long 0xff, 0x0, 0x0, 0x0, 0x0, 0x0, 0x0, 0x0
.long 0xff, 0x0, 0x0, 0x0, 0x0, 0x0, 0x0, 0x0
.long 0xff, 0x0, 0x0, 0x0, 0x0, 0x0, 0x0, 0x0
.long 0xff, 0x0, 0x0, 0x0, 0x0, 0x0, 0x0, 0x0
.long 0xff, 0x0, 0x0, 0x0, 0x0, 0x0, 0x0, 0x0
.long 0xff, 0x0, 0x0, 0x0, 0x0, 0x0, 0x0, 0x0
.long 0xff, 0x0, 0x0, 0x0, 0x0, 0x0, 0x0, 0x0
.long 0xff, 0x0, 0x0, 0x0, 0x0, 0x0, 0x0, 0x0
.long 0xff, 0x0, 0x0, 0x0, 0x0, 0x0, 0x0, 0x0
.long 0x1, 0x802000, 0xb00, 0x2582000, 0x57085c, 0x80000000, 0x0, 0x0
.long 0x1, 0x806000, 0xb00, 0x2586000, 0x57095c, 0x80000000, 0x0, 0x0
.long 0x11, 0x814000, 0xa00, 0x2514000, 0x570554, 0x57055c, 0x0, 0x0
.long 0x12, 0x81c000, 0x1400, 0x3a1c000, 0x570de8, 0x80000000, 0x0, 0x0
.long 0x13, 0x80c000, 0x1200, 0x490c000, 0x570ae4, 0x80000000, 0x0, 0x0
.long 0x40, 0xc, 0x2, 0xc, 0x4, 0x1, 0x0, 0x1
.long 0x40, 0x20, 0x2, 0xc, 0x4, 0x1, 0x0, 0x1
.long 0xe20, 0x401c000, 0x300, 0x380300, 0x575cc0, 0x575cc0, 0x570bc0, 0x100e00
.long 0x40, 0x28, 0x6, 0x13, 0x4, 0x0, 0x1, 0x4
.long 0x280225, 0x521e000, 0x200300, 0x3c0300, 0x575ecc, 0x575ec0, 0x573e00, 0x400408
.long 0xff, 0x0, 0x0, 0x0, 0x0, 0x0, 0x0, 0x0
.long 0xff, 0x0, 0x0, 0x0, 0x0, 0x0, 0x0, 0x0
.long 0xff, 0x0, 0x0, 0x0, 0x0, 0x0, 0x0, 0x0
.long 0xff, 0x0, 0x0, 0x0, 0x0, 0x0, 0x0, 0x0
.long 0xff, 0x0, 0x0, 0x0, 0x0, 0x0, 0x0, 0x0
.long 0xff, 0x0, 0x0, 0x0, 0x0, 0x0, 0x0, 0x0
.long 0xff, 0x0, 0x0, 0x0, 0x0, 0x0, 0x0, 0x0
.long 0xff, 0x0, 0x0, 0x0, 0x0, 0x0, 0x0, 0x0
.long 0xff, 0x0, 0x0, 0x0, 0x0, 0x0, 0x0, 0x0
.long 0xff, 0x0, 0x0, 0x0, 0x0, 0x0, 0x0, 0x0
.long 0x1, 0x800000, 0xc00, 0x2600000, 0x570064, 0x80000000, 0x0, 0x0
.long 0x1, 0x804000, 0xc00, 0x2604000, 0x570164, 0x80000000, 0x0, 0x0
.long 0x11, 0x808000, 0xc00, 0x2608000, 0x570264, 0x57026c, 0x0, 0x0
.long 0x12, 0x800000, 0x1600, 0x3b00000, 0x570c2c, 0x80000000, 0x0, 0x0
.long 0x13, 0x810000, 0x1200, 0x4910000, 0x570b24, 0x80000000, 0x0, 0x0
.long 0x40, 0xc, 0x2, 0x10, 0x4, 0x1, 0x0, 0x1
.long 0x40, 0x20, 0x2, 0x10, 0x4, 0x1, 0x0, 0x1
.long 0xe20, 0x401c000, 0x400, 0x380400, 0x575d00, 0x575d00, 0x570bc0, 0x100e00
.long 0x40, 0x28, 0x6, 0x14, 0x4, 0x0, 0x1, 0x4
.long 0x280225, 0x521e000, 0x200400, 0x3c0400, 0x575f0c, 0x575f00, 0x573e00, 0x400408
.long 0xff, 0x0, 0x0, 0x0, 0x0, 0x0, 0x0, 0x0
.long 0xff, 0x0, 0x0, 0x0, 0x0, 0x0, 0x0, 0x0
.long 0xff, 0x0, 0x0, 0x0, 0x0, 0x0, 0x0, 0x0
.long 0xff, 0x0, 0x0, 0x0, 0x0, 0x0, 0x0, 0x0
.long 0xff, 0x0, 0x0, 0x0, 0x0, 0x0, 0x0, 0x0
.long 0xff, 0x0, 0x0, 0x0, 0x0, 0x0, 0x0, 0x0
.long 0xff, 0x0, 0x0, 0x0, 0x0, 0x0, 0x0, 0x0
.long 0xff, 0x0, 0x0, 0x0, 0x0, 0x0, 0x0, 0x0
.long 0xff, 0x0, 0x0, 0x0, 0x0, 0x0, 0x0, 0x0
.long 0xff, 0x0, 0x0, 0x0, 0x0, 0x0, 0x0, 0x0
.long 0x1, 0x802000, 0xc00, 0x2602000, 0x570864, 0x80000000, 0x0, 0x0
.long 0x1, 0x806000, 0xc00, 0x2606000, 0x570964, 0x80000000, 0x0, 0x0
.long 0x11, 0x80c000, 0xc00, 0x260c000, 0x570364, 0x57036c, 0x0, 0x0
.long 0x12, 0x804000, 0x1600, 0x3b04000, 0x570c6c, 0x80000000, 0x0, 0x0
.long 0x13, 0x814000, 0x1200, 0x4914000, 0x570b64, 0x80000000, 0x0, 0x0
.long 0x40, 0xc, 0x2, 0x14, 0x4, 0x1, 0x0, 0x1
.long 0x40, 0x20, 0x2, 0x14, 0x4, 0x1, 0x0, 0x1
.long 0xe20, 0x401c000, 0x500, 0x380500, 0x575d40, 0x575d40, 0x570bc0, 0x100e00
.long 0x40, 0x28, 0x6, 0x15, 0x4, 0x0, 0x1, 0x4
.long 0x280225, 0x521e000, 0x200500, 0x3c0500, 0x575f4c, 0x575f40, 0x573e00, 0x400408
.long 0xff, 0x0, 0x0, 0x0, 0x0, 0x0, 0x0, 0x0
.long 0xff, 0x0, 0x0, 0x0, 0x0, 0x0, 0x0, 0x0
.long 0xff, 0x0, 0x0, 0x0, 0x0, 0x0, 0x0, 0x0
.long 0xff, 0x0, 0x0, 0x0, 0x0, 0x0, 0x0, 0x0
.long 0xff, 0x0, 0x0, 0x0, 0x0, 0x0, 0x0, 0x0
.long 0xff, 0x0, 0x0, 0x0, 0x0, 0x0, 0x0, 0x0
.long 0xff, 0x0, 0x0, 0x0, 0x0, 0x0, 0x0, 0x0
.long 0xff, 0x0, 0x0, 0x0, 0x0, 0x0, 0x0, 0x0
.long 0xff, 0x0, 0x0, 0x0, 0x0, 0x0, 0x0, 0x0
.long 0xff, 0x0, 0x0, 0x0, 0x0, 0x0, 0x0, 0x0
.long 0x1, 0x800000, 0xd00, 0x2680000, 0x57006c, 0x80000000, 0x0, 0x0
.long 0x1, 0x804000, 0xd00, 0x2684000, 0x57016c, 0x80000000, 0x0, 0x0
.long 0x11, 0x810000, 0xc00, 0x2610000, 0x570464, 0x57046c, 0x0, 0x0
.long 0x12, 0x808000, 0x1600, 0x3b08000, 0x570cac, 0x80000000, 0x0, 0x0
.long 0x13, 0x818000, 0x1200, 0x4918000, 0x570ba4, 0x80000000, 0x0, 0x0
.long 0x40, 0xc, 0x2, 0x18, 0x4, 0x1, 0x0, 0x1
.long 0x40, 0x20, 0x2, 0x18, 0x4, 0x1, 0x0, 0x1
.long 0xe20, 0x401c000, 0x600, 0x380600, 0x575d80, 0x575d80, 0x570bc0, 0x100e00
.long 0x40, 0x28, 0x6, 0x16, 0x4, 0x0, 0x1, 0x4
.long 0x280225, 0x521e000, 0x200600, 0x3c0600, 0x575f8c, 0x575f80, 0x573e00, 0x400408
.long 0xff, 0x0, 0x0, 0x0, 0x0, 0x0, 0x0, 0x0
.long 0xff, 0x0, 0x0, 0x0, 0x0, 0x0, 0x0, 0x0
.long 0xff, 0x0, 0x0, 0x0, 0x0, 0x0, 0x0, 0x0
.long 0xff, 0x0, 0x0, 0x0, 0x0, 0x0, 0x0, 0x0
.long 0xff, 0x0, 0x0, 0x0, 0x0, 0x0, 0x0, 0x0
.long 0xff, 0x0, 0x0, 0x0, 0x0, 0x0, 0x0, 0x0
.long 0xff, 0x0, 0x0, 0x0, 0x0, 0x0, 0x0, 0x0
.long 0xff, 0x0, 0x0, 0x0, 0x0, 0x0, 0x0, 0x0
.long 0xff, 0x0, 0x0, 0x0, 0x0, 0x0, 0x0, 0x0
.long 0xff, 0x0, 0x0, 0x0, 0x0, 0x0, 0x0, 0x0
.long 0x1, 0x802000, 0xd00, 0x2682000, 0x57086c, 0x80000000, 0x0, 0x0
.long 0x1, 0x806000, 0xd00, 0x2686000, 0x57096c, 0x80000000, 0x0, 0x0
.long 0x11, 0x814000, 0xc00, 0x2614000, 0x570564, 0x57056c, 0x0, 0x0
.long 0x12, 0x80c000, 0x1600, 0x3b0c000, 0x570cec, 0x80000000, 0x0, 0x0
.long 0x13, 0x81c000, 0x1200, 0x491c000, 0x570be4, 0x80000000, 0x0, 0x0
.long 0x40, 0xc, 0x2, 0x1c, 0x4, 0x1, 0x0, 0x1
.long 0x40, 0x20, 0x2, 0x1c, 0x4, 0x1, 0x0, 0x1
.long 0xe20, 0x401c000, 0x700, 0x380700, 0x575dc0, 0x575dc0, 0x570bc0, 0x100e00
.long 0x40, 0x28, 0x6, 0x17, 0x4, 0x0, 0x1, 0x4
.long 0x280225, 0x521e000, 0x200700, 0x3c0700, 0x575fcc, 0x575fc0, 0x573e00, 0x400408
.long 0xff, 0x0, 0x0, 0x0, 0x0, 0x0, 0x0, 0x0
.long 0xff, 0x0, 0x0, 0x0, 0x0, 0x0, 0x0, 0x0
.long 0xff, 0x0, 0x0, 0x0, 0x0, 0x0, 0x0, 0x0
.long 0xff, 0x0, 0x0, 0x0, 0x0, 0x0, 0x0, 0x0
.long 0xff, 0x0, 0x0, 0x0, 0x0, 0x0, 0x0, 0x0
.long 0xff, 0x0, 0x0, 0x0, 0x0, 0x0, 0x0, 0x0
.long 0xff, 0x0, 0x0, 0x0, 0x0, 0x0, 0x0, 0x0
.long 0xff, 0x0, 0x0, 0x0, 0x0, 0x0, 0x0, 0x0
.long 0xff, 0x0, 0x0, 0x0, 0x0, 0x0, 0x0, 0x0
.long 0xff, 0x0, 0x0, 0x0, 0x0, 0x0, 0x0, 0x0
.long 0x1, 0x800000, 0xe00, 0x2700000, 0x570074, 0x80000000, 0x0, 0x0
.long 0x1, 0x804000, 0xe00, 0x2704000, 0x570174, 0x80000000, 0x0, 0x0
.long 0x11, 0x808000, 0xe00, 0x2708000, 0x570274, 0x57027c, 0x0, 0x0
.long 0x12, 0x810000, 0x1600, 0x3b10000, 0x570d2c, 0x80000000, 0x0, 0x0
.long 0x13, 0x800000, 0x1400, 0x4a00000, 0x570a28, 0x80000000, 0x0, 0x0
.long 0x40, 0xe, 0x2, 0x0, 0x4, 0x1, 0x0, 0x1
.long 0x40, 0x22, 0x2, 0x0, 0x4, 0x1, 0x0, 0x1
.long 0xe28, 0x400c000, 0x400, 0x180400, 0x574d00, 0x574d00, 0x570ac0, 0x100e00
.long 0x1102b, 0x4e0c000, 0x400, 0x180400, 0x80000000, 0x574d00, 0x572c00, 0x402000
.long 0x240425, 0x5618000, 0x400000, 0x300000, 0x57580c, 0x575800, 0x573800, 0x400810
.long 0x680225, 0x5a1e000, 0x600000, 0x3c0000, 0x575e1c, 0x575e00, 0x573e00, 0x400418
.long 0xff, 0x0, 0x0, 0x0, 0x0, 0x0, 0x0, 0x0
.long 0xff, 0x0, 0x0, 0x0, 0x0, 0x0, 0x0, 0x0
.long 0xff, 0x0, 0x0, 0x0, 0x0, 0x0, 0x0, 0x0
.long 0xff, 0x0, 0x0, 0x0, 0x0, 0x0, 0x0, 0x0
.long 0xff, 0x0, 0x0, 0x0, 0x0, 0x0, 0x0, 0x0
.long 0xff, 0x0, 0x0, 0x0, 0x0, 0x0, 0x0, 0x0
.long 0xff, 0x0, 0x0, 0x0, 0x0, 0x0, 0x0, 0x0
.long 0xff, 0x0, 0x0, 0x0, 0x0, 0x0, 0x0, 0x0
.long 0xff, 0x0, 0x0, 0x0, 0x0, 0x0, 0x0, 0x0
.long 0x1, 0x802000, 0xe00, 0x2702000, 0x570874, 0x80000000, 0x0, 0x0
.long 0x1, 0x806000, 0xe00, 0x2706000, 0x570974, 0x80000000, 0x0, 0x0
.long 0x11, 0x80c000, 0xe00, 0x270c000, 0x570374, 0x57037c, 0x0, 0x0
.long 0x12, 0x814000, 0x1600, 0x3b14000, 0x570d6c, 0x80000000, 0x0, 0x0
.long 0x13, 0x804000, 0x1400, 0x4a04000, 0x570a68, 0x80000000, 0x0, 0x0
.long 0x40, 0xe, 0x2, 0x4, 0x4, 0x1, 0x0, 0x1
.long 0x40, 0x22, 0x2, 0x4, 0x4, 0x1, 0x0, 0x1
.long 0xe28, 0x400c000, 0x500, 0x180500, 0x574d40, 0x574d40, 0x570ac0, 0x100e00
.long 0x1102b, 0x4e0c000, 0x500, 0x180500, 0x80000000, 0x574d40, 0x572c00, 0x402000
.long 0x240425, 0x5618000, 0x400100, 0x300100, 0x57584c, 0x575840, 0x573800, 0x400810
.long 0x680225, 0x5a1e000, 0x600100, 0x3c0100, 0x575e5c, 0x575e40, 0x573e00, 0x400418
.long 0xff, 0x0, 0x0, 0x0, 0x0, 0x0, 0x0, 0x0
.long 0xff, 0x0, 0x0, 0x0, 0x0, 0x0, 0x0, 0x0
.long 0xff, 0x0, 0x0, 0x0, 0x0, 0x0, 0x0, 0x0
.long 0xff, 0x0, 0x0, 0x0, 0x0, 0x0, 0x0, 0x0
.long 0xff, 0x0, 0x0, 0x0, 0x0, 0x0, 0x0, 0x0
.long 0xff, 0x0, 0x0, 0x0, 0x0, 0x0, 0x0, 0x0
.long 0xff, 0x0, 0x0, 0x0, 0x0, 0x0, 0x0, 0x0
.long 0xff, 0x0, 0x0, 0x0, 0x0, 0x0, 0x0, 0x0
.long 0xff, 0x0, 0x0, 0x0, 0x0, 0x0, 0x0, 0x0
.long 0x1, 0x800000, 0xf00, 0x2780000, 0x57007c, 0x80000000, 0x0, 0x0
.long 0x1, 0x804000, 0xf00, 0x2784000, 0x57017c, 0x80000000, 0x0, 0x0
.long 0x11, 0x810000, 0xe00, 0x2710000, 0x570474, 0x57047c, 0x0, 0x0
.long 0x12, 0x818000, 0x1600, 0x3b18000, 0x570dac, 0x80000000, 0x0, 0x0
.long 0x13, 0x808000, 0x1400, 0x4a08000, 0x570aa8, 0x80000000, 0x0, 0x0
.long 0x40, 0xe, 0x2, 0x8, 0x4, 0x1, 0x0, 0x1
.long 0x40, 0x22, 0x2, 0x8, 0x4, 0x1, 0x0, 0x1
.long 0xe28, 0x400c000, 0x600, 0x180600, 0x574d80, 0x574d80, 0x570ac0, 0x100e00
.long 0x1102b, 0x4e0c000, 0x600, 0x180600, 0x80000000, 0x574d80, 0x572c00, 0x402000
.long 0x240425, 0x5618000, 0x400200, 0x300200, 0x57588c, 0x575880, 0x573800, 0x400810
.long 0x680225, 0x5a1e000, 0x600200, 0x3c0200, 0x575e9c, 0x575e80, 0x573e00, 0x400418
.long 0xff, 0x0, 0x0, 0x0, 0x0, 0x0, 0x0, 0x0
.long 0xff, 0x0, 0x0, 0x0, 0x0, 0x0, 0x0, 0x0
.long 0xff, 0x0, 0x0, 0x0, 0x0, 0x0, 0x0, 0x0
.long 0xff, 0x0, 0x0, 0x0, 0x0, 0x0, 0x0, 0x0
.long 0xff, 0x0, 0x0, 0x0, 0x0, 0x0, 0x0, 0x0
.long 0xff, 0x0, 0x0, 0x0, 0x0, 0x0, 0x0, 0x0
.long 0xff, 0x0, 0x0, 0x0, 0x0, 0x0, 0x0, 0x0
.long 0xff, 0x0, 0x0, 0x0, 0x0, 0x0, 0x0, 0x0
.long 0xff, 0x0, 0x0, 0x0, 0x0, 0x0, 0x0, 0x0
.long 0x1, 0x802000, 0xf00, 0x2782000, 0x57087c, 0x80000000, 0x0, 0x0
.long 0x1, 0x806000, 0xf00, 0x2786000, 0x57097c, 0x80000000, 0x0, 0x0
.long 0x11, 0x814000, 0xe00, 0x2714000, 0x570574, 0x57057c, 0x0, 0x0
.long 0x12, 0x81c000, 0x1600, 0x3b1c000, 0x570dec, 0x80000000, 0x0, 0x0
.long 0x13, 0x80c000, 0x1400, 0x4a0c000, 0x570ae8, 0x80000000, 0x0, 0x0
.long 0x40, 0xe, 0x2, 0xc, 0x4, 0x1, 0x0, 0x1
.long 0x40, 0x22, 0x2, 0xc, 0x4, 0x1, 0x0, 0x1
.long 0xe28, 0x400c000, 0x700, 0x180700, 0x574dc0, 0x574dc0, 0x570ac0, 0x100e00
.long 0x1102b, 0x4e0c000, 0x700, 0x180700, 0x80000000, 0x574dc0, 0x572c00, 0x402000
.long 0x240425, 0x5618000, 0x400300, 0x300300, 0x5758cc, 0x5758c0, 0x573800, 0x400810
.long 0x680225, 0x5a1e000, 0x600300, 0x3c0300, 0x575edc, 0x575ec0, 0x573e00, 0x400418
.long 0xff, 0x0, 0x0, 0x0, 0x0, 0x0, 0x0, 0x0
.long 0xff, 0x0, 0x0, 0x0, 0x0, 0x0, 0x0, 0x0
.long 0xff, 0x0, 0x0, 0x0, 0x0, 0x0, 0x0, 0x0
.long 0xff, 0x0, 0x0, 0x0, 0x0, 0x0, 0x0, 0x0
.long 0xff, 0x0, 0x0, 0x0, 0x0, 0x0, 0x0, 0x0
.long 0xff, 0x0, 0x0, 0x0, 0x0, 0x0, 0x0, 0x0
.long 0xff, 0x0, 0x0, 0x0, 0x0, 0x0, 0x0, 0x0
.long 0xff, 0x0, 0x0, 0x0, 0x0, 0x0, 0x0, 0x0
.long 0xff, 0x0, 0x0, 0x0, 0x0, 0x0, 0x0, 0x0
.long 0x1, 0x800000, 0x1000, 0x2800000, 0x570084, 0x80000000, 0x0, 0x0
.long 0x1, 0x804000, 0x1000, 0x2804000, 0x570184, 0x80000000, 0x0, 0x0
.long 0x11, 0x808000, 0x1000, 0x2808000, 0x570284, 0x57028c, 0x0, 0x0
.long 0x12, 0x800000, 0x1800, 0x3c00000, 0x570c30, 0x80000000, 0x0, 0x0
.long 0x11, 0x818000, 0x1000, 0x2818000, 0x570684, 0x57068c, 0x0, 0x0
.long 0x11, 0x818000, 0x1800, 0x2c18000, 0x5706c4, 0x5706cc, 0x0, 0x0
.long 0xe28, 0x4016000, 0x0, 0x2c0000, 0x575600, 0x575600, 0x570b40, 0x100e00
.long 0x1102b, 0x4e16000, 0x0, 0x2c0000, 0x80000000, 0x575600, 0x573600, 0x402000
.long 0x480225, 0x561e000, 0x400000, 0x3c0000, 0x575e14, 0x575e00, 0x573e00, 0x400410
.long 0xff, 0x0, 0x0, 0x0, 0x0, 0x0, 0x0, 0x0
.long 0xff, 0x0, 0x0, 0x0, 0x0, 0x0, 0x0, 0x0
.long 0xff, 0x0, 0x0, 0x0, 0x0, 0x0, 0x0, 0x0
.long 0xff, 0x0, 0x0, 0x0, 0x0, 0x0, 0x0, 0x0
.long 0xff, 0x0, 0x0, 0x0, 0x0, 0x0, 0x0, 0x0
.long 0xff, 0x0, 0x0, 0x0, 0x0, 0x0, 0x0, 0x0
.long 0xff, 0x0, 0x0, 0x0, 0x0, 0x0, 0x0, 0x0
.long 0xff, 0x0, 0x0, 0x0, 0x0, 0x0, 0x0, 0x0
.long 0xff, 0x0, 0x0, 0x0, 0x0, 0x0, 0x0, 0x0
.long 0xff, 0x0, 0x0, 0x0, 0x0, 0x0, 0x0, 0x0
.long 0xff, 0x0, 0x0, 0x0, 0x0, 0x0, 0x0, 0x0
.long 0x1, 0x802000, 0x1000, 0x2802000, 0x570884, 0x80000000, 0x0, 0x0
.long 0x1, 0x806000, 0x1000, 0x2806000, 0x570984, 0x80000000, 0x0, 0x0
.long 0x11, 0x80c000, 0x1000, 0x280c000, 0x570384, 0x57038c, 0x0, 0x0
.long 0x12, 0x804000, 0x1800, 0x3c04000, 0x570c70, 0x80000000, 0x0, 0x0
.long 0x11, 0x818000, 0x1200, 0x2918000, 0x570694, 0x57069c, 0x0, 0x0
.long 0x11, 0x818000, 0x1a00, 0x2d18000, 0x5706d4, 0x5706dc, 0x0, 0x0
.long 0xe28, 0x4016000, 0x100, 0x2c0100, 0x575640, 0x575640, 0x570b40, 0x100e00
.long 0x1102b, 0x4e16000, 0x100, 0x2c0100, 0x80000000, 0x575640, 0x573600, 0x402000
.long 0x480225, 0x561e000, 0x400100, 0x3c0100, 0x575e54, 0x575e40, 0x573e00, 0x400410
.long 0xff, 0x0, 0x0, 0x0, 0x0, 0x0, 0x0, 0x0
.long 0xff, 0x0, 0x0, 0x0, 0x0, 0x0, 0x0, 0x0
.long 0xff, 0x0, 0x0, 0x0, 0x0, 0x0, 0x0, 0x0
.long 0xff, 0x0, 0x0, 0x0, 0x0, 0x0, 0x0, 0x0
.long 0xff, 0x0, 0x0, 0x0, 0x0, 0x0, 0x0, 0x0
.long 0xff, 0x0, 0x0, 0x0, 0x0, 0x0, 0x0, 0x0
.long 0xff, 0x0, 0x0, 0x0, 0x0, 0x0, 0x0, 0x0
.long 0xff, 0x0, 0x0, 0x0, 0x0, 0x0, 0x0, 0x0
.long 0xff, 0x0, 0x0, 0x0, 0x0, 0x0, 0x0, 0x0
.long 0xff, 0x0, 0x0, 0x0, 0x0, 0x0, 0x0, 0x0
.long 0xff, 0x0, 0x0, 0x0, 0x0, 0x0, 0x0, 0x0
.long 0x1, 0x800000, 0x1100, 0x2880000, 0x57008c, 0x80000000, 0x0, 0x0
.long 0x1, 0x804000, 0x1100, 0x2884000, 0x57018c, 0x80000000, 0x0, 0x0
.long 0x11, 0x810000, 0x1000, 0x2810000, 0x570484, 0x57048c, 0x0, 0x0
.long 0x12, 0x808000, 0x1800, 0x3c08000, 0x570cb0, 0x80000000, 0x0, 0x0
.long 0x11, 0x818000, 0x1400, 0x2a18000, 0x5706a4, 0x5706ac, 0x0, 0x0
.long 0x11, 0x818000, 0x1c00, 0x2e18000, 0x5706e4, 0x5706ec, 0x0, 0x0
.long 0xe28, 0x4016000, 0x200, 0x2c0200, 0x575680, 0x575680, 0x570b40, 0x100e00
.long 0x1102b, 0x4e16000, 0x200, 0x2c0200, 0x80000000, 0x575680, 0x573600, 0x402000
.long 0x480225, 0x561e000, 0x400200, 0x3c0200, 0x575e94, 0x575e80, 0x573e00, 0x400410
.long 0xff, 0x0, 0x0, 0x0, 0x0, 0x0, 0x0, 0x0
.long 0xff, 0x0, 0x0, 0x0, 0x0, 0x0, 0x0, 0x0
.long 0xff, 0x0, 0x0, 0x0, 0x0, 0x0, 0x0, 0x0
.long 0xff, 0x0, 0x0, 0x0, 0x0, 0x0, 0x0, 0x0
.long 0xff, 0x0, 0x0, 0x0, 0x0, 0x0, 0x0, 0x0
.long 0xff, 0x0, 0x0, 0x0, 0x0, 0x0, 0x0, 0x0
.long 0xff, 0x0, 0x0, 0x0, 0x0, 0x0, 0x0, 0x0
.long 0xff, 0x0, 0x0, 0x0, 0x0, 0x0, 0x0, 0x0
.long 0xff, 0x0, 0x0, 0x0, 0x0, 0x0, 0x0, 0x0
.long 0xff, 0x0, 0x0, 0x0, 0x0, 0x0, 0x0, 0x0
.long 0xff, 0x0, 0x0, 0x0, 0x0, 0x0, 0x0, 0x0
.long 0x1, 0x802000, 0x1100, 0x2882000, 0x57088c, 0x80000000, 0x0, 0x0
.long 0x1, 0x806000, 0x1100, 0x2886000, 0x57098c, 0x80000000, 0x0, 0x0
.long 0x11, 0x814000, 0x1000, 0x2814000, 0x570584, 0x57058c, 0x0, 0x0
.long 0x12, 0x80c000, 0x1800, 0x3c0c000, 0x570cf0, 0x80000000, 0x0, 0x0
.long 0x11, 0x818000, 0x1600, 0x2b18000, 0x5706b4, 0x5706bc, 0x0, 0x0
.long 0x11, 0x818000, 0x1e00, 0x2f18000, 0x5706f4, 0x5706fc, 0x0, 0x0
.long 0xe28, 0x4016000, 0x300, 0x2c0300, 0x5756c0, 0x5756c0, 0x570b40, 0x100e00
.long 0x1102b, 0x4e16000, 0x300, 0x2c0300, 0x80000000, 0x5756c0, 0x573600, 0x402000
.long 0x480225, 0x561e000, 0x400300, 0x3c0300, 0x575ed4, 0x575ec0, 0x573e00, 0x400410
.long 0xff, 0x0, 0x0, 0x0, 0x0, 0x0, 0x0, 0x0
.long 0xff, 0x0, 0x0, 0x0, 0x0, 0x0, 0x0, 0x0
.long 0xff, 0x0, 0x0, 0x0, 0x0, 0x0, 0x0, 0x0
.long 0xff, 0x0, 0x0, 0x0, 0x0, 0x0, 0x0, 0x0
.long 0xff, 0x0, 0x0, 0x0, 0x0, 0x0, 0x0, 0x0
.long 0xff, 0x0, 0x0, 0x0, 0x0, 0x0, 0x0, 0x0
.long 0xff, 0x0, 0x0, 0x0, 0x0, 0x0, 0x0, 0x0
.long 0xff, 0x0, 0x0, 0x0, 0x0, 0x0, 0x0, 0x0
.long 0xff, 0x0, 0x0, 0x0, 0x0, 0x0, 0x0, 0x0
.long 0xff, 0x0, 0x0, 0x0, 0x0, 0x0, 0x0, 0x0
.long 0xff, 0x0, 0x0, 0x0, 0x0, 0x0, 0x0, 0x0
.long 0x1, 0x800000, 0x1200, 0x2900000, 0x570094, 0x80000000, 0x0, 0x0
.long 0x1, 0x804000, 0x1200, 0x2904000, 0x570194, 0x80000000, 0x0, 0x0
.long 0x11, 0x808000, 0x1200, 0x2908000, 0x570294, 0x57029c, 0x0, 0x0
.long 0x12, 0x810000, 0x1800, 0x3c10000, 0x570d30, 0x80000000, 0x0, 0x0
.long 0x13, 0x810000, 0x1400, 0x4a10000, 0x570b28, 0x80000000, 0x0, 0x0
.long 0x11, 0x81c000, 0x1000, 0x281c000, 0x570784, 0x57078c, 0x0, 0x0
.long 0xe28, 0x4016000, 0x400, 0x2c0400, 0x575700, 0x575700, 0x570b40, 0x100e00
.long 0x1102b, 0x4e16000, 0x400, 0x2c0400, 0x80000000, 0x575700, 0x573600, 0x402000
.long 0x480225, 0x561e000, 0x400400, 0x3c0400, 0x575f14, 0x575f00, 0x573e00, 0x400410
.long 0xff, 0x0, 0x0, 0x0, 0x0, 0x0, 0x0, 0x0
.long 0xff, 0x0, 0x0, 0x0, 0x0, 0x0, 0x0, 0x0
.long 0xff, 0x0, 0x0, 0x0, 0x0, 0x0, 0x0, 0x0
.long 0xff, 0x0, 0x0, 0x0, 0x0, 0x0, 0x0, 0x0
.long 0xff, 0x0, 0x0, 0x0, 0x0, 0x0, 0x0, 0x0
.long 0xff, 0x0, 0x0, 0x0, 0x0, 0x0, 0x0, 0x0
.long 0xff, 0x0, 0x0, 0x0, 0x0, 0x0, 0x0, 0x0
.long 0xff, 0x0, 0x0, 0x0, 0x0, 0x0, 0x0, 0x0
.long 0xff, 0x0, 0x0, 0x0, 0x0, 0x0, 0x0, 0x0
.long 0xff, 0x0, 0x0, 0x0, 0x0, 0x0, 0x0, 0x0
.long 0xff, 0x0, 0x0, 0x0, 0x0, 0x0, 0x0, 0x0
.long 0x1, 0x802000, 0x1200, 0x2902000, 0x570894, 0x80000000, 0x0, 0x0
.long 0x1, 0x806000, 0x1200, 0x2906000, 0x570994, 0x80000000, 0x0, 0x0
.long 0x11, 0x80c000, 0x1200, 0x290c000, 0x570394, 0x57039c, 0x0, 0x0
.long 0x12, 0x814000, 0x1800, 0x3c14000, 0x570d70, 0x80000000, 0x0, 0x0
.long 0x13, 0x814000, 0x1400, 0x4a14000, 0x570b68, 0x80000000, 0x0, 0x0
.long 0x11, 0x81c000, 0x1200, 0x291c000, 0x570794, 0x57079c, 0x0, 0x0
.long 0xe28, 0x4016000, 0x500, 0x2c0500, 0x575740, 0x575740, 0x570b40, 0x100e00
.long 0x1102b, 0x4e16000, 0x500, 0x2c0500, 0x80000000, 0x575740, 0x573600, 0x402000
.long 0x480225, 0x561e000, 0x400500, 0x3c0500, 0x575f54, 0x575f40, 0x573e00, 0x400410
.long 0xff, 0x0, 0x0, 0x0, 0x0, 0x0, 0x0, 0x0
.long 0xff, 0x0, 0x0, 0x0, 0x0, 0x0, 0x0, 0x0
.long 0xff, 0x0, 0x0, 0x0, 0x0, 0x0, 0x0, 0x0
.long 0xff, 0x0, 0x0, 0x0, 0x0, 0x0, 0x0, 0x0
.long 0xff, 0x0, 0x0, 0x0, 0x0, 0x0, 0x0, 0x0
.long 0xff, 0x0, 0x0, 0x0, 0x0, 0x0, 0x0, 0x0
.long 0xff, 0x0, 0x0, 0x0, 0x0, 0x0, 0x0, 0x0
.long 0xff, 0x0, 0x0, 0x0, 0x0, 0x0, 0x0, 0x0
.long 0xff, 0x0, 0x0, 0x0, 0x0, 0x0, 0x0, 0x0
.long 0xff, 0x0, 0x0, 0x0, 0x0, 0x0, 0x0, 0x0
.long 0xff, 0x0, 0x0, 0x0, 0x0, 0x0, 0x0, 0x0
.long 0x1, 0x800000, 0x1300, 0x2980000, 0x57009c, 0x80000000, 0x0, 0x0
.long 0x1, 0x804000, 0x1300, 0x2984000, 0x57019c, 0x80000000, 0x0, 0x0
.long 0x11, 0x810000, 0x1200, 0x2910000, 0x570494, 0x57049c, 0x0, 0x0
.long 0x12, 0x818000, 0x1800, 0x3c18000, 0x570db0, 0x80000000, 0x0, 0x0
.long 0x13, 0x818000, 0x1400, 0x4a18000, 0x570ba8, 0x80000000, 0x0, 0x0
.long 0x11, 0x81c000, 0x1400, 0x2a1c000, 0x5707a4, 0x5707ac, 0x0, 0x0
.long 0xe28, 0x4016000, 0x600, 0x2c0600, 0x575780, 0x575780, 0x570b40, 0x100e00
.long 0x1102b, 0x4e16000, 0x600, 0x2c0600, 0x80000000, 0x575780, 0x573600, 0x402000
.long 0x480225, 0x561e000, 0x400600, 0x3c0600, 0x575f94, 0x575f80, 0x573e00, 0x400410
.long 0xff, 0x0, 0x0, 0x0, 0x0, 0x0, 0x0, 0x0
.long 0xff, 0x0, 0x0, 0x0, 0x0, 0x0, 0x0, 0x0
.long 0xff, 0x0, 0x0, 0x0, 0x0, 0x0, 0x0, 0x0
.long 0xff, 0x0, 0x0, 0x0, 0x0, 0x0, 0x0, 0x0
.long 0xff, 0x0, 0x0, 0x0, 0x0, 0x0, 0x0, 0x0
.long 0xff, 0x0, 0x0, 0x0, 0x0, 0x0, 0x0, 0x0
.long 0xff, 0x0, 0x0, 0x0, 0x0, 0x0, 0x0, 0x0
.long 0xff, 0x0, 0x0, 0x0, 0x0, 0x0, 0x0, 0x0
.long 0xff, 0x0, 0x0, 0x0, 0x0, 0x0, 0x0, 0x0
.long 0xff, 0x0, 0x0, 0x0, 0x0, 0x0, 0x0, 0x0
.long 0xff, 0x0, 0x0, 0x0, 0x0, 0x0, 0x0, 0x0
.long 0x1, 0x802000, 0x1300, 0x2982000, 0x57089c, 0x80000000, 0x0, 0x0
.long 0x1, 0x806000, 0x1300, 0x2986000, 0x57099c, 0x80000000, 0x0, 0x0
.long 0x11, 0x814000, 0x1200, 0x2914000, 0x570594, 0x57059c, 0x0, 0x0
.long 0x12, 0x81c000, 0x1800, 0x3c1c000, 0x570df0, 0x80000000, 0x0, 0x0
.long 0x13, 0x81c000, 0x1400, 0x4a1c000, 0x570be8, 0x80000000, 0x0, 0x0
.long 0x11, 0x81c000, 0x1600, 0x2b1c000, 0x5707b4, 0x5707bc, 0x0, 0x0
.long 0xe28, 0x4016000, 0x700, 0x2c0700, 0x5757c0, 0x5757c0, 0x570b40, 0x100e00
.long 0x1102b, 0x4e16000, 0x700, 0x2c0700, 0x80000000, 0x5757c0, 0x573600, 0x402000
.long 0x480225, 0x561e000, 0x400700, 0x3c0700, 0x575fd4, 0x575fc0, 0x573e00, 0x400410
.long 0xff, 0x0, 0x0, 0x0, 0x0, 0x0, 0x0, 0x0
.long 0xff, 0x0, 0x0, 0x0, 0x0, 0x0, 0x0, 0x0
.long 0xff, 0x0, 0x0, 0x0, 0x0, 0x0, 0x0, 0x0
.long 0xff, 0x0, 0x0, 0x0, 0x0, 0x0, 0x0, 0x0
.long 0xff, 0x0, 0x0, 0x0, 0x0, 0x0, 0x0, 0x0
.long 0xff, 0x0, 0x0, 0x0, 0x0, 0x0, 0x0, 0x0
.long 0xff, 0x0, 0x0, 0x0, 0x0, 0x0, 0x0, 0x0
.long 0xff, 0x0, 0x0, 0x0, 0x0, 0x0, 0x0, 0x0
.long 0xff, 0x0, 0x0, 0x0, 0x0, 0x0, 0x0, 0x0
.long 0xff, 0x0, 0x0, 0x0, 0x0, 0x0, 0x0, 0x0
.long 0xff, 0x0, 0x0, 0x0, 0x0, 0x0, 0x0, 0x0
.long 0x1, 0x800000, 0x1400, 0x2a00000, 0x5700a4, 0x80000000, 0x0, 0x0
.long 0x1, 0x804000, 0x1400, 0x2a04000, 0x5701a4, 0x80000000, 0x0, 0x0
.long 0x11, 0x808000, 0x1400, 0x2a08000, 0x5702a4, 0x5702ac, 0x0, 0x0
.long 0x12, 0x800000, 0x1a00, 0x3d00000, 0x570c34, 0x80000000, 0x0, 0x0
.long 0x13, 0x800000, 0x1600, 0x4b00000, 0x570a2c, 0x80000000, 0x0, 0x0
.long 0x11, 0x81c000, 0x1800, 0x2c1c000, 0x5707c4, 0x5707cc, 0x0, 0x0
.long 0xe20, 0x401e000, 0x0, 0x3c0000, 0x575e00, 0x575e00, 0x570bc0, 0x100e00
.long 0x40, 0x28, 0x6, 0x18, 0x4, 0x0, 0x1, 0x4
.long 0x380225, 0x541e000, 0x300000, 0x3c0000, 0x575e10, 0x575e00, 0x573e00, 0x40040c
.long 0xff, 0x0, 0x0, 0x0, 0x0, 0x0, 0x0, 0x0
.long 0xff, 0x0, 0x0, 0x0, 0x0, 0x0, 0x0, 0x0
.long 0xff, 0x0, 0x0, 0x0, 0x0, 0x0, 0x0, 0x0
.long 0xff, 0x0, 0x0, 0x0, 0x0, 0x0, 0x0, 0x0
.long 0xff, 0x0, 0x0, 0x0, 0x0, 0x0, 0x0, 0x0
.long 0xff, 0x0, 0x0, 0x0, 0x0, 0x0, 0x0, 0x0
.long 0xff, 0x0, 0x0, 0x0, 0x0, 0x0, 0x0, 0x0
.long 0xff, 0x0, 0x0, 0x0, 0x0, 0x0, 0x0, 0x0
.long 0xff, 0x0, 0x0, 0x0, 0x0, 0x0, 0x0, 0x0
.long 0xff, 0x0, 0x0, 0x0, 0x0, 0x0, 0x0, 0x0
.long 0xff, 0x0, 0x0, 0x0, 0x0, 0x0, 0x0, 0x0
.long 0x1, 0x802000, 0x1400, 0x2a02000, 0x5708a4, 0x80000000, 0x0, 0x0
.long 0x1, 0x806000, 0x1400, 0x2a06000, 0x5709a4, 0x80000000, 0x0, 0x0
.long 0x11, 0x80c000, 0x1400, 0x2a0c000, 0x5703a4, 0x5703ac, 0x0, 0x0
.long 0x12, 0x804000, 0x1a00, 0x3d04000, 0x570c74, 0x80000000, 0x0, 0x0
.long 0x13, 0x804000, 0x1600, 0x4b04000, 0x570a6c, 0x80000000, 0x0, 0x0
.long 0x11, 0x81c000, 0x1a00, 0x2d1c000, 0x5707d4, 0x5707dc, 0x0, 0x0
.long 0xe20, 0x401e000, 0x100, 0x3c0100, 0x575e40, 0x575e40, 0x570bc0, 0x100e00
.long 0x40, 0x28, 0x6, 0x19, 0x4, 0x0, 0x1, 0x4
.long 0x380225, 0x541e000, 0x300100, 0x3c0100, 0x575e50, 0x575e40, 0x573e00, 0x40040c
.long 0xff, 0x0, 0x0, 0x0, 0x0, 0x0, 0x0, 0x0
.long 0xff, 0x0, 0x0, 0x0, 0x0, 0x0, 0x0, 0x0
.long 0xff, 0x0, 0x0, 0x0, 0x0, 0x0, 0x0, 0x0
.long 0xff, 0x0, 0x0, 0x0, 0x0, 0x0, 0x0, 0x0
.long 0xff, 0x0, 0x0, 0x0, 0x0, 0x0, 0x0, 0x0
.long 0xff, 0x0, 0x0, 0x0, 0x0, 0x0, 0x0, 0x0
.long 0xff, 0x0, 0x0, 0x0, 0x0, 0x0, 0x0, 0x0
.long 0xff, 0x0, 0x0, 0x0, 0x0, 0x0, 0x0, 0x0
.long 0xff, 0x0, 0x0, 0x0, 0x0, 0x0, 0x0, 0x0
.long 0xff, 0x0, 0x0, 0x0, 0x0, 0x0, 0x0, 0x0
.long 0xff, 0x0, 0x0, 0x0, 0x0, 0x0, 0x0, 0x0
.long 0x1, 0x800000, 0x1500, 0x2a80000, 0x5700ac, 0x80000000, 0x0, 0x0
.long 0x1, 0x804000, 0x1500, 0x2a84000, 0x5701ac, 0x80000000, 0x0, 0x0
.long 0x11, 0x810000, 0x1400, 0x2a10000, 0x5704a4, 0x5704ac, 0x0, 0x0
.long 0x12, 0x808000, 0x1a00, 0x3d08000, 0x570cb4, 0x80000000, 0x0, 0x0
.long 0x13, 0x808000, 0x1600, 0x4b08000, 0x570aac, 0x80000000, 0x0, 0x0
.long 0x11, 0x81c000, 0x1c00, 0x2e1c000, 0x5707e4, 0x5707ec, 0x0, 0x0
.long 0xe20, 0x401e000, 0x200, 0x3c0200, 0x575e80, 0x575e80, 0x570bc0, 0x100e00
.long 0x40, 0x28, 0x6, 0x1a, 0x4, 0x0, 0x1, 0x4
.long 0x380225, 0x541e000, 0x300200, 0x3c0200, 0x575e90, 0x575e80, 0x573e00, 0x40040c
.long 0xff, 0x0, 0x0, 0x0, 0x0, 0x0, 0x0, 0x0
.long 0xff, 0x0, 0x0, 0x0, 0x0, 0x0, 0x0, 0x0
.long 0xff, 0x0, 0x0, 0x0, 0x0, 0x0, 0x0, 0x0
.long 0xff, 0x0, 0x0, 0x0, 0x0, 0x0, 0x0, 0x0
.long 0xff, 0x0, 0x0, 0x0, 0x0, 0x0, 0x0, 0x0
.long 0xff, 0x0, 0x0, 0x0, 0x0, 0x0, 0x0, 0x0
.long 0xff, 0x0, 0x0, 0x0, 0x0, 0x0, 0x0, 0x0
.long 0xff, 0x0, 0x0, 0x0, 0x0, 0x0, 0x0, 0x0
.long 0xff, 0x0, 0x0, 0x0, 0x0, 0x0, 0x0, 0x0
.long 0xff, 0x0, 0x0, 0x0, 0x0, 0x0, 0x0, 0x0
.long 0xff, 0x0, 0x0, 0x0, 0x0, 0x0, 0x0, 0x0
.long 0x1, 0x802000, 0x1500, 0x2a82000, 0x5708ac, 0x80000000, 0x0, 0x0
.long 0x1, 0x806000, 0x1500, 0x2a86000, 0x5709ac, 0x80000000, 0x0, 0x0
.long 0x11, 0x814000, 0x1400, 0x2a14000, 0x5705a4, 0x5705ac, 0x0, 0x0
.long 0x12, 0x80c000, 0x1a00, 0x3d0c000, 0x570cf4, 0x80000000, 0x0, 0x0
.long 0x13, 0x80c000, 0x1600, 0x4b0c000, 0x570aec, 0x80000000, 0x0, 0x0
.long 0x11, 0x81c000, 0x1e00, 0x2f1c000, 0x5707f4, 0x5707fc, 0x0, 0x0
.long 0xe20, 0x401e000, 0x300, 0x3c0300, 0x575ec0, 0x575ec0, 0x570bc0, 0x100e00
.long 0x40, 0x28, 0x6, 0x1b, 0x4, 0x0, 0x1, 0x4
.long 0x380225, 0x541e000, 0x300300, 0x3c0300, 0x575ed0, 0x575ec0, 0x573e00, 0x40040c
.long 0xff, 0x0, 0x0, 0x0, 0x0, 0x0, 0x0, 0x0
.long 0xff, 0x0, 0x0, 0x0, 0x0, 0x0, 0x0, 0x0
.long 0xff, 0x0, 0x0, 0x0, 0x0, 0x0, 0x0, 0x0
.long 0xff, 0x0, 0x0, 0x0, 0x0, 0x0, 0x0, 0x0
.long 0xff, 0x0, 0x0, 0x0, 0x0, 0x0, 0x0, 0x0
.long 0xff, 0x0, 0x0, 0x0, 0x0, 0x0, 0x0, 0x0
.long 0xff, 0x0, 0x0, 0x0, 0x0, 0x0, 0x0, 0x0
.long 0xff, 0x0, 0x0, 0x0, 0x0, 0x0, 0x0, 0x0
.long 0xff, 0x0, 0x0, 0x0, 0x0, 0x0, 0x0, 0x0
.long 0xff, 0x0, 0x0, 0x0, 0x0, 0x0, 0x0, 0x0
.long 0xff, 0x0, 0x0, 0x0, 0x0, 0x0, 0x0, 0x0
.long 0x1, 0x800000, 0x1600, 0x2b00000, 0x5700b4, 0x80000000, 0x0, 0x0
.long 0x1, 0x804000, 0x1600, 0x2b04000, 0x5701b4, 0x80000000, 0x0, 0x0
.long 0x11, 0x808000, 0x1600, 0x2b08000, 0x5702b4, 0x5702bc, 0x0, 0x0
.long 0x12, 0x810000, 0x1a00, 0x3d10000, 0x570d34, 0x80000000, 0x0, 0x0
.long 0x13, 0x810000, 0x1600, 0x4b10000, 0x570b2c, 0x80000000, 0x0, 0x0
.long 0x40, 0xe, 0x2, 0x10, 0x4, 0x1, 0x0, 0x1
.long 0x40, 0x22, 0x2, 0x10, 0x4, 0x1, 0x0, 0x1
.long 0xe20, 0x401e000, 0x400, 0x3c0400, 0x575f00, 0x575f00, 0x570bc0, 0x100e00
.long 0x40, 0x28, 0x6, 0x1c, 0x4, 0x0, 0x1, 0x4
.long 0x380225, 0x541e000, 0x300400, 0x3c0400, 0x575f10, 0x575f00, 0x573e00, 0x40040c
.long 0xff, 0x0, 0x0, 0x0, 0x0, 0x0, 0x0, 0x0
.long 0xff, 0x0, 0x0, 0x0, 0x0, 0x0, 0x0, 0x0
.long 0xff, 0x0, 0x0, 0x0, 0x0, 0x0, 0x0, 0x0
.long 0xff, 0x0, 0x0, 0x0, 0x0, 0x0, 0x0, 0x0
.long 0xff, 0x0, 0x0, 0x0, 0x0, 0x0, 0x0, 0x0
.long 0xff, 0x0, 0x0, 0x0, 0x0, 0x0, 0x0, 0x0
.long 0xff, 0x0, 0x0, 0x0, 0x0, 0x0, 0x0, 0x0
.long 0xff, 0x0, 0x0, 0x0, 0x0, 0x0, 0x0, 0x0
.long 0xff, 0x0, 0x0, 0x0, 0x0, 0x0, 0x0, 0x0
.long 0xff, 0x0, 0x0, 0x0, 0x0, 0x0, 0x0, 0x0
.long 0x1, 0x802000, 0x1600, 0x2b02000, 0x5708b4, 0x80000000, 0x0, 0x0
.long 0x1, 0x806000, 0x1600, 0x2b06000, 0x5709b4, 0x80000000, 0x0, 0x0
.long 0x11, 0x80c000, 0x1600, 0x2b0c000, 0x5703b4, 0x5703bc, 0x0, 0x0
.long 0x12, 0x814000, 0x1a00, 0x3d14000, 0x570d74, 0x80000000, 0x0, 0x0
.long 0x13, 0x814000, 0x1600, 0x4b14000, 0x570b6c, 0x80000000, 0x0, 0x0
.long 0x40, 0xe, 0x2, 0x14, 0x4, 0x1, 0x0, 0x1
.long 0x40, 0x22, 0x2, 0x14, 0x4, 0x1, 0x0, 0x1
.long 0xe20, 0x401e000, 0x500, 0x3c0500, 0x575f40, 0x575f40, 0x570bc0, 0x100e00
.long 0x40, 0x28, 0x6, 0x1d, 0x4, 0x0, 0x1, 0x4
.long 0x380225, 0x541e000, 0x300500, 0x3c0500, 0x575f50, 0x575f40, 0x573e00, 0x40040c
.long 0xff, 0x0, 0x0, 0x0, 0x0, 0x0, 0x0, 0x0
.long 0xff, 0x0, 0x0, 0x0, 0x0, 0x0, 0x0, 0x0
.long 0xff, 0x0, 0x0, 0x0, 0x0, 0x0, 0x0, 0x0
.long 0xff, 0x0, 0x0, 0x0, 0x0, 0x0, 0x0, 0x0
.long 0xff, 0x0, 0x0, 0x0, 0x0, 0x0, 0x0, 0x0
.long 0xff, 0x0, 0x0, 0x0, 0x0, 0x0, 0x0, 0x0
.long 0xff, 0x0, 0x0, 0x0, 0x0, 0x0, 0x0, 0x0
.long 0xff, 0x0, 0x0, 0x0, 0x0, 0x0, 0x0, 0x0
.long 0xff, 0x0, 0x0, 0x0, 0x0, 0x0, 0x0, 0x0
.long 0xff, 0x0, 0x0, 0x0, 0x0, 0x0, 0x0, 0x0
.long 0x1, 0x800000, 0x1700, 0x2b80000, 0x5700bc, 0x80000000, 0x0, 0x0
.long 0x1, 0x804000, 0x1700, 0x2b84000, 0x5701bc, 0x80000000, 0x0, 0x0
.long 0x11, 0x810000, 0x1600, 0x2b10000, 0x5704b4, 0x5704bc, 0x0, 0x0
.long 0x12, 0x818000, 0x1a00, 0x3d18000, 0x570db4, 0x80000000, 0x0, 0x0
.long 0x13, 0x818000, 0x1600, 0x4b18000, 0x570bac, 0x80000000, 0x0, 0x0
.long 0x40, 0xe, 0x2, 0x18, 0x4, 0x1, 0x0, 0x1
.long 0x40, 0x22, 0x2, 0x18, 0x4, 0x1, 0x0, 0x1
.long 0xe20, 0x401e000, 0x600, 0x3c0600, 0x575f80, 0x575f80, 0x570bc0, 0x100e00
.long 0x40, 0x28, 0x6, 0x1e, 0x4, 0x0, 0x1, 0x4
.long 0x380225, 0x541e000, 0x300600, 0x3c0600, 0x575f90, 0x575f80, 0x573e00, 0x40040c
.long 0xff, 0x0, 0x0, 0x0, 0x0, 0x0, 0x0, 0x0
.long 0xff, 0x0, 0x0, 0x0, 0x0, 0x0, 0x0, 0x0
.long 0xff, 0x0, 0x0, 0x0, 0x0, 0x0, 0x0, 0x0
.long 0xff, 0x0, 0x0, 0x0, 0x0, 0x0, 0x0, 0x0
.long 0xff, 0x0, 0x0, 0x0, 0x0, 0x0, 0x0, 0x0
.long 0xff, 0x0, 0x0, 0x0, 0x0, 0x0, 0x0, 0x0
.long 0xff, 0x0, 0x0, 0x0, 0x0, 0x0, 0x0, 0x0
.long 0xff, 0x0, 0x0, 0x0, 0x0, 0x0, 0x0, 0x0
.long 0xff, 0x0, 0x0, 0x0, 0x0, 0x0, 0x0, 0x0
.long 0xff, 0x0, 0x0, 0x0, 0x0, 0x0, 0x0, 0x0
.long 0x1, 0x802000, 0x1700, 0x2b82000, 0x5708bc, 0x80000000, 0x0, 0x0
.long 0x1, 0x806000, 0x1700, 0x2b86000, 0x5709bc, 0x80000000, 0x0, 0x0
.long 0x11, 0x814000, 0x1600, 0x2b14000, 0x5705b4, 0x5705bc, 0x0, 0x0
.long 0x12, 0x81c000, 0x1a00, 0x3d1c000, 0x570df4, 0x80000000, 0x0, 0x0
.long 0x13, 0x81c000, 0x1600, 0x4b1c000, 0x570bec, 0x80000000, 0x0, 0x0
.long 0x40, 0xe, 0x2, 0x1c, 0x4, 0x1, 0x0, 0x1
.long 0x40, 0x22, 0x2, 0x1c, 0x4, 0x1, 0x0, 0x1
.long 0xe20, 0x401e000, 0x700, 0x3c0700, 0x575fc0, 0x575fc0, 0x570bc0, 0x100e00
.long 0x40, 0x28, 0x6, 0x1f, 0x4, 0x0, 0x1, 0x4
.long 0x380225, 0x541e000, 0x300700, 0x3c0700, 0x575fd0, 0x575fc0, 0x573e00, 0x40040c
.long 0xff, 0x0, 0x0, 0x0, 0x0, 0x0, 0x0, 0x0
.long 0xff, 0x0, 0x0, 0x0, 0x0, 0x0, 0x0, 0x0
.long 0xff, 0x0, 0x0, 0x0, 0x0, 0x0, 0x0, 0x0
.long 0xff, 0x0, 0x0, 0x0, 0x0, 0x0, 0x0, 0x0
.long 0xff, 0x0, 0x0, 0x0, 0x0, 0x0, 0x0, 0x0
.long 0xff, 0x0, 0x0, 0x0, 0x0, 0x0, 0x0, 0x0
.long 0xff, 0x0, 0x0, 0x0, 0x0, 0x0, 0x0, 0x0
.long 0xff, 0x0, 0x0, 0x0, 0x0, 0x0, 0x0, 0x0
.long 0xff, 0x0, 0x0, 0x0, 0x0, 0x0, 0x0, 0x0
.long 0xff, 0x0, 0x0, 0x0, 0x0, 0x0, 0x0, 0x0
.long 0x1, 0x800000, 0x1800, 0x2c00000, 0x5700c4, 0x80000000, 0x0, 0x0
.long 0x1, 0x804000, 0x1800, 0x2c04000, 0x5701c4, 0x80000000, 0x0, 0x0
.long 0x11, 0x808000, 0x1800, 0x2c08000, 0x5702c4, 0x5702cc, 0x0, 0x0
.long 0x12, 0x800000, 0x1c00, 0x3e00000, 0x570c38, 0x80000000, 0x0, 0x0
.long 0x13, 0x800000, 0x1800, 0x4c00000, 0x570a30, 0x80000000, 0x0, 0x0
.long 0x40, 0x10, 0x2, 0x0, 0x4, 0x1, 0x0, 0x1
.long 0x40, 0x24, 0x2, 0x0, 0x4, 0x1, 0x0, 0x1
.long 0xe28, 0x400e000, 0x0, 0x1c0000, 0x574e00, 0x574e00, 0x570ac0, 0x100e00
.long 0x1102b, 0x4e0e000, 0x0, 0x1c0000, 0x80000000, 0x574e00, 0x572e00, 0x402000
.long 0x40425, 0x4e1c000, 0x0, 0x380000, 0x575c04, 0x575c00, 0x573c00, 0x400800
.long 0xff, 0x0, 0x0, 0x0, 0x0, 0x0, 0x0, 0x0
.long 0xff, 0x0, 0x0, 0x0, 0x0, 0x0, 0x0, 0x0
.long 0xff, 0x0, 0x0, 0x0, 0x0, 0x0, 0x0, 0x0
.long 0xff, 0x0, 0x0, 0x0, 0x0, 0x0, 0x0, 0x0
.long 0xff, 0x0, 0x0, 0x0, 0x0, 0x0, 0x0, 0x0
.long 0xff, 0x0, 0x0, 0x0, 0x0, 0x0, 0x0, 0x0
.long 0xff, 0x0, 0x0, 0x0, 0x0, 0x0, 0x0, 0x0
.long 0xff, 0x0, 0x0, 0x0, 0x0, 0x0, 0x0, 0x0
.long 0xff, 0x0, 0x0, 0x0, 0x0, 0x0, 0x0, 0x0
.long 0xff, 0x0, 0x0, 0x0, 0x0, 0x0, 0x0, 0x0
.long 0x1, 0x802000, 0x1800, 0x2c02000, 0x5708c4, 0x80000000, 0x0, 0x0
.long 0x1, 0x806000, 0x1800, 0x2c06000, 0x5709c4, 0x80000000, 0x0, 0x0
.long 0x11, 0x80c000, 0x1800, 0x2c0c000, 0x5703c4, 0x5703cc, 0x0, 0x0
.long 0x12, 0x804000, 0x1c00, 0x3e04000, 0x570c78, 0x80000000, 0x0, 0x0
.long 0x13, 0x804000, 0x1800, 0x4c04000, 0x570a70, 0x80000000, 0x0, 0x0
.long 0x40, 0x10, 0x2, 0x4, 0x4, 0x1, 0x0, 0x1
.long 0x40, 0x24, 0x2, 0x4, 0x4, 0x1, 0x0, 0x1
.long 0xe28, 0x400e000, 0x100, 0x1c0100, 0x574e40, 0x574e40, 0x570ac0, 0x100e00
.long 0x1102b, 0x4e0e000, 0x100, 0x1c0100, 0x80000000, 0x574e40, 0x572e00, 0x402000
.long 0x40425, 0x4e1c000, 0x100, 0x380100, 0x575c44, 0x575c40, 0x573c00, 0x400800
.long 0xff, 0x0, 0x0, 0x0, 0x0, 0x0, 0x0, 0x0
.long 0xff, 0x0, 0x0, 0x0, 0x0, 0x0, 0x0, 0x0
.long 0xff, 0x0, 0x0, 0x0, 0x0, 0x0, 0x0, 0x0
.long 0xff, 0x0, 0x0, 0x0, 0x0, 0x0, 0x0, 0x0
.long 0xff, 0x0, 0x0, 0x0, 0x0, 0x0, 0x0, 0x0
.long 0xff, 0x0, 0x0, 0x0, 0x0, 0x0, 0x0, 0x0
.long 0xff, 0x0, 0x0, 0x0, 0x0, 0x0, 0x0, 0x0
.long 0xff, 0x0, 0x0, 0x0, 0x0, 0x0, 0x0, 0x0
.long 0xff, 0x0, 0x0, 0x0, 0x0, 0x0, 0x0, 0x0
.long 0xff, 0x0, 0x0, 0x0, 0x0, 0x0, 0x0, 0x0
.long 0x1, 0x800000, 0x1900, 0x2c80000, 0x5700cc, 0x80000000, 0x0, 0x0
.long 0x1, 0x804000, 0x1900, 0x2c84000, 0x5701cc, 0x80000000, 0x0, 0x0
.long 0x11, 0x810000, 0x1800, 0x2c10000, 0x5704c4, 0x5704cc, 0x0, 0x0
.long 0x12, 0x808000, 0x1c00, 0x3e08000, 0x570cb8, 0x80000000, 0x0, 0x0
.long 0x13, 0x808000, 0x1800, 0x4c08000, 0x570ab0, 0x80000000, 0x0, 0x0
.long 0x40, 0x10, 0x2, 0x8, 0x4, 0x1, 0x0, 0x1
.long 0x40, 0x24, 0x2, 0x8, 0x4, 0x1, 0x0, 0x1
.long 0xe28, 0x400e000, 0x200, 0x1c0200, 0x574e80, 0x574e80, 0x570ac0, 0x100e00
.long 0x1102b, 0x4e0e000, 0x200, 0x1c0200, 0x80000000, 0x574e80, 0x572e00, 0x402000
.long 0x40425, 0x4e1c000, 0x200, 0x380200, 0x575c84, 0x575c80, 0x573c00, 0x400800
.long 0xff, 0x0, 0x0, 0x0, 0x0, 0x0, 0x0, 0x0
.long 0xff, 0x0, 0x0, 0x0, 0x0, 0x0, 0x0, 0x0
.long 0xff, 0x0, 0x0, 0x0, 0x0, 0x0, 0x0, 0x0
.long 0xff, 0x0, 0x0, 0x0, 0x0, 0x0, 0x0, 0x0
.long 0xff, 0x0, 0x0, 0x0, 0x0, 0x0, 0x0, 0x0
.long 0xff, 0x0, 0x0, 0x0, 0x0, 0x0, 0x0, 0x0
.long 0xff, 0x0, 0x0, 0x0, 0x0, 0x0, 0x0, 0x0
.long 0xff, 0x0, 0x0, 0x0, 0x0, 0x0, 0x0, 0x0
.long 0xff, 0x0, 0x0, 0x0, 0x0, 0x0, 0x0, 0x0
.long 0xff, 0x0, 0x0, 0x0, 0x0, 0x0, 0x0, 0x0
.long 0x1, 0x802000, 0x1900, 0x2c82000, 0x5708cc, 0x80000000, 0x0, 0x0
.long 0x1, 0x806000, 0x1900, 0x2c86000, 0x5709cc, 0x80000000, 0x0, 0x0
.long 0x11, 0x814000, 0x1800, 0x2c14000, 0x5705c4, 0x5705cc, 0x0, 0x0
.long 0x12, 0x80c000, 0x1c00, 0x3e0c000, 0x570cf8, 0x80000000, 0x0, 0x0
.long 0x13, 0x80c000, 0x1800, 0x4c0c000, 0x570af0, 0x80000000, 0x0, 0x0
.long 0x40, 0x10, 0x2, 0xc, 0x4, 0x1, 0x0, 0x1
.long 0x40, 0x24, 0x2, 0xc, 0x4, 0x1, 0x0, 0x1
.long 0xe28, 0x400e000, 0x300, 0x1c0300, 0x574ec0, 0x574ec0, 0x570ac0, 0x100e00
.long 0x1102b, 0x4e0e000, 0x300, 0x1c0300, 0x80000000, 0x574ec0, 0x572e00, 0x402000
.long 0x40425, 0x4e1c000, 0x300, 0x380300, 0x575cc4, 0x575cc0, 0x573c00, 0x400800
.long 0xff, 0x0, 0x0, 0x0, 0x0, 0x0, 0x0, 0x0
.long 0xff, 0x0, 0x0, 0x0, 0x0, 0x0, 0x0, 0x0
.long 0xff, 0x0, 0x0, 0x0, 0x0, 0x0, 0x0, 0x0
.long 0xff, 0x0, 0x0, 0x0, 0x0, 0x0, 0x0, 0x0
.long 0xff, 0x0, 0x0, 0x0, 0x0, 0x0, 0x0, 0x0
.long 0xff, 0x0, 0x0, 0x0, 0x0, 0x0, 0x0, 0x0
.long 0xff, 0x0, 0x0, 0x0, 0x0, 0x0, 0x0, 0x0
.long 0xff, 0x0, 0x0, 0x0, 0x0, 0x0, 0x0, 0x0
.long 0xff, 0x0, 0x0, 0x0, 0x0, 0x0, 0x0, 0x0
.long 0xff, 0x0, 0x0, 0x0, 0x0, 0x0, 0x0, 0x0
.long 0x1, 0x800000, 0x1a00, 0x2d00000, 0x5700d4, 0x80000000, 0x0, 0x0
.long 0x1, 0x804000, 0x1a00, 0x2d04000, 0x5701d4, 0x80000000, 0x0, 0x0
.long 0x11, 0x808000, 0x1a00, 0x2d08000, 0x5702d4, 0x5702dc, 0x0, 0x0
.long 0x12, 0x810000, 0x1c00, 0x3e10000, 0x570d38, 0x80000000, 0x0, 0x0
.long 0x13, 0x810000, 0x1800, 0x4c10000, 0x570b30, 0x80000000, 0x0, 0x0
.long 0x40, 0x10, 0x2, 0x10, 0x4, 0x1, 0x0, 0x1
.long 0x40, 0x24, 0x2, 0x10, 0x4, 0x1, 0x0, 0x1
.long 0xe28, 0x400e000, 0x400, 0x1c0400, 0x574f00, 0x574f00, 0x570ac0, 0x100e00
.long 0x1102b, 0x4e0e000, 0x400, 0x1c0400, 0x80000000, 0x574f00, 0x572e00, 0x402000
.long 0x40425, 0x4e1c000, 0x400, 0x380400, 0x575d04, 0x575d00, 0x573c00, 0x400800
.long 0xff, 0x0, 0x0, 0x0, 0x0, 0x0, 0x0, 0x0
.long 0xff, 0x0, 0x0, 0x0, 0x0, 0x0, 0x0, 0x0
.long 0xff, 0x0, 0x0, 0x0, 0x0, 0x0, 0x0, 0x0
.long 0xff, 0x0, 0x0, 0x0, 0x0, 0x0, 0x0, 0x0
.long 0xff, 0x0, 0x0, 0x0, 0x0, 0x0, 0x0, 0x0
.long 0xff, 0x0, 0x0, 0x0, 0x0, 0x0, 0x0, 0x0
.long 0xff, 0x0, 0x0, 0x0, 0x0, 0x0, 0x0, 0x0
.long 0xff, 0x0, 0x0, 0x0, 0x0, 0x0, 0x0, 0x0
.long 0xff, 0x0, 0x0, 0x0, 0x0, 0x0, 0x0, 0x0
.long 0xff, 0x0, 0x0, 0x0, 0x0, 0x0, 0x0, 0x0
.long 0x1, 0x802000, 0x1a00, 0x2d02000, 0x5708d4, 0x80000000, 0x0, 0x0
.long 0x1, 0x806000, 0x1a00, 0x2d06000, 0x5709d4, 0x80000000, 0x0, 0x0
.long 0x11, 0x80c000, 0x1a00, 0x2d0c000, 0x5703d4, 0x5703dc, 0x0, 0x0
.long 0x12, 0x814000, 0x1c00, 0x3e14000, 0x570d78, 0x80000000, 0x0, 0x0
.long 0x13, 0x814000, 0x1800, 0x4c14000, 0x570b70, 0x80000000, 0x0, 0x0
.long 0x40, 0x10, 0x2, 0x14, 0x4, 0x1, 0x0, 0x1
.long 0x40, 0x24, 0x2, 0x14, 0x4, 0x1, 0x0, 0x1
.long 0xe28, 0x400e000, 0x500, 0x1c0500, 0x574f40, 0x574f40, 0x570ac0, 0x100e00
.long 0x1102b, 0x4e0e000, 0x500, 0x1c0500, 0x80000000, 0x574f40, 0x572e00, 0x402000
.long 0x40425, 0x4e1c000, 0x500, 0x380500, 0x575d44, 0x575d40, 0x573c00, 0x400800
.long 0xff, 0x0, 0x0, 0x0, 0x0, 0x0, 0x0, 0x0
.long 0xff, 0x0, 0x0, 0x0, 0x0, 0x0, 0x0, 0x0
.long 0xff, 0x0, 0x0, 0x0, 0x0, 0x0, 0x0, 0x0
.long 0xff, 0x0, 0x0, 0x0, 0x0, 0x0, 0x0, 0x0
.long 0xff, 0x0, 0x0, 0x0, 0x0, 0x0, 0x0, 0x0
.long 0xff, 0x0, 0x0, 0x0, 0x0, 0x0, 0x0, 0x0
.long 0xff, 0x0, 0x0, 0x0, 0x0, 0x0, 0x0, 0x0
.long 0xff, 0x0, 0x0, 0x0, 0x0, 0x0, 0x0, 0x0
.long 0xff, 0x0, 0x0, 0x0, 0x0, 0x0, 0x0, 0x0
.long 0xff, 0x0, 0x0, 0x0, 0x0, 0x0, 0x0, 0x0
.long 0x1, 0x800000, 0x1b00, 0x2d80000, 0x5700dc, 0x80000000, 0x0, 0x0
.long 0x1, 0x804000, 0x1b00, 0x2d84000, 0x5701dc, 0x80000000, 0x0, 0x0
.long 0x11, 0x810000, 0x1a00, 0x2d10000, 0x5704d4, 0x5704dc, 0x0, 0x0
.long 0x12, 0x818000, 0x1c00, 0x3e18000, 0x570db8, 0x80000000, 0x0, 0x0
.long 0x13, 0x818000, 0x1800, 0x4c18000, 0x570bb0, 0x80000000, 0x0, 0x0
.long 0x40, 0x10, 0x2, 0x18, 0x4, 0x1, 0x0, 0x1
.long 0x40, 0x24, 0x2, 0x18, 0x4, 0x1, 0x0, 0x1
.long 0xe28, 0x400e000, 0x600, 0x1c0600, 0x574f80, 0x574f80, 0x570ac0, 0x100e00
.long 0x1102b, 0x4e0e000, 0x600, 0x1c0600, 0x80000000, 0x574f80, 0x572e00, 0x402000
.long 0x40425, 0x4e1c000, 0x600, 0x380600, 0x575d84, 0x575d80, 0x573c00, 0x400800
.long 0xff, 0x0, 0x0, 0x0, 0x0, 0x0, 0x0, 0x0
.long 0xff, 0x0, 0x0, 0x0, 0x0, 0x0, 0x0, 0x0
.long 0xff, 0x0, 0x0, 0x0, 0x0, 0x0, 0x0, 0x0
.long 0xff, 0x0, 0x0, 0x0, 0x0, 0x0, 0x0, 0x0
.long 0xff, 0x0, 0x0, 0x0, 0x0, 0x0, 0x0, 0x0
.long 0xff, 0x0, 0x0, 0x0, 0x0, 0x0, 0x0, 0x0
.long 0xff, 0x0, 0x0, 0x0, 0x0, 0x0, 0x0, 0x0
.long 0xff, 0x0, 0x0, 0x0, 0x0, 0x0, 0x0, 0x0
.long 0xff, 0x0, 0x0, 0x0, 0x0, 0x0, 0x0, 0x0
.long 0xff, 0x0, 0x0, 0x0, 0x0, 0x0, 0x0, 0x0
.long 0x1, 0x802000, 0x1b00, 0x2d82000, 0x5708dc, 0x80000000, 0x0, 0x0
.long 0x1, 0x806000, 0x1b00, 0x2d86000, 0x5709dc, 0x80000000, 0x0, 0x0
.long 0x11, 0x814000, 0x1a00, 0x2d14000, 0x5705d4, 0x5705dc, 0x0, 0x0
.long 0x12, 0x81c000, 0x1c00, 0x3e1c000, 0x570df8, 0x80000000, 0x0, 0x0
.long 0x13, 0x81c000, 0x1800, 0x4c1c000, 0x570bf0, 0x80000000, 0x0, 0x0
.long 0x40, 0x10, 0x2, 0x1c, 0x4, 0x1, 0x0, 0x1
.long 0x40, 0x24, 0x2, 0x1c, 0x4, 0x1, 0x0, 0x1
.long 0xe28, 0x400e000, 0x700, 0x1c0700, 0x574fc0, 0x574fc0, 0x570ac0, 0x100e00
.long 0x1102b, 0x4e0e000, 0x700, 0x1c0700, 0x80000000, 0x574fc0, 0x572e00, 0x402000
.long 0x40425, 0x4e1c000, 0x700, 0x380700, 0x575dc4, 0x575dc0, 0x573c00, 0x400800
.long 0xff, 0x0, 0x0, 0x0, 0x0, 0x0, 0x0, 0x0
.long 0xff, 0x0, 0x0, 0x0, 0x0, 0x0, 0x0, 0x0
.long 0xff, 0x0, 0x0, 0x0, 0x0, 0x0, 0x0, 0x0
.long 0xff, 0x0, 0x0, 0x0, 0x0, 0x0, 0x0, 0x0
.long 0xff, 0x0, 0x0, 0x0, 0x0, 0x0, 0x0, 0x0
.long 0xff, 0x0, 0x0, 0x0, 0x0, 0x0, 0x0, 0x0
.long 0xff, 0x0, 0x0, 0x0, 0x0, 0x0, 0x0, 0x0
.long 0xff, 0x0, 0x0, 0x0, 0x0, 0x0, 0x0, 0x0
.long 0xff, 0x0, 0x0, 0x0, 0x0, 0x0, 0x0, 0x0
.long 0xff, 0x0, 0x0, 0x0, 0x0, 0x0, 0x0, 0x0
.long 0x1, 0x800000, 0x1c00, 0x2e00000, 0x5700e4, 0x80000000, 0x0, 0x0
.long 0x1, 0x804000, 0x1c00, 0x2e04000, 0x5701e4, 0x80000000, 0x0, 0x0
.long 0x11, 0x808000, 0x1c00, 0x2e08000, 0x5702e4, 0x5702ec, 0x0, 0x0
.long 0x12, 0x800000, 0x1e00, 0x3f00000, 0x570c3c, 0x80000000, 0x0, 0x0
.long 0x13, 0x800000, 0x1a00, 0x4d00000, 0x570a34, 0x80000000, 0x0, 0x0
.long 0x40, 0x12, 0x2, 0x0, 0x4, 0x1, 0x0, 0x1
.long 0x40, 0x26, 0x2, 0x0, 0x4, 0x1, 0x0, 0x1
.long 0xe28, 0x4006000, 0x0, 0xc0000, 0x574600, 0x574600, 0x570a40, 0x100e00
.long 0x1102b, 0x4e06000, 0x0, 0xc0000, 0x80000000, 0x574600, 0x572600, 0x402000
.long 0x580225, 0x581e000, 0x500000, 0x3c0000, 0x575e18, 0x575e00, 0x573e00, 0x400414
.long 0xff, 0x0, 0x0, 0x0, 0x0, 0x0, 0x0, 0x0
.long 0xff, 0x0, 0x0, 0x0, 0x0, 0x0, 0x0, 0x0
.long 0xff, 0x0, 0x0, 0x0, 0x0, 0x0, 0x0, 0x0
.long 0xff, 0x0, 0x0, 0x0, 0x0, 0x0, 0x0, 0x0
.long 0xff, 0x0, 0x0, 0x0, 0x0, 0x0, 0x0, 0x0
.long 0xff, 0x0, 0x0, 0x0, 0x0, 0x0, 0x0, 0x0
.long 0xff, 0x0, 0x0, 0x0, 0x0, 0x0, 0x0, 0x0
.long 0xff, 0x0, 0x0, 0x0, 0x0, 0x0, 0x0, 0x0
.long 0xff, 0x0, 0x0, 0x0, 0x0, 0x0, 0x0, 0x0
.long 0xff, 0x0, 0x0, 0x0, 0x0, 0x0, 0x0, 0x0
.long 0x1, 0x802000, 0x1c00, 0x2e02000, 0x5708e4, 0x80000000, 0x0, 0x0
.long 0x1, 0x806000, 0x1c00, 0x2e06000, 0x5709e4, 0x80000000, 0x0, 0x0
.long 0x11, 0x80c000, 0x1c00, 0x2e0c000, 0x5703e4, 0x5703ec, 0x0, 0x0
.long 0x12, 0x804000, 0x1e00, 0x3f04000, 0x570c7c, 0x80000000, 0x0, 0x0
.long 0x13, 0x804000, 0x1a00, 0x4d04000, 0x570a74, 0x80000000, 0x0, 0x0
.long 0x40, 0x12, 0x2, 0x4, 0x4, 0x1, 0x0, 0x1
.long 0x40, 0x26, 0x2, 0x4, 0x4, 0x1, 0x0, 0x1
.long 0xe28, 0x4006000, 0x100, 0xc0100, 0x574640, 0x574640, 0x570a40, 0x100e00
.long 0x1102b, 0x4e06000, 0x100, 0xc0100, 0x80000000, 0x574640, 0x572600, 0x402000
.long 0x580225, 0x581e000, 0x500100, 0x3c0100, 0x575e58, 0x575e40, 0x573e00, 0x400414
.long 0xff, 0x0, 0x0, 0x0, 0x0, 0x0, 0x0, 0x0
.long 0xff, 0x0, 0x0, 0x0, 0x0, 0x0, 0x0, 0x0
.long 0xff, 0x0, 0x0, 0x0, 0x0, 0x0, 0x0, 0x0
.long 0xff, 0x0, 0x0, 0x0, 0x0, 0x0, 0x0, 0x0
.long 0xff, 0x0, 0x0, 0x0, 0x0, 0x0, 0x0, 0x0
.long 0xff, 0x0, 0x0, 0x0, 0x0, 0x0, 0x0, 0x0
.long 0xff, 0x0, 0x0, 0x0, 0x0, 0x0, 0x0, 0x0
.long 0xff, 0x0, 0x0, 0x0, 0x0, 0x0, 0x0, 0x0
.long 0xff, 0x0, 0x0, 0x0, 0x0, 0x0, 0x0, 0x0
.long 0xff, 0x0, 0x0, 0x0, 0x0, 0x0, 0x0, 0x0
.long 0x1, 0x800000, 0x1d00, 0x2e80000, 0x5700ec, 0x80000000, 0x0, 0x0
.long 0x1, 0x804000, 0x1d00, 0x2e84000, 0x5701ec, 0x80000000, 0x0, 0x0
.long 0x11, 0x810000, 0x1c00, 0x2e10000, 0x5704e4, 0x5704ec, 0x0, 0x0
.long 0x12, 0x808000, 0x1e00, 0x3f08000, 0x570cbc, 0x80000000, 0x0, 0x0
.long 0x13, 0x808000, 0x1a00, 0x4d08000, 0x570ab4, 0x80000000, 0x0, 0x0
.long 0x40, 0x12, 0x2, 0x8, 0x4, 0x1, 0x0, 0x1
.long 0x40, 0x26, 0x2, 0x8, 0x4, 0x1, 0x0, 0x1
.long 0xe28, 0x4006000, 0x200, 0xc0200, 0x574680, 0x574680, 0x570a40, 0x100e00
.long 0x1102b, 0x4e06000, 0x200, 0xc0200, 0x80000000, 0x574680, 0x572600, 0x402000
.long 0x580225, 0x581e000, 0x500200, 0x3c0200, 0x575e98, 0x575e80, 0x573e00, 0x400414
.long 0xff, 0x0, 0x0, 0x0, 0x0, 0x0, 0x0, 0x0
.long 0xff, 0x0, 0x0, 0x0, 0x0, 0x0, 0x0, 0x0
.long 0xff, 0x0, 0x0, 0x0, 0x0, 0x0, 0x0, 0x0
.long 0xff, 0x0, 0x0, 0x0, 0x0, 0x0, 0x0, 0x0
.long 0xff, 0x0, 0x0, 0x0, 0x0, 0x0, 0x0, 0x0
.long 0xff, 0x0, 0x0, 0x0, 0x0, 0x0, 0x0, 0x0
.long 0xff, 0x0, 0x0, 0x0, 0x0, 0x0, 0x0, 0x0
.long 0xff, 0x0, 0x0, 0x0, 0x0, 0x0, 0x0, 0x0
.long 0xff, 0x0, 0x0, 0x0, 0x0, 0x0, 0x0, 0x0
.long 0xff, 0x0, 0x0, 0x0, 0x0, 0x0, 0x0, 0x0
.long 0x1, 0x802000, 0x1d00, 0x2e82000, 0x5708ec, 0x80000000, 0x0, 0x0
.long 0x1, 0x806000, 0x1d00, 0x2e86000, 0x5709ec, 0x80000000, 0x0, 0x0
.long 0x11, 0x814000, 0x1c00, 0x2e14000, 0x5705e4, 0x5705ec, 0x0, 0x0
.long 0x12, 0x80c000, 0x1e00, 0x3f0c000, 0x570cfc, 0x80000000, 0x0, 0x0
.long 0x13, 0x80c000, 0x1a00, 0x4d0c000, 0x570af4, 0x80000000, 0x0, 0x0
.long 0x40, 0x12, 0x2, 0xc, 0x4, 0x1, 0x0, 0x1
.long 0x40, 0x26, 0x2, 0xc, 0x4, 0x1, 0x0, 0x1
.long 0xe28, 0x4006000, 0x300, 0xc0300, 0x5746c0, 0x5746c0, 0x570a40, 0x100e00
.long 0x1102b, 0x4e06000, 0x300, 0xc0300, 0x80000000, 0x5746c0, 0x572600, 0x402000
.long 0x580225, 0x581e000, 0x500300, 0x3c0300, 0x575ed8, 0x575ec0, 0x573e00, 0x400414
.long 0xff, 0x0, 0x0, 0x0, 0x0, 0x0, 0x0, 0x0
.long 0xff, 0x0, 0x0, 0x0, 0x0, 0x0, 0x0, 0x0
.long 0xff, 0x0, 0x0, 0x0, 0x0, 0x0, 0x0, 0x0
.long 0xff, 0x0, 0x0, 0x0, 0x0, 0x0, 0x0, 0x0
.long 0xff, 0x0, 0x0, 0x0, 0x0, 0x0, 0x0, 0x0
.long 0xff, 0x0, 0x0, 0x0, 0x0, 0x0, 0x0, 0x0
.long 0xff, 0x0, 0x0, 0x0, 0x0, 0x0, 0x0, 0x0
.long 0xff, 0x0, 0x0, 0x0, 0x0, 0x0, 0x0, 0x0
.long 0xff, 0x0, 0x0, 0x0, 0x0, 0x0, 0x0, 0x0
.long 0xff, 0x0, 0x0, 0x0, 0x0, 0x0, 0x0, 0x0
.long 0x1, 0x800000, 0x1e00, 0x2f00000, 0x5700f4, 0x80000000, 0x0, 0x0
.long 0x1, 0x804000, 0x1e00, 0x2f04000, 0x5701f4, 0x80000000, 0x0, 0x0
.long 0x11, 0x808000, 0x1e00, 0x2f08000, 0x5702f4, 0x5702fc, 0x0, 0x0
.long 0x12, 0x810000, 0x1e00, 0x3f10000, 0x570d3c, 0x80000000, 0x0, 0x0
.long 0x13, 0x810000, 0x1a00, 0x4d10000, 0x570b34, 0x80000000, 0x0, 0x0
.long 0x40, 0x12, 0x2, 0x10, 0x4, 0x1, 0x0, 0x1
.long 0x40, 0x26, 0x2, 0x10, 0x4, 0x1, 0x0, 0x1
.long 0xe28, 0x4006000, 0x400, 0xc0400, 0x574700, 0x574700, 0x570a40, 0x100e00
.long 0x1102b, 0x4e06000, 0x400, 0xc0400, 0x80000000, 0x574700, 0x572600, 0x402000
.long 0x580225, 0x581e000, 0x500400, 0x3c0400, 0x575f18, 0x575f00, 0x573e00, 0x400414
.long 0xff, 0x0, 0x0, 0x0, 0x0, 0x0, 0x0, 0x0
.long 0xff, 0x0, 0x0, 0x0, 0x0, 0x0, 0x0, 0x0
.long 0xff, 0x0, 0x0, 0x0, 0x0, 0x0, 0x0, 0x0
.long 0xff, 0x0, 0x0, 0x0, 0x0, 0x0, 0x0, 0x0
.long 0xff, 0x0, 0x0, 0x0, 0x0, 0x0, 0x0, 0x0
.long 0xff, 0x0, 0x0, 0x0, 0x0, 0x0, 0x0, 0x0
.long 0xff, 0x0, 0x0, 0x0, 0x0, 0x0, 0x0, 0x0
.long 0xff, 0x0, 0x0, 0x0, 0x0, 0x0, 0x0, 0x0
.long 0xff, 0x0, 0x0, 0x0, 0x0, 0x0, 0x0, 0x0
.long 0xff, 0x0, 0x0, 0x0, 0x0, 0x0, 0x0, 0x0
.long 0x1, 0x802000, 0x1e00, 0x2f02000, 0x5708f4, 0x80000000, 0x0, 0x0
.long 0x1, 0x806000, 0x1e00, 0x2f06000, 0x5709f4, 0x80000000, 0x0, 0x0
.long 0x11, 0x80c000, 0x1e00, 0x2f0c000, 0x5703f4, 0x5703fc, 0x0, 0x0
.long 0x12, 0x814000, 0x1e00, 0x3f14000, 0x570d7c, 0x80000000, 0x0, 0x0
.long 0x13, 0x814000, 0x1a00, 0x4d14000, 0x570b74, 0x80000000, 0x0, 0x0
.long 0x40, 0x12, 0x2, 0x14, 0x4, 0x1, 0x0, 0x1
.long 0x40, 0x26, 0x2, 0x14, 0x4, 0x1, 0x0, 0x1
.long 0xe28, 0x4006000, 0x500, 0xc0500, 0x574740, 0x574740, 0x570a40, 0x100e00
.long 0x1102b, 0x4e06000, 0x500, 0xc0500, 0x80000000, 0x574740, 0x572600, 0x402000
.long 0x580225, 0x581e000, 0x500500, 0x3c0500, 0x575f58, 0x575f40, 0x573e00, 0x400414
.long 0xff, 0x0, 0x0, 0x0, 0x0, 0x0, 0x0, 0x0
.long 0xff, 0x0, 0x0, 0x0, 0x0, 0x0, 0x0, 0x0
.long 0xff, 0x0, 0x0, 0x0, 0x0, 0x0, 0x0, 0x0
.long 0xff, 0x0, 0x0, 0x0, 0x0, 0x0, 0x0, 0x0
.long 0xff, 0x0, 0x0, 0x0, 0x0, 0x0, 0x0, 0x0
.long 0xff, 0x0, 0x0, 0x0, 0x0, 0x0, 0x0, 0x0
.long 0xff, 0x0, 0x0, 0x0, 0x0, 0x0, 0x0, 0x0
.long 0xff, 0x0, 0x0, 0x0, 0x0, 0x0, 0x0, 0x0
.long 0xff, 0x0, 0x0, 0x0, 0x0, 0x0, 0x0, 0x0
.long 0xff, 0x0, 0x0, 0x0, 0x0, 0x0, 0x0, 0x0
.long 0x1, 0x800000, 0x1f00, 0x2f80000, 0x5700fc, 0x80000000, 0x0, 0x0
.long 0x1, 0x804000, 0x1f00, 0x2f84000, 0x5701fc, 0x80000000, 0x0, 0x0
.long 0x11, 0x810000, 0x1e00, 0x2f10000, 0x5704f4, 0x5704fc, 0x0, 0x0
.long 0x12, 0x818000, 0x1e00, 0x3f18000, 0x570dbc, 0x80000000, 0x0, 0x0
.long 0x13, 0x818000, 0x1a00, 0x4d18000, 0x570bb4, 0x80000000, 0x0, 0x0
.long 0x40, 0x12, 0x2, 0x18, 0x4, 0x1, 0x0, 0x1
.long 0x40, 0x26, 0x2, 0x18, 0x4, 0x1, 0x0, 0x1
.long 0xe28, 0x4006000, 0x600, 0xc0600, 0x574780, 0x574780, 0x570a40, 0x100e00
.long 0x1102b, 0x4e06000, 0x600, 0xc0600, 0x80000000, 0x574780, 0x572600, 0x402000
.long 0x580225, 0x581e000, 0x500600, 0x3c0600, 0x575f98, 0x575f80, 0x573e00, 0x400414
.long 0xff, 0x0, 0x0, 0x0, 0x0, 0x0, 0x0, 0x0
.long 0xff, 0x0, 0x0, 0x0, 0x0, 0x0, 0x0, 0x0
.long 0xff, 0x0, 0x0, 0x0, 0x0, 0x0, 0x0, 0x0
.long 0xff, 0x0, 0x0, 0x0, 0x0, 0x0, 0x0, 0x0
.long 0xff, 0x0, 0x0, 0x0, 0x0, 0x0, 0x0, 0x0
.long 0xff, 0x0, 0x0, 0x0, 0x0, 0x0, 0x0, 0x0
.long 0xff, 0x0, 0x0, 0x0, 0x0, 0x0, 0x0, 0x0
.long 0xff, 0x0, 0x0, 0x0, 0x0, 0x0, 0x0, 0x0
.long 0xff, 0x0, 0x0, 0x0, 0x0, 0x0, 0x0, 0x0
.long 0xff, 0x0, 0x0, 0x0, 0x0, 0x0, 0x0, 0x0
.long 0x1, 0x802000, 0x1f00, 0x2f82000, 0x5708fc, 0x80000000, 0x0, 0x0
.long 0x1, 0x806000, 0x1f00, 0x2f86000, 0x5709fc, 0x80000000, 0x0, 0x0
.long 0x11, 0x814000, 0x1e00, 0x2f14000, 0x5705f4, 0x5705fc, 0x0, 0x0
.long 0x12, 0x81c000, 0x1e00, 0x3f1c000, 0x570dfc, 0x80000000, 0x0, 0x0
.long 0x13, 0x81c000, 0x1a00, 0x4d1c000, 0x570bf4, 0x80000000, 0x0, 0x0
.long 0x40, 0x12, 0x2, 0x1c, 0x4, 0x1, 0x0, 0x1
.long 0x40, 0x26, 0x2, 0x1c, 0x4, 0x1, 0x0, 0x1
.long 0xe28, 0x4006000, 0x700, 0xc0700, 0x5747c0, 0x5747c0, 0x570a40, 0x100e00
.long 0x1102b, 0x4e06000, 0x700, 0xc0700, 0x80000000, 0x5747c0, 0x572600, 0x402000
.long 0x580225, 0x581e000, 0x500700, 0x3c0700, 0x575fd8, 0x575fc0, 0x573e00, 0x400414
.long 0xff, 0x0, 0x0, 0x0, 0x0, 0x0, 0x0, 0x0
.long 0xff, 0x0, 0x0, 0x0, 0x0, 0x0, 0x0, 0x0
.long 0xff, 0x0, 0x0, 0x0, 0x0, 0x0, 0x0, 0x0
.long 0xff, 0x0, 0x0, 0x0, 0x0, 0x0, 0x0, 0x0
.long 0xff, 0x0, 0x0, 0x0, 0x0, 0x0, 0x0, 0x0
.long 0xff, 0x0, 0x0, 0x0, 0x0, 0x0, 0x0, 0x0
.long 0xff, 0x0, 0x0, 0x0, 0x0, 0x0, 0x0, 0x0
.long 0xff, 0x0, 0x0, 0x0, 0x0, 0x0, 0x0, 0x0
.long 0xff, 0x0, 0x0, 0x0, 0x0, 0x0, 0x0, 0x0
.long 0xff, 0x0, 0x0, 0x0, 0x0, 0x0, 0x0, 0x0
.long 0xff, 0, 0, 0, 0, 0, 0, 0, 0, 0, 0, 0, 0, 0, 0, 0
.section .rodata,"a"
.p2align 6
.amdhsa_kernel parallel_sum__memory_aug_recurrent_mem_tr__dense_activation_relu__prompt_kernel
  .amdhsa_next_free_vgpr 512
  .amdhsa_next_free_sgpr 102
  .amdhsa_accum_offset 256
  .amdhsa_group_segment_fixed_size 0
  .amdhsa_kernarg_size 104
  .amdhsa_user_sgpr_count 2
  .amdhsa_user_sgpr_kernarg_segment_ptr 1
  .amdhsa_system_sgpr_workgroup_id_x 1
.end_amdhsa_kernel
```
